```python
import torch

def _softmax(x, axis=-1):
    return torch.softmax(x, dim=axis)

def _gelu(x):
    return torch.nn.functional.gelu(x, approximate='tanh')

def _silu(x):
    return torch.nn.functional.silu(x)

def _sigmoid(x):
    return torch.sigmoid(x)

def _layernorm(x, axis=-1, eps=1e-05):
    m = x.mean(dim=axis, keepdim=True)
    v = x.var(dim=axis, keepdim=True, unbiased=False)
    return (x - m) / torch.sqrt(v + eps)

def _scatter_add(tgt, idx, src, axis=0):
    return tgt.clone().index_add_(axis, idx, src)

def _segment_sum(src, seg, n):
    out = torch.zeros((n,) + src.shape[1:], dtype=src.dtype)
    return out.index_add_(0, seg, src)

def _pad(x, pw):
    flat = tuple((v for pair in reversed(pw) for v in pair))
    return torch.nn.functional.pad(x, flat)
kernel_name = 'standalone__swin_window_attn__vision'

def setup_inputs():

    _w = lambda a: (lambda t: t.to(torch.bfloat16) if t.is_floating_point() else t)(torch.as_tensor(a))
    H = W = 512 // 7 * 7
    C, win = (192, 7)
    return {'x': _w((lambda *s: torch.randn(*s, dtype=torch.bfloat16) * 0.2)(1, H, W, C)), 'wqkv': _w((lambda *s: torch.randn(*s, dtype=torch.bfloat16) * 0.2)(C, 3 * C)), 'wo': _w((lambda *s: torch.randn(*s, dtype=torch.bfloat16) * 0.05)(C, C))}

def reference(x, wqkv, wo):
    B, H, W, C = x.shape
    win = 7
    nh, nw = (H // win, W // win)
    xw = (lambda x, *d: x.permute(*d))(x.reshape(B, nh, win, nw, win, C), 0, 1, 3, 2, 4, 5)
    xw = xw.reshape(B * nh * nw, win * win, C)
    qkv = xw @ wqkv
    q, k, v = (qkv[..., :C].clone(), qkv[..., C:2 * C].clone(), qkv[..., 2 * C:].clone())
    scale = C ** (-0.5)
    p = _softmax(torch.einsum('bqc,bkc->bqk', q, k) * scale, axis=-1)
    o = torch.einsum('bqk,bkc->bqc', p, v) @ wo
    o = (lambda x, *d: x.permute(*d))(o.reshape(B, nh, nw, win, win, C), 0, 1, 3, 2, 4, 5)
    return o.reshape(B, H, W, C)
```

```asm
; @launch kernel=swin_prep_kernel grid=(256,1,1) block=(256,1,1) lds=0
; @launch kernel=standalone__swin_window_attn__vision_kernel grid=(256,1,1) block=(256,1,1) lds=163840
.amdgcn_target "amdgcn-amd-amdhsa--gfx950"
.text
.globl standalone__swin_window_attn__vision_kernel
.p2align 8
.p2align 12
.type standalone__swin_window_attn__vision_kernel,@function
standalone__swin_window_attn__vision_kernel:
s_cmp_ge_u32 s2, 256
s_cbranch_scc1 L_end
LW_first0:
LW_p0:
s_cbranch_execz LW_p18
s_getpc_b64 s[88:89]
s_and_b32 s88, s88, 0xffffff00
s_load_dwordx2 s[4:5], s[0:1], 0
s_load_dwordx2 s[24:25], s[0:1], 40
s_load_dwordx2 s[6:7], s[0:1], 24
s_bitcmp1_b32 s2, 3
s_cbranch_scc1 L_pB
v_lshrrev_b32 v220, 6, v0
v_and_b32 v0, 63, v0
v_readfirstlane_b32 s38, v220
v_and_b32 v221, 15, v0
v_lshrrev_b32 v222, 4, v0
v_lshlrev_b32 v1, 4, v0
s_lshl_b32 s39, s2, 2
s_add_u32 s39, s39, s38
s_mul_i32 s42, s38, 18432
s_lshr_b32 s90, s2, 3
s_lshl_b32 s90, s90, 2
s_add_u32 s90, s90, s38
s_mul_i32 s36, s90, 1152
v_lshlrev_b32 v235, 7, v0
v_add_u32 v235, s36, v235
v_cmp_gt_u32 vcc, 9, v0
s_nop 1
v_cndmask_b32 v235, -1, v235, vcc
s_lshr_b32 s87, s2, 4
s_lshl_b32 s87, s87, 3
s_and_b32 s34, s2, 7
s_add_u32 s87, s87, s34
s_add_u32 s87, s87, 5120
v_lshrrev_b32 v224, 5, v0
v_bfe_u32 v225, v0, 3, 2
v_and_b32 v226, 7, v0
v_lshlrev_b32 v226, 4, v226
s_mov_b32 s41, 196224
s_movk_i32 s40, 384
v_mad_u32_u24 v230, v225, s40, v226
v_mad_u32_u24 v231, v225, s41, v226
v_lshrrev_b32 v232, 1, v225
v_mad_u32_u24 v232, v232, s41, v226
v_and_b32 v233, 1, v225
v_mad_u32_u24 v232, v233, s40, v232
v_lshlrev_b32 v227, 3, v224
s_mov_b32 s34, 588253184
v_lshrrev_b32 v228, v227, s34
v_bfe_u32 v229, v228, 3, 3
v_and_b32 v228, 7, v228
v_mul_u32_u24 v229, 196224, v229
v_mad_u32_u24 v8, v228, s40, v229
v_add_u32 v8, v8, v230
s_mov_b32 s34, 403047684
v_lshrrev_b32 v228, v227, s34
v_bfe_u32 v229, v228, 3, 3
v_and_b32 v228, 7, v228
v_mul_u32_u24 v229, 196224, v229
v_mad_u32_u24 v10, v228, s40, v229
v_add_u32 v10, v10, v231
s_mov_b32 s34, 689515819
v_lshrrev_b32 v228, v227, s34
v_bfe_u32 v229, v228, 3, 3
v_and_b32 v228, 7, v228
v_mul_u32_u24 v229, 196224, v229
v_mad_u32_u24 v12, v228, s40, v229
v_add_u32 v12, v12, v232
v_lshlrev_b32 v227, 3, v224
v_add_u32 v227, 16, v227
s_mov_b32 s34, 588253184
v_lshrrev_b32 v228, v227, s34
v_bfe_u32 v229, v228, 3, 3
v_and_b32 v228, 7, v228
v_mul_u32_u24 v229, 196224, v229
v_mad_u32_u24 v9, v228, s40, v229
v_add_u32 v9, v9, v230
s_mov_b32 s34, 403047684
v_lshrrev_b32 v228, v227, s34
v_bfe_u32 v229, v228, 3, 3
v_and_b32 v228, 7, v228
v_mul_u32_u24 v229, 196224, v229
v_mad_u32_u24 v11, v228, s40, v229
v_add_u32 v11, v11, v231
s_mov_b32 s34, 689515819
v_lshrrev_b32 v228, v227, s34
v_bfe_u32 v229, v228, 3, 3
v_and_b32 v228, 7, v228
v_mul_u32_u24 v229, 196224, v229
v_mad_u32_u24 v13, v228, s40, v229
v_add_u32 v13, v13, v232
v_add_u32 v233, 589824, v226
s_cmp_eq_u32 s38, 1
s_cselect_b64 s[44:45], -1, 0
s_cmp_eq_u32 s38, 2
s_cselect_b64 s[46:47], -1, 0
s_cmp_eq_u32 s38, 3
s_cselect_b64 s[8:9], -1, 0
v_lshlrev_b32 v234, 4, v222
v_cndmask_b32 v60, v8, v10, s[44:45]
v_cndmask_b32 v60, v60, v12, s[46:47]
v_cndmask_b32 v60, v60, v233, s[8:9]
v_xor_b32 v60, v60, v234
v_cndmask_b32 v61, v9, v11, s[44:45]
v_cndmask_b32 v61, v61, v13, s[46:47]
v_cndmask_b32 v61, v61, v233, s[8:9]
v_xor_b32 v61, v61, v234
v_xor_b32 v61, 64, v61
s_mul_hi_u32 s34, s87, 58835169
s_mul_i32 s35, s34, 73
s_sub_u32 s35, s87, s35
s_mul_i32 s34, s34, 1373568
s_mul_i32 s35, s35, 2688
s_add_u32 s44, s34, s35
s_mul_i32 s43, s38, 6144
s_add_u32 s43, s43, 139264
s_mov_b32 s87, 9999
s_mul_hi_u32 s34, s39, 58835169
s_mul_i32 s35, s34, 73
s_sub_u32 s35, s39, s35
s_mul_i32 s34, s34, 1373568
s_mul_i32 s35, s35, 2688
s_add_u32 s28, s34, s35
s_mov_b32 s27, s39
s_mov_b32 s26, 0
s_lshr_b32 s10, s2, 3
s_and_b32 s10, s10, 15
s_lshl_b32 s10, s10, 12
s_lshl_b32 s34, s38, 10
s_add_u32 s10, s10, s34
s_add_u32 s96, s34, 139264
s_add_u32 s97, s34, 143360
s_lshl_b32 s34, s38, 12
s_add_u32 s34, s34, 147456
s_waitcnt lgkmcnt(0)
s_mov_b32 s16, s24
s_mov_b32 s17, s25
s_mov_b32 s18, 147456
s_mov_b32 s19, 0x20000
buffer_load_dword v235, v235, s[16:19], 0 offen offset:0
s_mov_b32 s20, s4
s_mov_b32 s21, s5
s_mov_b32 s22, 100270464
s_mov_b32 s23, 0x20000
s_add_u32 m0, s43, 0
s_nop 0
buffer_load_dwordx4 v60, s[20:23], s44 offen offset:0 nt lds
v_and_b32 v228, 7, v0
v_xor_b32 v228, v228, v222
v_lshlrev_b32 v228, 4, v228
v_lshrrev_b32 v229, 3, v0
v_lshlrev_b32 v229, 7, v229
v_add3_u32 v4, v228, v229, s34
v_xor_b32 v5, 64, v4
v_add_u32 v5, 0x400, v5
v_lshrrev_b32 v228, 1, v221
v_xor_b32 v228, v228, v222
v_lshlrev_b32 v228, 4, v228
s_add_u32 m0, s43, 1024
s_nop 0
buffer_load_dwordx4 v61, s[20:23], s44 offen offset:0 nt lds
v_lshlrev_b32 v229, 7, v221
v_add3_u32 v6, v228, v229, s34
v_xor_b32 v7, 64, v6
s_mov_b32 s35, 139264
v_add3_u32 v62, v228, v229, s35
v_xor_b32 v63, 64, v62
v_add_u32 v64, s42, v1
s_mul_i32 s91, s90, 704
s_min_u32 s91, s91, L_end-standalone__swin_window_attn__vision_kernel-704+64
s_add_u32 s92, s88, s91
s_addc_u32 s93, s89, 0
s_add_u32 m0, s43, 1920
s_nop 0
buffer_load_dwordx4 v60, s[20:23], s44 offen offset:128 nt lds
s_load_dword s94, s[92:93], 0
s_load_dword s94, s[92:93], 64
s_load_dword s94, s[92:93], 128
s_load_dword s94, s[92:93], 192
s_load_dword s94, s[92:93], 256
s_load_dword s94, s[92:93], 320
s_load_dword s94, s[92:93], 384
s_load_dword s94, s[92:93], 448
s_load_dword s94, s[92:93], 512
s_load_dword s94, s[92:93], 576
s_load_dword s94, s[92:93], 640
s_add_u32 m0, s43, 2944
s_nop 0
buffer_load_dwordx4 v61, s[20:23], s44 offen offset:128 nt lds
s_mov_b32 s12, s6
s_mov_b32 s13, s7
s_mov_b32 s14, 100270464
s_mov_b32 s15, 0x20000
v_mov_b32 v21, 0xff800000
v_lshlrev_b32 v227, 3, v222
v_lshlrev_b32 v234, 3, v221
s_mov_b32 s34, 588253184
v_lshrrev_b32 v228, v227, s34
v_bfe_u32 v229, v228, 3, 3
v_and_b32 v228, 7, v228
s_add_u32 m0, s43, 3840
s_nop 0
buffer_load_dwordx4 v60, s[20:23], s44 offen offset:256 nt lds
v_mul_u32_u24 v229, 196224, v229
v_mad_u32_u24 v14, v228, s40, v229
v_add_u32 v14, v14, v234
s_mov_b32 s34, 403047684
v_lshrrev_b32 v228, v227, s34
v_bfe_u32 v229, v228, 3, 3
v_and_b32 v228, 7, v228
v_mul_u32_u24 v229, 196224, v229
v_mad_u32_u24 v15, v228, s40, v229
v_add_u32 v15, v15, v234
s_mov_b32 s34, 689515819
s_add_u32 m0, s43, 4864
s_nop 0
buffer_load_dwordx4 v61, s[20:23], s44 offen offset:256 nt lds
v_lshrrev_b32 v228, v227, s34
v_bfe_u32 v229, v228, 3, 3
v_and_b32 v228, 7, v228
v_mul_u32_u24 v229, 196224, v229
v_mad_u32_u24 v16, v228, s40, v229
v_add_u32 v16, v16, v234
v_add_u32 v19, 589824, v234
v_lshlrev_b32 v20, 1, v222
v_add_u32 v2, 0x10000, v1
v_add_u32 v3, 0x20000, v1
v_mov_b32 v26, 0
s_add_u32 m0, s42, 0
s_nop 0
buffer_load_dwordx4 v1, s[16:19], m0 offen lds
v_mov_b32 v27, 0
v_mov_b32 v22, 0x80000000
s_add_u32 s33, s39, 1024
s_mul_hi_u32 s34, s33, 58835169
s_mul_i32 s35, s34, 73
s_sub_u32 s35, s33, s35
s_mul_i32 s34, s34, 1373568
s_mul_i32 s35, s35, 2688
s_add_u32 s32, s34, s35
s_sub_u32 s36, s26, 1
v_cmp_eq_u32 vcc, s26, v20
s_nop 1
v_cndmask_b32 v24, v21, v26, vcc
v_cndmask_b32 v17, v22, v19, vcc
s_add_u32 m0, s42, 1024
s_nop 0
buffer_load_dwordx4 v1, s[16:19], m0 offen lds
v_cmp_eq_u32 vcc, s36, v20
s_nop 1
v_cndmask_b32 v25, v21, v26, vcc
v_cndmask_b32 v18, v22, v19, vcc
v_mov_b32 v22, 0x80000000
s_and_b32 s36, s38, 1
s_lshl_b32 s35, s36, 1
s_lshl_b32 s37, s2, 2
s_add_u32 s35, s35, s37
s_lshl_b32 s3, s36, 10
s_lshl_b32 s36, s36, 6
v_lshrrev_b32 v224, 5, v0
s_add_u32 m0, s42, 2048
s_nop 0
buffer_load_dwordx4 v1, s[16:19], m0 offen lds
v_bfe_u32 v225, v0, 3, 2
s_cmp_ge_u32 s38, 2
s_cselect_b32 s37, 4096, 0
s_cselect_b32 s34, 0, 1024
s_cselect_b32 s4, 6144, 0
s_add_u32 s35, s35, s37
s_add_u32 s3, s3, s4
v_add_u32 v224, s35, v224
v_mad_u32_u24 v224, v225, s34, v224
s_xor_b32 s4, s10, 0x8000
s_and_b32 s4, s4, 0xc000
s_add_u32 m0, s42, 3072
s_nop 0
buffer_load_dwordx4 v1, s[16:19], m0 offen lds
s_add_u32 s4, s4, 73728
s_add_u32 s3, s3, s4
s_mov_b32 s34, 58835169
v_mul_hi_u32 v228, v224, s34
v_mul_u32_u24 v229, 73, v228
v_sub_u32 v229, v224, v229
v_mul_u32_u24 v228, 1373568, v228
v_mul_u32_u24 v229, 2688, v229
v_and_b32 v226, 7, v0
v_xor_b32 v226, v226, v222
v_lshlrev_b32 v226, 4, v226
s_add_u32 m0, s42, 4096
s_nop 0
buffer_load_dwordx4 v1, s[16:19], m0 offen lds
v_xor_b32 v226, s36, v226
v_add_u32 v226, 589824, v226
v_add3_u32 v91, v228, v229, v226
s_mul_i32 s34, s38, 3
s_add_u32 s34, s34, 0
s_lshr_b32 s35, s34, 1
s_lshl_b32 s35, s35, 12
s_and_b32 s34, s34, 1
s_lshl_b32 s34, s34, 3
s_add_u32 s34, s34, s35
s_add_u32 s34, s34, 139264
s_add_u32 m0, s42, 5120
s_nop 0
buffer_load_dwordx4 v1, s[16:19], m0 offen lds
v_add_u32 v65, s34, v1
s_mul_i32 s34, s38, 3
s_add_u32 s34, s34, 1
s_lshr_b32 s35, s34, 1
s_lshl_b32 s35, s35, 12
s_and_b32 s34, s34, 1
s_lshl_b32 s34, s34, 3
s_add_u32 s34, s34, s35
s_add_u32 s34, s34, 139264
v_add_u32 v66, s34, v1
s_mul_i32 s34, s38, 3
s_add_u32 m0, s42, 6144
s_nop 0
buffer_load_dwordx4 v1, s[16:19], m0 offen lds
s_add_u32 s34, s34, 2
s_lshr_b32 s35, s34, 1
s_lshl_b32 s35, s35, 12
s_and_b32 s34, s34, 1
s_lshl_b32 s34, s34, 3
s_add_u32 s34, s34, s35
s_add_u32 s34, s34, 139264
v_add_u32 v67, s34, v1
s_lshl_b32 s34, s38, 10
s_add_u32 s35, s34, 139264
v_add_u32 v68, s35, v1
s_add_u32 m0, s42, 7168
s_nop 0
buffer_load_dwordx4 v1, s[16:19], m0 offen lds
v_lshrrev_b32 v23, 1, v1
v_add_u32 v23, 147456, v23
v_add_u32 v69, s34, v23
s_mul_i32 s36, s38, 24576
s_add_u32 s36, s36, 73728
v_add_u32 v0, s36, v1
s_lshl_b32 s34, s38, 7
s_add_u32 s44, s44, s34
s_add_u32 s45, s44, 196224
s_add_u32 s46, s44, 392448
s_add_u32 s47, s44, 588672
s_add_u32 m0, s42, 8192
s_nop 0
buffer_load_dwordx4 v1, s[16:19], m0 offen lds
v_mov_b32 v99, 0
v_mov_b32 v107, 0
v_mov_b32 v115, 0
v_mov_b32 v123, 0
s_add_u32 m0, s42, 9216
s_nop 0
buffer_load_dwordx4 v1, s[16:19], m0 offen lds
s_add_u32 m0, s42, 10240
s_nop 0
buffer_load_dwordx4 v1, s[16:19], m0 offen lds
s_add_u32 m0, s42, 11264
s_nop 0
buffer_load_dwordx4 v1, s[16:19], m0 offen lds
s_waitcnt vmcnt(12)
s_barrier
s_add_u32 m0, s42, 12288
s_nop 0
buffer_load_dwordx4 v1, s[16:19], m0 offen lds
ds_read_b128 a[0:3], v62 offset:0
ds_read_b128 a[24:27], v62 offset:6144
ds_read_b128 a[48:51], v62 offset:12288
ds_read_b128 a[168:171], v62 offset:18432
s_waitcnt vmcnt(12)
ds_read_b128 a[216:219], v64 offset:0
s_add_u32 m0, s42, 13312
s_nop 0
buffer_load_dwordx4 v1, s[16:19], m0 offen lds
ds_read_b128 a[4:7], v63 offset:0
ds_read_b128 a[28:31], v63 offset:6144
ds_read_b128 a[52:55], v63 offset:12288
ds_read_b128 a[172:175], v63 offset:18432
s_waitcnt vmcnt(12)
ds_read_b128 a[220:223], v64 offset:1024
s_add_u32 m0, s42, 14336
s_nop 0
buffer_load_dwordx4 v1, s[16:19], m0 offen lds
ds_read_b128 a[8:11], v62 offset:2048
ds_read_b128 a[32:35], v62 offset:8192
ds_read_b128 a[56:59], v62 offset:14336
ds_read_b128 a[176:179], v62 offset:20480
s_waitcnt vmcnt(12)
ds_read_b128 a[224:227], v64 offset:2048
s_add_u32 m0, s42, 15360
s_nop 0
buffer_load_dwordx4 v1, s[16:19], m0 offen lds
ds_read_b128 a[12:15], v63 offset:2048
ds_read_b128 a[36:39], v63 offset:8192
ds_read_b128 a[60:63], v63 offset:14336
ds_read_b128 a[180:183], v63 offset:20480
s_waitcnt vmcnt(12)
ds_read_b128 a[228:231], v64 offset:3072
s_add_u32 m0, s42, 16384
s_nop 0
buffer_load_dwordx4 v1, s[16:19], m0 offen lds
ds_read_b128 a[16:19], v62 offset:4096
ds_read_b128 a[40:43], v62 offset:10240
ds_read_b128 a[64:67], v62 offset:16384
ds_read_b128 a[184:187], v62 offset:22528
s_add_u32 m0, s42, 17408
s_nop 0
buffer_load_dwordx4 v1, s[16:19], m0 offen lds
ds_read_b128 a[20:23], v63 offset:4096
ds_read_b128 a[44:47], v63 offset:10240
ds_read_b128 a[68:71], v63 offset:16384
ds_read_b128 a[188:191], v63 offset:22528
s_waitcnt lgkmcnt(15)
v_mfma_f32_16x16x32_bf16 v[188:191], a[216:219], a[0:3], 0
s_add_u32 m0, s3, 0
s_nop 0
buffer_load_dwordx4 v91, s[20:23], 0 offen offset:0 nt lds
v_mfma_f32_16x16x32_bf16 v[192:195], a[216:219], a[24:27], 0
s_add_u32 m0, s3, 1920
v_mfma_f32_16x16x32_bf16 v[196:199], a[216:219], a[48:51], 0
buffer_load_dwordx4 v91, s[20:23], 0 offen offset:128 nt lds
s_add_u32 m0, s3, 3840
v_mfma_f32_16x16x32_bf16 v[200:203], a[216:219], a[168:171], 0
s_waitcnt vmcnt(15)
s_xor_b32 s7, s10, 0xc000
ds_read_b128 a[232:235], v64 offset:4096
v_bfe_u32 v84, v1, 4, 2
v_mfma_f32_16x16x32_bf16 v[188:191], a[220:223], a[4:7], v[188:191]
buffer_load_dwordx4 v91, s[20:23], 0 offen offset:256 nt lds
s_and_b32 s7, s7, 0xc000
v_mfma_f32_16x16x32_bf16 v[192:195], a[220:223], a[28:31], v[192:195]
s_add_u32 s7, s7, 75728
v_bfe_u32 v85, v1, 6, 2
v_lshrrev_b32 v86, 8, v1
v_mfma_f32_16x16x32_bf16 v[196:199], a[220:223], a[52:55], v[196:199]
buffer_load_dwordx4 v[44:47], v0, s[16:19], 0 offen offset:0
v_mfma_f32_16x16x32_bf16 v[200:203], a[220:223], a[172:175], v[200:203]
s_waitcnt vmcnt(16) lgkmcnt(14)
ds_read_b128 a[236:239], v64 offset:5120
v_mfma_f32_16x16x32_bf16 v[188:191], a[224:227], a[8:11], v[188:191]
v_lshl_add_u32 v87, v86, 3, s7
v_mfma_f32_16x16x32_bf16 v[192:195], a[224:227], a[32:35], v[192:195]
buffer_load_dwordx4 v[48:51], v0, s[16:19], 0 offen offset:1024
v_mul_u32_u24 v83, 4032, v85
v_mfma_f32_16x16x32_bf16 v[196:199], a[224:227], a[56:59], v[196:199]
v_mul_u32_u24 v88, 400, v84
v_mfma_f32_16x16x32_bf16 v[200:203], a[224:227], a[176:179], v[200:203]
s_waitcnt vmcnt(16) lgkmcnt(10)
s_mul_i32 s6, s38, 4032
ds_read_b128 a[192:195], v64 offset:6144
v_add3_u32 v83, v83, v88, v87
v_mfma_f32_16x16x32_bf16 v[188:191], a[228:231], a[12:15], v[188:191]
buffer_load_dwordx4 v[52:55], v0, s[16:19], 0 offen offset:2048
v_add_u32 v90, 1600, v83
v_mfma_f32_16x16x32_bf16 v[192:195], a[228:231], a[36:39], v[192:195]
v_mfma_f32_16x16x32_bf16 v[196:199], a[228:231], a[60:63], v[196:199]
v_lshl_add_u32 v87, v86, 3, v87
v_mfma_f32_16x16x32_bf16 v[200:203], a[228:231], a[180:183], v[200:203]
s_waitcnt vmcnt(16) lgkmcnt(2)
ds_read_b128 a[196:199], v64 offset:7168
buffer_load_dwordx4 v[56:59], v0, s[16:19], 0 offen offset:3072
v_mfma_f32_16x16x32_bf16 v[188:191], a[232:235], a[16:19], v[188:191]
v_mul_u32_u24 v88, 800, v85
v_add3_u32 v88, v88, v87, s6
v_mfma_f32_16x16x32_bf16 v[192:195], a[232:235], a[40:43], v[192:195]
s_movk_i32 s11, 4096
v_and_b32 v87, 1, v84
v_mfma_f32_16x16x32_bf16 v[196:199], a[232:235], a[64:67], v[196:199]
v_mul_u32_u24 v87, 192, v87
v_mfma_f32_16x16x32_bf16 v[200:203], a[232:235], a[184:187], v[200:203]
buffer_load_dwordx4 a[240:243], v0, s[16:19], s11 offen offset:0
s_waitcnt vmcnt(17) lgkmcnt(2)
ds_read_b128 a[200:203], v64 offset:8192
v_mfma_f32_16x16x32_bf16 v[188:191], a[236:239], a[20:23], v[188:191]
s_barrier
v_add_u32 v88, v88, v87
v_lshrrev_b32 v87, 1, v84
v_mfma_f32_16x16x32_bf16 v[192:195], a[236:239], a[44:47], v[192:195]
v_mul_u32_u24 v87, 2000, v87
v_mfma_f32_16x16x32_bf16 v[196:199], a[236:239], a[68:71], v[196:199]
buffer_load_dwordx4 a[244:247], v0, s[16:19], s11 offen offset:1024
v_sub_u32 v88, v88, v87
v_mfma_f32_16x16x32_bf16 v[200:203], a[236:239], a[188:191], v[200:203]
s_waitcnt vmcnt(17) lgkmcnt(2)
ds_read_b128 a[204:207], v64 offset:9216
v_cvt_pk_bf16_f32 v244, v188, v189
v_mfma_f32_16x16x32_bf16 v[204:207], a[192:195], a[0:3], 0
v_cvt_pk_bf16_f32 v245, v190, v191
v_cvt_pk_bf16_f32 v246, v192, v193
v_mfma_f32_16x16x32_bf16 v[208:211], a[192:195], a[24:27], 0
buffer_load_dwordx4 a[248:251], v0, s[16:19], s11 offen offset:2048
v_cvt_pk_bf16_f32 v247, v194, v195
v_mfma_f32_16x16x32_bf16 v[212:215], a[192:195], a[48:51], 0
v_cvt_pk_bf16_f32 v248, v196, v197
v_cvt_pk_bf16_f32 v249, v198, v199
v_mfma_f32_16x16x32_bf16 v[216:219], a[192:195], a[168:171], 0
s_waitcnt vmcnt(17) lgkmcnt(2)
ds_read_b128 a[208:211], v64 offset:10240
v_cvt_pk_bf16_f32 v250, v200, v201
v_mfma_f32_16x16x32_bf16 v[204:207], a[196:199], a[4:7], v[204:207]
v_cvt_pk_bf16_f32 v251, v202, v203
buffer_load_dwordx4 a[252:255], v0, s[16:19], s11 offen offset:3072
v_mfma_f32_16x16x32_bf16 v[208:211], a[196:199], a[28:31], v[208:211]
v_lshlrev_b32 v84, 8, v84
v_lshl_add_u32 v84, v86, 6, v84
v_mfma_f32_16x16x32_bf16 v[212:215], a[196:199], a[52:55], v[212:215]
s_mul_i32 s7, s38, 18432
s_movk_i32 s11, 8192
v_lshl_add_u32 v84, v85, 4, v84
v_mfma_f32_16x16x32_bf16 v[216:219], a[196:199], a[172:175], v[216:219]
s_waitcnt vmcnt(17) lgkmcnt(2)
s_add_u32 s7, s7, 73728
ds_read_b128 a[212:215], v64 offset:11264
v_bfe_u32 v85, v1, 4, 1
v_mfma_f32_16x16x32_bf16 v[204:207], a[200:203], a[8:11], v[204:207]
buffer_load_dwordx4 v[236:239], v0, s[16:19], s11 offen offset:0
v_lshl_add_u32 v84, v85, 3, v84
v_mfma_f32_16x16x32_bf16 v[208:211], a[200:203], a[32:35], v[208:211]
ds_write_b64 v65, v[244:245] offset:0
v_mfma_f32_16x16x32_bf16 v[212:215], a[200:203], a[56:59], v[212:215]
v_add_u32 v254, s7, v1
v_lshl_add_u32 v80, s38, 11, v84
v_mfma_f32_16x16x32_bf16 v[216:219], a[200:203], a[176:179], v[216:219]
buffer_load_dwordx4 v[240:243], v0, s[16:19], s11 offen offset:1024
s_waitcnt vmcnt(18) lgkmcnt(3)
ds_read_b128 a[216:219], v64 offset:12288
v_mfma_f32_16x16x32_bf16 v[204:207], a[204:207], a[12:15], v[204:207]
s_lshl_b32 s7, s38, 4
v_and_b32 v85, 1, v86
v_lshlrev_b32 v85, 3, v85
v_mfma_f32_16x16x32_bf16 v[208:211], a[204:207], a[36:39], v[208:211]
v_lshl_add_u32 v85, v86, 6, v85
v_add_u32 v82, 36864, v80
v_mfma_f32_16x16x32_bf16 v[212:215], a[204:207], a[60:63], v[212:215]
s_lshl_b32 s85, s38, 12
buffer_load_dwordx4 v[180:183], v0, s[16:19], s11 offen offset:2048
v_xor_b32 v81, 8, v80
v_mfma_f32_16x16x32_bf16 v[216:219], a[204:207], a[180:183], v[216:219]
s_waitcnt vmcnt(18) lgkmcnt(3)
ds_read_b128 a[220:223], v64 offset:13312
v_add_u32 v89, s7, v85
v_mfma_f32_16x16x32_bf16 v[204:207], a[208:211], a[16:19], v[204:207]
s_xor_b32 s7, s10, 0x8000
s_and_b32 s7, s7, 0xc000
v_xor_b32 v255, 8, v82
v_mfma_f32_16x16x32_bf16 v[208:211], a[208:211], a[40:43], v[208:211]
s_add_u32 s85, s85, 73728
ds_write_b64 v65, v[246:247] offset:1024
v_mfma_f32_16x16x32_bf16 v[212:215], a[208:211], a[64:67], v[212:215]
buffer_load_dwordx4 v[184:187], v0, s[16:19], s11 offen offset:3072
s_sub_u32 s85, s85, s7
v_mfma_f32_16x16x32_bf16 v[216:219], a[208:211], a[184:187], v[216:219]
s_waitcnt vmcnt(18) lgkmcnt(4)
s_and_b32 s7, s10, 0x8000
s_movk_i32 s11, 12288
ds_read_b128 a[224:227], v64 offset:14336
v_mfma_f32_16x16x32_bf16 v[204:207], a[212:215], a[20:23], v[204:207]
s_lshl_b32 s43, s38, 13
ds_write_b64 v65, v[248:249] offset:2048
v_mfma_f32_16x16x32_bf16 v[208:211], a[212:215], a[44:47], v[208:211]
buffer_load_dwordx4 v[124:127], v0, s[16:19], s11 offen offset:0
s_add_u32 s43, s43, s7
v_mfma_f32_16x16x32_bf16 v[212:215], a[212:215], a[68:71], v[212:215]
s_add_u32 s43, s43, 73728
ds_write_b64 v65, v[250:251] offset:3072
v_mfma_f32_16x16x32_bf16 v[216:219], a[212:215], a[188:191], v[216:219]
s_waitcnt vmcnt(18) lgkmcnt(5)
s_lshl_b32 s86, s38, 12
ds_read_b128 a[228:231], v64 offset:15360
v_cvt_pk_bf16_f32 v252, v204, v205
v_mfma_f32_16x16x32_bf16 v[188:191], a[216:219], a[0:3], 0
buffer_load_dwordx4 v[128:131], v0, s[16:19], s11 offen offset:1024
v_cvt_pk_bf16_f32 v253, v206, v207
v_mfma_f32_16x16x32_bf16 v[192:195], a[216:219], a[24:27], 0
s_add_u32 s86, s86, 147456
v_cvt_pk_bf16_f32 v244, v208, v209
v_cvt_pk_bf16_f32 v245, v210, v211
v_mfma_f32_16x16x32_bf16 v[196:199], a[216:219], a[48:51], 0
s_sub_u32 s86, s86, s43
v_cvt_pk_bf16_f32 v246, v212, v213
v_cvt_pk_bf16_f32 v247, v214, v215
v_mfma_f32_16x16x32_bf16 v[200:203], a[216:219], a[168:171], 0
buffer_load_dwordx4 v[132:135], v0, s[16:19], s11 offen offset:2048
s_waitcnt vmcnt(19) lgkmcnt(5)
ds_read_b128 a[232:235], v64 offset:16384
v_mfma_f32_16x16x32_bf16 v[188:191], a[220:223], a[4:7], v[188:191]
v_cvt_pk_bf16_f32 v248, v216, v217
v_cvt_pk_bf16_f32 v249, v218, v219
v_mfma_f32_16x16x32_bf16 v[192:195], a[220:223], a[28:31], v[192:195]
ds_write_b64 v66, v[252:253] offset:0
v_mfma_f32_16x16x32_bf16 v[196:199], a[220:223], a[52:55], v[196:199]
ds_write_b64 v66, v[244:245] offset:1024
v_mfma_f32_16x16x32_bf16 v[200:203], a[220:223], a[172:175], v[200:203]
buffer_load_dwordx4 v[136:139], v0, s[16:19], s11 offen offset:3072
s_waitcnt vmcnt(19) lgkmcnt(6)
ds_read_b128 a[236:239], v64 offset:17408
v_mfma_f32_16x16x32_bf16 v[188:191], a[224:227], a[8:11], v[188:191]
s_movk_i32 s11, 16384
v_mfma_f32_16x16x32_bf16 v[192:195], a[224:227], a[32:35], v[192:195]
ds_write_b64 v66, v[246:247] offset:2048
v_mfma_f32_16x16x32_bf16 v[196:199], a[224:227], a[56:59], v[196:199]
buffer_load_dwordx4 v[140:143], v0, s[16:19], s11 offen offset:0
v_mfma_f32_16x16x32_bf16 v[200:203], a[224:227], a[176:179], v[200:203]
s_waitcnt lgkmcnt(5)
ds_write_b64 v66, v[248:249] offset:3072
v_mfma_f32_16x16x32_bf16 v[188:191], a[228:231], a[12:15], v[188:191]
v_mfma_f32_16x16x32_bf16 v[192:195], a[228:231], a[36:39], v[192:195]
buffer_load_dwordx4 v[144:147], v0, s[16:19], s11 offen offset:1024
v_mfma_f32_16x16x32_bf16 v[196:199], a[228:231], a[60:63], v[196:199]
v_mfma_f32_16x16x32_bf16 v[200:203], a[228:231], a[180:183], v[200:203]
s_waitcnt lgkmcnt(5)
v_mfma_f32_16x16x32_bf16 v[188:191], a[232:235], a[16:19], v[188:191]
buffer_load_dwordx4 v[148:151], v0, s[16:19], s11 offen offset:2048
v_mfma_f32_16x16x32_bf16 v[192:195], a[232:235], a[40:43], v[192:195]
v_mfma_f32_16x16x32_bf16 v[196:199], a[232:235], a[64:67], v[196:199]
v_mfma_f32_16x16x32_bf16 v[200:203], a[232:235], a[184:187], v[200:203]
buffer_load_dwordx4 v[152:155], v0, s[16:19], s11 offen offset:3072
s_waitcnt lgkmcnt(2)
v_mfma_f32_16x16x32_bf16 v[188:191], a[236:239], a[20:23], v[188:191]
v_mfma_f32_16x16x32_bf16 v[192:195], a[236:239], a[44:47], v[192:195]
v_mfma_f32_16x16x32_bf16 v[196:199], a[236:239], a[68:71], v[196:199]
v_mfma_f32_16x16x32_bf16 v[200:203], a[236:239], a[188:191], v[200:203]
s_cmp_eq_u32 s38, 3
s_cbranch_scc1 L_co2w
s_waitcnt vmcnt(19)
v_mfma_f32_16x16x32_bf16 v[212:215], a[0:3], v[44:47], 0
s_movk_i32 s11, 20480
s_nop 0
v_cvt_pk_bf16_f32 v252, v192, v193
v_cvt_pk_bf16_f32 v253, v194, v195
v_mfma_f32_16x16x32_bf16 v[216:219], a[24:27], v[44:47], 0
buffer_load_dwordx4 a[224:227], v0, s[16:19], s11 offen offset:0
ds_write_b64 v67, v[252:253] offset:1024
v_mfma_f32_16x16x32_bf16 v[220:223], a[48:51], v[44:47], 0
v_cvt_pk_bf16_f32 v250, v188, v189
v_cvt_pk_bf16_f32 v251, v190, v191
v_mfma_f32_16x16x32_bf16 v[204:207], a[168:171], v[44:47], 0
LW_first1:
LW_p1:
s_cbranch_execz LW_p19
s_waitcnt vmcnt(19)
v_cvt_pk_bf16_f32 v244, v196, v197
v_cvt_pk_bf16_f32 v245, v198, v199
v_mfma_f32_16x16x32_bf16 v[212:215], a[4:7], v[48:51], v[212:215]
buffer_load_dwordx4 a[228:231], v0, s[16:19], s11 offen offset:1024
v_cvt_pk_bf16_f32 v246, v200, v201
v_mfma_f32_16x16x32_bf16 v[216:219], a[28:31], v[48:51], v[216:219]
v_cvt_pk_bf16_f32 v247, v202, v203
ds_write_b64 v67, v[250:251] offset:0
v_mfma_f32_16x16x32_bf16 v[220:223], a[52:55], v[48:51], v[220:223]
ds_write_b64 v67, v[244:245] offset:2048
v_mfma_f32_16x16x32_bf16 v[204:207], a[172:175], v[48:51], v[204:207]
buffer_load_dwordx4 a[232:235], v0, s[16:19], s11 offen offset:2048
s_waitcnt vmcnt(20)
ds_write_b64 v67, v[246:247] offset:3072
v_mfma_f32_16x16x32_bf16 v[212:215], a[8:11], v[52:55], v[212:215]
v_mfma_f32_16x16x32_bf16 v[216:219], a[32:35], v[52:55], v[216:219]
v_mfma_f32_16x16x32_bf16 v[220:223], a[56:59], v[52:55], v[220:223]
buffer_load_dwordx4 a[236:239], v0, s[16:19], s11 offen offset:3072
v_lshrrev_b32 v91, 4, v1
v_mfma_f32_16x16x32_bf16 v[204:207], a[176:179], v[52:55], v[204:207]
s_waitcnt vmcnt(20)
v_and_b32 v91, 48, v91
s_add_u32 m0, s43, 0
v_mfma_f32_16x16x32_bf16 v[212:215], a[12:15], v[56:59], v[212:215]
s_waitcnt lgkmcnt(0)
s_barrier
v_xor_b32 v248, v8, v91
v_xor_b32 v249, v9, v91
v_mfma_f32_16x16x32_bf16 v[216:219], a[36:39], v[56:59], v[216:219]
buffer_load_dwordx4 v248, s[20:23], s28 offen offset:0 nt lds
v_xor_b32 v249, 64, v249
v_mfma_f32_16x16x32_bf16 v[220:223], a[60:63], v[56:59], v[220:223]
ds_read_b128 v[156:159], v68 offset:0
ds_read_b128 v[160:163], v68 offset:4096
v_mfma_f32_16x16x32_bf16 v[204:207], a[180:183], v[56:59], v[204:207]
s_waitcnt vmcnt(20)
ds_read_b128 v[164:167], v68 offset:8192
s_add_u32 m0, s43, 1024
v_mfma_f32_16x16x32_bf16 v[212:215], a[16:19], a[240:243], v[212:215]
ds_read_b128 v[168:171], v68 offset:12288
ds_read_b128 v[172:175], v68 offset:16384
v_mfma_f32_16x16x32_bf16 v[216:219], a[40:43], a[240:243], v[216:219]
buffer_load_dwordx4 v249, s[20:23], s28 offen offset:0 nt lds
ds_read_b128 v[176:179], v68 offset:20480
v_mfma_f32_16x16x32_bf16 v[220:223], a[64:67], a[240:243], v[220:223]
v_mfma_f32_16x16x32_bf16 v[204:207], a[184:187], a[240:243], v[204:207]
s_waitcnt lgkmcnt(5)
s_add_u32 m0, s43, 1920
s_nop 0
buffer_load_dwordx4 v248, s[20:23], s28 offen offset:128 nt lds
v_mfma_f32_16x16x32_bf16 v[28:31], a[0:3], v[156:159], 0
s_add_u32 m0, s43, 2944
ds_read_b64_tr_b16 a[96:97], v80 offset:0
v_mfma_f32_16x16x32_bf16 v[32:35], a[24:27], v[156:159], 0
ds_read_b64_tr_b16 a[98:99], v80 offset:6144
buffer_load_dwordx4 v249, s[20:23], s28 offen offset:128 nt lds
v_mfma_f32_16x16x32_bf16 v[36:39], a[48:51], v[156:159], 0
s_mov_b32 s98, 0x11111111
ds_read_b64_tr_b16 a[100:101], v80 offset:12288
v_subrev_u32 v250, s85, v6
v_mfma_f32_16x16x32_bf16 v[40:43], a[168:171], v[156:159], v[24:27]
s_waitcnt lgkmcnt(7)
s_mov_b32 s99, 0x11111111
ds_read_b64_tr_b16 a[102:103], v80 offset:18432
ds_read_b128 a[144:147], v250 offset:6144
v_mfma_f32_16x16x32_bf16 v[28:31], a[4:7], v[160:163], v[28:31]
s_add_u32 m0, s43, 3840
ds_read_b64_tr_b16 a[104:105], v80 offset:24576
v_xor_b32 v251, 64, v250
v_mfma_f32_16x16x32_bf16 v[32:35], a[28:31], v[160:163], v[32:35]
ds_read_b64_tr_b16 a[106:107], v80 offset:30720
buffer_load_dwordx4 v248, s[20:23], s28 offen offset:256 nt lds
v_mfma_f32_16x16x32_bf16 v[36:39], a[52:55], v[160:163], v[36:39]
v_xor_b32 v248, v10, v91
ds_read_b64_tr_b16 a[108:109], v82 offset:0
v_mfma_f32_16x16x32_bf16 v[40:43], a[172:175], v[160:163], v[40:43]
s_waitcnt lgkmcnt(11)
ds_read_b64_tr_b16 a[110:111], v82 offset:6144
ds_read_b128 a[148:151], v251 offset:6144
v_mfma_f32_16x16x32_bf16 v[28:31], a[8:11], v[164:167], v[28:31]
s_add_u32 m0, s43, 4864
ds_read_b64_tr_b16 a[112:113], v82 offset:12288
ds_read_b128 a[152:155], v250 offset:8192
v_mfma_f32_16x16x32_bf16 v[32:35], a[32:35], v[164:167], v[32:35]
ds_read_b64_tr_b16 a[114:115], v82 offset:18432
buffer_load_dwordx4 v249, s[20:23], s28 offen offset:256 nt lds
v_mfma_f32_16x16x32_bf16 v[36:39], a[56:59], v[164:167], v[36:39]
v_xor_b32 v249, v11, v91
v_xor_b32 v249, 64, v249
v_mfma_f32_16x16x32_bf16 v[40:43], a[176:179], v[164:167], v[40:43]
s_waitcnt lgkmcnt(15)
ds_read_b64_tr_b16 a[116:117], v82 offset:24576
ds_read_b64_tr_b16 a[118:119], v82 offset:30720
v_mfma_f32_16x16x32_bf16 v[28:31], a[12:15], v[168:171], v[28:31]
v_lshrrev_b32 v76, 6, v1
v_and_b32 v76, 4, v76
v_mfma_f32_16x16x32_bf16 v[32:35], a[36:39], v[168:171], v[32:35]
v_lshl_add_u32 v76, s38, 6, v76
v_subrev_u32 v76, 2000, v76
v_mfma_f32_16x16x32_bf16 v[36:39], a[60:63], v[168:171], v[36:39]
v_add_u32 v244, v76, v83
v_mfma_f32_16x16x32_bf16 v[40:43], a[180:183], v[168:171], v[40:43]
s_waitcnt lgkmcnt(15)
ds_read_b128 a[156:159], v251 offset:8192
ds_read_b128 a[160:163], v250 offset:10240
v_mfma_f32_16x16x32_bf16 v[28:31], a[16:19], v[172:175], v[28:31]
v_add_u32 v246, v76, v90
v_xor_b32 v245, 4, v244
v_mfma_f32_16x16x32_bf16 v[32:35], a[40:43], v[172:175], v[32:35]
ds_read_b128 a[164:167], v251 offset:10240
ds_read_b64_tr_b16 a[120:121], v81 offset:0
v_mfma_f32_16x16x32_bf16 v[36:39], a[64:67], v[172:175], v[36:39]
ds_read_b64_tr_b16 a[122:123], v81 offset:6144
ds_read_b64_tr_b16 a[124:125], v81 offset:12288
v_mfma_f32_16x16x32_bf16 v[40:43], a[184:187], v[172:175], v[40:43]
ds_read_b64_tr_b16 a[126:127], v81 offset:18432
ds_read_b64_tr_b16 a[128:129], v81 offset:24576
v_mfma_f32_16x16x32_bf16 v[28:31], a[20:23], v[176:179], v[28:31]
ds_read_b64_tr_b16 a[130:131], v81 offset:30720
ds_read_b64_tr_b16 a[132:133], v255 offset:0
v_mfma_f32_16x16x32_bf16 v[32:35], a[44:47], v[176:179], v[32:35]
ds_read_b64_tr_b16 a[134:135], v255 offset:6144
ds_read_b64_tr_b16 a[136:137], v255 offset:12288
v_mfma_f32_16x16x32_bf16 v[36:39], a[68:71], v[176:179], v[36:39]
ds_read_b64_tr_b16 a[138:139], v255 offset:18432
ds_read_b64_tr_b16 a[140:141], v255 offset:24576
v_mfma_f32_16x16x32_bf16 v[40:43], a[188:191], v[176:179], v[40:43]
s_waitcnt vmcnt(24)
v_subrev_u32 v252, s86, v6
v_xor_b32 v247, 4, v246
v_mfma_f32_16x16x32_bf16 v[212:215], a[20:23], a[244:247], v[212:215]
v_xor_b32 v253, 64, v252
v_mfma_f32_16x16x32_bf16 v[216:219], a[44:47], a[244:247], v[216:219]
ds_read_b64_tr_b16 a[142:143], v255 offset:30720
ds_read_b64_tr_b16 a[240:241], v80 offset:1024
v_mfma_f32_16x16x32_bf16 v[220:223], a[68:71], a[244:247], v[220:223]
v_max3_f32 v42, v28, v29, v30
v_max3_f32 v42, v42, v31, v32
v_mfma_f32_16x16x32_bf16 v[204:207], a[188:191], a[244:247], v[204:207]
s_waitcnt vmcnt(23)
v_max3_f32 v42, v42, v33, v34
v_max3_f32 v42, v42, v35, v36
v_mfma_f32_16x16x32_bf16 v[224:227], a[0:3], a[248:251], 0
v_max3_f32 v42, v42, v37, v38
v_max3_f32 v42, v42, v39, v40
v_mfma_f32_16x16x32_bf16 v[228:231], a[24:27], a[248:251], 0
v_mov_b32 v43, v42
v_cvt_pk_bf16_f32 v92, v212, v213
v_mfma_f32_16x16x32_bf16 v[232:235], a[48:51], a[248:251], 0
v_permlane32_swap_b32 v42, v43
v_mfma_f32_16x16x32_bf16 v[208:211], a[168:171], a[248:251], 0
s_waitcnt vmcnt(22)
v_max_f32 v42, v42, v43
v_mov_b32 v43, v42
v_mfma_f32_16x16x32_bf16 v[224:227], a[4:7], a[252:255], v[224:227]
v_cvt_pk_bf16_f32 v93, v214, v215
v_cvt_pk_bf16_f32 v94, v216, v217
v_mfma_f32_16x16x32_bf16 v[228:231], a[28:31], a[252:255], v[228:231]
v_permlane16_swap_b32 v42, v43
v_mfma_f32_16x16x32_bf16 v[232:235], a[52:55], a[252:255], v[232:235]
v_max_f32 v42, v42, v43
v_sub_f32 v28, v28, v42
v_mfma_f32_16x16x32_bf16 v[208:211], a[172:175], a[252:255], v[208:211]
s_waitcnt vmcnt(21)
v_sub_f32 v29, v29, v42
v_sub_f32 v30, v30, v42
v_mfma_f32_16x16x32_bf16 v[224:227], a[8:11], v[236:239], v[224:227]
v_exp_f32 v28, v28
v_mfma_f32_16x16x32_bf16 v[228:231], a[32:35], v[236:239], v[228:231]
v_exp_f32 v29, v29
v_mfma_f32_16x16x32_bf16 v[232:235], a[56:59], v[236:239], v[232:235]
v_sub_f32 v31, v31, v42
v_sub_f32 v32, v32, v42
v_mfma_f32_16x16x32_bf16 v[208:211], a[176:179], v[236:239], v[208:211]
s_waitcnt vmcnt(20)
v_sub_f32 v33, v33, v42
v_sub_f32 v34, v34, v42
v_mfma_f32_16x16x32_bf16 v[224:227], a[12:15], v[240:243], v[224:227]
v_sub_f32 v35, v35, v42
v_sub_f32 v36, v36, v42
v_mfma_f32_16x16x32_bf16 v[228:231], a[36:39], v[240:243], v[228:231]
v_sub_f32 v37, v37, v42
v_sub_f32 v38, v38, v42
v_mfma_f32_16x16x32_bf16 v[232:235], a[60:63], v[240:243], v[232:235]
v_sub_f32 v39, v39, v42
v_sub_f32 v40, v40, v42
v_mfma_f32_16x16x32_bf16 v[208:211], a[180:183], v[240:243], v[208:211]
s_waitcnt vmcnt(19)
v_exp_f32 v30, v30
v_mfma_f32_16x16x32_bf16 v[224:227], a[16:19], v[180:183], v[224:227]
v_exp_f32 v31, v31
v_mfma_f32_16x16x32_bf16 v[228:231], a[40:43], v[180:183], v[228:231]
v_add_f32 v42, v28, v29
v_add_f32 v42, v42, v30
v_mfma_f32_16x16x32_bf16 v[232:235], a[64:67], v[180:183], v[232:235]
v_exp_f32 v32, v32
v_mfma_f32_16x16x32_bf16 v[208:211], a[184:187], v[180:183], v[208:211]
s_waitcnt vmcnt(18)
v_exp_f32 v33, v33
v_mfma_f32_16x16x32_bf16 v[224:227], a[20:23], v[184:187], v[224:227]
v_add_f32 v42, v42, v31
v_add_f32 v42, v42, v32
v_mfma_f32_16x16x32_bf16 v[228:231], a[44:47], v[184:187], v[228:231]
v_exp_f32 v34, v34
v_mfma_f32_16x16x32_bf16 v[232:235], a[68:71], v[184:187], v[232:235]
v_exp_f32 v35, v35
v_mfma_f32_16x16x32_bf16 v[208:211], a[188:191], v[184:187], v[208:211]
s_waitcnt vmcnt(17)
v_add_f32 v42, v42, v33
v_add_f32 v42, v42, v34
v_mfma_f32_16x16x32_bf16 v[188:191], a[0:3], v[124:127], 0
v_exp_f32 v36, v36
v_mfma_f32_16x16x32_bf16 v[192:195], a[24:27], v[124:127], 0
v_exp_f32 v37, v37
v_mfma_f32_16x16x32_bf16 v[196:199], a[48:51], v[124:127], 0
v_add_f32 v42, v42, v35
v_add_f32 v42, v42, v36
v_mfma_f32_16x16x32_bf16 v[200:203], a[168:171], v[124:127], 0
s_waitcnt vmcnt(16)
v_exp_f32 v38, v38
v_mfma_f32_16x16x32_bf16 v[188:191], a[4:7], v[128:131], v[188:191]
v_exp_f32 v39, v39
v_mfma_f32_16x16x32_bf16 v[192:195], a[28:31], v[128:131], v[192:195]
v_add_f32 v42, v42, v37
v_add_f32 v42, v42, v38
v_mfma_f32_16x16x32_bf16 v[196:199], a[52:55], v[128:131], v[196:199]
v_exp_f32 v40, v40
v_mfma_f32_16x16x32_bf16 v[200:203], a[172:175], v[128:131], v[200:203]
s_waitcnt vmcnt(15)
v_add_f32 v42, v42, v39
v_add_f32 v42, v42, v40
v_mfma_f32_16x16x32_bf16 v[188:191], a[8:11], v[132:135], v[188:191]
v_mov_b32 v43, v42
v_cvt_pk_bf16_f32 v95, v218, v219
v_mfma_f32_16x16x32_bf16 v[192:195], a[32:35], v[132:135], v[192:195]
v_permlane32_swap_b32 v42, v43
v_mfma_f32_16x16x32_bf16 v[196:199], a[56:59], v[132:135], v[196:199]
v_add_f32 v42, v42, v43
v_mov_b32 v43, v42
v_mfma_f32_16x16x32_bf16 v[200:203], a[176:179], v[132:135], v[200:203]
s_waitcnt vmcnt(14)
v_cvt_pk_bf16_f32 v96, v220, v221
v_cvt_pk_bf16_f32 v97, v222, v223
v_mfma_f32_16x16x32_bf16 v[188:191], a[12:15], v[136:139], v[188:191]
v_permlane16_swap_b32 v42, v43
v_mfma_f32_16x16x32_bf16 v[192:195], a[36:39], v[136:139], v[192:195]
v_add_f32 v42, v42, v43
v_cvt_pk_bf16_f32 v98, v204, v205
v_mfma_f32_16x16x32_bf16 v[196:199], a[60:63], v[136:139], v[196:199]
v_rcp_f32 v42, v42
v_mfma_f32_16x16x32_bf16 v[200:203], a[180:183], v[136:139], v[200:203]
s_waitcnt vmcnt(13)
v_mul_f32 v28, v28, v42
v_mul_f32 v29, v29, v42
v_mfma_f32_16x16x32_bf16 v[188:191], a[16:19], v[140:143], v[188:191]
v_mul_f32 v36, v36, v42
v_mul_f32 v37, v37, v42
v_mfma_f32_16x16x32_bf16 v[192:195], a[40:43], v[140:143], v[192:195]
v_mul_f32 v30, v30, v42
v_mul_f32 v31, v31, v42
v_mfma_f32_16x16x32_bf16 v[196:199], a[64:67], v[140:143], v[196:199]
v_mul_f32 v38, v38, v42
v_mul_f32 v39, v39, v42
v_mfma_f32_16x16x32_bf16 v[200:203], a[184:187], v[140:143], v[200:203]
s_waitcnt vmcnt(12)
v_cvt_pk_bf16_f32 v28, v28, v29
v_cvt_pk_bf16_f32 v36, v36, v37
v_mfma_f32_16x16x32_bf16 v[188:191], a[20:23], v[144:147], v[188:191]
v_mul_f32 v32, v32, v42
v_mul_f32 v33, v33, v42
v_mfma_f32_16x16x32_bf16 v[192:195], a[44:47], v[144:147], v[192:195]
v_mul_f32 v34, v34, v42
v_mul_f32 v35, v35, v42
v_mfma_f32_16x16x32_bf16 v[196:199], a[68:71], v[144:147], v[196:199]
v_mul_f32 v40, v40, v42
v_cvt_pk_bf16_f32 v29, v30, v31
v_mfma_f32_16x16x32_bf16 v[200:203], a[188:191], v[144:147], v[200:203]
s_waitcnt vmcnt(11)
v_cvt_pk_bf16_f32 v37, v38, v39
v_cvt_pk_bf16_f32 v30, v32, v33
v_mfma_f32_16x16x32_bf16 v[212:215], a[0:3], v[148:151], 0
v_cvt_pk_bf16_f32 v31, v34, v35
v_cvt_pk_bf16_f32 v38, v40, 0
v_mfma_f32_16x16x32_bf16 v[216:219], a[24:27], v[148:151], 0
v_mov_b32 v39, 0
ds_write_b64 v69, v[28:29] offset:0
v_mfma_f32_16x16x32_bf16 v[220:223], a[48:51], v[148:151], 0
ds_write_b64 v69, v[30:31] offset:4096
v_mfma_f32_16x16x32_bf16 v[204:207], a[168:171], v[148:151], 0
s_waitcnt vmcnt(10)
ds_write_b64 v69, v[36:37] offset:8192
v_mfma_f32_16x16x32_bf16 v[212:215], a[4:7], v[152:155], v[212:215]
ds_write_b64 v69, v[38:39] offset:12288
v_mfma_f32_16x16x32_bf16 v[216:219], a[28:31], v[152:155], v[216:219]
v_cvt_pk_bf16_f32 v108, v188, v189
v_cvt_pk_bf16_f32 v109, v190, v191
v_mfma_f32_16x16x32_bf16 v[220:223], a[52:55], v[152:155], v[220:223]
v_cvt_pk_bf16_f32 v100, v224, v225
v_cvt_pk_bf16_f32 v101, v226, v227
v_mfma_f32_16x16x32_bf16 v[204:207], a[172:175], v[152:155], v[204:207]
s_waitcnt vmcnt(9)
v_cvt_pk_bf16_f32 v102, v228, v229
v_cvt_pk_bf16_f32 v103, v230, v231
v_mfma_f32_16x16x32_bf16 v[212:215], a[8:11], a[224:227], v[212:215]
v_cvt_pk_bf16_f32 v110, v192, v193
v_cvt_pk_bf16_f32 v111, v194, v195
v_mfma_f32_16x16x32_bf16 v[216:219], a[32:35], a[224:227], v[216:219]
s_waitcnt lgkmcnt(0)
s_barrier
ds_read_b64 v[76:77], v23 offset:3072
ds_read_b64 v[78:79], v23 offset:7168
v_mfma_f32_16x16x32_bf16 v[220:223], a[56:59], a[224:227], v[220:223]
ds_read_b64 v[84:85], v23 offset:11264
ds_read_b64 v[86:87], v23 offset:15360
v_mfma_f32_16x16x32_bf16 v[204:207], a[176:179], a[224:227], v[204:207]
s_waitcnt vmcnt(8)
ds_read_b64 v[28:29], v23 offset:0
ds_read_b64 v[30:31], v23 offset:4096
v_mfma_f32_16x16x32_bf16 v[212:215], a[12:15], a[228:231], v[212:215]
v_cvt_pk_bf16_f32 v112, v196, v197
v_cvt_pk_bf16_f32 v113, v198, v199
v_mfma_f32_16x16x32_bf16 v[216:219], a[36:39], a[228:231], v[216:219]
ds_read_b64 v[36:37], v23 offset:8192
ds_read_b64 v[38:39], v23 offset:12288
v_mfma_f32_16x16x32_bf16 v[220:223], a[60:63], a[228:231], v[220:223]
s_waitcnt vmcnt(4)
ds_read_b128 a[72:75], v252 offset:0
v_cvt_pk_bf16_f32 v114, v200, v201
v_mfma_f32_16x16x32_bf16 v[204:207], a[180:183], a[228:231], v[204:207]
ds_read_b128 a[76:79], v253 offset:0
v_cvt_pk_bf16_f32 v104, v232, v233
v_mfma_f32_16x16x32_bf16 v[212:215], a[16:19], a[232:235], v[212:215]
s_waitcnt vmcnt(2)
ds_read_b128 a[80:83], v252 offset:2048
v_cvt_pk_bf16_f32 v105, v234, v235
v_mfma_f32_16x16x32_bf16 v[216:219], a[40:43], a[232:235], v[216:219]
s_add_u32 m0, s43, 0
ds_read_b128 a[84:87], v253 offset:2048
v_cvt_pk_bf16_f32 v106, v208, v209
v_mfma_f32_16x16x32_bf16 v[220:223], a[64:67], a[232:235], v[220:223]
s_waitcnt vmcnt(0)
ds_read_b128 a[88:91], v252 offset:4096
ds_read_b64 v[44:45], v23 offset:1024
v_mfma_f32_16x16x32_bf16 v[204:207], a[184:187], a[232:235], v[204:207]
ds_read_b128 a[92:95], v253 offset:4096
ds_read_b64 v[46:47], v23 offset:5120
v_mfma_f32_16x16x32_bf16 v[212:215], a[20:23], a[236:239], v[212:215]
ds_read_b64 v[52:53], v23 offset:9216
ds_read_b64 v[54:55], v23 offset:13312
v_mfma_f32_16x16x32_bf16 v[216:219], a[44:47], a[236:239], v[216:219]
s_nop 0
ds_read_b64 v[60:61], v23 offset:2048
ds_read_b64 v[62:63], v23 offset:6144
v_mfma_f32_16x16x32_bf16 v[220:223], a[68:71], a[236:239], v[220:223]
s_nop 0
v_cvt_pk_bf16_f32 v116, v212, v213
v_cvt_pk_bf16_f32 v117, v214, v215
v_mfma_f32_16x16x32_bf16 v[204:207], a[188:191], a[236:239], v[204:207]
s_waitcnt lgkmcnt(15)
v_cvt_pk_bf16_f32 v118, v216, v217
v_cvt_pk_bf16_f32 v119, v218, v219
v_mfma_f32_16x16x32_bf16 v[188:191], v[76:79], v[92:95], 0
s_waitcnt lgkmcnt(10)
buffer_load_dwordx4 v248, s[20:23], s28 offen offset:0 nt lds
s_add_u32 m0, s43, 1024
v_mfma_f32_16x16x32_bf16 v[192:195], v[76:79], v[100:103], 0
s_nop 0
buffer_load_dwordx4 v249, s[20:23], s28 offen offset:0 nt lds
s_add_u32 m0, s43, 1920
v_mfma_f32_16x16x32_bf16 v[196:199], v[76:79], v[108:111], 0
s_waitcnt lgkmcnt(8)
buffer_load_dwordx4 v248, s[20:23], s28 offen offset:128 nt lds
s_add_u32 m0, s43, 2944
v_mfma_f32_16x16x32_bf16 v[200:203], v[76:79], v[116:119], 0
buffer_load_dwordx4 v249, s[20:23], s28 offen offset:128 nt lds
s_add_u32 m0, s43, 3840
v_mfma_f32_16x16x32_bf16 v[188:191], v[84:87], v[96:99], v[188:191]
s_waitcnt lgkmcnt(5)
buffer_load_dwordx4 v248, s[20:23], s28 offen offset:256 nt lds
s_add_u32 m0, s43, 4864
v_mfma_f32_16x16x32_bf16 v[192:195], v[84:87], v[104:107], v[192:195]
buffer_load_dwordx4 v249, s[20:23], s28 offen offset:256 nt lds
v_cvt_pk_bf16_f32 v120, v220, v221
v_mfma_f32_16x16x32_bf16 v[196:199], v[84:87], v[112:115], v[196:199]
v_cvt_pk_bf16_f32 v121, v222, v223
v_cvt_pk_bf16_f32 v122, v204, v205
v_xor_b32 v249, v13, v91
v_xor_b32 v248, v12, v91
v_mfma_f32_16x16x32_bf16 v[200:203], v[84:87], v[120:123], v[200:203]
v_cvt_pk_bf16_f32 v124, v188, v192
v_xor_b32 v249, 64, v249
v_mfma_f32_16x16x32_bf16 v[204:207], v[28:31], v[92:95], 0
ds_read_b64 v[68:69], v23 offset:10240
ds_read_b64 v[70:71], v23 offset:14336
v_mfma_f32_16x16x32_bf16 v[208:211], v[28:31], v[100:103], 0
ds_read_b128 v[180:183], v250 offset:0
ds_read_b128 v[184:187], v251 offset:0
v_mfma_f32_16x16x32_bf16 v[212:215], v[28:31], v[108:111], 0
v_cvt_pk_bf16_f32 v125, v196, v200
v_mfma_f32_16x16x32_bf16 v[216:219], v[28:31], v[116:119], 0
buffer_store_dwordx2 v[124:125], v17, s[12:15], s44 offen offset:0 sc1
ds_read_b128 v[164:167], v250 offset:2048
v_mfma_f32_16x16x32_bf16 v[204:207], v[36:39], v[96:99], v[204:207]
ds_read_b128 v[168:171], v251 offset:2048
ds_read_b128 v[172:175], v250 offset:4096
v_mfma_f32_16x16x32_bf16 v[208:211], v[36:39], v[104:107], v[208:211]
ds_read_b128 v[176:179], v251 offset:4096
ds_read_b64_tr_b16 a[242:243], v80 offset:7168
v_mfma_f32_16x16x32_bf16 v[212:215], v[36:39], v[112:115], v[212:215]
ds_read_b64_tr_b16 a[244:245], v80 offset:13312
ds_read_b64_tr_b16 a[246:247], v80 offset:19456
v_mfma_f32_16x16x32_bf16 v[216:219], v[36:39], v[120:123], v[216:219]
s_waitcnt lgkmcnt(15)
ds_read_b64_tr_b16 a[248:249], v80 offset:25600
ds_read_b64_tr_b16 a[250:251], v80 offset:31744
v_mfma_f32_16x16x32_bf16 v[188:191], v[44:47], v[92:95], 0
v_cvt_pk_bf16_f32 v126, v204, v208
v_cvt_pk_bf16_f32 v128, v205, v209
v_mfma_f32_16x16x32_bf16 v[192:195], v[44:47], v[100:103], 0
v_cvt_pk_bf16_f32 v130, v206, v210
v_cvt_pk_bf16_f32 v132, v207, v211
v_mfma_f32_16x16x32_bf16 v[196:199], v[44:47], v[108:111], 0
v_cvt_pk_bf16_f32 v127, v212, v216
v_cvt_pk_bf16_f32 v129, v213, v217
v_mfma_f32_16x16x32_bf16 v[200:203], v[44:47], v[116:119], 0
buffer_store_dwordx2 v[126:127], v14, s[12:15], s44 offen offset:0 sc1
s_waitcnt lgkmcnt(15)
v_cvt_pk_bf16_f32 v131, v214, v218
v_mfma_f32_16x16x32_bf16 v[188:191], v[52:55], v[96:99], v[188:191]
v_cvt_pk_bf16_f32 v133, v215, v219
v_mfma_f32_16x16x32_bf16 v[192:195], v[52:55], v[104:107], v[192:195]
buffer_store_dwordx2 v[128:129], v14, s[12:15], s44 offen offset:384 sc1
ds_read_b64_tr_b16 a[252:253], v82 offset:1024
v_mfma_f32_16x16x32_bf16 v[196:199], v[52:55], v[112:115], v[196:199]
ds_read_b64_tr_b16 a[254:255], v82 offset:7168
ds_read_b64_tr_b16 a[0:1], v82 offset:13312
v_mfma_f32_16x16x32_bf16 v[200:203], v[52:55], v[120:123], v[200:203]
s_waitcnt lgkmcnt(15)
ds_read_b64_tr_b16 a[2:3], v82 offset:19456
ds_read_b64_tr_b16 a[4:5], v82 offset:25600
v_mfma_f32_16x16x32_bf16 v[204:207], v[60:63], v[92:95], 0
ds_read_b64_tr_b16 a[6:7], v82 offset:31744
ds_read_b64_tr_b16 a[8:9], v81 offset:1024
v_mfma_f32_16x16x32_bf16 v[208:211], v[60:63], v[100:103], 0
ds_read_b64_tr_b16 a[10:11], v81 offset:7168
ds_read_b64_tr_b16 a[12:13], v81 offset:13312
v_mfma_f32_16x16x32_bf16 v[212:215], v[60:63], v[108:111], 0
buffer_store_dwordx2 v[130:131], v14, s[12:15], s44 offen offset:768 sc1
ds_read_b64_tr_b16 a[14:15], v81 offset:19456
v_mfma_f32_16x16x32_bf16 v[216:219], v[60:63], v[116:119], 0
s_waitcnt lgkmcnt(15)
ds_read_b64_tr_b16 a[16:17], v81 offset:25600
ds_read_b64_tr_b16 a[18:19], v81 offset:31744
v_mfma_f32_16x16x32_bf16 v[204:207], v[68:71], v[96:99], v[204:207]
ds_read_b64_tr_b16 a[20:21], v255 offset:1024
ds_read_b64_tr_b16 a[22:23], v255 offset:7168
v_mfma_f32_16x16x32_bf16 v[208:211], v[68:71], v[104:107], v[208:211]
ds_read_b64_tr_b16 a[24:25], v255 offset:13312
ds_read_b64_tr_b16 a[26:27], v255 offset:19456
v_mfma_f32_16x16x32_bf16 v[212:215], v[68:71], v[112:115], v[212:215]
ds_read_b64_tr_b16 a[28:29], v255 offset:25600
ds_read_b64_tr_b16 a[30:31], v255 offset:31744
v_mfma_f32_16x16x32_bf16 v[216:219], v[68:71], v[120:123], v[216:219]
buffer_store_dwordx2 v[132:133], v14, s[12:15], s44 offen offset:1152 sc1
ds_read_b128 a[192:195], v1 offset:6144
v_mfma_f32_16x16x32_bf16 v[220:223], a[96:99], v[180:183], 0
ds_read_b128 a[196:199], v1 offset:7168
ds_read_b128 a[200:203], v1 offset:8192
v_mfma_f32_16x16x32_bf16 v[224:227], a[96:99], a[144:147], 0
ds_read_b128 a[204:207], v1 offset:9216
ds_read_b128 a[208:211], v1 offset:10240
v_mfma_f32_16x16x32_bf16 v[220:223], a[100:103], v[184:187], v[220:223]
ds_read_b128 a[212:215], v1 offset:11264
ds_read_b128 a[216:219], v1 offset:0
v_mfma_f32_16x16x32_bf16 v[224:227], a[100:103], a[148:151], v[224:227]
ds_read_b128 a[220:223], v1 offset:1024
ds_read_b128 a[224:227], v1 offset:2048
v_mfma_f32_16x16x32_bf16 v[220:223], a[104:107], v[164:167], v[220:223]
ds_read_b128 a[228:231], v1 offset:3072
ds_read_b128 a[232:235], v1 offset:4096
v_mfma_f32_16x16x32_bf16 v[224:227], a[104:107], a[152:155], v[224:227]
ds_read_b128 a[236:239], v1 offset:5120
v_cvt_pk_bf16_f32 v134, v188, v192
v_mfma_f32_16x16x32_bf16 v[220:223], a[108:111], v[168:171], v[220:223]
v_cvt_pk_bf16_f32 v135, v196, v200
v_cvt_pk_bf16_f32 v136, v189, v193
v_mfma_f32_16x16x32_bf16 v[224:227], a[108:111], a[156:159], v[224:227]
buffer_store_dwordx2 v[134:135], v15, s[12:15], s44 offen offset:0 sc1
v_cvt_pk_bf16_f32 v137, v197, v201
v_mfma_f32_16x16x32_bf16 v[220:223], a[112:115], v[172:175], v[220:223]
v_cvt_pk_bf16_f32 v138, v190, v194
v_cvt_pk_bf16_f32 v139, v198, v202
v_mfma_f32_16x16x32_bf16 v[224:227], a[112:115], a[160:163], v[224:227]
buffer_store_dwordx2 v[136:137], v15, s[12:15], s45 offen offset:0 sc1
v_cvt_pk_bf16_f32 v140, v191, v195
v_mfma_f32_16x16x32_bf16 v[220:223], a[116:119], v[176:179], v[220:223]
v_cvt_pk_bf16_f32 v141, v199, v203
v_cvt_pk_bf16_f32 v142, v204, v208
v_mfma_f32_16x16x32_bf16 v[224:227], a[116:119], a[164:167], v[224:227]
v_cvt_pk_bf16_f32 v143, v212, v216
v_cvt_pk_bf16_f32 v148, v205, v209
v_mfma_f32_16x16x32_bf16 v[228:231], a[120:123], v[180:183], 0
v_cvt_pk_bf16_f32 v149, v213, v217
v_cvt_pk_bf16_f32 v150, v206, v210
v_mfma_f32_16x16x32_bf16 v[232:235], a[120:123], a[144:147], 0
v_cvt_pk_bf16_f32 v220, v220, v221
v_cvt_pk_bf16_f32 v221, v222, v223
v_mfma_f32_16x16x32_bf16 v[228:231], a[124:127], v[184:187], v[228:231]
buffer_store_dwordx2 v[138:139], v15, s[12:15], s46 offen offset:0 sc1
v_cvt_pk_bf16_f32 v224, v224, v225
v_mfma_f32_16x16x32_bf16 v[232:235], a[124:127], a[148:151], v[232:235]
ds_write2_b32 v244, v220, v221 offset0:0 offset1:48
v_mfma_f32_16x16x32_bf16 v[228:231], a[128:131], v[164:167], v[228:231]
v_cvt_pk_bf16_f32 v225, v226, v227
v_cvt_pk_bf16_f32 v151, v214, v218
v_mfma_f32_16x16x32_bf16 v[232:235], a[128:131], a[152:155], v[232:235]
s_mov_b64 exec, s[98:99]
ds_write2_b32 v246, v224, v225 offset0:0 offset1:48
s_mov_b64 exec, -1
v_mfma_f32_16x16x32_bf16 v[228:231], a[132:135], v[168:171], v[228:231]
v_cvt_pk_bf16_f32 v156, v207, v211
v_cvt_pk_bf16_f32 v157, v215, v219
v_mfma_f32_16x16x32_bf16 v[232:235], a[132:135], a[156:159], v[232:235]
buffer_store_dwordx2 v[140:141], v15, s[12:15], s47 offen offset:0 sc1
v_mfma_f32_16x16x32_bf16 v[228:231], a[136:139], v[172:175], v[228:231]
v_mfma_f32_16x16x32_bf16 v[232:235], a[136:139], a[160:163], v[232:235]
v_mfma_f32_16x16x32_bf16 v[228:231], a[140:143], v[176:179], v[228:231]
v_mfma_f32_16x16x32_bf16 v[232:235], a[140:143], a[164:167], v[232:235]
s_waitcnt lgkmcnt(15)
v_mfma_f32_16x16x32_bf16 v[220:223], a[240:243], v[180:183], 0
buffer_store_dwordx2 v[142:143], v16, s[12:15], s44 offen offset:0 sc1
v_mfma_f32_16x16x32_bf16 v[224:227], a[240:243], a[144:147], 0
v_mfma_f32_16x16x32_bf16 v[220:223], a[244:247], v[184:187], v[220:223]
s_nop 0
s_nop 0
v_mfma_f32_16x16x32_bf16 v[224:227], a[244:247], a[148:151], v[224:227]
v_cvt_pk_bf16_f32 v228, v228, v229
v_cvt_pk_bf16_f32 v229, v230, v231
v_mfma_f32_16x16x32_bf16 v[220:223], a[248:251], v[164:167], v[220:223]
ds_write2_b32 v245, v228, v229 offset0:0 offset1:48
v_mfma_f32_16x16x32_bf16 v[224:227], a[248:251], a[152:155], v[224:227]
buffer_store_dwordx2 v[148:149], v16, s[12:15], s44 offen offset:384 sc1
v_cvt_pk_bf16_f32 v232, v232, v233
v_mfma_f32_16x16x32_bf16 v[220:223], a[252:255], v[168:171], v[220:223]
v_cvt_pk_bf16_f32 v233, v234, v235
s_mov_b64 exec, s[98:99]
ds_write2_b32 v247, v232, v233 offset0:0 offset1:48
s_mov_b64 exec, -1
v_mfma_f32_16x16x32_bf16 v[224:227], a[252:255], a[156:159], v[224:227]
v_mfma_f32_16x16x32_bf16 v[220:223], a[0:3], v[172:175], v[220:223]
v_mfma_f32_16x16x32_bf16 v[224:227], a[0:3], a[160:163], v[224:227]
v_mfma_f32_16x16x32_bf16 v[220:223], a[4:7], v[176:179], v[220:223]
buffer_store_dwordx2 v[150:151], v16, s[12:15], s45 offen offset:0 sc1
v_mfma_f32_16x16x32_bf16 v[224:227], a[4:7], a[164:167], v[224:227]
v_mfma_f32_16x16x32_bf16 v[228:231], a[8:11], v[180:183], 0
v_mfma_f32_16x16x32_bf16 v[232:235], a[8:11], a[144:147], 0
v_mfma_f32_16x16x32_bf16 v[228:231], a[12:15], v[184:187], v[228:231]
v_mfma_f32_16x16x32_bf16 v[232:235], a[12:15], a[148:151], v[232:235]
buffer_store_dwordx2 v[156:157], v16, s[12:15], s45 offen offset:384 sc1
v_mfma_f32_16x16x32_bf16 v[228:231], a[16:19], v[164:167], v[228:231]
s_waitcnt vmcnt(17)
ds_read_b128 a[96:99], v252 offset:0
v_cvt_pk_bf16_f32 v220, v220, v221
v_mfma_f32_16x16x32_bf16 v[232:235], a[16:19], a[152:155], v[232:235]
ds_read_b128 a[100:103], v253 offset:0
v_cvt_pk_bf16_f32 v224, v224, v225
v_mfma_f32_16x16x32_bf16 v[228:231], a[20:23], v[168:171], v[228:231]
s_waitcnt vmcnt(15)
ds_read_b128 a[104:107], v252 offset:2048
v_cvt_pk_bf16_f32 v221, v222, v223
v_mfma_f32_16x16x32_bf16 v[232:235], a[20:23], a[156:159], v[232:235]
ds_read_b128 a[108:111], v253 offset:2048
v_cvt_pk_bf16_f32 v225, v226, v227
v_mfma_f32_16x16x32_bf16 v[228:231], a[24:27], v[172:175], v[228:231]
s_waitcnt vmcnt(13)
ds_read_b128 a[112:115], v252 offset:4096
ds_write2_b32 v244, v220, v221 offset0:8 offset1:56
v_mfma_f32_16x16x32_bf16 v[232:235], a[24:27], a[160:163], v[232:235]
s_waitcnt lgkmcnt(15)
ds_read_b128 a[116:119], v253 offset:4096
s_mov_b64 exec, s[98:99]
ds_write2_b32 v246, v224, v225 offset0:8 offset1:56
s_mov_b64 exec, -1
v_mfma_f32_16x16x32_bf16 v[228:231], a[28:31], v[176:179], v[228:231]
LW_first2:
LW_p2:
s_cbranch_execz LW_p16
v_mfma_f32_16x16x32_bf16 v[232:235], a[28:31], a[164:167], v[232:235]
s_nop 0
s_nop 0
s_nop 0
s_nop 0
s_nop 0
s_nop 0
s_nop 0
v_cvt_pk_bf16_f32 v228, v228, v229
v_cvt_pk_bf16_f32 v232, v232, v233
v_cvt_pk_bf16_f32 v229, v230, v231
v_cvt_pk_bf16_f32 v233, v234, v235
ds_write2_b32 v245, v228, v229 offset0:8 offset1:56
s_mov_b64 exec, s[98:99]
ds_write2_b32 v247, v232, v233 offset0:8 offset1:56
s_mov_b64 exec, -1
L_b0:
s_waitcnt lgkmcnt(10)
v_mfma_f32_16x16x32_bf16 v[224:227], a[216:219], a[72:75], 0
s_waitcnt lgkmcnt(8)
s_add_u32 m0, s43, 0
s_mov_b32 s4, 0
buffer_load_dwordx4 v248, s[20:23], s28 offen offset:0 nt lds
v_mfma_f32_16x16x32_bf16 v[224:227], a[220:223], a[76:79], v[224:227]
s_waitcnt lgkmcnt(6)
s_add_u32 m0, s43, 1024
s_mov_b32 s5, 0xffff
buffer_load_dwordx4 v249, s[20:23], s28 offen offset:0 nt lds
v_mfma_f32_16x16x32_bf16 v[224:227], a[224:227], a[80:83], v[224:227]
s_waitcnt lgkmcnt(4)
s_add_u32 m0, s43, 1920
s_mov_b32 s6, 0x100001
s_mov_b32 s92, 0
v_mfma_f32_16x16x32_bf16 v[224:227], a[228:231], a[84:87], v[224:227]
s_waitcnt lgkmcnt(6)
buffer_load_dwordx4 v248, s[20:23], s28 offen offset:128 nt lds
s_waitcnt lgkmcnt(3)
s_add_u32 m0, s43, 2944
v_mfma_f32_16x16x32_bf16 v[224:227], a[232:235], a[88:91], v[224:227]
buffer_load_dwordx4 v249, s[20:23], s28 offen offset:128 nt lds
s_waitcnt lgkmcnt(2)
s_mov_b32 s93, 0xffff0000
v_mfma_f32_16x16x32_bf16 v[224:227], a[236:239], a[92:95], v[224:227]
s_add_u32 m0, s43, 3840
s_mov_b32 s27, s33
s_mov_b32 s44, s28
v_mfma_f32_16x16x32_bf16 v[228:231], a[216:219], a[96:99], 0
s_waitcnt lgkmcnt(3)
buffer_load_dwordx4 v248, s[20:23], s28 offen offset:256 nt lds
s_add_u32 m0, s43, 4864
v_mfma_f32_16x16x32_bf16 v[228:231], a[220:223], a[100:103], v[228:231]
buffer_load_dwordx4 v249, s[20:23], s28 offen offset:256 nt lds
s_add_u32 s29, s28, 196224
v_mfma_f32_16x16x32_bf16 v[228:231], a[224:227], a[104:107], v[228:231]
s_add_u32 s30, s28, 392448
s_add_u32 s31, s28, 588672
ds_read_b128 a[216:219], v1 offset:12288
v_mfma_f32_16x16x32_bf16 v[228:231], a[228:231], a[108:111], v[228:231]
s_mov_b32 s45, s29
ds_read_b128 a[220:223], v1 offset:13312
ds_read_b128 a[224:227], v1 offset:14336
v_mfma_f32_16x16x32_bf16 v[228:231], a[232:235], a[112:115], v[228:231]
s_mov_b32 s46, s30
ds_read_b128 a[228:231], v1 offset:15360
ds_read_b128 a[232:235], v1 offset:16384
v_mfma_f32_16x16x32_bf16 v[228:231], a[236:239], a[116:119], v[228:231]
s_mov_b32 s47, s31
ds_read_b128 a[236:239], v1 offset:17408
v_cvt_pk_bf16_f32 v60, v224, v225
v_mfma_f32_16x16x32_bf16 v[232:235], a[192:195], a[72:75], 0
v_cvt_pk_bf16_f32 v61, v226, v227
v_mfma_f32_16x16x32_bf16 v[232:235], a[196:199], a[76:79], v[232:235]
v_mfma_f32_16x16x32_bf16 v[232:235], a[200:203], a[80:83], v[232:235]
v_mfma_f32_16x16x32_bf16 v[232:235], a[204:207], a[84:87], v[232:235]
v_cvt_pk_bf16_f32 v92, v228, v229
v_cvt_pk_bf16_f32 v93, v230, v231
v_mfma_f32_16x16x32_bf16 v[232:235], a[208:211], a[88:91], v[232:235]
v_mfma_f32_16x16x32_bf16 v[232:235], a[212:215], a[92:95], v[232:235]
v_mfma_f32_16x16x32_bf16 v[220:223], a[192:195], a[96:99], 0
ds_read_b128 a[192:195], v1 offset:18432
v_mfma_f32_16x16x32_bf16 v[220:223], a[196:199], a[100:103], v[220:223]
ds_read_b128 a[196:199], v1 offset:19456
v_mfma_f32_16x16x32_bf16 v[220:223], a[200:203], a[104:107], v[220:223]
s_waitcnt lgkmcnt(8)
s_barrier
ds_read_b128 a[168:171], v88 offset:0
ds_read_b128 a[200:203], v1 offset:20480
v_mfma_f32_16x16x32_bf16 v[220:223], a[204:207], a[108:111], v[220:223]
ds_read_b128 a[204:207], v1 offset:21504
v_cvt_pk_bf16_f32 v62, v232, v233
v_mfma_f32_16x16x32_bf16 v[220:223], a[208:211], a[112:115], v[220:223]
ds_read_b128 a[172:175], v88 offset:64
ds_read_b128 a[208:211], v1 offset:22528
v_mfma_f32_16x16x32_bf16 v[220:223], a[212:215], a[116:119], v[220:223]
s_waitcnt lgkmcnt(12)
ds_read_b128 a[212:215], v1 offset:23552
v_cvt_pk_bf16_f32 v63, v234, v235
v_mfma_f32_16x16x32_bf16 v[224:227], a[216:219], a[72:75], 0
s_waitcnt lgkmcnt(12)
ds_read_b128 a[176:179], v88 offset:128
v_mfma_f32_16x16x32_bf16 v[224:227], a[220:223], a[76:79], v[224:227]
s_waitcnt lgkmcnt(12)
v_mfma_f32_16x16x32_bf16 v[224:227], a[224:227], a[80:83], v[224:227]
s_waitcnt lgkmcnt(11)
ds_read_b128 a[180:183], v88 offset:400
v_mfma_f32_16x16x32_bf16 v[224:227], a[228:231], a[84:87], v[224:227]
s_waitcnt lgkmcnt(11)
v_cvt_pk_bf16_f32 v94, v220, v221
v_cvt_pk_bf16_f32 v95, v222, v223
v_mfma_f32_16x16x32_bf16 v[224:227], a[232:235], a[88:91], v[224:227]
s_waitcnt lgkmcnt(10)
ds_read_b128 a[184:187], v88 offset:464
v_mfma_f32_16x16x32_bf16 v[224:227], a[236:239], a[92:95], v[224:227]
v_mfma_f32_16x16x32_bf16 v[228:231], a[216:219], a[96:99], 0
ds_read_b128 a[188:191], v88 offset:528
ds_read_b128 a[216:219], v1 offset:24576
v_mfma_f32_16x16x32_bf16 v[228:231], a[220:223], a[100:103], v[228:231]
ds_read_b128 a[220:223], v1 offset:25600
v_mfma_f32_16x16x32_bf16 v[228:231], a[224:227], a[104:107], v[228:231]
ds_read_b128 a[224:227], v1 offset:26624
v_mfma_f32_16x16x32_bf16 v[228:231], a[228:231], a[108:111], v[228:231]
ds_read_b128 a[228:231], v1 offset:27648
v_cvt_pk_bf16_f32 v64, v224, v225
v_mfma_f32_16x16x32_bf16 v[228:231], a[232:235], a[112:115], v[228:231]
ds_read_b128 a[232:235], v1 offset:28672
v_cvt_pk_bf16_f32 v65, v226, v227
v_mfma_f32_16x16x32_bf16 v[228:231], a[236:239], a[116:119], v[228:231]
s_waitcnt lgkmcnt(15)
ds_read_b128 a[236:239], v1 offset:29696
v_mfma_f32_16x16x32_bf16 v[232:235], a[192:195], a[72:75], 0
v_mfma_f32_16x16x32_bf16 v[232:235], a[196:199], a[76:79], v[232:235]
s_waitcnt lgkmcnt(14)
v_mfma_f32_16x16x32_bf16 v[232:235], a[200:203], a[80:83], v[232:235]
s_waitcnt lgkmcnt(13)
v_mfma_f32_16x16x32_bf16 v[232:235], a[204:207], a[84:87], v[232:235]
s_waitcnt lgkmcnt(11)
v_mfma_f32_16x16x32_bf16 v[232:235], a[208:211], a[88:91], v[232:235]
s_waitcnt lgkmcnt(10)
v_mfma_f32_16x16x32_bf16 v[232:235], a[212:215], a[92:95], v[232:235]
v_mfma_f32_16x16x32_bf16 v[220:223], a[192:195], a[96:99], 0
ds_read_b128 a[192:195], v1 offset:30720
v_cvt_pk_bf16_f32 v100, v228, v229
v_mfma_f32_16x16x32_bf16 v[220:223], a[196:199], a[100:103], v[220:223]
ds_read_b128 a[196:199], v1 offset:31744
v_cvt_pk_bf16_f32 v101, v230, v231
v_mfma_f32_16x16x32_bf16 v[220:223], a[200:203], a[104:107], v[220:223]
ds_read_b128 a[200:203], v1 offset:32768
v_cvt_pk_bf16_f32 v66, v232, v233
v_mfma_f32_16x16x32_bf16 v[220:223], a[204:207], a[108:111], v[220:223]
ds_read_b128 a[204:207], v1 offset:33792
v_cvt_pk_bf16_f32 v67, v234, v235
v_mfma_f32_16x16x32_bf16 v[220:223], a[208:211], a[112:115], v[220:223]
ds_read_b128 a[208:211], v1 offset:34816
v_mfma_f32_16x16x32_bf16 v[220:223], a[212:215], a[116:119], v[220:223]
s_waitcnt lgkmcnt(10)
ds_read_b128 a[212:215], v1 offset:35840
v_mfma_f32_16x16x32_bf16 v[224:227], a[216:219], a[72:75], 0
s_waitcnt lgkmcnt(10)
v_mfma_f32_16x16x32_bf16 v[224:227], a[220:223], a[76:79], v[224:227]
s_waitcnt lgkmcnt(9)
v_mfma_f32_16x16x32_bf16 v[224:227], a[224:227], a[80:83], v[224:227]
s_waitcnt lgkmcnt(8)
v_mfma_f32_16x16x32_bf16 v[224:227], a[228:231], a[84:87], v[224:227]
s_waitcnt lgkmcnt(7)
v_mfma_f32_16x16x32_bf16 v[224:227], a[232:235], a[88:91], v[224:227]
s_waitcnt lgkmcnt(6)
v_mfma_f32_16x16x32_bf16 v[224:227], a[236:239], a[92:95], v[224:227]
v_mfma_f32_16x16x32_bf16 v[228:231], a[216:219], a[96:99], 0
ds_read_b128 a[216:219], v1 offset:36864
v_cvt_pk_bf16_f32 v102, v220, v221
v_mfma_f32_16x16x32_bf16 v[228:231], a[220:223], a[100:103], v[228:231]
ds_read_b128 a[220:223], v1 offset:37888
v_cvt_pk_bf16_f32 v103, v222, v223
v_mfma_f32_16x16x32_bf16 v[228:231], a[224:227], a[104:107], v[228:231]
ds_read_b128 a[224:227], v1 offset:38912
v_cvt_pk_bf16_f32 v68, v224, v225
v_mfma_f32_16x16x32_bf16 v[228:231], a[228:231], a[108:111], v[228:231]
ds_read_b128 a[228:231], v1 offset:39936
v_cvt_pk_bf16_f32 v69, v226, v227
v_mfma_f32_16x16x32_bf16 v[228:231], a[232:235], a[112:115], v[228:231]
ds_read_b128 a[232:235], v1 offset:40960
v_mfma_f32_16x16x32_bf16 v[228:231], a[236:239], a[116:119], v[228:231]
s_waitcnt lgkmcnt(10)
ds_read_b128 a[236:239], v1 offset:41984
v_mfma_f32_16x16x32_bf16 v[232:235], a[192:195], a[72:75], 0
s_waitcnt lgkmcnt(10)
v_bfe_u32 v76, v1, 4, 2
v_mfma_f32_16x16x32_bf16 v[232:235], a[196:199], a[76:79], v[232:235]
s_waitcnt lgkmcnt(9)
v_bfe_u32 v77, v1, 6, 2
v_mfma_f32_16x16x32_bf16 v[232:235], a[200:203], a[80:83], v[232:235]
s_waitcnt lgkmcnt(8)
v_mov_b32 v26, v24
v_mfma_f32_16x16x32_bf16 v[232:235], a[204:207], a[84:87], v[232:235]
s_waitcnt lgkmcnt(7)
v_lshrrev_b32 v78, 8, v1
v_cvt_pk_bf16_f32 v108, v228, v229
v_mfma_f32_16x16x32_bf16 v[232:235], a[208:211], a[88:91], v[232:235]
s_waitcnt lgkmcnt(6)
v_mov_b32 v22, 151040
v_mov_b32 v24, 0
v_mfma_f32_16x16x32_bf16 v[232:235], a[212:215], a[92:95], v[232:235]
v_cvt_pk_bf16_f32 v109, v230, v231
v_mfma_f32_16x16x32_bf16 v[220:223], a[192:195], a[96:99], 0
v_lshl_add_u32 v22, s38, 12, v22
v_mov_b32 v25, 0
v_mfma_f32_16x16x32_bf16 v[220:223], a[196:199], a[100:103], v[220:223]
v_min_u32 v79, 2, v78
v_mfma_f32_16x16x32_bf16 v[220:223], a[200:203], a[104:107], v[220:223]
ds_read_b128 a[192:195], v1 offset:43008
ds_read_b128 a[196:199], v1 offset:44032
v_mfma_f32_16x16x32_bf16 v[220:223], a[204:207], a[108:111], v[220:223]
v_lshlrev_b32 v79, 9, v79
v_cvt_pk_bf16_f32 v70, v232, v233
v_mfma_f32_16x16x32_bf16 v[220:223], a[208:211], a[112:115], v[220:223]
v_sub_u32 v20, v22, v79
v_cvt_pk_bf16_f32 v71, v234, v235
v_mfma_f32_16x16x32_bf16 v[220:223], a[212:215], a[116:119], v[220:223]
s_waitcnt lgkmcnt(7)
ds_read_b128 a[200:203], v1 offset:45056
ds_read_b128 a[204:207], v1 offset:46080
v_mfma_f32_16x16x32_bf16 v[224:227], a[216:219], a[72:75], 0
s_waitcnt lgkmcnt(8)
v_lshl_add_u32 v22, v78, 4, v22
v_mov_b32 v99, 0
v_mfma_f32_16x16x32_bf16 v[224:227], a[220:223], a[76:79], v[224:227]
s_waitcnt lgkmcnt(7)
v_lshl_add_u32 v20, v77, 3, v20
v_mov_b32 v107, 0
v_mfma_f32_16x16x32_bf16 v[224:227], a[224:227], a[80:83], v[224:227]
s_waitcnt lgkmcnt(6)
ds_read_b128 a[208:211], v1 offset:47104
ds_read_b128 a[212:215], v1 offset:48128
v_mfma_f32_16x16x32_bf16 v[224:227], a[228:231], a[84:87], v[224:227]
s_waitcnt lgkmcnt(7)
v_and_b32 v79, 1, v76
v_cvt_pk_bf16_f32 v110, v220, v221
v_mfma_f32_16x16x32_bf16 v[224:227], a[232:235], a[88:91], v[224:227]
s_waitcnt lgkmcnt(6)
v_lshl_add_u32 v20, v79, 1, v20
v_cvt_pk_bf16_f32 v111, v222, v223
v_mfma_f32_16x16x32_bf16 v[224:227], a[236:239], a[92:95], v[224:227]
v_mov_b32 v115, 0
v_mov_b32 v123, 0
v_mfma_f32_16x16x32_bf16 v[228:231], a[216:219], a[96:99], 0
v_lshl_add_u32 v22, v79, 6, v22
v_mov_b32 v131, 0
v_mfma_f32_16x16x32_bf16 v[228:231], a[220:223], a[100:103], v[228:231]
v_mul_u32_u24 v0, 0xaaaa, v79
v_mov_b32 v139, 0
v_mfma_f32_16x16x32_bf16 v[228:231], a[224:227], a[104:107], v[228:231]
ds_read_b128 a[216:219], v1 offset:49152
ds_read_b128 a[220:223], v1 offset:50176
v_mfma_f32_16x16x32_bf16 v[228:231], a[228:231], a[108:111], v[228:231]
ds_read_b128 a[224:227], v1 offset:51200
ds_read_b128 a[228:231], v1 offset:52224
v_mfma_f32_16x16x32_bf16 v[228:231], a[232:235], a[112:115], v[228:231]
v_lshrrev_b32 v79, 1, v76
v_cvt_pk_bf16_f32 v72, v224, v225
v_mfma_f32_16x16x32_bf16 v[228:231], a[236:239], a[116:119], v[228:231]
s_waitcnt lgkmcnt(9)
ds_read_b128 a[232:235], v1 offset:53248
ds_read_b128 a[236:239], v1 offset:54272
v_mfma_f32_16x16x32_bf16 v[232:235], a[192:195], a[72:75], 0
s_waitcnt lgkmcnt(10)
v_lshl_add_u32 v20, v79, 6, v20
v_cvt_pk_bf16_f32 v73, v226, v227
v_mfma_f32_16x16x32_bf16 v[232:235], a[196:199], a[76:79], v[232:235]
s_waitcnt lgkmcnt(9)
v_lshl_add_u32 v79, v79, 2, v77
v_add_u32 v0, 0x4444, v0
v_mfma_f32_16x16x32_bf16 v[232:235], a[200:203], a[80:83], v[232:235]
s_waitcnt lgkmcnt(8)
v_cvt_pk_bf16_f32 v116, v228, v229
v_cvt_pk_bf16_f32 v117, v230, v231
v_mfma_f32_16x16x32_bf16 v[232:235], a[204:207], a[84:87], v[232:235]
s_waitcnt lgkmcnt(7)
v_lshlrev_b32 v79, 7, v79
v_mfma_f32_16x16x32_bf16 v[232:235], a[208:211], a[88:91], v[232:235]
s_waitcnt lgkmcnt(6)
v_sub_u32 v22, v22, v79
v_mfma_f32_16x16x32_bf16 v[232:235], a[212:215], a[92:95], v[232:235]
v_mfma_f32_16x16x32_bf16 v[220:223], a[192:195], a[96:99], 0
ds_read_b128 a[192:195], v1 offset:55296
v_lshl_add_u32 v76, v77, 2, v76
v_mfma_f32_16x16x32_bf16 v[220:223], a[196:199], a[100:103], v[220:223]
ds_read_b128 a[196:199], v1 offset:56320
v_lshlrev_b32 v76, 3, v76
v_mfma_f32_16x16x32_bf16 v[220:223], a[200:203], a[104:107], v[220:223]
ds_read_b128 a[200:203], v1 offset:57344
v_cvt_pk_bf16_f32 v74, v232, v233
v_mfma_f32_16x16x32_bf16 v[220:223], a[204:207], a[108:111], v[220:223]
ds_read_b128 a[204:207], v1 offset:58368
v_cvt_pk_bf16_f32 v75, v234, v235
v_mfma_f32_16x16x32_bf16 v[220:223], a[208:211], a[112:115], v[220:223]
ds_read_b128 a[208:211], v1 offset:59392
v_lshl_add_u32 v76, v78, 1, v76
v_mfma_f32_16x16x32_bf16 v[220:223], a[212:215], a[116:119], v[220:223]
s_waitcnt lgkmcnt(10)
ds_read_b128 a[212:215], v1 offset:60416
v_add_u32 v17, 589824, v76
v_mfma_f32_16x16x32_bf16 v[224:227], a[216:219], a[72:75], 0
s_waitcnt lgkmcnt(10)
v_mfma_f32_16x16x32_bf16 v[224:227], a[220:223], a[76:79], v[224:227]
s_waitcnt lgkmcnt(9)
v_mfma_f32_16x16x32_bf16 v[224:227], a[224:227], a[80:83], v[224:227]
s_waitcnt lgkmcnt(8)
v_mfma_f32_16x16x32_bf16 v[224:227], a[228:231], a[84:87], v[224:227]
s_waitcnt lgkmcnt(7)
v_mfma_f32_16x16x32_bf16 v[224:227], a[232:235], a[88:91], v[224:227]
s_waitcnt lgkmcnt(6)
v_mfma_f32_16x16x32_bf16 v[224:227], a[236:239], a[92:95], v[224:227]
v_cvt_pk_bf16_f32 v118, v220, v221
v_cvt_pk_bf16_f32 v119, v222, v223
v_mfma_f32_16x16x32_bf16 v[228:231], a[216:219], a[96:99], 0
ds_read_b128 a[216:219], v1 offset:61440
v_mfma_f32_16x16x32_bf16 v[228:231], a[220:223], a[100:103], v[228:231]
ds_read_b128 a[220:223], v1 offset:62464
v_mfma_f32_16x16x32_bf16 v[228:231], a[224:227], a[104:107], v[228:231]
ds_read_b128 a[224:227], v1 offset:63488
v_cvt_pk_bf16_f32 v236, v224, v225
v_mfma_f32_16x16x32_bf16 v[228:231], a[228:231], a[108:111], v[228:231]
ds_read_b128 a[228:231], v1 offset:64512
v_cvt_pk_bf16_f32 v237, v226, v227
v_mfma_f32_16x16x32_bf16 v[228:231], a[232:235], a[112:115], v[228:231]
ds_read_b128 a[232:235], v2 offset:0
v_mfma_f32_16x16x32_bf16 v[228:231], a[236:239], a[116:119], v[228:231]
s_waitcnt lgkmcnt(10)
ds_read_b128 a[236:239], v2 offset:1024
v_mfma_f32_16x16x32_bf16 v[232:235], a[192:195], a[72:75], 0
s_waitcnt lgkmcnt(10)
v_mfma_f32_16x16x32_bf16 v[232:235], a[196:199], a[76:79], v[232:235]
s_waitcnt lgkmcnt(9)
v_mfma_f32_16x16x32_bf16 v[232:235], a[200:203], a[80:83], v[232:235]
s_waitcnt lgkmcnt(8)
v_mfma_f32_16x16x32_bf16 v[232:235], a[204:207], a[84:87], v[232:235]
s_waitcnt lgkmcnt(7)
v_mfma_f32_16x16x32_bf16 v[232:235], a[208:211], a[88:91], v[232:235]
s_waitcnt lgkmcnt(6)
v_mfma_f32_16x16x32_bf16 v[232:235], a[212:215], a[92:95], v[232:235]
v_mfma_f32_16x16x32_bf16 v[220:223], a[192:195], a[96:99], 0
ds_read_b128 a[192:195], v2 offset:2048
v_cvt_pk_bf16_f32 v124, v228, v229
v_mfma_f32_16x16x32_bf16 v[220:223], a[196:199], a[100:103], v[220:223]
ds_read_b128 a[196:199], v2 offset:3072
v_cvt_pk_bf16_f32 v125, v230, v231
v_mfma_f32_16x16x32_bf16 v[220:223], a[200:203], a[104:107], v[220:223]
ds_read_b128 a[200:203], v2 offset:4096
v_cvt_pk_bf16_f32 v238, v232, v233
v_mfma_f32_16x16x32_bf16 v[220:223], a[204:207], a[108:111], v[220:223]
ds_read_b128 a[204:207], v2 offset:5120
v_cvt_pk_bf16_f32 v239, v234, v235
v_mfma_f32_16x16x32_bf16 v[220:223], a[208:211], a[112:115], v[220:223]
ds_read_b128 a[208:211], v2 offset:6144
v_mfma_f32_16x16x32_bf16 v[220:223], a[212:215], a[116:119], v[220:223]
s_waitcnt lgkmcnt(10)
ds_read_b128 a[212:215], v2 offset:7168
v_mfma_f32_16x16x32_bf16 v[224:227], a[216:219], a[72:75], 0
s_waitcnt lgkmcnt(10)
v_mfma_f32_16x16x32_bf16 v[224:227], a[220:223], a[76:79], v[224:227]
s_waitcnt lgkmcnt(9)
v_mfma_f32_16x16x32_bf16 v[224:227], a[224:227], a[80:83], v[224:227]
s_waitcnt lgkmcnt(8)
v_mfma_f32_16x16x32_bf16 v[224:227], a[228:231], a[84:87], v[224:227]
s_waitcnt lgkmcnt(7)
v_mfma_f32_16x16x32_bf16 v[224:227], a[232:235], a[88:91], v[224:227]
s_waitcnt lgkmcnt(6)
v_mfma_f32_16x16x32_bf16 v[224:227], a[236:239], a[92:95], v[224:227]
v_mfma_f32_16x16x32_bf16 v[228:231], a[216:219], a[96:99], 0
ds_read_b128 a[216:219], v1 offset:0
v_cvt_pk_bf16_f32 v126, v220, v221
v_mfma_f32_16x16x32_bf16 v[228:231], a[220:223], a[100:103], v[228:231]
ds_read_b128 a[220:223], v1 offset:1024
v_cvt_pk_bf16_f32 v127, v222, v223
v_mfma_f32_16x16x32_bf16 v[228:231], a[224:227], a[104:107], v[228:231]
ds_read_b128 a[224:227], v1 offset:2048
v_cvt_pk_bf16_f32 v240, v224, v225
v_mfma_f32_16x16x32_bf16 v[228:231], a[228:231], a[108:111], v[228:231]
ds_read_b128 a[228:231], v1 offset:3072
v_cvt_pk_bf16_f32 v241, v226, v227
v_mfma_f32_16x16x32_bf16 v[228:231], a[232:235], a[112:115], v[228:231]
ds_read_b128 a[232:235], v1 offset:4096
v_mfma_f32_16x16x32_bf16 v[228:231], a[236:239], a[116:119], v[228:231]
s_waitcnt lgkmcnt(10)
ds_read_b128 a[236:239], v1 offset:5120
v_mfma_f32_16x16x32_bf16 v[232:235], a[192:195], a[72:75], 0
s_waitcnt vmcnt(4) lgkmcnt(10)
ds_read_b128 a[120:123], v252 offset:0
v_mfma_f32_16x16x32_bf16 v[232:235], a[196:199], a[76:79], v[232:235]
s_waitcnt lgkmcnt(10)
ds_read_b128 a[124:127], v253 offset:0
v_mfma_f32_16x16x32_bf16 v[232:235], a[200:203], a[80:83], v[232:235]
s_waitcnt vmcnt(2) lgkmcnt(10)
ds_read_b128 a[128:131], v252 offset:2048
v_mfma_f32_16x16x32_bf16 v[232:235], a[204:207], a[84:87], v[232:235]
s_waitcnt lgkmcnt(10)
ds_read_b128 a[132:135], v253 offset:2048
v_cvt_pk_bf16_f32 v132, v228, v229
v_mfma_f32_16x16x32_bf16 v[232:235], a[208:211], a[88:91], v[232:235]
s_waitcnt vmcnt(0) lgkmcnt(10)
ds_read_b128 a[136:139], v252 offset:4096
v_cvt_pk_bf16_f32 v133, v230, v231
v_mfma_f32_16x16x32_bf16 v[232:235], a[212:215], a[92:95], v[232:235]
s_mov_b32 m0, s96
ds_read_b128 a[140:143], v253 offset:4096
v_mfma_f32_16x16x32_bf16 v[220:223], a[192:195], a[96:99], 0
buffer_load_dwordx4 v1, s[16:19], m0 offen lds
ds_read_b128 a[192:195], v1 offset:6144
v_mfma_f32_16x16x32_bf16 v[220:223], a[196:199], a[100:103], v[220:223]
ds_read_b128 a[196:199], v1 offset:7168
v_mfma_f32_16x16x32_bf16 v[220:223], a[200:203], a[104:107], v[220:223]
ds_read_b128 a[200:203], v1 offset:8192
v_cvt_pk_bf16_f32 v242, v232, v233
v_mfma_f32_16x16x32_bf16 v[220:223], a[204:207], a[108:111], v[220:223]
s_mov_b32 m0, s97
ds_read_b128 a[204:207], v1 offset:9216
v_cvt_pk_bf16_f32 v243, v234, v235
v_mfma_f32_16x16x32_bf16 v[220:223], a[208:211], a[112:115], v[220:223]
buffer_load_dwordx4 v1, s[16:19], m0 offen lds
ds_read_b128 a[208:211], v1 offset:10240
v_mfma_f32_16x16x32_bf16 v[220:223], a[212:215], a[116:119], v[220:223]
s_waitcnt lgkmcnt(10)
ds_read_b128 a[212:215], v1 offset:11264
v_mfma_f32_16x16x32_bf16 v[224:227], a[216:219], a[120:123], 0
s_waitcnt lgkmcnt(10)
ds_read_b128 a[216:219], v1 offset:12288
v_mfma_f32_16x16x32_bf16 v[224:227], a[220:223], a[124:127], v[224:227]
s_waitcnt lgkmcnt(10)
s_xor_b32 s11, s10, 0
s_add_u32 m0, s11, 73728
ds_read_b128 a[220:223], v1 offset:13312
v_mfma_f32_16x16x32_bf16 v[224:227], a[224:227], a[128:131], v[224:227]
s_waitcnt lgkmcnt(8)
s_barrier
buffer_load_dwordx4 v1, s[16:19], m0 offen lds
v_mfma_f32_16x16x32_bf16 v[224:227], a[228:231], a[132:135], v[224:227]
ds_read_b128 a[224:227], v1 offset:14336
ds_read_b128 a[228:231], v1 offset:15360
v_mfma_f32_16x16x32_bf16 v[224:227], a[232:235], a[136:139], v[224:227]
ds_read_b128 a[232:235], v1 offset:16384
v_cvt_pk_bf16_f32 v134, v220, v221
v_mfma_f32_16x16x32_bf16 v[224:227], a[236:239], a[140:143], v[224:227]
s_waitcnt lgkmcnt(10)
s_xor_b32 s11, s10, 4096
s_add_u32 m0, s11, 73728
ds_read_b128 a[236:239], v1 offset:17408
v_mfma_f32_16x16x32_bf16 v[228:231], a[192:195], a[120:123], 0
buffer_load_dwordx4 v1, s[16:19], m0 offen lds
s_waitcnt lgkmcnt(10)
ds_read_b128 a[192:195], v1 offset:18432
v_mfma_f32_16x16x32_bf16 v[228:231], a[196:199], a[124:127], v[228:231]
s_waitcnt lgkmcnt(10)
ds_read_b128 a[196:199], v1 offset:19456
v_cvt_pk_bf16_f32 v135, v222, v223
v_mfma_f32_16x16x32_bf16 v[228:231], a[200:203], a[128:131], v[228:231]
s_waitcnt lgkmcnt(10)
ds_read_b128 a[200:203], v1 offset:20480
v_cvt_pk_bf16_f32 v140, v224, v225
v_mfma_f32_16x16x32_bf16 v[228:231], a[204:207], a[132:135], v[228:231]
s_waitcnt lgkmcnt(10)
s_xor_b32 s11, s10, 8192
s_add_u32 m0, s11, 73728
ds_read_b128 a[204:207], v1 offset:21504
v_mfma_f32_16x16x32_bf16 v[228:231], a[208:211], a[136:139], v[228:231]
buffer_load_dwordx4 v1, s[16:19], m0 offen lds
s_waitcnt lgkmcnt(10)
ds_read_b128 a[208:211], v1 offset:22528
v_mfma_f32_16x16x32_bf16 v[228:231], a[212:215], a[140:143], v[228:231]
s_waitcnt lgkmcnt(10)
ds_read_b128 a[212:215], v1 offset:23552
v_cvt_pk_bf16_f32 v141, v226, v227
v_mfma_f32_16x16x32_bf16 v[232:235], a[216:219], a[120:123], 0
s_waitcnt lgkmcnt(10)
ds_read_b128 a[216:219], v1 offset:24576
v_mfma_f32_16x16x32_bf16 v[232:235], a[220:223], a[124:127], v[232:235]
s_waitcnt lgkmcnt(10)
s_xor_b32 s11, s10, 12288
s_add_u32 m0, s11, 73728
ds_read_b128 a[220:223], v1 offset:25600
v_mfma_f32_16x16x32_bf16 v[232:235], a[224:227], a[128:131], v[232:235]
buffer_load_dwordx4 v1, s[16:19], m0 offen lds
s_waitcnt lgkmcnt(10)
ds_read_b128 a[224:227], v1 offset:26624
v_mfma_f32_16x16x32_bf16 v[232:235], a[228:231], a[132:135], v[232:235]
s_waitcnt lgkmcnt(10)
ds_read_b128 a[228:231], v1 offset:27648
v_cvt_pk_bf16_f32 v142, v228, v229
v_mfma_f32_16x16x32_bf16 v[232:235], a[232:235], a[136:139], v[232:235]
s_waitcnt lgkmcnt(10)
ds_read_b128 a[232:235], v1 offset:28672
v_cvt_pk_bf16_f32 v143, v230, v231
v_mfma_f32_16x16x32_bf16 v[232:235], a[236:239], a[140:143], v[232:235]
s_waitcnt lgkmcnt(10)
s_xor_b32 s11, s10, 16384
s_add_u32 m0, s11, 73728
ds_read_b128 a[236:239], v1 offset:29696
v_mfma_f32_16x16x32_bf16 v[220:223], a[192:195], a[120:123], 0
buffer_load_dwordx4 v1, s[16:19], m0 offen lds
s_waitcnt lgkmcnt(10)
ds_read_b128 a[192:195], v1 offset:30720
v_mfma_f32_16x16x32_bf16 v[220:223], a[196:199], a[124:127], v[220:223]
s_waitcnt lgkmcnt(10)
ds_read_b128 a[196:199], v1 offset:31744
v_cvt_pk_bf16_f32 v144, v232, v233
v_mfma_f32_16x16x32_bf16 v[220:223], a[200:203], a[128:131], v[220:223]
s_waitcnt lgkmcnt(10)
ds_read_b128 a[200:203], v1 offset:32768
v_cvt_pk_bf16_f32 v145, v234, v235
v_mfma_f32_16x16x32_bf16 v[220:223], a[204:207], a[132:135], v[220:223]
s_waitcnt lgkmcnt(10)
s_xor_b32 s11, s10, 20480
s_add_u32 m0, s11, 73728
ds_read_b128 a[204:207], v1 offset:33792
v_mfma_f32_16x16x32_bf16 v[220:223], a[208:211], a[136:139], v[220:223]
buffer_load_dwordx4 v1, s[16:19], m0 offen lds
s_waitcnt lgkmcnt(10)
ds_read_b128 a[208:211], v1 offset:34816
v_mfma_f32_16x16x32_bf16 v[220:223], a[212:215], a[140:143], v[220:223]
s_waitcnt lgkmcnt(10)
ds_read_b128 a[212:215], v1 offset:35840
v_mfma_f32_16x16x32_bf16 v[224:227], a[216:219], a[120:123], 0
s_waitcnt lgkmcnt(10)
ds_read_b128 a[216:219], v1 offset:36864
s_nop 0
v_mfma_f32_16x16x32_bf16 v[224:227], a[220:223], a[124:127], v[224:227]
s_waitcnt lgkmcnt(10)
s_xor_b32 s11, s10, 24576
s_add_u32 m0, s11, 73728
v_cvt_pk_bf16_f32 v146, v220, v221
v_mfma_f32_16x16x32_bf16 v[224:227], a[224:227], a[128:131], v[224:227]
buffer_load_dwordx4 v1, s[16:19], m0 offen lds
s_waitcnt lgkmcnt(9)
ds_read_b128 a[220:223], v1 offset:37888
v_mfma_f32_16x16x32_bf16 v[224:227], a[228:231], a[132:135], v[224:227]
s_waitcnt lgkmcnt(9)
ds_read_b128 a[224:227], v1 offset:38912
ds_read_b128 a[228:231], v1 offset:39936
v_mfma_f32_16x16x32_bf16 v[224:227], a[232:235], a[136:139], v[224:227]
s_waitcnt lgkmcnt(10)
ds_read_b128 a[232:235], v1 offset:40960
v_cvt_pk_bf16_f32 v147, v222, v223
v_mfma_f32_16x16x32_bf16 v[224:227], a[236:239], a[140:143], v[224:227]
s_waitcnt lgkmcnt(10)
s_xor_b32 s11, s10, 28672
s_add_u32 m0, s11, 73728
ds_read_b128 a[236:239], v1 offset:41984
v_mfma_f32_16x16x32_bf16 v[228:231], a[192:195], a[120:123], 0
buffer_load_dwordx4 v1, s[16:19], m0 offen lds
s_waitcnt lgkmcnt(10)
ds_read_b128 a[192:195], v1 offset:43008
v_mfma_f32_16x16x32_bf16 v[228:231], a[196:199], a[124:127], v[228:231]
s_waitcnt lgkmcnt(10)
ds_read_b128 a[196:199], v1 offset:44032
v_cvt_pk_bf16_f32 v148, v224, v225
v_mfma_f32_16x16x32_bf16 v[228:231], a[200:203], a[128:131], v[228:231]
s_waitcnt lgkmcnt(10)
ds_read_b128 a[200:203], v1 offset:45056
v_cvt_pk_bf16_f32 v149, v226, v227
v_mfma_f32_16x16x32_bf16 v[228:231], a[204:207], a[132:135], v[228:231]
s_waitcnt lgkmcnt(10)
s_xor_b32 s11, s10, 32768
s_add_u32 m0, s11, 73728
ds_read_b128 a[204:207], v1 offset:46080
v_mfma_f32_16x16x32_bf16 v[228:231], a[208:211], a[136:139], v[228:231]
buffer_load_dwordx4 v1, s[16:19], m0 offen lds
s_waitcnt lgkmcnt(10)
ds_read_b128 a[208:211], v1 offset:47104
v_mfma_f32_16x16x32_bf16 v[228:231], a[212:215], a[140:143], v[228:231]
s_waitcnt lgkmcnt(10)
ds_read_b128 a[212:215], v1 offset:48128
v_mfma_f32_16x16x32_bf16 v[232:235], a[216:219], a[120:123], 0
s_waitcnt lgkmcnt(10)
ds_read_b128 a[216:219], v1 offset:49152
v_mfma_f32_16x16x32_bf16 v[232:235], a[220:223], a[124:127], v[232:235]
s_waitcnt lgkmcnt(10)
s_xor_b32 s11, s10, 36864
s_add_u32 m0, s11, 73728
ds_read_b128 a[220:223], v1 offset:50176
v_mfma_f32_16x16x32_bf16 v[232:235], a[224:227], a[128:131], v[232:235]
buffer_load_dwordx4 v1, s[16:19], m0 offen lds
s_waitcnt lgkmcnt(10)
ds_read_b128 a[224:227], v1 offset:51200
v_mfma_f32_16x16x32_bf16 v[232:235], a[228:231], a[132:135], v[232:235]
s_waitcnt lgkmcnt(10)
ds_read_b128 a[228:231], v1 offset:52224
v_cvt_pk_bf16_f32 v150, v228, v229
v_mfma_f32_16x16x32_bf16 v[232:235], a[232:235], a[136:139], v[232:235]
LW_p3:
s_cbranch_execz LW_p20
s_waitcnt lgkmcnt(10)
ds_read_b128 a[232:235], v1 offset:53248
v_cvt_pk_bf16_f32 v151, v230, v231
v_mfma_f32_16x16x32_bf16 v[232:235], a[236:239], a[140:143], v[232:235]
s_waitcnt lgkmcnt(10)
s_xor_b32 s11, s10, 40960
s_add_u32 m0, s11, 73728
ds_read_b128 a[236:239], v1 offset:54272
v_mfma_f32_16x16x32_bf16 v[220:223], a[192:195], a[120:123], 0
buffer_load_dwordx4 v1, s[16:19], m0 offen lds
s_waitcnt lgkmcnt(10)
ds_read_b128 a[192:195], v1 offset:55296
v_mfma_f32_16x16x32_bf16 v[220:223], a[196:199], a[124:127], v[220:223]
s_waitcnt lgkmcnt(10)
ds_read_b128 a[196:199], v1 offset:56320
v_cvt_pk_bf16_f32 v152, v232, v233
v_mfma_f32_16x16x32_bf16 v[220:223], a[200:203], a[128:131], v[220:223]
s_waitcnt lgkmcnt(10)
ds_read_b128 a[200:203], v1 offset:57344
v_cvt_pk_bf16_f32 v153, v234, v235
v_mfma_f32_16x16x32_bf16 v[220:223], a[204:207], a[132:135], v[220:223]
s_waitcnt lgkmcnt(10)
s_xor_b32 s11, s10, 45056
s_add_u32 m0, s11, 73728
ds_read_b128 a[204:207], v1 offset:58368
v_mfma_f32_16x16x32_bf16 v[220:223], a[208:211], a[136:139], v[220:223]
buffer_load_dwordx4 v1, s[16:19], m0 offen lds
s_waitcnt lgkmcnt(10)
ds_read_b128 a[208:211], v1 offset:59392
v_mfma_f32_16x16x32_bf16 v[220:223], a[212:215], a[140:143], v[220:223]
s_waitcnt lgkmcnt(10)
ds_read_b128 a[212:215], v1 offset:60416
v_mfma_f32_16x16x32_bf16 v[224:227], a[216:219], a[120:123], 0
s_waitcnt lgkmcnt(10)
ds_read_b128 a[216:219], v1 offset:61440
s_nop 0
v_mfma_f32_16x16x32_bf16 v[224:227], a[220:223], a[124:127], v[224:227]
s_waitcnt lgkmcnt(10)
s_xor_b32 s11, s10, 49152
s_add_u32 m0, s11, 73728
v_cvt_pk_bf16_f32 v154, v220, v221
v_mfma_f32_16x16x32_bf16 v[224:227], a[224:227], a[128:131], v[224:227]
buffer_load_dwordx4 v1, s[16:19], m0 offen lds
s_waitcnt lgkmcnt(9)
ds_read_b128 a[220:223], v1 offset:62464
v_mfma_f32_16x16x32_bf16 v[224:227], a[228:231], a[132:135], v[224:227]
s_waitcnt lgkmcnt(9)
ds_read_b128 a[224:227], v1 offset:63488
ds_read_b128 a[228:231], v1 offset:64512
v_mfma_f32_16x16x32_bf16 v[224:227], a[232:235], a[136:139], v[224:227]
s_waitcnt lgkmcnt(10)
ds_read_b128 a[232:235], v2 offset:0
v_cvt_pk_bf16_f32 v155, v222, v223
v_mfma_f32_16x16x32_bf16 v[224:227], a[236:239], a[140:143], v[224:227]
s_waitcnt lgkmcnt(10)
s_xor_b32 s11, s10, 53248
s_add_u32 m0, s11, 73728
ds_read_b128 a[236:239], v2 offset:1024
v_mfma_f32_16x16x32_bf16 v[228:231], a[192:195], a[120:123], 0
buffer_load_dwordx4 v1, s[16:19], m0 offen lds
s_waitcnt lgkmcnt(10)
ds_read_b128 a[192:195], v2 offset:2048
v_mfma_f32_16x16x32_bf16 v[228:231], a[196:199], a[124:127], v[228:231]
s_waitcnt lgkmcnt(10)
ds_read_b128 a[196:199], v2 offset:3072
v_cvt_pk_bf16_f32 v156, v224, v225
v_mfma_f32_16x16x32_bf16 v[228:231], a[200:203], a[128:131], v[228:231]
s_waitcnt lgkmcnt(10)
ds_read_b128 a[200:203], v2 offset:4096
v_cvt_pk_bf16_f32 v157, v226, v227
v_mfma_f32_16x16x32_bf16 v[228:231], a[204:207], a[132:135], v[228:231]
s_waitcnt lgkmcnt(10)
s_xor_b32 s11, s10, 57344
s_add_u32 m0, s11, 73728
ds_read_b128 a[204:207], v2 offset:5120
v_mfma_f32_16x16x32_bf16 v[228:231], a[208:211], a[136:139], v[228:231]
buffer_load_dwordx4 v1, s[16:19], m0 offen lds
s_waitcnt lgkmcnt(10)
ds_read_b128 a[208:211], v2 offset:6144
v_mfma_f32_16x16x32_bf16 v[228:231], a[212:215], a[140:143], v[228:231]
s_waitcnt lgkmcnt(10)
ds_read_b128 a[212:215], v2 offset:7168
v_mfma_f32_16x16x32_bf16 v[232:235], a[216:219], a[120:123], 0
s_waitcnt lgkmcnt(10)
v_mov_b64 v[188:189], 0
v_mfma_f32_16x16x32_bf16 v[232:235], a[220:223], a[124:127], v[232:235]
s_waitcnt lgkmcnt(9)
s_xor_b32 s11, s10, 61440
s_add_u32 m0, s11, 73728
v_mfma_f32_16x16x32_bf16 v[232:235], a[224:227], a[128:131], v[232:235]
buffer_load_dwordx4 v1, s[16:19], m0 offen lds
s_waitcnt lgkmcnt(8)
v_cvt_pk_bf16_f32 v158, v228, v229
v_mfma_f32_16x16x32_bf16 v[232:235], a[228:231], a[132:135], v[232:235]
s_waitcnt lgkmcnt(7)
v_mov_b64 v[192:193], 0
v_mfma_f32_16x16x32_bf16 v[232:235], a[232:235], a[136:139], v[232:235]
s_waitcnt lgkmcnt(6)
v_mov_b64 v[196:197], 0
v_mfma_f32_16x16x32_bf16 v[232:235], a[236:239], a[140:143], v[232:235]
s_waitcnt lgkmcnt(5)
v_mov_b64 v[76:77], 0
v_mfma_f32_16x16x32_bf16 v[220:223], a[192:195], a[120:123], 0
s_waitcnt lgkmcnt(4)
v_mov_b64 v[78:79], v[26:27]
v_mfma_f32_16x16x32_bf16 v[220:223], a[196:199], a[124:127], v[220:223]
s_waitcnt lgkmcnt(3)
v_mov_b64 v[80:81], 0
v_mfma_f32_16x16x32_bf16 v[220:223], a[200:203], a[128:131], v[220:223]
s_waitcnt lgkmcnt(2)
v_mov_b64 v[82:83], v[26:27]
v_mfma_f32_16x16x32_bf16 v[220:223], a[204:207], a[132:135], v[220:223]
s_waitcnt lgkmcnt(1)
v_mov_b64 v[84:85], 0
v_mfma_f32_16x16x32_bf16 v[220:223], a[208:211], a[136:139], v[220:223]
s_waitcnt lgkmcnt(0)
v_mov_b64 v[86:87], v[26:27]
v_mfma_f32_16x16x32_bf16 v[220:223], a[212:215], a[140:143], v[220:223]
v_cvt_pk_bf16_f32 v159, v230, v231
v_cvt_pk_bf16_f32 v160, v232, v233
v_smfmac_f32_16x16x64_bf16 v[188:191], a[168:171], v[180:187], v0
s_nop 0
s_nop 0
v_cvt_pk_bf16_f32 v161, v234, v235
v_smfmac_f32_16x16x64_bf16 v[188:191], a[172:175], v[164:171], v0
s_nop 0
v_cvt_pk_bf16_f32 v162, v220, v221
v_smfmac_f32_16x16x64_bf16 v[188:191], a[176:179], v[172:179], v0
v_bfe_u32 v250, v1, 2, 6
v_smfmac_f32_16x16x64_bf16 v[192:195], a[168:171], a[144:151], v0
s_nop 0
s_nop 0
v_lshrrev_b32 v251, 8, v1
v_smfmac_f32_16x16x64_bf16 v[192:195], a[172:175], a[152:159], v0
s_mul_i32 s7, s38, 576
s_nop 0
v_add_f32 v188, v188, v189
v_smfmac_f32_16x16x64_bf16 v[192:195], a[176:179], a[160:167], v0
s_add_u32 s7, s7, 147456
v_cvt_pk_bf16_f32 v163, v222, v223
v_smfmac_f32_16x16x64_bf16 v[196:199], a[180:183], v[180:187], v0
s_nop 0
s_nop 0
v_lshl_add_u32 v252, v251, 12, v250
v_smfmac_f32_16x16x64_bf16 v[196:199], a[184:187], v[164:171], v0
s_nop 0
v_add_f32 v192, v192, v193
v_smfmac_f32_16x16x64_bf16 v[196:199], a[188:191], v[172:179], v0
v_cndmask_b32 v188, v188, v192, s[4:5]
v_smfmac_f32_16x16x64_bf16 v[76:79], a[168:171], a[72:79], v0
s_nop 0
s_nop 0
ds_bpermute_b32 v189, v89, v188 offset:0
v_smfmac_f32_16x16x64_bf16 v[76:79], a[172:175], a[80:87], v0
s_nop 0
s_nop 0
v_add_u32 v252, s7, v252
v_smfmac_f32_16x16x64_bf16 v[76:79], a[176:179], a[88:95], v0
s_lshl_b32 s7, s38, 12
s_add_u32 s7, s7, 147456
v_min_u32 v251, 2, v251
v_smfmac_f32_16x16x64_bf16 v[80:83], a[168:171], a[96:103], v0
s_add_u32 s26, s26, 1
s_add_u32 s33, s33, 1024
v_lshl_add_u32 v253, v251, 6, v250
v_smfmac_f32_16x16x64_bf16 v[80:83], a[172:175], a[104:111], v0
s_cmp_eq_u32 s26, 4
s_cselect_b32 s33, s87, s33
v_add_u32 v253, s7, v253
v_smfmac_f32_16x16x64_bf16 v[80:83], a[176:179], a[112:119], v0
s_mov_b32 s7, 0x10000100
s_mul_hi_u32 s34, s33, 58835169
v_add_f32 v76, v76, v77
v_smfmac_f32_16x16x64_bf16 v[84:87], a[168:171], a[120:127], v0
s_mul_i32 s35, s34, 73
s_sub_u32 s35, s33, s35
v_add_f32 v196, v196, v197
v_smfmac_f32_16x16x64_bf16 v[84:87], a[172:175], a[128:135], v0
s_mul_i32 s34, s34, 1373568
s_mul_i32 s35, s35, 2688
v_add_f32 v80, v80, v81
v_smfmac_f32_16x16x64_bf16 v[84:87], a[176:179], a[136:143], v0
ds_bpermute_b32 v197, v89, v196 offset:4
v_mfma_f32_16x16x32_bf16 v[28:31], a[72:75], v[60:63], 0
s_nop 0
ds_write_b64 v22, v[24:25] offset:384
v_mfma_f32_16x16x32_bf16 v[28:31], a[76:79], v[64:67], v[28:31]
s_waitcnt lgkmcnt(2)
v_cndmask_b32 v18, v21, v189, s[6:7]
v_max3_f32 v88, v18, v76, v80
v_mfma_f32_16x16x32_bf16 v[28:31], a[80:83], v[68:71], v[28:31]
s_mov_b32 s6, 0x200002
v_add_f32 v84, v84, v85
v_max_f32 v88, v88, v84
v_mfma_f32_16x16x32_bf16 v[28:31], a[84:87], v[72:75], v[28:31]
s_mov_b32 s7, 0x20000200
v_max_f32_dpp v88, v88, v88 row_ror:8 row_mask:0xf bank_mask:0xf
ds_write_b64 v22, v[24:25] offset:392
v_mfma_f32_16x16x32_bf16 v[28:31], a[88:91], v[236:239], v[28:31]
buffer_load_dwordx4 a[0:3], v8, s[20:23], s32 offen offset:0 nt
v_max_f32_dpp v88, v88, v88 row_ror:4 row_mask:0xf bank_mask:0xf
v_mfma_f32_16x16x32_bf16 v[28:31], a[92:95], v[240:243], v[28:31]
buffer_load_dwordx4 a[4:7], v9, s[20:23], s32 offen offset:0 nt
v_max_f32_dpp v88, v88, v88 row_ror:2 row_mask:0xf bank_mask:0xf
v_mfma_f32_16x16x32_bf16 v[32:35], a[96:99], v[60:63], 0
buffer_load_dwordx4 a[24:27], v10, s[20:23], s32 offen offset:0 nt
v_max_f32_dpp v88, v88, v88 row_ror:1 row_mask:0xf bank_mask:0xf
v_mfma_f32_16x16x32_bf16 v[32:35], a[100:103], v[64:67], v[32:35]
v_sub_f32 v89, v18, v88
v_sub_f32 v76, v76, v88
v_mfma_f32_16x16x32_bf16 v[32:35], a[104:107], v[68:71], v[32:35]
v_sub_f32 v80, v80, v88
v_sub_f32 v84, v84, v88
v_mfma_f32_16x16x32_bf16 v[32:35], a[108:111], v[72:75], v[32:35]
v_exp_f32 v76, v76
v_mfma_f32_16x16x32_bf16 v[32:35], a[112:115], v[236:239], v[32:35]
v_exp_f32 v80, v80
v_mfma_f32_16x16x32_bf16 v[32:35], a[116:119], v[240:243], v[32:35]
v_exp_f32 v84, v84
v_mfma_f32_16x16x32_bf16 v[36:39], a[120:123], v[60:63], 0
v_exp_f32 v89, v89
v_mfma_f32_16x16x32_bf16 v[36:39], a[124:127], v[64:67], v[36:39]
v_add_f32 v88, v76, v80
v_add_f32 v90, v84, v89
v_mfma_f32_16x16x32_bf16 v[36:39], a[128:131], v[68:71], v[36:39]
buffer_load_dwordx4 a[28:31], v11, s[20:23], s32 offen offset:0 nt
v_add_f32 v88, v88, v90
v_mfma_f32_16x16x32_bf16 v[36:39], a[132:135], v[72:75], v[36:39]
s_waitcnt vmcnt(4)
s_barrier
v_add_f32_dpp v88, v88, v88 row_ror:8 row_mask:0xf bank_mask:0xf
v_max3_f32 v42, v28, v29, v30
v_mfma_f32_16x16x32_bf16 v[36:39], a[136:139], v[236:239], v[36:39]
v_add_f32_dpp v88, v88, v88 row_ror:4 row_mask:0xf bank_mask:0xf
v_max3_f32 v42, v42, v31, v32
v_mfma_f32_16x16x32_bf16 v[36:39], a[140:143], v[240:243], v[36:39]
v_add_f32_dpp v88, v88, v88 row_ror:2 row_mask:0xf bank_mask:0xf
v_max3_f32 v42, v42, v33, v34
v_mfma_f32_16x16x32_bf16 v[44:47], a[72:75], v[92:95], 0
buffer_load_dwordx4 a[48:51], v12, s[20:23], s32 offen offset:0 nt
v_add_f32_dpp v88, v88, v88 row_ror:1 row_mask:0xf bank_mask:0xf
v_mfma_f32_16x16x32_bf16 v[44:47], a[76:79], v[100:103], v[44:47]
v_rcp_f32 v88, v88
v_mfma_f32_16x16x32_bf16 v[44:47], a[80:83], v[108:111], v[44:47]
v_mul_f32 v76, v76, v88
v_mul_f32 v80, v80, v88
v_mfma_f32_16x16x32_bf16 v[44:47], a[84:87], v[116:119], v[44:47]
v_mul_f32 v84, v84, v88
v_mul_f32 v89, v89, v88
v_mfma_f32_16x16x32_bf16 v[44:47], a[88:91], v[124:127], v[44:47]
v_cvt_pk_bf16_f32 v90, v76, v80
v_cvt_pk_bf16_f32 v91, v84, v89
v_mfma_f32_16x16x32_bf16 v[44:47], a[92:95], v[132:135], v[44:47]
ds_write_b16 v20, v90 offset:0
v_mfma_f32_16x16x32_bf16 v[48:51], a[96:99], v[92:95], 0
ds_write_b16_d16_hi v20, v90 offset:4
v_mfma_f32_16x16x32_bf16 v[48:51], a[100:103], v[100:103], v[48:51]
ds_write_b16 v20, v91 offset:32
v_mfma_f32_16x16x32_bf16 v[48:51], a[104:107], v[108:111], v[48:51]
buffer_load_dwordx4 a[52:55], v13, s[20:23], s32 offen offset:0 nt
ds_write_b16_d16_hi v20, v91 offset:36
v_mfma_f32_16x16x32_bf16 v[48:51], a[108:111], v[116:119], v[48:51]
ds_read_b128 a[216:219], v254 offset:0
ds_read_b128 a[220:223], v254 offset:1024
v_mfma_f32_16x16x32_bf16 v[48:51], a[112:115], v[124:127], v[48:51]
ds_read_b128 a[224:227], v254 offset:2048
ds_read_b128 a[228:231], v254 offset:3072
v_mfma_f32_16x16x32_bf16 v[48:51], a[116:119], v[132:135], v[48:51]
ds_read_b128 a[232:235], v254 offset:4096
ds_read_b128 a[236:239], v254 offset:5120
v_mfma_f32_16x16x32_bf16 v[52:55], a[120:123], v[92:95], 0
ds_read_b128 a[192:195], v254 offset:6144
ds_read_b128 a[196:199], v254 offset:7168
v_mfma_f32_16x16x32_bf16 v[52:55], a[124:127], v[100:103], v[52:55]
ds_read_b128 a[200:203], v254 offset:8192
ds_read_b128 a[204:207], v254 offset:9216
v_mfma_f32_16x16x32_bf16 v[52:55], a[128:131], v[108:111], v[52:55]
ds_read_b128 a[208:211], v254 offset:10240
ds_read_b128 a[212:215], v254 offset:11264
v_mfma_f32_16x16x32_bf16 v[52:55], a[132:135], v[116:119], v[52:55]
v_max3_f32 v42, v42, v35, v36
v_add_f32 v78, v78, v79
v_mfma_f32_16x16x32_bf16 v[52:55], a[136:139], v[124:127], v[52:55]
buffer_load_dwordx4 a[8:11], v8, s[20:23], s32 offen offset:128 nt
v_max3_f32 v42, v42, v37, v38
v_mfma_f32_16x16x32_bf16 v[52:55], a[140:143], v[132:135], v[52:55]
v_max3_f32 v42, v42, v39, v78
v_mov_b32 v43, v42
v_mfma_f32_16x16x32_bf16 v[60:63], a[72:75], v[140:143], 0
ds_read_b128 a[240:243], v22 offset:0
v_max3_f32 v58, v44, v45, v46
v_mfma_f32_16x16x32_bf16 v[60:63], a[76:79], v[144:147], v[60:63]
v_permlane32_swap_b32 v42, v43
v_mfma_f32_16x16x32_bf16 v[60:63], a[80:83], v[148:151], v[60:63]
v_max_f32 v42, v42, v43
v_mov_b32 v43, v42
v_mfma_f32_16x16x32_bf16 v[60:63], a[84:87], v[152:155], v[60:63]
v_max3_f32 v58, v58, v47, v48
v_max3_f32 v58, v58, v49, v50
v_mfma_f32_16x16x32_bf16 v[60:63], a[88:91], v[156:159], v[60:63]
v_permlane16_swap_b32 v42, v43
v_mfma_f32_16x16x32_bf16 v[60:63], a[92:95], v[160:163], v[60:63]
v_max_f32 v42, v42, v43
v_sub_f32 v28, v28, v42
v_mfma_f32_16x16x32_bf16 v[64:67], a[96:99], v[140:143], 0
buffer_load_dwordx4 a[12:15], v9, s[20:23], s32 offen offset:128 nt
v_sub_f32 v29, v29, v42
v_mfma_f32_16x16x32_bf16 v[64:67], a[100:103], v[144:147], v[64:67]
v_sub_f32 v30, v30, v42
v_sub_f32 v31, v31, v42
v_mfma_f32_16x16x32_bf16 v[64:67], a[104:107], v[148:151], v[64:67]
v_exp_f32 v28, v28
v_mfma_f32_16x16x32_bf16 v[64:67], a[108:111], v[152:155], v[64:67]
v_exp_f32 v29, v29
v_mfma_f32_16x16x32_bf16 v[64:67], a[112:115], v[156:159], v[64:67]
v_sub_f32 v32, v32, v42
v_sub_f32 v33, v33, v42
v_mfma_f32_16x16x32_bf16 v[64:67], a[116:119], v[160:163], v[64:67]
v_sub_f32 v34, v34, v42
v_sub_f32 v35, v35, v42
v_mfma_f32_16x16x32_bf16 v[68:71], a[120:123], v[140:143], 0
v_sub_f32 v36, v36, v42
v_sub_f32 v37, v37, v42
v_mfma_f32_16x16x32_bf16 v[68:71], a[124:127], v[144:147], v[68:71]
v_sub_f32 v38, v38, v42
v_sub_f32 v39, v39, v42
v_mfma_f32_16x16x32_bf16 v[68:71], a[128:131], v[148:151], v[68:71]
buffer_load_dwordx4 a[32:35], v10, s[20:23], s32 offen offset:128 nt
v_sub_f32 v78, v78, v42
v_mfma_f32_16x16x32_bf16 v[68:71], a[132:135], v[152:155], v[68:71]
v_exp_f32 v30, v30
v_mfma_f32_16x16x32_bf16 v[68:71], a[136:139], v[156:159], v[68:71]
v_exp_f32 v31, v31
v_mfma_f32_16x16x32_bf16 v[68:71], a[140:143], v[160:163], v[68:71]
s_waitcnt lgkmcnt(12)
v_add_f32 v42, v28, v29
v_add_f32 v42, v42, v30
v_mfma_f32_16x16x32_bf16 v[200:203], v[180:183], a[216:219], 0
s_waitcnt lgkmcnt(11)
v_exp_f32 v32, v32
v_mfma_f32_16x16x32_bf16 v[200:203], v[184:187], a[220:223], v[200:203]
s_waitcnt lgkmcnt(10)
v_exp_f32 v33, v33
v_mfma_f32_16x16x32_bf16 v[200:203], v[164:167], a[224:227], v[200:203]
s_waitcnt lgkmcnt(9)
v_add_f32 v42, v42, v31
v_add_f32 v42, v42, v32
v_mfma_f32_16x16x32_bf16 v[200:203], v[168:171], a[228:231], v[200:203]
s_waitcnt lgkmcnt(8)
v_exp_f32 v34, v34
v_mfma_f32_16x16x32_bf16 v[200:203], v[172:175], a[232:235], v[200:203]
buffer_load_dwordx4 a[36:39], v11, s[20:23], s32 offen offset:128 nt
s_waitcnt lgkmcnt(7)
v_add_f32 v42, v42, v33
v_mfma_f32_16x16x32_bf16 v[200:203], v[176:179], a[236:239], v[200:203]
v_exp_f32 v35, v35
v_mfma_f32_16x16x32_bf16 v[204:207], a[144:147], a[216:219], 0
s_nop 0
ds_read_b128 a[216:219], v254 offset:12288
v_add_f32 v42, v42, v34
v_mfma_f32_16x16x32_bf16 v[204:207], a[148:151], a[220:223], v[204:207]
s_nop 0
ds_read_b128 a[220:223], v254 offset:13312
v_cvt_pk_bf16_f32 v200, v200, v201
v_mfma_f32_16x16x32_bf16 v[204:207], a[152:155], a[224:227], v[204:207]
v_cvt_pk_bf16_f32 v201, v202, v203
ds_write2_b32 v252, v200, v201 offset0:0 offset1:16
v_mfma_f32_16x16x32_bf16 v[204:207], a[156:159], a[228:231], v[204:207]
ds_read_b128 a[224:227], v254 offset:14336
ds_read_b128 a[228:231], v254 offset:15360
v_mfma_f32_16x16x32_bf16 v[204:207], a[160:163], a[232:235], v[204:207]
ds_read_b128 a[232:235], v254 offset:16384
v_add_f32 v42, v42, v35
v_mfma_f32_16x16x32_bf16 v[204:207], a[164:167], a[236:239], v[204:207]
s_waitcnt lgkmcnt(12)
ds_read_b128 a[236:239], v254 offset:17408
ds_read_b128 a[244:247], v22 offset:128
v_mfma_f32_16x16x32_bf16 v[208:211], v[180:183], a[192:195], 0
buffer_load_dwordx4 a[56:59], v12, s[20:23], s32 offen offset:128 nt
s_waitcnt lgkmcnt(13)
v_max3_f32 v58, v58, v51, v52
v_mfma_f32_16x16x32_bf16 v[208:211], v[184:187], a[196:199], v[208:211]
s_waitcnt lgkmcnt(12)
v_exp_f32 v36, v36
v_mfma_f32_16x16x32_bf16 v[208:211], v[164:167], a[200:203], v[208:211]
s_waitcnt lgkmcnt(11)
v_cvt_pk_bf16_f32 v204, v204, v205
ds_write_b32 v252, v204 offset:128
v_mfma_f32_16x16x32_bf16 v[208:211], v[168:171], a[204:207], v[208:211]
s_waitcnt lgkmcnt(11)
v_exp_f32 v37, v37
v_mfma_f32_16x16x32_bf16 v[208:211], v[172:175], a[208:211], v[208:211]
s_waitcnt lgkmcnt(10)
v_exp_f32 v38, v38
v_mfma_f32_16x16x32_bf16 v[208:211], v[176:179], a[212:215], v[208:211]
v_add_f32 v42, v42, v36
v_add_f32 v42, v42, v37
v_mfma_f32_16x16x32_bf16 v[212:215], a[144:147], a[192:195], 0
s_nop 0
ds_read_b128 a[192:195], v2 offset:8192
v_add_f32 v42, v42, v38
v_mfma_f32_16x16x32_bf16 v[212:215], a[148:151], a[196:199], v[212:215]
s_nop 0
v_cvt_pk_bf16_f32 v208, v208, v209
v_cvt_pk_bf16_f32 v209, v210, v211
v_mfma_f32_16x16x32_bf16 v[212:215], a[152:155], a[200:203], v[212:215]
buffer_load_dwordx4 a[60:63], v13, s[20:23], s32 offen offset:128 nt
ds_write2_b32 v252, v208, v209 offset0:48 offset1:64
v_mfma_f32_16x16x32_bf16 v[212:215], a[156:159], a[204:207], v[212:215]
ds_read_b128 a[196:199], v2 offset:9216
ds_read_b128 a[200:203], v2 offset:10240
v_mfma_f32_16x16x32_bf16 v[212:215], a[160:163], a[208:211], v[212:215]
ds_read_b128 a[204:207], v2 offset:11264
ds_read_b128 a[208:211], v2 offset:12288
v_mfma_f32_16x16x32_bf16 v[212:215], a[164:167], a[212:215], v[212:215]
s_waitcnt lgkmcnt(14)
ds_read_b128 a[212:215], v2 offset:13312
v_add_f32 v82, v82, v83
v_mfma_f32_16x16x32_bf16 v[216:219], v[180:183], a[216:219], 0
s_waitcnt lgkmcnt(14)
v_exp_f32 v39, v39
v_mfma_f32_16x16x32_bf16 v[216:219], v[184:187], a[220:223], v[216:219]
s_waitcnt lgkmcnt(12)
v_exp_f32 v78, v78
v_mfma_f32_16x16x32_bf16 v[216:219], v[164:167], a[224:227], v[216:219]
s_waitcnt lgkmcnt(11)
v_cvt_pk_bf16_f32 v212, v212, v213
ds_write_b32 v252, v212 offset:320
v_mfma_f32_16x16x32_bf16 v[216:219], v[168:171], a[228:231], v[216:219]
s_waitcnt lgkmcnt(11)
v_add_f32 v42, v42, v39
v_add_f32 v42, v42, v78
v_mfma_f32_16x16x32_bf16 v[216:219], v[172:175], a[232:235], v[216:219]
buffer_load_dwordx4 a[16:19], v8, s[20:23], s32 offen offset:256 nt
s_waitcnt lgkmcnt(10)
v_mov_b32 v43, v42
v_mfma_f32_16x16x32_bf16 v[216:219], v[176:179], a[236:239], v[216:219]
v_max3_f32 v58, v58, v53, v54
v_max3_f32 v58, v58, v55, v82
v_mfma_f32_16x16x32_bf16 v[188:191], a[144:147], a[216:219], 0
s_nop 0
ds_read_b128 a[216:219], v2 offset:14336
ds_read_b128 a[248:251], v22 offset:256
v_mfma_f32_16x16x32_bf16 v[188:191], a[148:151], a[220:223], v[188:191]
s_nop 0
v_cvt_pk_bf16_f32 v216, v216, v217
v_cvt_pk_bf16_f32 v217, v218, v219
v_mfma_f32_16x16x32_bf16 v[188:191], a[152:155], a[224:227], v[188:191]
ds_write2_b32 v252, v216, v217 offset0:96 offset1:112
v_mfma_f32_16x16x32_bf16 v[188:191], a[156:159], a[228:231], v[188:191]
ds_read_b128 a[220:223], v2 offset:15360
ds_read_b128 a[224:227], v2 offset:16384
v_mfma_f32_16x16x32_bf16 v[188:191], a[160:163], a[232:235], v[188:191]
ds_read_b128 a[228:231], v2 offset:17408
ds_read_b128 a[232:235], v2 offset:18432
v_mfma_f32_16x16x32_bf16 v[188:191], a[164:167], a[236:239], v[188:191]
s_waitcnt lgkmcnt(14)
ds_read_b128 a[236:239], v2 offset:19456
v_mov_b32 v59, v58
v_mfma_f32_16x16x32_bf16 v[224:227], a[72:75], a[192:195], 0
buffer_load_dwordx4 a[20:23], v9, s[20:23], s32 offen offset:256 nt
s_waitcnt lgkmcnt(13)
ds_read_b128 a[252:255], v22 offset:384
v_mfma_f32_16x16x32_bf16 v[224:227], a[76:79], a[196:199], v[224:227]
s_waitcnt lgkmcnt(13)
v_permlane32_swap_b32 v42, v43
v_mfma_f32_16x16x32_bf16 v[224:227], a[80:83], a[200:203], v[224:227]
s_waitcnt lgkmcnt(12)
v_cvt_pk_bf16_f32 v188, v188, v189
ds_write_b32 v252, v188 offset:512
v_mfma_f32_16x16x32_bf16 v[224:227], a[84:87], a[204:207], v[224:227]
s_waitcnt lgkmcnt(12)
v_add_f32 v42, v42, v43
v_mov_b32 v43, v42
v_mfma_f32_16x16x32_bf16 v[224:227], a[88:91], a[208:211], v[224:227]
s_waitcnt lgkmcnt(11)
v_permlane32_swap_b32 v58, v59
v_mfma_f32_16x16x32_bf16 v[224:227], a[92:95], a[212:215], v[224:227]
v_permlane16_swap_b32 v42, v43
v_mfma_f32_16x16x32_bf16 v[228:231], a[96:99], a[192:195], 0
v_add_f32 v42, v42, v43
v_max_f32 v58, v58, v59
v_mfma_f32_16x16x32_bf16 v[228:231], a[100:103], a[196:199], v[228:231]
v_rcp_f32 v42, v42
v_mfma_f32_16x16x32_bf16 v[228:231], a[104:107], a[200:203], v[228:231]
buffer_load_dwordx4 a[40:43], v10, s[20:23], s32 offen offset:256 nt
v_cvt_pk_bf16_f32 v92, v224, v225
v_mfma_f32_16x16x32_bf16 v[228:231], a[108:111], a[204:207], v[228:231]
v_cvt_pk_bf16_f32 v93, v226, v227
v_mul_f32 v28, v28, v42
v_mfma_f32_16x16x32_bf16 v[228:231], a[112:115], a[208:211], v[228:231]
v_mul_f32 v29, v29, v42
v_mul_f32 v30, v30, v42
v_mfma_f32_16x16x32_bf16 v[228:231], a[116:119], a[212:215], v[228:231]
v_mul_f32 v31, v31, v42
v_cvt_pk_bf16_f32 v28, v28, v29
v_mfma_f32_16x16x32_bf16 v[232:235], a[120:123], a[192:195], 0
s_waitcnt lgkmcnt(0)
s_barrier
ds_read_b32 v98, v253 offset:0
ds_read_b128 a[192:195], v2 offset:20480
v_mfma_f32_16x16x32_bf16 v[232:235], a[124:127], a[196:199], v[232:235]
ds_read_b128 a[196:199], v2 offset:21504
v_cvt_pk_bf16_f32 v94, v228, v229
v_mfma_f32_16x16x32_bf16 v[232:235], a[128:131], a[200:203], v[232:235]
ds_read_b128 a[200:203], v2 offset:22528
v_cvt_pk_bf16_f32 v95, v230, v231
v_mfma_f32_16x16x32_bf16 v[232:235], a[132:135], a[204:207], v[232:235]
ds_read_b32 v106, v253 offset:192
ds_read_b128 a[204:207], v2 offset:23552
v_mfma_f32_16x16x32_bf16 v[232:235], a[136:139], a[208:211], v[232:235]
buffer_load_dwordx4 a[44:47], v11, s[20:23], s32 offen offset:256 nt
ds_read_b128 a[208:211], v2 offset:24576
v_mfma_f32_16x16x32_bf16 v[232:235], a[140:143], a[212:215], v[232:235]
ds_read_b128 a[212:215], v2 offset:25600
v_mul_f32 v32, v32, v42
v_mfma_f32_16x16x32_bf16 v[220:223], a[72:75], a[216:219], 0
ds_read_b32 v114, v253 offset:384
v_mul_f32 v33, v33, v42
v_mfma_f32_16x16x32_bf16 v[220:223], a[76:79], a[220:223], v[220:223]
v_mul_f32 v34, v34, v42
v_mul_f32 v35, v35, v42
v_mfma_f32_16x16x32_bf16 v[220:223], a[80:83], a[224:227], v[220:223]
v_cvt_pk_bf16_f32 v96, v232, v233
v_cvt_pk_bf16_f32 v97, v234, v235
v_mfma_f32_16x16x32_bf16 v[220:223], a[84:87], a[228:231], v[220:223]
ds_read_b32 v122, v253 offset:576
v_cvt_pk_bf16_f32 v29, v30, v31
v_mfma_f32_16x16x32_bf16 v[220:223], a[88:91], a[232:235], v[220:223]
v_cvt_pk_bf16_f32 v30, v32, v33
v_cvt_pk_bf16_f32 v31, v34, v35
v_mfma_f32_16x16x32_bf16 v[220:223], a[92:95], a[236:239], v[220:223]
v_mul_f32 v36, v36, v42
v_mul_f32 v37, v37, v42
v_mfma_f32_16x16x32_bf16 v[224:227], a[96:99], a[216:219], 0
buffer_load_dwordx4 a[64:67], v12, s[20:23], s32 offen offset:256 nt
ds_read_b32 v130, v253 offset:768
v_mfma_f32_16x16x32_bf16 v[224:227], a[100:103], a[220:223], v[224:227]
v_mul_f32 v38, v38, v42
v_mul_f32 v39, v39, v42
v_mfma_f32_16x16x32_bf16 v[224:227], a[104:107], a[224:227], v[224:227]
v_cvt_pk_bf16_f32 v100, v220, v221
v_cvt_pk_bf16_f32 v101, v222, v223
v_mfma_f32_16x16x32_bf16 v[224:227], a[108:111], a[228:231], v[224:227]
ds_read_b32 v138, v253 offset:960
v_cvt_pk_bf16_f32 v36, v36, v37
v_mfma_f32_16x16x32_bf16 v[224:227], a[112:115], a[232:235], v[224:227]
v_mul_f32 v78, v78, v42
v_cvt_pk_bf16_f32 v37, v38, v39
v_mfma_f32_16x16x32_bf16 v[224:227], a[116:119], a[236:239], v[224:227]
v_cvt_pk_bf16_f32 v38, v78, 0
v_mov_b32 v39, 0
v_mfma_f32_16x16x32_bf16 v[228:231], a[120:123], a[216:219], 0
ds_read_b32 v146, v253 offset:1152
ds_read_b128 a[216:219], v2 offset:26624
v_mfma_f32_16x16x32_bf16 v[228:231], a[124:127], a[220:223], v[228:231]
ds_read_b128 a[220:223], v2 offset:27648
v_mov_b32 v59, v58
v_mfma_f32_16x16x32_bf16 v[228:231], a[128:131], a[224:227], v[228:231]
buffer_load_dwordx4 a[68:71], v13, s[20:23], s32 offen offset:256 nt
ds_read_b128 a[224:227], v2 offset:28672
v_mfma_f32_16x16x32_bf16 v[228:231], a[132:135], a[228:231], v[228:231]
ds_read_b32 v154, v253 offset:1344
ds_read_b128 a[228:231], v2 offset:29696
v_mfma_f32_16x16x32_bf16 v[228:231], a[136:139], a[232:235], v[228:231]
v_cvt_pk_bf16_f32 v102, v224, v225
v_cvt_pk_bf16_f32 v103, v226, v227
v_mfma_f32_16x16x32_bf16 v[228:231], a[140:143], a[236:239], v[228:231]
s_waitcnt lgkmcnt(15)
ds_read_b128 a[232:235], v2 offset:30720
ds_read_b128 a[236:239], v2 offset:31744
v_mfma_f32_16x16x32_bf16 v[232:235], a[72:75], a[192:195], 0
ds_read_b32 v162, v253 offset:1536
v_cndmask_b32 v19, v21, v197, s[6:7]
v_mfma_f32_16x16x32_bf16 v[232:235], a[76:79], a[196:199], v[232:235]
s_waitcnt lgkmcnt(15)
v_permlane16_swap_b32 v58, v59
v_mfma_f32_16x16x32_bf16 v[232:235], a[80:83], a[200:203], v[232:235]
v_cvt_pk_bf16_f32 v104, v228, v229
v_cvt_pk_bf16_f32 v105, v230, v231
v_mfma_f32_16x16x32_bf16 v[232:235], a[84:87], a[204:207], v[232:235]
s_waitcnt lgkmcnt(14)
ds_read_b32 v170, v253 offset:1728
v_max_f32 v58, v58, v59
v_mfma_f32_16x16x32_bf16 v[232:235], a[88:91], a[208:211], v[232:235]
s_waitcnt lgkmcnt(14)
v_sub_f32 v44, v44, v58
v_sub_f32 v45, v45, v58
v_mfma_f32_16x16x32_bf16 v[232:235], a[92:95], a[212:215], v[232:235]
v_sub_f32 v46, v46, v58
v_sub_f32 v47, v47, v58
v_mfma_f32_16x16x32_bf16 v[220:223], a[96:99], a[192:195], 0
ds_read_b32 v178, v253 offset:1920
v_sub_f32 v48, v48, v58
v_mfma_f32_16x16x32_bf16 v[220:223], a[100:103], a[196:199], v[220:223]
v_exp_f32 v44, v44
v_mfma_f32_16x16x32_bf16 v[220:223], a[104:107], a[200:203], v[220:223]
v_cvt_pk_bf16_f32 v108, v232, v233
v_cvt_pk_bf16_f32 v109, v234, v235
v_mfma_f32_16x16x32_bf16 v[220:223], a[108:111], a[204:207], v[220:223]
ds_read_b32 v186, v253 offset:2112
v_sub_f32 v49, v49, v58
v_mfma_f32_16x16x32_bf16 v[220:223], a[112:115], a[208:211], v[220:223]
v_exp_f32 v45, v45
v_mfma_f32_16x16x32_bf16 v[220:223], a[116:119], a[212:215], v[220:223]
v_sub_f32 v50, v50, v58
v_sub_f32 v51, v51, v58
v_mfma_f32_16x16x32_bf16 v[224:227], a[120:123], a[192:195], 0
ds_read_b128 a[192:195], v2 offset:32768
v_sub_f32 v52, v52, v58
v_mfma_f32_16x16x32_bf16 v[224:227], a[124:127], a[196:199], v[224:227]
ds_read_b128 a[196:199], v2 offset:33792
v_sub_f32 v53, v53, v58
v_mfma_f32_16x16x32_bf16 v[224:227], a[128:131], a[200:203], v[224:227]
ds_read_b128 a[200:203], v2 offset:34816
v_cvt_pk_bf16_f32 v110, v220, v221
v_mfma_f32_16x16x32_bf16 v[224:227], a[132:135], a[204:207], v[224:227]
LW_p4:
s_cbranch_execz LW_p21
ds_read_b128 a[204:207], v2 offset:35840
v_cvt_pk_bf16_f32 v111, v222, v223
v_mfma_f32_16x16x32_bf16 v[224:227], a[136:139], a[208:211], v[224:227]
ds_read_b128 a[208:211], v2 offset:36864
v_sub_f32 v54, v54, v58
v_mfma_f32_16x16x32_bf16 v[224:227], a[140:143], a[212:215], v[224:227]
s_waitcnt lgkmcnt(15)
ds_read_b128 a[212:215], v2 offset:37888
v_sub_f32 v55, v55, v58
v_mfma_f32_16x16x32_bf16 v[228:231], a[72:75], a[216:219], 0
s_waitcnt lgkmcnt(15)
v_sub_f32 v82, v82, v58
v_add_f32 v58, v44, v45
v_mfma_f32_16x16x32_bf16 v[228:231], a[76:79], a[220:223], v[228:231]
s_waitcnt lgkmcnt(14)
v_exp_f32 v46, v46
v_mfma_f32_16x16x32_bf16 v[228:231], a[80:83], a[224:227], v[228:231]
s_waitcnt lgkmcnt(12)
v_cvt_pk_bf16_f32 v112, v224, v225
v_cvt_pk_bf16_f32 v113, v226, v227
v_mfma_f32_16x16x32_bf16 v[228:231], a[84:87], a[228:231], v[228:231]
s_waitcnt lgkmcnt(11)
v_exp_f32 v47, v47
v_mfma_f32_16x16x32_bf16 v[228:231], a[88:91], a[232:235], v[228:231]
s_waitcnt lgkmcnt(10)
v_exp_f32 v48, v48
v_mfma_f32_16x16x32_bf16 v[228:231], a[92:95], a[236:239], v[228:231]
v_add_f32 v58, v58, v46
v_add_f32 v58, v58, v47
v_mfma_f32_16x16x32_bf16 v[232:235], a[96:99], a[216:219], 0
v_exp_f32 v49, v49
v_mfma_f32_16x16x32_bf16 v[232:235], a[100:103], a[220:223], v[232:235]
v_exp_f32 v50, v50
v_mfma_f32_16x16x32_bf16 v[232:235], a[104:107], a[224:227], v[232:235]
v_add_f32 v58, v58, v48
v_cvt_pk_bf16_f32 v116, v228, v229
v_mfma_f32_16x16x32_bf16 v[232:235], a[108:111], a[228:231], v[232:235]
v_cvt_pk_bf16_f32 v117, v230, v231
v_add_f32 v58, v58, v49
v_mfma_f32_16x16x32_bf16 v[232:235], a[112:115], a[232:235], v[232:235]
v_exp_f32 v51, v51
v_mfma_f32_16x16x32_bf16 v[232:235], a[116:119], a[236:239], v[232:235]
v_exp_f32 v52, v52
v_mfma_f32_16x16x32_bf16 v[220:223], a[120:123], a[216:219], 0
ds_read_b128 a[216:219], v2 offset:38912
v_add_f32 v58, v58, v50
v_mfma_f32_16x16x32_bf16 v[220:223], a[124:127], a[220:223], v[220:223]
ds_read_b128 a[220:223], v2 offset:39936
v_add_f32 v58, v58, v51
v_mfma_f32_16x16x32_bf16 v[220:223], a[128:131], a[224:227], v[220:223]
ds_read_b128 a[224:227], v2 offset:40960
v_cvt_pk_bf16_f32 v118, v232, v233
v_mfma_f32_16x16x32_bf16 v[220:223], a[132:135], a[228:231], v[220:223]
ds_read_b128 a[228:231], v2 offset:41984
v_cvt_pk_bf16_f32 v119, v234, v235
v_mfma_f32_16x16x32_bf16 v[220:223], a[136:139], a[232:235], v[220:223]
ds_read_b128 a[232:235], v2 offset:43008
v_add_f32 v58, v58, v52
v_mfma_f32_16x16x32_bf16 v[220:223], a[140:143], a[236:239], v[220:223]
s_waitcnt lgkmcnt(10)
ds_read_b128 a[236:239], v2 offset:44032
v_max3_f32 v74, v60, v61, v62
v_mfma_f32_16x16x32_bf16 v[224:227], a[72:75], a[192:195], 0
s_waitcnt lgkmcnt(10)
v_exp_f32 v53, v53
v_mfma_f32_16x16x32_bf16 v[224:227], a[76:79], a[196:199], v[224:227]
s_waitcnt lgkmcnt(9)
v_exp_f32 v54, v54
v_mfma_f32_16x16x32_bf16 v[224:227], a[80:83], a[200:203], v[224:227]
s_waitcnt lgkmcnt(8)
v_exp_f32 v55, v55
v_mfma_f32_16x16x32_bf16 v[224:227], a[84:87], a[204:207], v[224:227]
s_waitcnt lgkmcnt(7)
v_cvt_pk_bf16_f32 v120, v220, v221
v_cvt_pk_bf16_f32 v121, v222, v223
v_mfma_f32_16x16x32_bf16 v[224:227], a[88:91], a[208:211], v[224:227]
s_waitcnt lgkmcnt(6)
v_add_f32 v58, v58, v53
v_add_f32 v58, v58, v54
v_mfma_f32_16x16x32_bf16 v[224:227], a[92:95], a[212:215], v[224:227]
v_exp_f32 v82, v82
v_mfma_f32_16x16x32_bf16 v[228:231], a[96:99], a[192:195], 0
v_add_f32 v58, v58, v55
v_add_f32 v58, v58, v82
v_mfma_f32_16x16x32_bf16 v[228:231], a[100:103], a[196:199], v[228:231]
v_mov_b32 v59, v58
v_max3_f32 v74, v74, v63, v64
v_mfma_f32_16x16x32_bf16 v[228:231], a[104:107], a[200:203], v[228:231]
v_cvt_pk_bf16_f32 v124, v224, v225
v_cvt_pk_bf16_f32 v125, v226, v227
v_mfma_f32_16x16x32_bf16 v[228:231], a[108:111], a[204:207], v[228:231]
v_max3_f32 v74, v74, v65, v66
v_max3_f32 v74, v74, v67, v68
v_mfma_f32_16x16x32_bf16 v[228:231], a[112:115], a[208:211], v[228:231]
v_add_f32 v86, v86, v87
v_max3_f32 v74, v74, v69, v70
v_mfma_f32_16x16x32_bf16 v[228:231], a[116:119], a[212:215], v[228:231]
v_permlane32_swap_b32 v58, v59
v_mfma_f32_16x16x32_bf16 v[232:235], a[120:123], a[192:195], 0
ds_read_b128 a[192:195], v2 offset:45056
v_max3_f32 v74, v74, v71, v86
v_mfma_f32_16x16x32_bf16 v[232:235], a[124:127], a[196:199], v[232:235]
ds_read_b128 a[196:199], v2 offset:46080
v_add_f32 v58, v58, v59
v_mfma_f32_16x16x32_bf16 v[232:235], a[128:131], a[200:203], v[232:235]
ds_read_b128 a[200:203], v2 offset:47104
v_cvt_pk_bf16_f32 v126, v228, v229
v_mfma_f32_16x16x32_bf16 v[232:235], a[132:135], a[204:207], v[232:235]
ds_read_b128 a[204:207], v2 offset:48128
v_cvt_pk_bf16_f32 v127, v230, v231
v_mfma_f32_16x16x32_bf16 v[232:235], a[136:139], a[208:211], v[232:235]
ds_read_b128 a[208:211], v2 offset:49152
v_mov_b32 v75, v74
v_mfma_f32_16x16x32_bf16 v[232:235], a[140:143], a[212:215], v[232:235]
s_waitcnt lgkmcnt(10)
ds_read_b128 a[212:215], v2 offset:50176
v_mov_b32 v59, v58
v_mfma_f32_16x16x32_bf16 v[220:223], a[72:75], a[216:219], 0
s_waitcnt lgkmcnt(10)
v_permlane32_swap_b32 v74, v75
v_mfma_f32_16x16x32_bf16 v[220:223], a[76:79], a[220:223], v[220:223]
s_waitcnt lgkmcnt(9)
v_permlane16_swap_b32 v58, v59
v_mfma_f32_16x16x32_bf16 v[220:223], a[80:83], a[224:227], v[220:223]
s_waitcnt lgkmcnt(8)
v_max_f32 v74, v74, v75
v_cvt_pk_bf16_f32 v128, v232, v233
v_mfma_f32_16x16x32_bf16 v[220:223], a[84:87], a[228:231], v[220:223]
s_waitcnt lgkmcnt(7)
v_cvt_pk_bf16_f32 v129, v234, v235
v_add_f32 v58, v58, v59
v_mfma_f32_16x16x32_bf16 v[220:223], a[88:91], a[232:235], v[220:223]
s_waitcnt lgkmcnt(6)
v_mov_b32 v75, v74
v_mov_b32 v147, 0
v_mfma_f32_16x16x32_bf16 v[220:223], a[92:95], a[236:239], v[220:223]
v_rcp_f32 v58, v58
v_mfma_f32_16x16x32_bf16 v[224:227], a[96:99], a[216:219], 0
v_mul_f32 v44, v44, v58
v_mul_f32 v45, v45, v58
v_mfma_f32_16x16x32_bf16 v[224:227], a[100:103], a[220:223], v[224:227]
v_permlane16_swap_b32 v74, v75
v_mfma_f32_16x16x32_bf16 v[224:227], a[104:107], a[224:227], v[224:227]
v_mul_f32 v46, v46, v58
v_cvt_pk_bf16_f32 v132, v220, v221
v_mfma_f32_16x16x32_bf16 v[224:227], a[108:111], a[228:231], v[224:227]
v_cvt_pk_bf16_f32 v133, v222, v223
v_mul_f32 v47, v47, v58
v_mfma_f32_16x16x32_bf16 v[224:227], a[112:115], a[232:235], v[224:227]
v_cvt_pk_bf16_f32 v44, v44, v45
v_mul_f32 v48, v48, v58
v_mfma_f32_16x16x32_bf16 v[224:227], a[116:119], a[236:239], v[224:227]
v_mul_f32 v49, v49, v58
v_mul_f32 v50, v50, v58
v_mfma_f32_16x16x32_bf16 v[228:231], a[120:123], a[216:219], 0
ds_read_b128 a[216:219], v2 offset:51200
v_mul_f32 v51, v51, v58
v_mfma_f32_16x16x32_bf16 v[228:231], a[124:127], a[220:223], v[228:231]
ds_read_b128 a[220:223], v2 offset:52224
v_cvt_pk_bf16_f32 v45, v46, v47
v_mfma_f32_16x16x32_bf16 v[228:231], a[128:131], a[224:227], v[228:231]
ds_read_b128 a[224:227], v2 offset:53248
v_cvt_pk_bf16_f32 v134, v224, v225
v_mfma_f32_16x16x32_bf16 v[228:231], a[132:135], a[228:231], v[228:231]
ds_read_b128 a[228:231], v2 offset:54272
v_cvt_pk_bf16_f32 v135, v226, v227
v_mfma_f32_16x16x32_bf16 v[228:231], a[136:139], a[232:235], v[228:231]
ds_read_b128 a[232:235], v2 offset:55296
v_max_f32 v74, v74, v75
v_mfma_f32_16x16x32_bf16 v[228:231], a[140:143], a[236:239], v[228:231]
s_waitcnt lgkmcnt(10)
ds_read_b128 a[236:239], v2 offset:56320
v_cvt_pk_bf16_f32 v46, v48, v49
v_mfma_f32_16x16x32_bf16 v[232:235], a[72:75], a[192:195], 0
s_waitcnt lgkmcnt(10)
v_cvt_pk_bf16_f32 v47, v50, v51
v_sub_f32 v60, v60, v74
v_mfma_f32_16x16x32_bf16 v[232:235], a[76:79], a[196:199], v[232:235]
s_waitcnt lgkmcnt(9)
v_sub_f32 v61, v61, v74
v_mul_f32 v52, v52, v58
v_mfma_f32_16x16x32_bf16 v[232:235], a[80:83], a[200:203], v[232:235]
s_waitcnt lgkmcnt(8)
v_cvt_pk_bf16_f32 v136, v228, v229
v_cvt_pk_bf16_f32 v137, v230, v231
v_mfma_f32_16x16x32_bf16 v[232:235], a[84:87], a[204:207], v[232:235]
s_waitcnt lgkmcnt(7)
v_mul_f32 v53, v53, v58
v_sub_f32 v62, v62, v74
v_mfma_f32_16x16x32_bf16 v[232:235], a[88:91], a[208:211], v[232:235]
s_waitcnt lgkmcnt(6)
v_exp_f32 v60, v60
v_mfma_f32_16x16x32_bf16 v[232:235], a[92:95], a[212:215], v[232:235]
v_exp_f32 v61, v61
v_mfma_f32_16x16x32_bf16 v[220:223], a[96:99], a[192:195], 0
v_mul_f32 v54, v54, v58
v_mul_f32 v55, v55, v58
v_mfma_f32_16x16x32_bf16 v[220:223], a[100:103], a[196:199], v[220:223]
v_cvt_pk_bf16_f32 v52, v52, v53
v_sub_f32 v63, v63, v74
v_mfma_f32_16x16x32_bf16 v[220:223], a[104:107], a[200:203], v[220:223]
v_cvt_pk_bf16_f32 v140, v232, v233
v_cvt_pk_bf16_f32 v141, v234, v235
v_mfma_f32_16x16x32_bf16 v[220:223], a[108:111], a[204:207], v[220:223]
v_sub_f32 v64, v64, v74
v_sub_f32 v65, v65, v74
v_mfma_f32_16x16x32_bf16 v[220:223], a[112:115], a[208:211], v[220:223]
v_sub_f32 v66, v66, v74
v_sub_f32 v67, v67, v74
v_mfma_f32_16x16x32_bf16 v[220:223], a[116:119], a[212:215], v[220:223]
v_sub_f32 v68, v68, v74
v_sub_f32 v69, v69, v74
v_mfma_f32_16x16x32_bf16 v[224:227], a[120:123], a[192:195], 0
v_sub_f32 v70, v70, v74
v_sub_f32 v71, v71, v74
v_mfma_f32_16x16x32_bf16 v[224:227], a[124:127], a[196:199], v[224:227]
v_sub_f32 v86, v86, v74
v_mul_f32 v82, v82, v58
v_mfma_f32_16x16x32_bf16 v[224:227], a[128:131], a[200:203], v[224:227]
v_cvt_pk_bf16_f32 v142, v220, v221
v_cvt_pk_bf16_f32 v143, v222, v223
v_mfma_f32_16x16x32_bf16 v[224:227], a[132:135], a[204:207], v[224:227]
v_exp_f32 v62, v62
v_mfma_f32_16x16x32_bf16 v[224:227], a[136:139], a[208:211], v[224:227]
v_cvt_pk_bf16_f32 v53, v54, v55
v_add_f32 v74, v60, v61
v_mfma_f32_16x16x32_bf16 v[224:227], a[140:143], a[212:215], v[224:227]
s_waitcnt lgkmcnt(5)
v_exp_f32 v63, v63
v_mfma_f32_16x16x32_bf16 v[228:231], a[72:75], a[216:219], 0
s_waitcnt lgkmcnt(4)
v_cvt_pk_bf16_f32 v54, v82, 0
v_mov_b32 v55, 0
v_mfma_f32_16x16x32_bf16 v[228:231], a[76:79], a[220:223], v[228:231]
s_waitcnt lgkmcnt(3)
v_exp_f32 v64, v64
v_mfma_f32_16x16x32_bf16 v[228:231], a[80:83], a[224:227], v[228:231]
s_waitcnt lgkmcnt(2)
v_add_f32 v74, v74, v62
v_add_f32 v74, v74, v63
v_mfma_f32_16x16x32_bf16 v[228:231], a[84:87], a[228:231], v[228:231]
s_waitcnt lgkmcnt(1)
v_exp_f32 v65, v65
v_mfma_f32_16x16x32_bf16 v[228:231], a[88:91], a[232:235], v[228:231]
s_waitcnt lgkmcnt(0)
v_exp_f32 v66, v66
v_mfma_f32_16x16x32_bf16 v[228:231], a[92:95], a[236:239], v[228:231]
v_add_f32 v74, v74, v64
v_add_f32 v74, v74, v65
v_mfma_f32_16x16x32_bf16 v[232:235], a[96:99], a[216:219], 0
v_exp_f32 v67, v67
v_mfma_f32_16x16x32_bf16 v[232:235], a[100:103], a[220:223], v[232:235]
v_exp_f32 v68, v68
v_mfma_f32_16x16x32_bf16 v[232:235], a[104:107], a[224:227], v[232:235]
v_add_f32 v74, v74, v66
v_add_f32 v74, v74, v67
v_mfma_f32_16x16x32_bf16 v[232:235], a[108:111], a[228:231], v[232:235]
v_exp_f32 v69, v69
v_mfma_f32_16x16x32_bf16 v[232:235], a[112:115], a[232:235], v[232:235]
v_exp_f32 v70, v70
v_mfma_f32_16x16x32_bf16 v[232:235], a[116:119], a[236:239], v[232:235]
v_add_f32 v74, v74, v68
v_add_f32 v74, v74, v69
v_mfma_f32_16x16x32_bf16 v[220:223], a[120:123], a[216:219], 0
v_mov_b64 v[244:245], 0
v_mfma_f32_16x16x32_bf16 v[220:223], a[124:127], a[220:223], v[220:223]
v_exp_f32 v71, v71
v_mfma_f32_16x16x32_bf16 v[220:223], a[128:131], a[224:227], v[220:223]
v_exp_f32 v86, v86
v_mfma_f32_16x16x32_bf16 v[220:223], a[132:135], a[228:231], v[220:223]
v_add_f32 v74, v74, v70
v_add_f32 v74, v74, v71
v_mfma_f32_16x16x32_bf16 v[220:223], a[136:139], a[232:235], v[220:223]
v_add_f32 v74, v74, v86
v_mov_b32 v75, v74
v_mfma_f32_16x16x32_bf16 v[220:223], a[140:143], a[236:239], v[220:223]
v_cvt_pk_bf16_f32 v144, v224, v225
v_cvt_pk_bf16_f32 v145, v226, v227
v_mfma_f32_16x16x32_bf16 v[188:191], v[28:31], v[92:95], 0
v_permlane32_swap_b32 v74, v75
v_mfma_f32_16x16x32_bf16 v[188:191], v[36:39], v[96:99], v[188:191]
v_add_f32 v74, v74, v75
v_mov_b32 v75, v74
v_mfma_f32_16x16x32_bf16 v[192:195], v[28:31], v[100:103], 0
v_cvt_pk_bf16_f32 v148, v228, v229
v_cvt_pk_bf16_f32 v149, v230, v231
v_mfma_f32_16x16x32_bf16 v[192:195], v[36:39], v[104:107], v[192:195]
v_permlane16_swap_b32 v74, v75
v_mfma_f32_16x16x32_bf16 v[196:199], v[28:31], v[108:111], 0
v_add_f32 v74, v74, v75
v_cvt_pk_bf16_f32 v150, v232, v233
v_mfma_f32_16x16x32_bf16 v[196:199], v[36:39], v[112:115], v[196:199]
v_rcp_f32 v74, v74
v_mfma_f32_16x16x32_bf16 v[200:203], v[28:31], v[116:119], 0
v_mul_f32 v60, v60, v74
v_mul_f32 v61, v61, v74
v_mfma_f32_16x16x32_bf16 v[200:203], v[36:39], v[120:123], v[200:203]
v_mul_f32 v62, v62, v74
v_mul_f32 v63, v63, v74
v_smfmac_f32_16x16x64_bf16 v[244:247], a[240:243], v[92:99], v0
v_cvt_pk_bf16_f32 v60, v60, v61
v_smfmac_f32_16x16x64_bf16 v[244:247], a[244:247], v[100:107], v0
v_mul_f32 v64, v64, v74
v_smfmac_f32_16x16x64_bf16 v[244:247], a[248:251], v[108:115], v0
v_mul_f32 v65, v65, v74
v_smfmac_f32_16x16x64_bf16 v[244:247], a[252:255], v[116:123], v0
v_mul_f32 v66, v66, v74
v_mfma_f32_16x16x32_bf16 v[204:207], v[44:47], v[92:95], 0
v_mul_f32 v67, v67, v74
v_cvt_pk_bf16_f32 v61, v62, v63
v_mfma_f32_16x16x32_bf16 v[204:207], v[52:55], v[96:99], v[204:207]
v_cvt_pk_bf16_f32 v62, v64, v65
v_cvt_pk_bf16_f32 v63, v66, v67
v_mfma_f32_16x16x32_bf16 v[208:211], v[44:47], v[100:103], 0
v_mul_f32 v68, v68, v74
v_mul_f32 v69, v69, v74
v_mfma_f32_16x16x32_bf16 v[208:211], v[52:55], v[104:107], v[208:211]
v_mul_f32 v70, v70, v74
v_mul_f32 v71, v71, v74
v_mfma_f32_16x16x32_bf16 v[212:215], v[44:47], v[108:111], 0
v_cvt_pk_bf16_f32 v68, v68, v69
v_cvt_pk_bf16_f32 v64, v188, v192
v_mfma_f32_16x16x32_bf16 v[212:215], v[52:55], v[112:115], v[212:215]
v_cvt_pk_bf16_f32 v76, v189, v193
v_cvt_pk_bf16_f32 v78, v190, v194
v_mfma_f32_16x16x32_bf16 v[216:219], v[44:47], v[116:119], 0
v_cvt_pk_bf16_f32 v80, v191, v195
v_mul_f32 v86, v86, v74
v_mfma_f32_16x16x32_bf16 v[216:219], v[52:55], v[120:123], v[216:219]
v_cvt_pk_bf16_f32 v69, v70, v71
v_cvt_pk_bf16_f32 v70, v86, 0
v_mfma_f32_16x16x32_bf16 v[188:191], v[60:63], v[92:95], 0
v_mov_b32 v71, 0
v_cvt_pk_bf16_f32 v65, v196, v200
v_cvt_pk_bf16_f32 v77, v197, v201
v_mfma_f32_16x16x32_bf16 v[188:191], v[68:71], v[96:99], v[188:191]
v_cvt_pk_bf16_f32 v79, v198, v202
v_cvt_pk_bf16_f32 v81, v199, v203
v_mfma_f32_16x16x32_bf16 v[192:195], v[60:63], v[100:103], 0
buffer_store_dwordx2 v[64:65], v14, s[12:15], s28 offen offset:0 sc1
v_add_f32 v64, v244, v245
v_mfma_f32_16x16x32_bf16 v[192:195], v[68:71], v[104:107], v[192:195]
buffer_store_dwordx2 v[76:77], v14, s[12:15], s28 offen offset:384 sc1
v_cvt_pk_bf16_f32 v64, v64, v64
v_mfma_f32_16x16x32_bf16 v[196:199], v[60:63], v[108:111], 0
buffer_store_short v64, v17, s[12:15], s28 offen offset:0 sc1
v_cvt_pk_bf16_f32 v64, v204, v208
v_mfma_f32_16x16x32_bf16 v[196:199], v[68:71], v[112:115], v[196:199]
v_cvt_pk_bf16_f32 v82, v205, v209
v_cvt_pk_bf16_f32 v84, v206, v210
v_mfma_f32_16x16x32_bf16 v[200:203], v[60:63], v[116:119], 0
buffer_store_dwordx2 v[78:79], v14, s[12:15], s28 offen offset:768 sc1
v_cvt_pk_bf16_f32 v86, v207, v211
v_mfma_f32_16x16x32_bf16 v[200:203], v[68:71], v[120:123], v[200:203]
v_cvt_pk_bf16_f32 v65, v212, v216
v_cvt_pk_bf16_f32 v83, v213, v217
v_mfma_f32_16x16x32_bf16 v[204:207], v[28:31], v[124:127], 0
v_cvt_pk_bf16_f32 v85, v214, v218
v_cvt_pk_bf16_f32 v87, v215, v219
v_mfma_f32_16x16x32_bf16 v[204:207], v[36:39], v[128:131], v[204:207]
v_cvt_pk_bf16_f32 v151, v234, v235
v_mov_b32 v155, 0
v_mfma_f32_16x16x32_bf16 v[208:211], v[28:31], v[132:135], 0
v_cvt_pk_bf16_f32 v152, v220, v221
v_cvt_pk_bf16_f32 v153, v222, v223
v_mfma_f32_16x16x32_bf16 v[208:211], v[36:39], v[136:139], v[208:211]
buffer_store_dwordx2 v[80:81], v14, s[12:15], s28 offen offset:1152 sc1
v_mov_b64 v[244:245], 0
v_mfma_f32_16x16x32_bf16 v[212:215], v[28:31], v[140:143], 0
v_subrev_u32 v88, 512, v20
v_cndmask_b32 v20, v20, v88, s[92:93]
v_mfma_f32_16x16x32_bf16 v[212:215], v[36:39], v[144:147], v[212:215]
v_cvt_pk_bf16_f32 v76, v188, v192
v_cvt_pk_bf16_f32 v66, v189, v193
v_mfma_f32_16x16x32_bf16 v[216:219], v[28:31], v[148:151], 0
v_cvt_pk_bf16_f32 v88, v190, v194
v_cvt_pk_bf16_f32 v90, v191, v195
v_mfma_f32_16x16x32_bf16 v[216:219], v[36:39], v[152:155], v[216:219]
v_cvt_pk_bf16_f32 v77, v196, v200
v_cvt_pk_bf16_f32 v67, v197, v201
v_smfmac_f32_16x16x64_bf16 v[244:247], a[240:243], v[124:131], v0
v_cvt_pk_bf16_f32 v89, v198, v202
v_smfmac_f32_16x16x64_bf16 v[244:247], a[244:247], v[132:139], v0
v_cvt_pk_bf16_f32 v91, v199, v203
v_smfmac_f32_16x16x64_bf16 v[244:247], a[248:251], v[140:147], v0
ds_read_b128 a[192:195], v2 offset:57344
v_smfmac_f32_16x16x64_bf16 v[244:247], a[252:255], v[148:155], v0
ds_read_b128 a[196:199], v2 offset:58368
v_mfma_f32_16x16x32_bf16 v[188:191], v[44:47], v[124:127], 0
buffer_store_dwordx2 v[64:65], v15, s[12:15], s28 offen offset:0 sc1
v_cvt_pk_bf16_f32 v92, v204, v208
v_mfma_f32_16x16x32_bf16 v[188:191], v[52:55], v[128:131], v[188:191]
v_cvt_pk_bf16_f32 v94, v205, v209
v_cvt_pk_bf16_f32 v100, v206, v210
v_mfma_f32_16x16x32_bf16 v[192:195], v[44:47], v[132:135], 0
buffer_store_dwordx2 v[82:83], v15, s[12:15], s29 offen offset:0 sc1
v_cvt_pk_bf16_f32 v78, v207, v211
v_mfma_f32_16x16x32_bf16 v[192:195], v[52:55], v[136:139], v[192:195]
ds_read_b128 a[200:203], v2 offset:59392
ds_read_b128 a[204:207], v2 offset:60416
v_mfma_f32_16x16x32_bf16 v[196:199], v[44:47], v[140:143], 0
ds_read_b128 a[208:211], v2 offset:61440
ds_read_b128 a[212:215], v2 offset:62464
v_mfma_f32_16x16x32_bf16 v[196:199], v[52:55], v[144:147], v[196:199]
v_cvt_pk_bf16_f32 v93, v212, v216
v_cvt_pk_bf16_f32 v95, v213, v217
v_mfma_f32_16x16x32_bf16 v[200:203], v[44:47], v[148:151], 0
v_cvt_pk_bf16_f32 v101, v214, v218
v_cvt_pk_bf16_f32 v79, v215, v219
v_mfma_f32_16x16x32_bf16 v[200:203], v[52:55], v[152:155], v[200:203]
ds_read_b128 a[216:219], v2 offset:63488
ds_read_b128 a[220:223], v2 offset:64512
v_mfma_f32_16x16x32_bf16 v[204:207], v[60:63], v[124:127], 0
ds_read_b128 a[224:227], v3 offset:0
ds_read_b128 a[228:231], v3 offset:1024
v_mfma_f32_16x16x32_bf16 v[204:207], v[68:71], v[128:131], v[204:207]
ds_read_b128 a[232:235], v3 offset:2048
ds_read_b128 a[236:239], v3 offset:3072
v_mfma_f32_16x16x32_bf16 v[208:211], v[60:63], v[132:135], 0
v_add_f32 v64, v244, v245
v_cvt_pk_bf16_f32 v64, v64, v64
v_mfma_f32_16x16x32_bf16 v[208:211], v[68:71], v[136:139], v[208:211]
buffer_store_short v64, v17, s[12:15], s28 offen offset:128 sc1
v_mov_b32 v163, 0
v_mfma_f32_16x16x32_bf16 v[212:215], v[60:63], v[140:143], 0
buffer_store_dwordx2 v[84:85], v15, s[12:15], s30 offen offset:0 sc1
v_mov_b32 v171, 0
v_mfma_f32_16x16x32_bf16 v[212:215], v[68:71], v[144:147], v[212:215]
v_mov_b32 v179, 0
v_mov_b32 v187, 0
v_mfma_f32_16x16x32_bf16 v[216:219], v[60:63], v[148:151], 0
v_cvt_pk_bf16_f32 v64, v204, v208
v_cvt_pk_bf16_f32 v84, v205, v209
v_mfma_f32_16x16x32_bf16 v[216:219], v[68:71], v[152:155], v[216:219]
s_waitcnt lgkmcnt(11)
v_cvt_pk_bf16_f32 v110, v206, v210
v_cvt_pk_bf16_f32 v72, v207, v211
v_mfma_f32_16x16x32_bf16 v[224:227], a[72:75], a[192:195], 0
s_waitcnt lgkmcnt(10)
v_cvt_pk_bf16_f32 v80, v188, v192
v_cvt_pk_bf16_f32 v82, v189, v193
v_mfma_f32_16x16x32_bf16 v[224:227], a[76:79], a[196:199], v[224:227]
buffer_store_dwordx2 v[86:87], v15, s[12:15], s31 offen offset:0 sc1
s_waitcnt lgkmcnt(9)
v_cvt_pk_bf16_f32 v102, v190, v194
v_mfma_f32_16x16x32_bf16 v[224:227], a[80:83], a[200:203], v[224:227]
s_waitcnt lgkmcnt(8)
v_cvt_pk_bf16_f32 v65, v212, v216
v_cvt_pk_bf16_f32 v85, v213, v217
v_mfma_f32_16x16x32_bf16 v[224:227], a[84:87], a[204:207], v[224:227]
s_waitcnt lgkmcnt(7)
v_cvt_pk_bf16_f32 v111, v214, v218
v_cvt_pk_bf16_f32 v73, v215, v219
v_mfma_f32_16x16x32_bf16 v[224:227], a[88:91], a[208:211], v[224:227]
s_waitcnt lgkmcnt(6)
v_cvt_pk_bf16_f32 v108, v191, v195
v_cvt_pk_bf16_f32 v81, v196, v200
v_mfma_f32_16x16x32_bf16 v[224:227], a[92:95], a[212:215], v[224:227]
v_cvt_pk_bf16_f32 v83, v197, v201
v_cvt_pk_bf16_f32 v103, v198, v202
v_mfma_f32_16x16x32_bf16 v[228:231], a[96:99], a[192:195], 0
buffer_store_dwordx2 v[76:77], v16, s[12:15], s28 offen offset:0 sc1
v_cvt_pk_bf16_f32 v109, v199, v203
v_mfma_f32_16x16x32_bf16 v[228:231], a[100:103], a[196:199], v[228:231]
s_waitcnt vmcnt(28)
ds_write_b64 v4, a[0:1] offset:0
v_mfma_f32_16x16x32_bf16 v[228:231], a[104:107], a[200:203], v[228:231]
v_cvt_pk_bf16_f32 v156, v224, v225
v_cvt_pk_bf16_f32 v157, v226, v227
v_mfma_f32_16x16x32_bf16 v[228:231], a[108:111], a[204:207], v[228:231]
ds_write_b64 v4, a[2:3] offset:8
v_mfma_f32_16x16x32_bf16 v[228:231], a[112:115], a[208:211], v[228:231]
s_waitcnt vmcnt(27)
ds_write_b64 v5, a[4:5] offset:0
v_mfma_f32_16x16x32_bf16 v[228:231], a[116:119], a[212:215], v[228:231]
ds_write_b64 v5, a[6:7] offset:8
v_mfma_f32_16x16x32_bf16 v[232:235], a[120:123], a[192:195], 0
buffer_store_dwordx2 v[66:67], v16, s[12:15], s28 offen offset:384 sc1
ds_read_b128 a[192:195], v3 offset:4096
v_mfma_f32_16x16x32_bf16 v[232:235], a[124:127], a[196:199], v[232:235]
ds_read_b128 a[196:199], v3 offset:5120
ds_read_b128 a[0:3], v6 offset:0
v_mfma_f32_16x16x32_bf16 v[232:235], a[128:131], a[200:203], v[232:235]
ds_read_b128 a[200:203], v3 offset:6144
v_cvt_pk_bf16_f32 v158, v228, v229
v_mfma_f32_16x16x32_bf16 v[232:235], a[132:135], a[204:207], v[232:235]
ds_read_b128 a[204:207], v3 offset:7168
v_cvt_pk_bf16_f32 v159, v230, v231
v_mfma_f32_16x16x32_bf16 v[232:235], a[136:139], a[208:211], v[232:235]
ds_read_b128 a[208:211], v3 offset:8192
ds_read_b128 a[4:7], v7 offset:0
v_mfma_f32_16x16x32_bf16 v[232:235], a[140:143], a[212:215], v[232:235]
buffer_store_dwordx2 v[88:89], v16, s[12:15], s29 offen offset:0 sc1
s_waitcnt lgkmcnt(15)
ds_read_b128 a[212:215], v3 offset:9216
v_mfma_f32_16x16x32_bf16 v[220:223], a[72:75], a[216:219], 0
s_waitcnt vmcnt(28)
ds_write_b64 v4, a[24:25] offset:2048
v_mfma_f32_16x16x32_bf16 v[220:223], a[76:79], a[220:223], v[220:223]
s_waitcnt lgkmcnt(15)
ds_write_b64 v4, a[26:27] offset:2056
v_mfma_f32_16x16x32_bf16 v[220:223], a[80:83], a[224:227], v[220:223]
s_waitcnt vmcnt(27)
ds_write_b64 v5, a[28:29] offset:2048
v_mfma_f32_16x16x32_bf16 v[220:223], a[84:87], a[228:231], v[220:223]
s_waitcnt lgkmcnt(15)
v_cvt_pk_bf16_f32 v160, v232, v233
v_cvt_pk_bf16_f32 v161, v234, v235
v_mfma_f32_16x16x32_bf16 v[220:223], a[88:91], a[232:235], v[220:223]
buffer_store_dwordx2 v[90:91], v16, s[12:15], s29 offen offset:384 sc1
v_mfma_f32_16x16x32_bf16 v[220:223], a[92:95], a[236:239], v[220:223]
ds_write_b64 v5, a[30:31] offset:2056
v_mfma_f32_16x16x32_bf16 v[224:227], a[96:99], a[216:219], 0
ds_read_b128 a[24:27], v6 offset:2048
ds_read_b128 a[28:31], v7 offset:2048
v_mfma_f32_16x16x32_bf16 v[224:227], a[100:103], a[220:223], v[224:227]
s_waitcnt vmcnt(25)
ds_write_b64 v4, a[8:9] offset:2048
v_mfma_f32_16x16x32_bf16 v[224:227], a[104:107], a[224:227], v[224:227]
ds_write_b64 v4, a[10:11] offset:2056
v_mfma_f32_16x16x32_bf16 v[224:227], a[108:111], a[228:231], v[224:227]
buffer_store_dwordx2 v[92:93], v14, s[12:15], s28 offen offset:128 sc1
v_cvt_pk_bf16_f32 v164, v220, v221
v_mfma_f32_16x16x32_bf16 v[224:227], a[112:115], a[232:235], v[224:227]
v_cvt_pk_bf16_f32 v165, v222, v223
v_mfma_f32_16x16x32_bf16 v[224:227], a[116:119], a[236:239], v[224:227]
s_waitcnt vmcnt(25)
ds_write_b64 v5, a[12:13] offset:2048
v_mfma_f32_16x16x32_bf16 v[228:231], a[120:123], a[216:219], 0
ds_read_b128 a[216:219], v3 offset:10240
v_mfma_f32_16x16x32_bf16 v[228:231], a[124:127], a[220:223], v[228:231]
ds_read_b128 a[220:223], v3 offset:11264
v_mfma_f32_16x16x32_bf16 v[228:231], a[128:131], a[224:227], v[228:231]
buffer_store_dwordx2 v[94:95], v14, s[12:15], s28 offen offset:512 sc1
ds_read_b128 a[224:227], v3 offset:12288
v_mfma_f32_16x16x32_bf16 v[228:231], a[132:135], a[228:231], v[228:231]
ds_read_b128 a[228:231], v3 offset:13312
v_cvt_pk_bf16_f32 v166, v224, v225
v_mfma_f32_16x16x32_bf16 v[228:231], a[136:139], a[232:235], v[228:231]
v_cvt_pk_bf16_f32 v167, v226, v227
v_mfma_f32_16x16x32_bf16 v[228:231], a[140:143], a[236:239], v[228:231]
s_waitcnt lgkmcnt(15)
ds_read_b128 a[232:235], v3 offset:14336
ds_read_b128 a[236:239], v3 offset:15360
v_mfma_f32_16x16x32_bf16 v[232:235], a[72:75], a[192:195], 0
ds_write_b64 v5, a[14:15] offset:2056
v_mfma_f32_16x16x32_bf16 v[232:235], a[76:79], a[196:199], v[232:235]
ds_read_b128 a[8:11], v6 offset:2048
ds_read_b128 a[12:15], v7 offset:2048
v_mfma_f32_16x16x32_bf16 v[232:235], a[80:83], a[200:203], v[232:235]
buffer_store_dwordx2 v[100:101], v14, s[12:15], s28 offen offset:896 sc1
v_cvt_pk_bf16_f32 v168, v228, v229
v_mfma_f32_16x16x32_bf16 v[232:235], a[84:87], a[204:207], v[232:235]
v_cvt_pk_bf16_f32 v169, v230, v231
v_mfma_f32_16x16x32_bf16 v[232:235], a[88:91], a[208:211], v[232:235]
s_waitcnt lgkmcnt(15)
ds_write_b64 v4, a[48:49] offset:0
v_mfma_f32_16x16x32_bf16 v[232:235], a[92:95], a[212:215], v[232:235]
ds_write_b64 v4, a[50:51] offset:8
v_mfma_f32_16x16x32_bf16 v[220:223], a[96:99], a[192:195], 0
ds_write_b64 v5, a[52:53] offset:0
v_mfma_f32_16x16x32_bf16 v[220:223], a[100:103], a[196:199], v[220:223]
buffer_store_dwordx2 v[78:79], v14, s[12:15], s28 offen offset:1280 sc1
v_mfma_f32_16x16x32_bf16 v[220:223], a[104:107], a[200:203], v[220:223]
ds_write_b64 v5, a[54:55] offset:8
v_mfma_f32_16x16x32_bf16 v[220:223], a[108:111], a[204:207], v[220:223]
v_cvt_pk_bf16_f32 v172, v232, v233
v_cvt_pk_bf16_f32 v173, v234, v235
v_mfma_f32_16x16x32_bf16 v[220:223], a[112:115], a[208:211], v[220:223]
ds_read_b128 a[48:51], v6 offset:0
ds_read_b128 a[52:55], v7 offset:0
v_mfma_f32_16x16x32_bf16 v[220:223], a[116:119], a[212:215], v[220:223]
s_waitcnt vmcnt(27)
ds_write_b64 v4, a[32:33] offset:0
v_mfma_f32_16x16x32_bf16 v[224:227], a[120:123], a[192:195], 0
buffer_store_dwordx2 v[80:81], v15, s[12:15], s28 offen offset:128 sc1
ds_read_b128 a[192:195], v1 offset:0
v_mfma_f32_16x16x32_bf16 v[224:227], a[124:127], a[196:199], v[224:227]
ds_read_b128 a[196:199], v1 offset:1024
v_mfma_f32_16x16x32_bf16 v[224:227], a[128:131], a[200:203], v[224:227]
ds_read_b128 a[200:203], v1 offset:2048
v_cvt_pk_bf16_f32 v174, v220, v221
v_mfma_f32_16x16x32_bf16 v[224:227], a[132:135], a[204:207], v[224:227]
v_cvt_pk_bf16_f32 v175, v222, v223
v_mfma_f32_16x16x32_bf16 v[224:227], a[136:139], a[208:211], v[224:227]
ds_read_b128 a[204:207], v1 offset:3072
ds_read_b128 a[208:211], v1 offset:4096
v_mfma_f32_16x16x32_bf16 v[224:227], a[140:143], a[212:215], v[224:227]
buffer_store_dwordx2 v[82:83], v15, s[12:15], s29 offen offset:128 sc1
s_waitcnt lgkmcnt(15)
ds_read_b128 a[212:215], v1 offset:5120
v_mfma_f32_16x16x32_bf16 v[228:231], a[72:75], a[216:219], 0
ds_write_b64 v4, a[34:35] offset:8
v_mfma_f32_16x16x32_bf16 v[228:231], a[76:79], a[220:223], v[228:231]
s_waitcnt vmcnt(28)
ds_write_b64 v5, a[36:37] offset:0
v_mfma_f32_16x16x32_bf16 v[228:231], a[80:83], a[224:227], v[228:231]
LW_p5:
s_cbranch_execz LW_p22
ds_write_b64 v5, a[38:39] offset:8
v_mfma_f32_16x16x32_bf16 v[228:231], a[84:87], a[228:231], v[228:231]
v_cvt_pk_bf16_f32 v176, v224, v225
v_cvt_pk_bf16_f32 v177, v226, v227
v_mfma_f32_16x16x32_bf16 v[228:231], a[88:91], a[232:235], v[228:231]
ds_read_b128 a[32:35], v6 offset:0
ds_read_b128 a[36:39], v7 offset:0
v_mfma_f32_16x16x32_bf16 v[228:231], a[92:95], a[236:239], v[228:231]
buffer_store_dwordx2 v[102:103], v15, s[12:15], s30 offen offset:128 sc1
v_mfma_f32_16x16x32_bf16 v[232:235], a[96:99], a[216:219], 0
s_waitcnt vmcnt(26)
ds_write_b64 v4, a[16:17] offset:0
v_mfma_f32_16x16x32_bf16 v[232:235], a[100:103], a[220:223], v[232:235]
ds_write_b64 v4, a[18:19] offset:8
v_mfma_f32_16x16x32_bf16 v[232:235], a[104:107], a[224:227], v[232:235]
s_waitcnt vmcnt(25)
ds_write_b64 v5, a[20:21] offset:0
v_mfma_f32_16x16x32_bf16 v[232:235], a[108:111], a[228:231], v[232:235]
v_cvt_pk_bf16_f32 v180, v228, v229
v_cvt_pk_bf16_f32 v181, v230, v231
v_mfma_f32_16x16x32_bf16 v[232:235], a[112:115], a[232:235], v[232:235]
buffer_store_dwordx2 v[108:109], v15, s[12:15], s31 offen offset:128 sc1
v_mfma_f32_16x16x32_bf16 v[232:235], a[116:119], a[236:239], v[232:235]
ds_write_b64 v5, a[22:23] offset:8
v_mfma_f32_16x16x32_bf16 v[220:223], a[120:123], a[216:219], 0
v_mov_b64 v[244:245], 0
v_mfma_f32_16x16x32_bf16 v[220:223], a[124:127], a[220:223], v[220:223]
ds_read_b128 a[216:219], v1 offset:6144
ds_read_b128 a[16:19], v6 offset:0
v_mfma_f32_16x16x32_bf16 v[220:223], a[128:131], a[224:227], v[220:223]
ds_read_b128 a[20:23], v7 offset:0
v_cvt_pk_bf16_f32 v182, v232, v233
v_mfma_f32_16x16x32_bf16 v[220:223], a[132:135], a[228:231], v[220:223]
buffer_store_dwordx2 v[64:65], v16, s[12:15], s28 offen offset:128 sc1
v_cvt_pk_bf16_f32 v183, v234, v235
v_mfma_f32_16x16x32_bf16 v[220:223], a[136:139], a[232:235], v[220:223]
ds_read_b128 a[220:223], v1 offset:7168
ds_read_b128 a[224:227], v1 offset:8192
v_mfma_f32_16x16x32_bf16 v[220:223], a[140:143], a[236:239], v[220:223]
ds_read_b128 a[228:231], v1 offset:9216
ds_read_b128 a[232:235], v1 offset:10240
v_mfma_f32_16x16x32_bf16 v[204:207], v[28:31], v[156:159], 0
s_nop 0
ds_read_b128 a[236:239], v1 offset:11264
s_nop 0
v_mfma_f32_16x16x32_bf16 v[204:207], v[36:39], v[160:163], v[204:207]
s_nop 0
v_cvt_pk_bf16_f32 v184, v220, v221
v_cvt_pk_bf16_f32 v185, v222, v223
v_mfma_f32_16x16x32_bf16 v[208:211], v[28:31], v[164:167], 0
buffer_store_dwordx2 v[84:85], v16, s[12:15], s28 offen offset:512 sc1
v_mfma_f32_16x16x32_bf16 v[208:211], v[36:39], v[168:171], v[208:211]
ds_write_b64 v4, a[56:57] offset:2048
v_mfma_f32_16x16x32_bf16 v[212:215], v[28:31], v[172:175], 0
ds_write_b64 v4, a[58:59] offset:2056
v_mfma_f32_16x16x32_bf16 v[212:215], v[36:39], v[176:179], v[212:215]
ds_write_b64 v5, a[60:61] offset:2048
v_mfma_f32_16x16x32_bf16 v[216:219], v[28:31], v[180:183], 0
ds_write_b64 v5, a[62:63] offset:2056
v_mfma_f32_16x16x32_bf16 v[216:219], v[36:39], v[184:187], v[216:219]
buffer_store_dwordx2 v[110:111], v16, s[12:15], s29 offen offset:128 sc1
v_cvt_pk_bf16_f32 v92, v204, v208
v_smfmac_f32_16x16x64_bf16 v[244:247], a[240:243], v[156:163], v0
v_cvt_pk_bf16_f32 v140, v205, v209
v_smfmac_f32_16x16x64_bf16 v[244:247], a[244:247], v[164:171], v0
v_cvt_pk_bf16_f32 v94, v206, v210
v_smfmac_f32_16x16x64_bf16 v[244:247], a[248:251], v[172:179], v0
v_cvt_pk_bf16_f32 v142, v207, v211
v_smfmac_f32_16x16x64_bf16 v[244:247], a[252:255], v[180:187], v0
v_cvt_pk_bf16_f32 v93, v212, v216
v_mfma_f32_16x16x32_bf16 v[188:191], v[44:47], v[156:159], 0
v_cvt_pk_bf16_f32 v141, v213, v217
v_cvt_pk_bf16_f32 v95, v214, v218
v_mfma_f32_16x16x32_bf16 v[188:191], v[52:55], v[160:163], v[188:191]
buffer_store_dwordx2 v[72:73], v16, s[12:15], s29 offen offset:512 sc1
v_cvt_pk_bf16_f32 v143, v215, v219
v_mfma_f32_16x16x32_bf16 v[192:195], v[44:47], v[164:167], 0
ds_read_b128 a[56:59], v6 offset:2048
ds_read_b128 a[60:63], v7 offset:2048
v_mfma_f32_16x16x32_bf16 v[192:195], v[52:55], v[168:171], v[192:195]
s_waitcnt vmcnt(29)
ds_write_b64 v4, a[40:41] offset:2048
v_mfma_f32_16x16x32_bf16 v[196:199], v[44:47], v[172:175], 0
ds_write_b64 v4, a[42:43] offset:2056
v_mfma_f32_16x16x32_bf16 v[196:199], v[52:55], v[176:179], v[196:199]
s_waitcnt vmcnt(28)
ds_write_b64 v5, a[44:45] offset:2048
v_mfma_f32_16x16x32_bf16 v[200:203], v[44:47], v[180:183], 0
ds_write_b64 v5, a[46:47] offset:2056
v_mfma_f32_16x16x32_bf16 v[200:203], v[52:55], v[184:187], v[200:203]
ds_read_b128 a[40:43], v6 offset:2048
ds_read_b128 a[44:47], v7 offset:2048
v_mfma_f32_16x16x32_bf16 v[204:207], v[60:63], v[156:159], 0
v_add_f32 v64, v244, v245
v_cvt_pk_bf16_f32 v64, v64, v64
v_mfma_f32_16x16x32_bf16 v[204:207], v[68:71], v[160:163], v[204:207]
s_nop 0
buffer_store_short v64, v17, s[12:15], s28 offen offset:256 sc1
s_mov_b32 s28, s32
v_mfma_f32_16x16x32_bf16 v[208:211], v[60:63], v[164:167], 0
s_add_u32 s32, s34, s35
s_cmp_lt_u32 s33, 5329
s_cselect_b32 s22, 100270464, 0
v_mfma_f32_16x16x32_bf16 v[208:211], v[68:71], v[168:171], v[208:211]
s_lshr_b32 s36, s26, 1
s_lshl_b32 s36, s36, 4
s_lshl_b64 s[98:99], 0xffff, s36
v_mfma_f32_16x16x32_bf16 v[212:215], v[60:63], v[172:175], 0
v_cvt_pk_bf16_f32 v100, v188, v192
v_cvt_pk_bf16_f32 v101, v196, v200
v_mfma_f32_16x16x32_bf16 v[212:215], v[68:71], v[176:179], v[212:215]
v_cvt_pk_bf16_f32 v148, v189, v193
v_cvt_pk_bf16_f32 v149, v197, v201
v_mfma_f32_16x16x32_bf16 v[216:219], v[60:63], v[180:183], 0
v_cvt_pk_bf16_f32 v102, v190, v194
v_cvt_pk_bf16_f32 v103, v198, v202
v_mfma_f32_16x16x32_bf16 v[216:219], v[68:71], v[184:187], v[216:219]
s_waitcnt vmcnt(27)
v_cvt_pk_bf16_f32 v150, v191, v195
v_cvt_pk_bf16_f32 v151, v199, v203
v_cndmask_b32 v26, v21, v24, s[98:99]
ds_write_b64 v4, a[64:65] offset:0
ds_write_b64 v4, a[66:67] offset:8
ds_write_b64 v5, a[68:69] offset:0
ds_write_b64 v5, a[70:71] offset:8
ds_read_b128 a[64:67], v6 offset:0
ds_read_b128 a[68:71], v7 offset:0
.p2align 6
L_loop:
s_waitcnt lgkmcnt(15)
v_mfma_f32_16x16x32_bf16 v[224:227], a[192:195], a[0:3], 0
buffer_store_dwordx2 v[92:93], v14, s[12:15], s44 offen offset:256 sc1
v_cvt_pk_bf16_f32 v108, v204, v208
v_mfma_f32_16x16x32_bf16 v[224:227], a[196:199], a[4:7], v[224:227]
s_add_u32 s29, s28, 196224
v_cvt_pk_bf16_f32 v109, v212, v216
v_cvt_pk_bf16_f32 v110, v205, v209
v_mfma_f32_16x16x32_bf16 v[224:227], a[200:203], a[8:11], v[224:227]
s_add_u32 s30, s28, 392448
v_cvt_pk_bf16_f32 v111, v213, v217
v_cvt_pk_bf16_f32 v72, v206, v210
v_mfma_f32_16x16x32_bf16 v[224:227], a[204:207], a[12:15], v[224:227]
s_add_u32 s31, s28, 588672
v_cvt_pk_bf16_f32 v73, v214, v218
v_cvt_pk_bf16_f32 v116, v207, v211
v_mfma_f32_16x16x32_bf16 v[224:227], a[208:211], a[16:19], v[224:227]
s_add_u32 s26, s26, 1
v_cvt_pk_bf16_f32 v117, v215, v219
s_mov_b32 s27, s33
v_mfma_f32_16x16x32_bf16 v[224:227], a[212:215], a[20:23], v[224:227]
buffer_store_dwordx2 v[140:141], v14, s[12:15], s44 offen offset:640 sc1
s_add_u32 s33, s33, 1024
v_mfma_f32_16x16x32_bf16 v[228:231], a[192:195], a[24:27], 0
s_cmp_eq_u32 s26, 4
ds_write_b64 v22, v[24:25] offset:384
v_mfma_f32_16x16x32_bf16 v[228:231], a[196:199], a[28:31], v[228:231]
s_cselect_b32 s33, s87, s33
ds_write_b64 v22, v[24:25] offset:392
v_mfma_f32_16x16x32_bf16 v[228:231], a[200:203], a[32:35], v[228:231]
s_mul_hi_u32 s34, s33, 58835169
v_cvt_pk_bf16_f32 v60, v224, v225
v_cvt_pk_bf16_f32 v61, v226, v227
v_mfma_f32_16x16x32_bf16 v[228:231], a[204:207], a[36:39], v[228:231]
s_waitcnt lgkmcnt(9)
s_mul_i32 s35, s34, 73
s_sub_u32 s35, s33, s35
s_mul_i32 s34, s34, 1373568
v_mfma_f32_16x16x32_bf16 v[228:231], a[208:211], a[40:43], v[228:231]
buffer_store_dwordx2 v[94:95], v14, s[12:15], s44 offen offset:1024 sc1
s_waitcnt lgkmcnt(8)
s_mul_i32 s35, s35, 2688
v_mfma_f32_16x16x32_bf16 v[228:231], a[212:215], a[44:47], v[228:231]
v_mfma_f32_16x16x32_bf16 v[232:235], a[192:195], a[48:51], 0
ds_read_b128 a[192:195], v1 offset:12288
v_mfma_f32_16x16x32_bf16 v[232:235], a[196:199], a[52:55], v[232:235]
ds_read_b128 a[196:199], v1 offset:13312
v_mfma_f32_16x16x32_bf16 v[232:235], a[200:203], a[56:59], v[232:235]
ds_read_b128 a[200:203], v1 offset:14336
v_mfma_f32_16x16x32_bf16 v[232:235], a[204:207], a[60:63], v[232:235]
buffer_store_dwordx2 v[142:143], v14, s[12:15], s44 offen offset:1408 sc1
s_waitcnt lgkmcnt(6)
ds_read_b128 a[204:207], v1 offset:15360
v_mfma_f32_16x16x32_bf16 v[232:235], a[208:211], a[64:67], v[232:235]
s_waitcnt lgkmcnt(6)
v_cvt_pk_bf16_f32 v92, v228, v229
v_cvt_pk_bf16_f32 v93, v230, v231
v_mfma_f32_16x16x32_bf16 v[232:235], a[212:215], a[68:71], v[232:235]
ds_read_b128 a[208:211], v1 offset:16384
ds_read_b128 a[212:215], v1 offset:17408
v_mfma_f32_16x16x32_bf16 v[220:223], a[216:219], a[0:3], 0
v_mfma_f32_16x16x32_bf16 v[220:223], a[220:223], a[4:7], v[220:223]
v_mfma_f32_16x16x32_bf16 v[220:223], a[224:227], a[8:11], v[220:223]
buffer_store_dwordx2 v[100:101], v15, s[12:15], s44 offen offset:256 sc1
v_mfma_f32_16x16x32_bf16 v[220:223], a[228:231], a[12:15], v[220:223]
v_mfma_f32_16x16x32_bf16 v[220:223], a[232:235], a[16:19], v[220:223]
v_cvt_pk_bf16_f32 v140, v232, v233
v_cvt_pk_bf16_f32 v141, v234, v235
v_mfma_f32_16x16x32_bf16 v[220:223], a[236:239], a[20:23], v[220:223]
v_mfma_f32_16x16x32_bf16 v[224:227], a[216:219], a[24:27], 0
v_mfma_f32_16x16x32_bf16 v[224:227], a[220:223], a[28:31], v[224:227]
buffer_store_dwordx2 v[148:149], v15, s[12:15], s45 offen offset:256 sc1
v_mfma_f32_16x16x32_bf16 v[224:227], a[224:227], a[32:35], v[224:227]
v_mfma_f32_16x16x32_bf16 v[224:227], a[228:231], a[36:39], v[224:227]
v_mfma_f32_16x16x32_bf16 v[224:227], a[232:235], a[40:43], v[224:227]
v_mfma_f32_16x16x32_bf16 v[224:227], a[236:239], a[44:47], v[224:227]
v_mfma_f32_16x16x32_bf16 v[228:231], a[216:219], a[48:51], 0
buffer_store_dwordx2 v[102:103], v15, s[12:15], s46 offen offset:256 sc1
v_cvt_pk_bf16_f32 v62, v220, v221
v_mfma_f32_16x16x32_bf16 v[228:231], a[220:223], a[52:55], v[228:231]
s_mov_b32 s46, s30
v_cvt_pk_bf16_f32 v63, v222, v223
v_mfma_f32_16x16x32_bf16 v[228:231], a[224:227], a[56:59], v[228:231]
ds_read_b128 a[216:219], v1 offset:18432
ds_read_b128 a[220:223], v1 offset:19456
v_mfma_f32_16x16x32_bf16 v[228:231], a[228:231], a[60:63], v[228:231]
ds_read_b128 a[224:227], v1 offset:20480
ds_read_b128 a[228:231], v1 offset:21504
v_mfma_f32_16x16x32_bf16 v[228:231], a[232:235], a[64:67], v[228:231]
v_cvt_pk_bf16_f32 v94, v224, v225
v_cvt_pk_bf16_f32 v95, v226, v227
v_mfma_f32_16x16x32_bf16 v[228:231], a[236:239], a[68:71], v[228:231]
buffer_store_dwordx2 v[150:151], v15, s[12:15], s47 offen offset:256 sc1
s_waitcnt lgkmcnt(9)
ds_read_b128 a[232:235], v1 offset:22528
v_mfma_f32_16x16x32_bf16 v[232:235], a[192:195], a[0:3], 0
s_waitcnt lgkmcnt(9)
s_mov_b32 s47, s31
ds_read_b128 a[236:239], v1 offset:23552
v_mfma_f32_16x16x32_bf16 v[232:235], a[196:199], a[4:7], v[232:235]
s_waitcnt lgkmcnt(9)
v_mfma_f32_16x16x32_bf16 v[232:235], a[200:203], a[8:11], v[232:235]
s_waitcnt lgkmcnt(8)
v_mfma_f32_16x16x32_bf16 v[232:235], a[204:207], a[12:15], v[232:235]
s_waitcnt lgkmcnt(7)
v_cvt_pk_bf16_f32 v142, v228, v229
v_cvt_pk_bf16_f32 v143, v230, v231
v_mfma_f32_16x16x32_bf16 v[232:235], a[208:211], a[16:19], v[232:235]
buffer_store_dwordx2 v[108:109], v16, s[12:15], s44 offen offset:256 sc1
s_waitcnt lgkmcnt(6)
v_mfma_f32_16x16x32_bf16 v[232:235], a[212:215], a[20:23], v[232:235]
v_mfma_f32_16x16x32_bf16 v[220:223], a[192:195], a[24:27], 0
v_mfma_f32_16x16x32_bf16 v[220:223], a[196:199], a[28:31], v[220:223]
v_mfma_f32_16x16x32_bf16 v[220:223], a[200:203], a[32:35], v[220:223]
v_mfma_f32_16x16x32_bf16 v[220:223], a[204:207], a[36:39], v[220:223]
buffer_store_dwordx2 v[110:111], v16, s[12:15], s44 offen offset:640 sc1
s_mov_b32 s44, s28
v_mfma_f32_16x16x32_bf16 v[220:223], a[208:211], a[40:43], v[220:223]
v_mfma_f32_16x16x32_bf16 v[220:223], a[212:215], a[44:47], v[220:223]
v_cvt_pk_bf16_f32 v64, v232, v233
v_cvt_pk_bf16_f32 v65, v234, v235
v_mfma_f32_16x16x32_bf16 v[224:227], a[192:195], a[48:51], 0
ds_read_b128 a[192:195], v1 offset:24576
v_mfma_f32_16x16x32_bf16 v[224:227], a[196:199], a[52:55], v[224:227]
ds_read_b128 a[196:199], v1 offset:25600
v_mfma_f32_16x16x32_bf16 v[224:227], a[200:203], a[56:59], v[224:227]
buffer_store_dwordx2 v[72:73], v16, s[12:15], s45 offen offset:256 sc1
v_cvt_pk_bf16_f32 v100, v220, v221
v_mfma_f32_16x16x32_bf16 v[224:227], a[204:207], a[60:63], v[224:227]
v_cvt_pk_bf16_f32 v101, v222, v223
v_mfma_f32_16x16x32_bf16 v[224:227], a[208:211], a[64:67], v[224:227]
ds_read_b128 a[200:203], v1 offset:26624
ds_read_b128 a[204:207], v1 offset:27648
v_mfma_f32_16x16x32_bf16 v[224:227], a[212:215], a[68:71], v[224:227]
s_waitcnt lgkmcnt(9)
ds_read_b128 a[208:211], v1 offset:28672
ds_read_b128 a[212:215], v1 offset:29696
v_mfma_f32_16x16x32_bf16 v[228:231], a[216:219], a[0:3], 0
s_waitcnt lgkmcnt(10)
v_mfma_f32_16x16x32_bf16 v[228:231], a[220:223], a[4:7], v[228:231]
buffer_store_dwordx2 v[116:117], v16, s[12:15], s45 offen offset:640 sc1
s_waitcnt lgkmcnt(9)
s_mov_b32 s45, s29
v_mfma_f32_16x16x32_bf16 v[228:231], a[224:227], a[8:11], v[228:231]
s_waitcnt lgkmcnt(8)
v_mfma_f32_16x16x32_bf16 v[228:231], a[228:231], a[12:15], v[228:231]
s_waitcnt lgkmcnt(7)
v_cvt_pk_bf16_f32 v148, v224, v225
v_cvt_pk_bf16_f32 v149, v226, v227
v_mfma_f32_16x16x32_bf16 v[228:231], a[232:235], a[16:19], v[228:231]
s_waitcnt lgkmcnt(6)
v_mfma_f32_16x16x32_bf16 v[228:231], a[236:239], a[20:23], v[228:231]
v_mfma_f32_16x16x32_bf16 v[232:235], a[216:219], a[24:27], 0
buffer_load_dwordx4 a[72:75], v8, s[20:23], s32 offen offset:0 nt
v_mfma_f32_16x16x32_bf16 v[232:235], a[220:223], a[28:31], v[232:235]
v_mov_b64 v[76:77], 0
v_mfma_f32_16x16x32_bf16 v[232:235], a[224:227], a[32:35], v[232:235]
v_mov_b64 v[78:79], v[26:27]
v_mfma_f32_16x16x32_bf16 v[232:235], a[228:231], a[36:39], v[232:235]
v_mov_b64 v[80:81], 0
v_mfma_f32_16x16x32_bf16 v[232:235], a[232:235], a[40:43], v[232:235]
v_mov_b64 v[82:83], v[26:27]
v_mfma_f32_16x16x32_bf16 v[232:235], a[236:239], a[44:47], v[232:235]
v_mov_b64 v[84:85], 0
v_mfma_f32_16x16x32_bf16 v[220:223], a[216:219], a[48:51], 0
v_mov_b64 v[86:87], v[26:27]
v_mfma_f32_16x16x32_bf16 v[220:223], a[220:223], a[52:55], v[220:223]
v_cvt_pk_bf16_f32 v66, v228, v229
v_cvt_pk_bf16_f32 v67, v230, v231
v_mfma_f32_16x16x32_bf16 v[220:223], a[224:227], a[56:59], v[220:223]
ds_read_b128 a[216:219], v1 offset:30720
ds_read_b128 a[220:223], v1 offset:31744
v_mfma_f32_16x16x32_bf16 v[220:223], a[228:231], a[60:63], v[220:223]
ds_read_b128 a[224:227], v1 offset:32768
ds_read_b128 a[228:231], v1 offset:33792
v_mfma_f32_16x16x32_bf16 v[220:223], a[232:235], a[64:67], v[220:223]
v_cvt_pk_bf16_f32 v102, v232, v233
v_cvt_pk_bf16_f32 v103, v234, v235
v_mfma_f32_16x16x32_bf16 v[220:223], a[236:239], a[68:71], v[220:223]
ds_read_b128 a[232:235], v1 offset:34816
ds_read_b128 a[236:239], v1 offset:35840
v_smfmac_f32_16x16x64_bf16 v[76:79], a[180:183], a[0:7], v0
v_smfmac_f32_16x16x64_bf16 v[76:79], a[184:187], a[8:15], v0
v_smfmac_f32_16x16x64_bf16 v[76:79], a[188:191], a[16:23], v0
v_smfmac_f32_16x16x64_bf16 v[80:83], a[180:183], a[24:31], v0
v_smfmac_f32_16x16x64_bf16 v[80:83], a[184:187], a[32:39], v0
v_smfmac_f32_16x16x64_bf16 v[80:83], a[188:191], a[40:47], v0
v_cvt_pk_bf16_f32 v150, v220, v221
v_smfmac_f32_16x16x64_bf16 v[84:87], a[180:183], a[48:55], v0
v_cvt_pk_bf16_f32 v151, v222, v223
v_smfmac_f32_16x16x64_bf16 v[84:87], a[184:187], a[56:63], v0
v_smfmac_f32_16x16x64_bf16 v[84:87], a[188:191], a[64:71], v0
s_waitcnt lgkmcnt(11)
v_add_f32 v78, v78, v79
v_mfma_f32_16x16x32_bf16 v[224:227], a[192:195], a[0:3], 0
buffer_load_dwordx4 a[76:79], v9, s[20:23], s32 offen offset:0 nt
s_waitcnt lgkmcnt(10)
v_add_f32 v76, v76, v77
v_mfma_f32_16x16x32_bf16 v[224:227], a[196:199], a[4:7], v[224:227]
s_waitcnt lgkmcnt(9)
v_add_f32 v80, v80, v81
v_max3_f32 v88, v19, v76, v80
v_mfma_f32_16x16x32_bf16 v[224:227], a[200:203], a[8:11], v[224:227]
s_waitcnt lgkmcnt(8)
v_add_f32 v84, v84, v85
v_max_f32 v88, v88, v84
v_mfma_f32_16x16x32_bf16 v[224:227], a[204:207], a[12:15], v[224:227]
s_waitcnt lgkmcnt(7)
v_add_f32 v82, v82, v83
v_max_f32_dpp v88, v88, v88 row_ror:8 row_mask:0xf bank_mask:0xf
v_mfma_f32_16x16x32_bf16 v[224:227], a[208:211], a[16:19], v[224:227]
s_waitcnt lgkmcnt(6)
v_add_f32 v86, v86, v87
v_max_f32_dpp v88, v88, v88 row_ror:4 row_mask:0xf bank_mask:0xf
v_mfma_f32_16x16x32_bf16 v[224:227], a[212:215], a[20:23], v[224:227]
v_mfma_f32_16x16x32_bf16 v[228:231], a[192:195], a[24:27], 0
v_max_f32_dpp v88, v88, v88 row_ror:2 row_mask:0xf bank_mask:0xf
v_mfma_f32_16x16x32_bf16 v[228:231], a[196:199], a[28:31], v[228:231]
v_mfma_f32_16x16x32_bf16 v[228:231], a[200:203], a[32:35], v[228:231]
v_max_f32_dpp v88, v88, v88 row_ror:1 row_mask:0xf bank_mask:0xf
v_sub_f32 v89, v19, v88
v_mfma_f32_16x16x32_bf16 v[228:231], a[204:207], a[36:39], v[228:231]
v_sub_f32 v76, v76, v88
v_cvt_pk_bf16_f32 v68, v224, v225
v_mfma_f32_16x16x32_bf16 v[228:231], a[208:211], a[40:43], v[228:231]
v_cvt_pk_bf16_f32 v69, v226, v227
v_sub_f32 v80, v80, v88
v_mfma_f32_16x16x32_bf16 v[228:231], a[212:215], a[44:47], v[228:231]
v_sub_f32 v84, v84, v88
v_mfma_f32_16x16x32_bf16 v[232:235], a[192:195], a[48:51], 0
ds_read_b128 a[192:195], v1 offset:36864
v_mfma_f32_16x16x32_bf16 v[232:235], a[196:199], a[52:55], v[232:235]
ds_read_b128 a[196:199], v1 offset:37888
v_mfma_f32_16x16x32_bf16 v[232:235], a[200:203], a[56:59], v[232:235]
buffer_load_dwordx4 a[96:99], v10, s[20:23], s32 offen offset:0 nt
ds_read_b128 a[200:203], v1 offset:38912
v_mfma_f32_16x16x32_bf16 v[232:235], a[204:207], a[60:63], v[232:235]
ds_read_b128 a[204:207], v1 offset:39936
v_cvt_pk_bf16_f32 v108, v228, v229
v_mfma_f32_16x16x32_bf16 v[232:235], a[208:211], a[64:67], v[232:235]
v_cvt_pk_bf16_f32 v109, v230, v231
v_mfma_f32_16x16x32_bf16 v[232:235], a[212:215], a[68:71], v[232:235]
s_waitcnt lgkmcnt(9)
ds_read_b128 a[208:211], v1 offset:40960
ds_read_b128 a[212:215], v1 offset:41984
v_mfma_f32_16x16x32_bf16 v[220:223], a[216:219], a[0:3], 0
s_waitcnt lgkmcnt(10)
v_exp_f32 v76, v76
v_mfma_f32_16x16x32_bf16 v[220:223], a[220:223], a[4:7], v[220:223]
s_waitcnt lgkmcnt(9)
v_exp_f32 v80, v80
v_mfma_f32_16x16x32_bf16 v[220:223], a[224:227], a[8:11], v[220:223]
s_waitcnt lgkmcnt(8)
v_exp_f32 v84, v84
v_mfma_f32_16x16x32_bf16 v[220:223], a[228:231], a[12:15], v[220:223]
s_waitcnt lgkmcnt(7)
v_cvt_pk_bf16_f32 v156, v232, v233
v_cvt_pk_bf16_f32 v157, v234, v235
v_mfma_f32_16x16x32_bf16 v[220:223], a[232:235], a[16:19], v[220:223]
s_waitcnt lgkmcnt(6)
v_exp_f32 v89, v89
v_mfma_f32_16x16x32_bf16 v[220:223], a[236:239], a[20:23], v[220:223]
v_add_f32 v88, v76, v80
v_add_f32 v90, v84, v89
v_mfma_f32_16x16x32_bf16 v[224:227], a[216:219], a[24:27], 0
v_add_f32 v88, v88, v90
v_mfma_f32_16x16x32_bf16 v[224:227], a[220:223], a[28:31], v[224:227]
v_mfma_f32_16x16x32_bf16 v[224:227], a[224:227], a[32:35], v[224:227]
v_add_f32_dpp v88, v88, v88 row_ror:8 row_mask:0xf bank_mask:0xf
v_mfma_f32_16x16x32_bf16 v[224:227], a[228:231], a[36:39], v[224:227]
v_cvt_pk_bf16_f32 v70, v220, v221
v_cvt_pk_bf16_f32 v71, v222, v223
v_mfma_f32_16x16x32_bf16 v[224:227], a[232:235], a[40:43], v[224:227]
v_add_f32_dpp v88, v88, v88 row_ror:4 row_mask:0xf bank_mask:0xf
v_mfma_f32_16x16x32_bf16 v[224:227], a[236:239], a[44:47], v[224:227]
v_mfma_f32_16x16x32_bf16 v[228:231], a[216:219], a[48:51], 0
ds_read_b128 a[216:219], v1 offset:43008
v_add_f32_dpp v88, v88, v88 row_ror:2 row_mask:0xf bank_mask:0xf
v_mfma_f32_16x16x32_bf16 v[228:231], a[220:223], a[52:55], v[228:231]
buffer_load_dwordx4 a[100:103], v11, s[20:23], s32 offen offset:0 nt
ds_read_b128 a[220:223], v1 offset:44032
v_mfma_f32_16x16x32_bf16 v[228:231], a[224:227], a[56:59], v[228:231]
ds_read_b128 a[224:227], v1 offset:45056
v_cvt_pk_bf16_f32 v110, v224, v225
v_mfma_f32_16x16x32_bf16 v[228:231], a[228:231], a[60:63], v[228:231]
ds_read_b128 a[228:231], v1 offset:46080
v_cvt_pk_bf16_f32 v111, v226, v227
v_mfma_f32_16x16x32_bf16 v[228:231], a[232:235], a[64:67], v[228:231]
ds_read_b128 a[232:235], v1 offset:47104
v_add_f32_dpp v88, v88, v88 row_ror:1 row_mask:0xf bank_mask:0xf
v_mfma_f32_16x16x32_bf16 v[228:231], a[236:239], a[68:71], v[228:231]
s_waitcnt lgkmcnt(10)
ds_read_b128 a[236:239], v1 offset:48128
v_mfma_f32_16x16x32_bf16 v[232:235], a[192:195], a[0:3], 0
s_waitcnt lgkmcnt(10)
v_rcp_f32 v88, v88
v_mfma_f32_16x16x32_bf16 v[232:235], a[196:199], a[4:7], v[232:235]
s_waitcnt lgkmcnt(9)
v_mul_f32 v76, v76, v88
v_mul_f32 v80, v80, v88
v_mfma_f32_16x16x32_bf16 v[232:235], a[200:203], a[8:11], v[232:235]
s_waitcnt lgkmcnt(8)
v_mul_f32 v84, v84, v88
v_cvt_pk_bf16_f32 v158, v228, v229
v_mfma_f32_16x16x32_bf16 v[232:235], a[204:207], a[12:15], v[232:235]
s_waitcnt lgkmcnt(7)
v_cvt_pk_bf16_f32 v159, v230, v231
v_mul_f32 v89, v89, v88
v_mfma_f32_16x16x32_bf16 v[232:235], a[208:211], a[16:19], v[232:235]
s_waitcnt lgkmcnt(6)
v_cvt_pk_bf16_f32 v90, v76, v80
v_cvt_pk_bf16_f32 v91, v84, v89
v_mfma_f32_16x16x32_bf16 v[232:235], a[212:215], a[20:23], v[232:235]
ds_write_b16 v20, v90 offset:0
v_mfma_f32_16x16x32_bf16 v[220:223], a[192:195], a[24:27], 0
ds_write_b16_d16_hi v20, v90 offset:4
v_mfma_f32_16x16x32_bf16 v[220:223], a[196:199], a[28:31], v[220:223]
ds_write_b16 v20, v91 offset:32
v_mfma_f32_16x16x32_bf16 v[220:223], a[200:203], a[32:35], v[220:223]
ds_write_b16_d16_hi v20, v91 offset:36
v_mfma_f32_16x16x32_bf16 v[220:223], a[204:207], a[36:39], v[220:223]
v_cvt_pk_bf16_f32 v72, v232, v233
v_cvt_pk_bf16_f32 v73, v234, v235
v_mfma_f32_16x16x32_bf16 v[220:223], a[208:211], a[40:43], v[220:223]
ds_read_b128 a[240:243], v22 offset:0
ds_read_b128 a[244:247], v22 offset:128
v_mfma_f32_16x16x32_bf16 v[220:223], a[212:215], a[44:47], v[220:223]
ds_read_b128 a[248:251], v22 offset:256
ds_read_b128 a[252:255], v22 offset:384
v_mfma_f32_16x16x32_bf16 v[224:227], a[192:195], a[48:51], 0
ds_read_b128 a[192:195], v1 offset:49152
v_subrev_u32 v22, 512, v22
v_mfma_f32_16x16x32_bf16 v[224:227], a[196:199], a[52:55], v[224:227]
buffer_load_dwordx4 a[120:123], v12, s[20:23], s32 offen offset:0 nt
ds_read_b128 a[196:199], v1 offset:50176
v_mfma_f32_16x16x32_bf16 v[224:227], a[200:203], a[56:59], v[224:227]
ds_read_b128 a[200:203], v1 offset:51200
v_cvt_pk_bf16_f32 v116, v220, v221
v_mfma_f32_16x16x32_bf16 v[224:227], a[204:207], a[60:63], v[224:227]
ds_read_b128 a[204:207], v1 offset:52224
v_cvt_pk_bf16_f32 v117, v222, v223
v_mfma_f32_16x16x32_bf16 v[224:227], a[208:211], a[64:67], v[224:227]
ds_read_b128 a[208:211], v1 offset:53248
v_mfma_f32_16x16x32_bf16 v[224:227], a[212:215], a[68:71], v[224:227]
s_waitcnt lgkmcnt(15)
ds_read_b128 a[212:215], v1 offset:54272
v_mfma_f32_16x16x32_bf16 v[228:231], a[216:219], a[0:3], 0
v_mfma_f32_16x16x32_bf16 v[228:231], a[220:223], a[4:7], v[228:231]
v_mfma_f32_16x16x32_bf16 v[228:231], a[224:227], a[8:11], v[228:231]
v_mfma_f32_16x16x32_bf16 v[228:231], a[228:231], a[12:15], v[228:231]
s_waitcnt lgkmcnt(15)
v_mfma_f32_16x16x32_bf16 v[228:231], a[232:235], a[16:19], v[228:231]
s_waitcnt lgkmcnt(14)
v_mfma_f32_16x16x32_bf16 v[228:231], a[236:239], a[20:23], v[228:231]
v_mfma_f32_16x16x32_bf16 v[232:235], a[216:219], a[24:27], 0
v_cvt_pk_bf16_f32 v164, v224, v225
v_cvt_pk_bf16_f32 v165, v226, v227
v_mfma_f32_16x16x32_bf16 v[232:235], a[220:223], a[28:31], v[232:235]
v_mfma_f32_16x16x32_bf16 v[232:235], a[224:227], a[32:35], v[232:235]
v_mfma_f32_16x16x32_bf16 v[232:235], a[228:231], a[36:39], v[232:235]
v_mfma_f32_16x16x32_bf16 v[232:235], a[232:235], a[40:43], v[232:235]
v_mfma_f32_16x16x32_bf16 v[232:235], a[236:239], a[44:47], v[232:235]
v_cvt_pk_bf16_f32 v74, v228, v229
v_cvt_pk_bf16_f32 v75, v230, v231
v_mfma_f32_16x16x32_bf16 v[220:223], a[216:219], a[48:51], 0
buffer_load_dwordx4 a[124:127], v13, s[20:23], s32 offen offset:0 nt
ds_read_b128 a[216:219], v1 offset:55296
v_mfma_f32_16x16x32_bf16 v[220:223], a[220:223], a[52:55], v[220:223]
ds_read_b128 a[220:223], v1 offset:56320
v_mfma_f32_16x16x32_bf16 v[220:223], a[224:227], a[56:59], v[220:223]
ds_read_b128 a[224:227], v1 offset:57344
v_cvt_pk_bf16_f32 v118, v232, v233
v_mfma_f32_16x16x32_bf16 v[220:223], a[228:231], a[60:63], v[220:223]
ds_read_b128 a[228:231], v1 offset:58368
v_cvt_pk_bf16_f32 v119, v234, v235
v_mfma_f32_16x16x32_bf16 v[220:223], a[232:235], a[64:67], v[220:223]
ds_read_b128 a[232:235], v1 offset:59392
v_mfma_f32_16x16x32_bf16 v[220:223], a[236:239], a[68:71], v[220:223]
s_waitcnt lgkmcnt(10)
ds_read_b128 a[236:239], v1 offset:60416
v_mfma_f32_16x16x32_bf16 v[224:227], a[192:195], a[0:3], 0
s_waitcnt lgkmcnt(10)
v_mfma_f32_16x16x32_bf16 v[224:227], a[196:199], a[4:7], v[224:227]
s_waitcnt lgkmcnt(9)
v_mfma_f32_16x16x32_bf16 v[224:227], a[200:203], a[8:11], v[224:227]
s_waitcnt lgkmcnt(8)
v_mfma_f32_16x16x32_bf16 v[224:227], a[204:207], a[12:15], v[224:227]
s_waitcnt lgkmcnt(7)
v_mfma_f32_16x16x32_bf16 v[224:227], a[208:211], a[16:19], v[224:227]
s_waitcnt lgkmcnt(6)
v_mfma_f32_16x16x32_bf16 v[224:227], a[212:215], a[20:23], v[224:227]
v_mfma_f32_16x16x32_bf16 v[228:231], a[192:195], a[24:27], 0
v_cvt_pk_bf16_f32 v166, v220, v221
v_cvt_pk_bf16_f32 v167, v222, v223
v_mfma_f32_16x16x32_bf16 v[228:231], a[196:199], a[28:31], v[228:231]
v_mfma_f32_16x16x32_bf16 v[228:231], a[200:203], a[32:35], v[228:231]
v_mfma_f32_16x16x32_bf16 v[228:231], a[204:207], a[36:39], v[228:231]
v_mfma_f32_16x16x32_bf16 v[228:231], a[208:211], a[40:43], v[228:231]
v_mfma_f32_16x16x32_bf16 v[228:231], a[212:215], a[44:47], v[228:231]
v_cvt_pk_bf16_f32 v236, v224, v225
v_cvt_pk_bf16_f32 v237, v226, v227
v_mfma_f32_16x16x32_bf16 v[232:235], a[192:195], a[48:51], 0
buffer_load_dwordx4 a[80:83], v8, s[20:23], s32 offen offset:128 nt
ds_read_b128 a[192:195], v1 offset:61440
v_mfma_f32_16x16x32_bf16 v[232:235], a[196:199], a[52:55], v[232:235]
ds_read_b128 a[196:199], v1 offset:62464
v_mfma_f32_16x16x32_bf16 v[232:235], a[200:203], a[56:59], v[232:235]
ds_read_b128 a[200:203], v1 offset:63488
v_cvt_pk_bf16_f32 v124, v228, v229
v_mfma_f32_16x16x32_bf16 v[232:235], a[204:207], a[60:63], v[232:235]
ds_read_b128 a[204:207], v1 offset:64512
v_cvt_pk_bf16_f32 v125, v230, v231
v_mfma_f32_16x16x32_bf16 v[232:235], a[208:211], a[64:67], v[232:235]
ds_read_b128 a[208:211], v2 offset:0
v_mfma_f32_16x16x32_bf16 v[232:235], a[212:215], a[68:71], v[232:235]
s_waitcnt lgkmcnt(10)
ds_read_b128 a[212:215], v2 offset:1024
v_mfma_f32_16x16x32_bf16 v[220:223], a[216:219], a[0:3], 0
s_waitcnt lgkmcnt(10)
v_mfma_f32_16x16x32_bf16 v[220:223], a[220:223], a[4:7], v[220:223]
s_waitcnt lgkmcnt(9)
v_mfma_f32_16x16x32_bf16 v[220:223], a[224:227], a[8:11], v[220:223]
s_waitcnt lgkmcnt(8)
v_mfma_f32_16x16x32_bf16 v[220:223], a[228:231], a[12:15], v[220:223]
s_waitcnt lgkmcnt(7)
v_mfma_f32_16x16x32_bf16 v[220:223], a[232:235], a[16:19], v[220:223]
s_waitcnt lgkmcnt(6)
v_mfma_f32_16x16x32_bf16 v[220:223], a[236:239], a[20:23], v[220:223]
LW_p6:
s_cbranch_execz LW_p9
v_mfma_f32_16x16x32_bf16 v[224:227], a[216:219], a[24:27], 0
v_cvt_pk_bf16_f32 v172, v232, v233
v_cvt_pk_bf16_f32 v173, v234, v235
v_mfma_f32_16x16x32_bf16 v[224:227], a[220:223], a[28:31], v[224:227]
v_mfma_f32_16x16x32_bf16 v[224:227], a[224:227], a[32:35], v[224:227]
v_mfma_f32_16x16x32_bf16 v[224:227], a[228:231], a[36:39], v[224:227]
v_mfma_f32_16x16x32_bf16 v[224:227], a[232:235], a[40:43], v[224:227]
v_mfma_f32_16x16x32_bf16 v[224:227], a[236:239], a[44:47], v[224:227]
buffer_load_dwordx4 a[84:87], v9, s[20:23], s32 offen offset:128 nt
v_cvt_pk_bf16_f32 v238, v220, v221
v_mfma_f32_16x16x32_bf16 v[228:231], a[216:219], a[48:51], 0
v_cvt_pk_bf16_f32 v239, v222, v223
v_mfma_f32_16x16x32_bf16 v[228:231], a[220:223], a[52:55], v[228:231]
ds_read_b128 a[216:219], v2 offset:2048
ds_read_b128 a[220:223], v2 offset:3072
v_mfma_f32_16x16x32_bf16 v[228:231], a[224:227], a[56:59], v[228:231]
ds_read_b128 a[224:227], v2 offset:4096
v_cvt_pk_bf16_f32 v126, v224, v225
v_mfma_f32_16x16x32_bf16 v[228:231], a[228:231], a[60:63], v[228:231]
ds_read_b128 a[228:231], v2 offset:5120
v_cvt_pk_bf16_f32 v127, v226, v227
v_mfma_f32_16x16x32_bf16 v[228:231], a[232:235], a[64:67], v[228:231]
ds_read_b128 a[232:235], v2 offset:6144
v_mfma_f32_16x16x32_bf16 v[228:231], a[236:239], a[68:71], v[228:231]
s_waitcnt lgkmcnt(10)
ds_read_b128 a[236:239], v2 offset:7168
v_mfma_f32_16x16x32_bf16 v[232:235], a[192:195], a[0:3], 0
s_waitcnt lgkmcnt(10)
v_mfma_f32_16x16x32_bf16 v[232:235], a[196:199], a[4:7], v[232:235]
s_waitcnt lgkmcnt(9)
v_mfma_f32_16x16x32_bf16 v[232:235], a[200:203], a[8:11], v[232:235]
s_waitcnt lgkmcnt(8)
v_mfma_f32_16x16x32_bf16 v[232:235], a[204:207], a[12:15], v[232:235]
s_waitcnt lgkmcnt(7)
v_mfma_f32_16x16x32_bf16 v[232:235], a[208:211], a[16:19], v[232:235]
s_waitcnt lgkmcnt(6)
v_mfma_f32_16x16x32_bf16 v[232:235], a[212:215], a[20:23], v[232:235]
v_mfma_f32_16x16x32_bf16 v[220:223], a[192:195], a[24:27], 0
v_cvt_pk_bf16_f32 v174, v228, v229
v_cvt_pk_bf16_f32 v175, v230, v231
v_mfma_f32_16x16x32_bf16 v[220:223], a[196:199], a[28:31], v[220:223]
v_mfma_f32_16x16x32_bf16 v[220:223], a[200:203], a[32:35], v[220:223]
v_mfma_f32_16x16x32_bf16 v[220:223], a[204:207], a[36:39], v[220:223]
v_mfma_f32_16x16x32_bf16 v[220:223], a[208:211], a[40:43], v[220:223]
v_mfma_f32_16x16x32_bf16 v[220:223], a[212:215], a[44:47], v[220:223]
buffer_load_dwordx4 a[104:107], v10, s[20:23], s32 offen offset:128 nt
v_cvt_pk_bf16_f32 v240, v232, v233
v_mfma_f32_16x16x32_bf16 v[224:227], a[192:195], a[48:51], 0
v_cvt_pk_bf16_f32 v241, v234, v235
v_mfma_f32_16x16x32_bf16 v[224:227], a[196:199], a[52:55], v[224:227]
ds_read_b128 a[192:195], v2 offset:8192
ds_read_b128 a[196:199], v2 offset:9216
v_mfma_f32_16x16x32_bf16 v[224:227], a[200:203], a[56:59], v[224:227]
v_cvt_pk_bf16_f32 v132, v220, v221
v_cvt_pk_bf16_f32 v133, v222, v223
v_mfma_f32_16x16x32_bf16 v[224:227], a[204:207], a[60:63], v[224:227]
ds_read_b128 a[200:203], v2 offset:10240
ds_read_b128 a[204:207], v2 offset:11264
v_mfma_f32_16x16x32_bf16 v[224:227], a[208:211], a[64:67], v[224:227]
ds_read_b128 a[208:211], v2 offset:12288
v_mfma_f32_16x16x32_bf16 v[224:227], a[212:215], a[68:71], v[224:227]
s_waitcnt lgkmcnt(10)
ds_read_b128 a[212:215], v2 offset:13312
v_mfma_f32_16x16x32_bf16 v[228:231], a[216:219], a[0:3], 0
s_waitcnt lgkmcnt(10)
v_mfma_f32_16x16x32_bf16 v[228:231], a[220:223], a[4:7], v[228:231]
s_waitcnt lgkmcnt(9)
v_mfma_f32_16x16x32_bf16 v[228:231], a[224:227], a[8:11], v[228:231]
s_waitcnt lgkmcnt(8)
v_mfma_f32_16x16x32_bf16 v[228:231], a[228:231], a[12:15], v[228:231]
s_waitcnt lgkmcnt(7)
v_mfma_f32_16x16x32_bf16 v[228:231], a[232:235], a[16:19], v[228:231]
s_waitcnt lgkmcnt(6)
v_mfma_f32_16x16x32_bf16 v[228:231], a[236:239], a[20:23], v[228:231]
v_mfma_f32_16x16x32_bf16 v[232:235], a[216:219], a[24:27], 0
v_cvt_pk_bf16_f32 v180, v224, v225
v_cvt_pk_bf16_f32 v181, v226, v227
v_mfma_f32_16x16x32_bf16 v[232:235], a[220:223], a[28:31], v[232:235]
v_mfma_f32_16x16x32_bf16 v[232:235], a[224:227], a[32:35], v[232:235]
v_mfma_f32_16x16x32_bf16 v[232:235], a[228:231], a[36:39], v[232:235]
v_mfma_f32_16x16x32_bf16 v[232:235], a[232:235], a[40:43], v[232:235]
buffer_load_dwordx4 a[108:111], v11, s[20:23], s32 offen offset:128 nt
v_cvt_pk_bf16_f32 v242, v228, v229
v_mfma_f32_16x16x32_bf16 v[232:235], a[236:239], a[44:47], v[232:235]
v_cvt_pk_bf16_f32 v243, v230, v231
v_mfma_f32_16x16x32_bf16 v[220:223], a[216:219], a[48:51], 0
ds_read_b128 a[216:219], v2 offset:14336
v_mfma_f32_16x16x32_bf16 v[220:223], a[220:223], a[52:55], v[220:223]
ds_read_b128 a[220:223], v2 offset:15360
v_mfma_f32_16x16x32_bf16 v[220:223], a[224:227], a[56:59], v[220:223]
ds_read_b128 a[224:227], v2 offset:16384
v_mfma_f32_16x16x32_bf16 v[220:223], a[228:231], a[60:63], v[220:223]
v_cvt_pk_bf16_f32 v134, v232, v233
v_cvt_pk_bf16_f32 v135, v234, v235
v_mfma_f32_16x16x32_bf16 v[220:223], a[232:235], a[64:67], v[220:223]
ds_read_b128 a[228:231], v2 offset:17408
ds_read_b128 a[232:235], v2 offset:18432
v_mfma_f32_16x16x32_bf16 v[220:223], a[236:239], a[68:71], v[220:223]
ds_read_b128 a[236:239], v2 offset:19456
v_mfma_f32_16x16x32_bf16 v[28:31], a[0:3], v[60:63], 0
v_mfma_f32_16x16x32_bf16 v[28:31], a[4:7], v[64:67], v[28:31]
v_mfma_f32_16x16x32_bf16 v[28:31], a[8:11], v[68:71], v[28:31]
v_mfma_f32_16x16x32_bf16 v[28:31], a[12:15], v[72:75], v[28:31]
v_mfma_f32_16x16x32_bf16 v[28:31], a[16:19], v[236:239], v[28:31]
v_mfma_f32_16x16x32_bf16 v[28:31], a[20:23], v[240:243], v[28:31]
v_mfma_f32_16x16x32_bf16 v[32:35], a[24:27], v[60:63], 0
v_cvt_pk_bf16_f32 v182, v220, v221
v_cvt_pk_bf16_f32 v183, v222, v223
v_mfma_f32_16x16x32_bf16 v[32:35], a[28:31], v[64:67], v[32:35]
v_mfma_f32_16x16x32_bf16 v[32:35], a[32:35], v[68:71], v[32:35]
v_mfma_f32_16x16x32_bf16 v[32:35], a[36:39], v[72:75], v[32:35]
v_mfma_f32_16x16x32_bf16 v[32:35], a[40:43], v[236:239], v[32:35]
buffer_load_dwordx4 a[128:131], v12, s[20:23], s32 offen offset:128 nt
v_max3_f32 v42, v28, v29, v30
v_mfma_f32_16x16x32_bf16 v[32:35], a[44:47], v[240:243], v[32:35]
v_mfma_f32_16x16x32_bf16 v[36:39], a[48:51], v[60:63], 0
v_mfma_f32_16x16x32_bf16 v[36:39], a[52:55], v[64:67], v[36:39]
v_mfma_f32_16x16x32_bf16 v[36:39], a[56:59], v[68:71], v[36:39]
v_mfma_f32_16x16x32_bf16 v[36:39], a[60:63], v[72:75], v[36:39]
v_mfma_f32_16x16x32_bf16 v[36:39], a[64:67], v[236:239], v[36:39]
v_mfma_f32_16x16x32_bf16 v[36:39], a[68:71], v[240:243], v[36:39]
v_mfma_f32_16x16x32_bf16 v[44:47], a[0:3], v[92:95], 0
v_mfma_f32_16x16x32_bf16 v[44:47], a[4:7], v[100:103], v[44:47]
v_max3_f32 v42, v42, v31, v32
v_max3_f32 v42, v42, v33, v34
v_mfma_f32_16x16x32_bf16 v[44:47], a[8:11], v[108:111], v[44:47]
v_mfma_f32_16x16x32_bf16 v[44:47], a[12:15], v[116:119], v[44:47]
v_mfma_f32_16x16x32_bf16 v[44:47], a[16:19], v[124:127], v[44:47]
v_mfma_f32_16x16x32_bf16 v[44:47], a[20:23], v[132:135], v[44:47]
v_max3_f32 v42, v42, v35, v36
v_max3_f32 v42, v42, v37, v38
v_mfma_f32_16x16x32_bf16 v[48:51], a[24:27], v[92:95], 0
v_max3_f32 v42, v42, v39, v78
v_mov_b32 v43, v42
v_mfma_f32_16x16x32_bf16 v[48:51], a[28:31], v[100:103], v[48:51]
v_mfma_f32_16x16x32_bf16 v[48:51], a[32:35], v[108:111], v[48:51]
v_permlane32_swap_b32 v42, v43
v_mfma_f32_16x16x32_bf16 v[48:51], a[36:39], v[116:119], v[48:51]
buffer_load_dwordx4 a[132:135], v13, s[20:23], s32 offen offset:128 nt
v_max_f32 v42, v42, v43
v_mfma_f32_16x16x32_bf16 v[48:51], a[40:43], v[124:127], v[48:51]
v_mov_b32 v43, v42
v_max3_f32 v58, v44, v45, v46
v_mfma_f32_16x16x32_bf16 v[48:51], a[44:47], v[132:135], v[48:51]
v_permlane16_swap_b32 v42, v43
v_mfma_f32_16x16x32_bf16 v[52:55], a[48:51], v[92:95], 0
v_max_f32 v42, v42, v43
v_sub_f32 v28, v28, v42
v_mfma_f32_16x16x32_bf16 v[52:55], a[52:55], v[100:103], v[52:55]
v_sub_f32 v29, v29, v42
v_sub_f32 v30, v30, v42
v_mfma_f32_16x16x32_bf16 v[52:55], a[56:59], v[108:111], v[52:55]
v_exp_f32 v28, v28
v_mfma_f32_16x16x32_bf16 v[52:55], a[60:63], v[116:119], v[52:55]
v_exp_f32 v29, v29
v_mfma_f32_16x16x32_bf16 v[52:55], a[64:67], v[124:127], v[52:55]
v_sub_f32 v31, v31, v42
v_sub_f32 v32, v32, v42
v_mfma_f32_16x16x32_bf16 v[52:55], a[68:71], v[132:135], v[52:55]
v_sub_f32 v33, v33, v42
v_sub_f32 v34, v34, v42
v_mfma_f32_16x16x32_bf16 v[60:63], a[0:3], v[140:143], 0
v_sub_f32 v35, v35, v42
v_sub_f32 v36, v36, v42
v_mfma_f32_16x16x32_bf16 v[60:63], a[4:7], v[148:151], v[60:63]
v_sub_f32 v37, v37, v42
v_sub_f32 v38, v38, v42
v_mfma_f32_16x16x32_bf16 v[60:63], a[8:11], v[156:159], v[60:63]
v_sub_f32 v39, v39, v42
v_sub_f32 v78, v78, v42
v_mfma_f32_16x16x32_bf16 v[60:63], a[12:15], v[164:167], v[60:63]
v_exp_f32 v30, v30
v_mfma_f32_16x16x32_bf16 v[60:63], a[16:19], v[172:175], v[60:63]
v_exp_f32 v31, v31
v_mfma_f32_16x16x32_bf16 v[60:63], a[20:23], v[180:183], v[60:63]
v_add_f32 v42, v28, v29
v_add_f32 v42, v42, v30
v_mfma_f32_16x16x32_bf16 v[64:67], a[24:27], v[140:143], 0
v_exp_f32 v32, v32
v_mfma_f32_16x16x32_bf16 v[64:67], a[28:31], v[148:151], v[64:67]
v_exp_f32 v33, v33
v_mfma_f32_16x16x32_bf16 v[64:67], a[32:35], v[156:159], v[64:67]
v_add_f32 v42, v42, v31
v_add_f32 v42, v42, v32
v_mfma_f32_16x16x32_bf16 v[64:67], a[36:39], v[164:167], v[64:67]
buffer_load_dwordx4 a[88:91], v8, s[20:23], s32 offen offset:256 nt
v_add_f32 v42, v42, v33
v_mfma_f32_16x16x32_bf16 v[64:67], a[40:43], v[172:175], v[64:67]
v_exp_f32 v34, v34
v_mfma_f32_16x16x32_bf16 v[64:67], a[44:47], v[180:183], v[64:67]
v_exp_f32 v35, v35
v_mfma_f32_16x16x32_bf16 v[68:71], a[48:51], v[140:143], 0
v_exp_f32 v36, v36
v_mfma_f32_16x16x32_bf16 v[68:71], a[52:55], v[148:151], v[68:71]
v_add_f32 v42, v42, v34
v_add_f32 v42, v42, v35
v_mfma_f32_16x16x32_bf16 v[68:71], a[56:59], v[156:159], v[68:71]
v_exp_f32 v37, v37
v_mfma_f32_16x16x32_bf16 v[68:71], a[60:63], v[164:167], v[68:71]
v_exp_f32 v38, v38
v_mfma_f32_16x16x32_bf16 v[68:71], a[64:67], v[172:175], v[68:71]
v_add_f32 v42, v42, v36
v_add_f32 v42, v42, v37
v_mfma_f32_16x16x32_bf16 v[68:71], a[68:71], v[180:183], v[68:71]
s_waitcnt lgkmcnt(11)
v_exp_f32 v39, v39
v_mfma_f32_16x16x32_bf16 v[224:227], a[0:3], a[192:195], 0
s_waitcnt lgkmcnt(10)
v_exp_f32 v78, v78
v_mfma_f32_16x16x32_bf16 v[224:227], a[4:7], a[196:199], v[224:227]
s_waitcnt lgkmcnt(9)
v_add_f32 v42, v42, v38
v_add_f32 v42, v42, v39
v_mfma_f32_16x16x32_bf16 v[224:227], a[8:11], a[200:203], v[224:227]
s_waitcnt lgkmcnt(8)
v_add_f32 v42, v42, v78
v_mov_b32 v43, v42
v_mfma_f32_16x16x32_bf16 v[224:227], a[12:15], a[204:207], v[224:227]
s_waitcnt lgkmcnt(7)
v_max3_f32 v58, v58, v47, v48
v_max3_f32 v58, v58, v49, v50
v_mfma_f32_16x16x32_bf16 v[224:227], a[16:19], a[208:211], v[224:227]
s_waitcnt lgkmcnt(6)
v_permlane32_swap_b32 v42, v43
v_mfma_f32_16x16x32_bf16 v[224:227], a[20:23], a[212:215], v[224:227]
v_add_f32 v42, v42, v43
v_mov_b32 v43, v42
v_mfma_f32_16x16x32_bf16 v[228:231], a[24:27], a[192:195], 0
v_max3_f32 v58, v58, v51, v52
v_max3_f32 v58, v58, v53, v54
v_mfma_f32_16x16x32_bf16 v[228:231], a[28:31], a[196:199], v[228:231]
v_permlane16_swap_b32 v42, v43
v_mfma_f32_16x16x32_bf16 v[228:231], a[32:35], a[200:203], v[228:231]
buffer_load_dwordx4 a[92:95], v9, s[20:23], s32 offen offset:256 nt
v_cvt_pk_bf16_f32 v92, v224, v225
v_mfma_f32_16x16x32_bf16 v[228:231], a[36:39], a[204:207], v[228:231]
v_cvt_pk_bf16_f32 v93, v226, v227
v_add_f32 v42, v42, v43
v_mfma_f32_16x16x32_bf16 v[228:231], a[40:43], a[208:211], v[228:231]
v_rcp_f32 v42, v42
v_mfma_f32_16x16x32_bf16 v[228:231], a[44:47], a[212:215], v[228:231]
v_mul_f32 v28, v28, v42
v_mul_f32 v29, v29, v42
v_mfma_f32_16x16x32_bf16 v[232:235], a[48:51], a[192:195], 0
ds_read_b128 a[192:195], v2 offset:20480
v_mul_f32 v30, v30, v42
v_mfma_f32_16x16x32_bf16 v[232:235], a[52:55], a[196:199], v[232:235]
ds_read_b128 a[196:199], v2 offset:21504
v_mul_f32 v31, v31, v42
v_mfma_f32_16x16x32_bf16 v[232:235], a[56:59], a[200:203], v[232:235]
ds_read_b128 a[200:203], v2 offset:22528
v_cvt_pk_bf16_f32 v94, v228, v229
v_mfma_f32_16x16x32_bf16 v[232:235], a[60:63], a[204:207], v[232:235]
ds_read_b128 a[204:207], v2 offset:23552
v_cvt_pk_bf16_f32 v95, v230, v231
v_mfma_f32_16x16x32_bf16 v[232:235], a[64:67], a[208:211], v[232:235]
ds_read_b128 a[208:211], v2 offset:24576
v_cvt_pk_bf16_f32 v28, v28, v29
v_mfma_f32_16x16x32_bf16 v[232:235], a[68:71], a[212:215], v[232:235]
s_waitcnt lgkmcnt(10)
ds_read_b128 a[212:215], v2 offset:25600
v_mul_f32 v32, v32, v42
v_mfma_f32_16x16x32_bf16 v[220:223], a[0:3], a[216:219], 0
s_waitcnt lgkmcnt(10)
v_mul_f32 v33, v33, v42
v_mul_f32 v34, v34, v42
v_mfma_f32_16x16x32_bf16 v[220:223], a[4:7], a[220:223], v[220:223]
s_waitcnt lgkmcnt(9)
v_mul_f32 v35, v35, v42
v_cvt_pk_bf16_f32 v29, v30, v31
v_mfma_f32_16x16x32_bf16 v[220:223], a[8:11], a[224:227], v[220:223]
s_waitcnt lgkmcnt(8)
v_cvt_pk_bf16_f32 v96, v232, v233
v_cvt_pk_bf16_f32 v97, v234, v235
v_mfma_f32_16x16x32_bf16 v[220:223], a[12:15], a[228:231], v[220:223]
s_waitcnt lgkmcnt(7)
v_cvt_pk_bf16_f32 v30, v32, v33
v_cvt_pk_bf16_f32 v31, v34, v35
v_mfma_f32_16x16x32_bf16 v[220:223], a[16:19], a[232:235], v[220:223]
s_waitcnt lgkmcnt(6)
v_mul_f32 v36, v36, v42
v_mul_f32 v37, v37, v42
v_mfma_f32_16x16x32_bf16 v[220:223], a[20:23], a[236:239], v[220:223]
v_mul_f32 v38, v38, v42
v_mul_f32 v39, v39, v42
v_mfma_f32_16x16x32_bf16 v[224:227], a[24:27], a[216:219], 0
v_cvt_pk_bf16_f32 v36, v36, v37
v_mul_f32 v78, v78, v42
v_mfma_f32_16x16x32_bf16 v[224:227], a[28:31], a[220:223], v[224:227]
v_cvt_pk_bf16_f32 v37, v38, v39
v_max3_f32 v58, v58, v55, v82
v_mfma_f32_16x16x32_bf16 v[224:227], a[32:35], a[224:227], v[224:227]
buffer_load_dwordx4 a[112:115], v10, s[20:23], s32 offen offset:256 nt
v_cvt_pk_bf16_f32 v100, v220, v221
v_mfma_f32_16x16x32_bf16 v[224:227], a[36:39], a[228:231], v[224:227]
v_cvt_pk_bf16_f32 v101, v222, v223
v_cvt_pk_bf16_f32 v38, 0, v78
v_mfma_f32_16x16x32_bf16 v[224:227], a[40:43], a[232:235], v[224:227]
v_mov_b32 v39, 0
v_mov_b32 v59, v58
v_mfma_f32_16x16x32_bf16 v[224:227], a[44:47], a[236:239], v[224:227]
v_max3_f32 v74, v60, v61, v62
v_max3_f32 v74, v74, v63, v64
v_mfma_f32_16x16x32_bf16 v[228:231], a[48:51], a[216:219], 0
ds_read_b128 a[216:219], v2 offset:26624
v_max3_f32 v74, v74, v65, v66
v_mfma_f32_16x16x32_bf16 v[228:231], a[52:55], a[220:223], v[228:231]
ds_read_b128 a[220:223], v2 offset:27648
v_max3_f32 v74, v74, v67, v68
v_mfma_f32_16x16x32_bf16 v[228:231], a[56:59], a[224:227], v[228:231]
ds_read_b128 a[224:227], v2 offset:28672
v_cvt_pk_bf16_f32 v102, v224, v225
v_mfma_f32_16x16x32_bf16 v[228:231], a[60:63], a[228:231], v[228:231]
ds_read_b128 a[228:231], v2 offset:29696
v_cvt_pk_bf16_f32 v103, v226, v227
v_mfma_f32_16x16x32_bf16 v[228:231], a[64:67], a[232:235], v[228:231]
ds_read_b128 a[232:235], v2 offset:30720
v_max3_f32 v74, v74, v69, v70
v_mfma_f32_16x16x32_bf16 v[228:231], a[68:71], a[236:239], v[228:231]
s_waitcnt lgkmcnt(10)
ds_read_b128 a[236:239], v2 offset:31744
v_max3_f32 v74, v74, v71, v86
v_mfma_f32_16x16x32_bf16 v[232:235], a[0:3], a[192:195], 0
s_waitcnt lgkmcnt(10)
v_permlane32_swap_b32 v58, v59
v_mfma_f32_16x16x32_bf16 v[232:235], a[4:7], a[196:199], v[232:235]
s_waitcnt lgkmcnt(9)
v_max_f32 v58, v58, v59
v_mov_b32 v59, v58
v_mfma_f32_16x16x32_bf16 v[232:235], a[8:11], a[200:203], v[232:235]
s_waitcnt lgkmcnt(8)
v_cvt_pk_bf16_f32 v104, v228, v229
v_cvt_pk_bf16_f32 v105, v230, v231
v_mfma_f32_16x16x32_bf16 v[232:235], a[12:15], a[204:207], v[232:235]
s_waitcnt lgkmcnt(7)
v_permlane16_swap_b32 v58, v59
v_mfma_f32_16x16x32_bf16 v[232:235], a[16:19], a[208:211], v[232:235]
s_waitcnt lgkmcnt(6)
v_max_f32 v58, v58, v59
v_sub_f32 v44, v44, v58
v_mfma_f32_16x16x32_bf16 v[232:235], a[20:23], a[212:215], v[232:235]
v_sub_f32 v45, v45, v58
v_sub_f32 v46, v46, v58
v_mfma_f32_16x16x32_bf16 v[220:223], a[24:27], a[192:195], 0
v_exp_f32 v44, v44
v_mfma_f32_16x16x32_bf16 v[220:223], a[28:31], a[196:199], v[220:223]
buffer_load_dwordx4 a[116:119], v11, s[20:23], s32 offen offset:256 nt
v_sub_f32 v47, v47, v58
v_mfma_f32_16x16x32_bf16 v[220:223], a[32:35], a[200:203], v[220:223]
v_cvt_pk_bf16_f32 v108, v232, v233
v_cvt_pk_bf16_f32 v109, v234, v235
v_mfma_f32_16x16x32_bf16 v[220:223], a[36:39], a[204:207], v[220:223]
v_exp_f32 v45, v45
v_mfma_f32_16x16x32_bf16 v[220:223], a[40:43], a[208:211], v[220:223]
v_sub_f32 v48, v48, v58
v_sub_f32 v49, v49, v58
v_mfma_f32_16x16x32_bf16 v[220:223], a[44:47], a[212:215], v[220:223]
v_sub_f32 v50, v50, v58
v_sub_f32 v51, v51, v58
v_mfma_f32_16x16x32_bf16 v[224:227], a[48:51], a[192:195], 0
ds_read_b128 a[192:195], v2 offset:32768
v_sub_f32 v52, v52, v58
v_mfma_f32_16x16x32_bf16 v[224:227], a[52:55], a[196:199], v[224:227]
ds_read_b128 a[196:199], v2 offset:33792
v_sub_f32 v53, v53, v58
v_mfma_f32_16x16x32_bf16 v[224:227], a[56:59], a[200:203], v[224:227]
ds_read_b128 a[200:203], v2 offset:34816
v_cvt_pk_bf16_f32 v110, v220, v221
v_mfma_f32_16x16x32_bf16 v[224:227], a[60:63], a[204:207], v[224:227]
ds_read_b128 a[204:207], v2 offset:35840
v_cvt_pk_bf16_f32 v111, v222, v223
v_mfma_f32_16x16x32_bf16 v[224:227], a[64:67], a[208:211], v[224:227]
ds_read_b128 a[208:211], v2 offset:36864
v_sub_f32 v54, v54, v58
v_mfma_f32_16x16x32_bf16 v[224:227], a[68:71], a[212:215], v[224:227]
s_waitcnt lgkmcnt(10)
ds_read_b128 a[212:215], v2 offset:37888
v_sub_f32 v55, v55, v58
v_mfma_f32_16x16x32_bf16 v[228:231], a[0:3], a[216:219], 0
s_waitcnt lgkmcnt(10)
v_sub_f32 v82, v82, v58
v_add_f32 v58, v44, v45
v_mfma_f32_16x16x32_bf16 v[228:231], a[4:7], a[220:223], v[228:231]
s_waitcnt lgkmcnt(9)
v_exp_f32 v46, v46
v_mfma_f32_16x16x32_bf16 v[228:231], a[8:11], a[224:227], v[228:231]
s_waitcnt lgkmcnt(8)
v_cvt_pk_bf16_f32 v112, v224, v225
v_cvt_pk_bf16_f32 v113, v226, v227
v_mfma_f32_16x16x32_bf16 v[228:231], a[12:15], a[228:231], v[228:231]
s_waitcnt lgkmcnt(7)
v_exp_f32 v47, v47
v_mfma_f32_16x16x32_bf16 v[228:231], a[16:19], a[232:235], v[228:231]
s_waitcnt lgkmcnt(6)
v_exp_f32 v48, v48
v_mfma_f32_16x16x32_bf16 v[228:231], a[20:23], a[236:239], v[228:231]
v_add_f32 v58, v58, v46
v_add_f32 v58, v58, v47
v_mfma_f32_16x16x32_bf16 v[232:235], a[24:27], a[216:219], 0
v_exp_f32 v49, v49
v_mfma_f32_16x16x32_bf16 v[232:235], a[28:31], a[220:223], v[232:235]
buffer_load_dwordx4 a[136:139], v12, s[20:23], s32 offen offset:256 nt
v_add_f32 v58, v58, v48
v_mfma_f32_16x16x32_bf16 v[232:235], a[32:35], a[224:227], v[232:235]
v_cvt_pk_bf16_f32 v116, v228, v229
v_cvt_pk_bf16_f32 v117, v230, v231
v_mfma_f32_16x16x32_bf16 v[232:235], a[36:39], a[228:231], v[232:235]
v_exp_f32 v50, v50
v_mfma_f32_16x16x32_bf16 v[232:235], a[40:43], a[232:235], v[232:235]
v_exp_f32 v51, v51
v_mfma_f32_16x16x32_bf16 v[232:235], a[44:47], a[236:239], v[232:235]
v_add_f32 v58, v58, v49
v_add_f32 v58, v58, v50
v_mfma_f32_16x16x32_bf16 v[220:223], a[48:51], a[216:219], 0
ds_read_b128 a[216:219], v2 offset:38912
v_add_f32 v58, v58, v51
v_mfma_f32_16x16x32_bf16 v[220:223], a[52:55], a[220:223], v[220:223]
ds_read_b128 a[220:223], v2 offset:39936
v_mov_b32 v75, v74
v_mfma_f32_16x16x32_bf16 v[220:223], a[56:59], a[224:227], v[220:223]
ds_read_b128 a[224:227], v2 offset:40960
v_cvt_pk_bf16_f32 v118, v232, v233
v_mfma_f32_16x16x32_bf16 v[220:223], a[60:63], a[228:231], v[220:223]
ds_read_b128 a[228:231], v2 offset:41984
v_cvt_pk_bf16_f32 v119, v234, v235
v_mfma_f32_16x16x32_bf16 v[220:223], a[64:67], a[232:235], v[220:223]
ds_read_b128 a[232:235], v2 offset:43008
v_mfma_f32_16x16x32_bf16 v[220:223], a[68:71], a[236:239], v[220:223]
s_waitcnt lgkmcnt(10)
ds_read_b128 a[236:239], v2 offset:44032
v_mfma_f32_16x16x32_bf16 v[224:227], a[0:3], a[192:195], 0
s_waitcnt lgkmcnt(10)
v_exp_f32 v52, v52
v_mfma_f32_16x16x32_bf16 v[224:227], a[4:7], a[196:199], v[224:227]
s_waitcnt lgkmcnt(9)
v_exp_f32 v53, v53
v_mfma_f32_16x16x32_bf16 v[224:227], a[8:11], a[200:203], v[224:227]
s_waitcnt lgkmcnt(8)
v_exp_f32 v54, v54
v_mfma_f32_16x16x32_bf16 v[224:227], a[12:15], a[204:207], v[224:227]
s_waitcnt lgkmcnt(7)
v_cvt_pk_bf16_f32 v120, v220, v221
v_cvt_pk_bf16_f32 v121, v222, v223
v_mfma_f32_16x16x32_bf16 v[224:227], a[16:19], a[208:211], v[224:227]
s_waitcnt lgkmcnt(6)
v_add_f32 v58, v58, v52
v_add_f32 v58, v58, v53
v_mfma_f32_16x16x32_bf16 v[224:227], a[20:23], a[212:215], v[224:227]
v_exp_f32 v55, v55
v_mfma_f32_16x16x32_bf16 v[228:231], a[24:27], a[192:195], 0
buffer_load_dwordx4 a[140:143], v13, s[20:23], s32 offen offset:256 nt
v_add_f32 v58, v58, v54
v_mfma_f32_16x16x32_bf16 v[228:231], a[28:31], a[196:199], v[228:231]
v_exp_f32 v82, v82
v_mfma_f32_16x16x32_bf16 v[228:231], a[32:35], a[200:203], v[228:231]
v_add_f32 v58, v58, v55
v_cvt_pk_bf16_f32 v124, v224, v225
v_mfma_f32_16x16x32_bf16 v[228:231], a[36:39], a[204:207], v[228:231]
v_cvt_pk_bf16_f32 v125, v226, v227
v_add_f32 v58, v58, v82
v_mfma_f32_16x16x32_bf16 v[228:231], a[40:43], a[208:211], v[228:231]
v_mov_b32 v59, v58
v_mfma_f32_16x16x32_bf16 v[228:231], a[44:47], a[212:215], v[228:231]
v_permlane32_swap_b32 v74, v75
v_mfma_f32_16x16x32_bf16 v[232:235], a[48:51], a[192:195], 0
ds_read_b128 a[192:195], v2 offset:45056
v_max_f32 v74, v74, v75
v_mfma_f32_16x16x32_bf16 v[232:235], a[52:55], a[196:199], v[232:235]
ds_read_b128 a[196:199], v2 offset:46080
v_mov_b32 v75, v74
v_mfma_f32_16x16x32_bf16 v[232:235], a[56:59], a[200:203], v[232:235]
ds_read_b128 a[200:203], v2 offset:47104
v_cvt_pk_bf16_f32 v126, v228, v229
v_mfma_f32_16x16x32_bf16 v[232:235], a[60:63], a[204:207], v[232:235]
ds_read_b128 a[204:207], v2 offset:48128
v_cvt_pk_bf16_f32 v127, v230, v231
v_mfma_f32_16x16x32_bf16 v[232:235], a[64:67], a[208:211], v[232:235]
ds_read_b128 a[208:211], v2 offset:49152
v_mfma_f32_16x16x32_bf16 v[232:235], a[68:71], a[212:215], v[232:235]
s_waitcnt lgkmcnt(10)
ds_read_b128 a[212:215], v2 offset:50176
v_mfma_f32_16x16x32_bf16 v[220:223], a[0:3], a[216:219], 0
s_waitcnt lgkmcnt(10)
v_permlane32_swap_b32 v58, v59
v_mfma_f32_16x16x32_bf16 v[220:223], a[4:7], a[220:223], v[220:223]
s_waitcnt lgkmcnt(9)
v_add_f32 v58, v58, v59
v_mov_b32 v59, v58
v_mfma_f32_16x16x32_bf16 v[220:223], a[8:11], a[224:227], v[220:223]
s_waitcnt lgkmcnt(8)
v_permlane16_swap_b32 v74, v75
v_mfma_f32_16x16x32_bf16 v[220:223], a[12:15], a[228:231], v[220:223]
s_waitcnt lgkmcnt(7)
v_cvt_pk_bf16_f32 v128, v232, v233
v_cvt_pk_bf16_f32 v129, v234, v235
v_mfma_f32_16x16x32_bf16 v[220:223], a[16:19], a[232:235], v[220:223]
s_waitcnt lgkmcnt(6)
v_permlane16_swap_b32 v58, v59
v_mfma_f32_16x16x32_bf16 v[220:223], a[20:23], a[236:239], v[220:223]
v_add_f32 v58, v58, v59
v_max_f32 v74, v74, v75
v_mfma_f32_16x16x32_bf16 v[224:227], a[24:27], a[216:219], 0
v_rcp_f32 v58, v58
v_mfma_f32_16x16x32_bf16 v[224:227], a[28:31], a[220:223], v[224:227]
v_mul_f32 v44, v44, v58
v_mul_f32 v45, v45, v58
v_mfma_f32_16x16x32_bf16 v[224:227], a[32:35], a[224:227], v[224:227]
v_cvt_pk_bf16_f32 v132, v220, v221
v_cvt_pk_bf16_f32 v133, v222, v223
v_mfma_f32_16x16x32_bf16 v[224:227], a[36:39], a[228:231], v[224:227]
v_mul_f32 v46, v46, v58
v_mul_f32 v47, v47, v58
v_mfma_f32_16x16x32_bf16 v[224:227], a[40:43], a[232:235], v[224:227]
v_cvt_pk_bf16_f32 v44, v44, v45
v_mul_f32 v48, v48, v58
v_mfma_f32_16x16x32_bf16 v[224:227], a[44:47], a[236:239], v[224:227]
v_mul_f32 v49, v49, v58
v_mul_f32 v50, v50, v58
v_mfma_f32_16x16x32_bf16 v[228:231], a[48:51], a[216:219], 0
ds_read_b128 a[216:219], v2 offset:51200
v_mul_f32 v51, v51, v58
v_mfma_f32_16x16x32_bf16 v[228:231], a[52:55], a[220:223], v[228:231]
ds_read_b128 a[220:223], v2 offset:52224
v_cvt_pk_bf16_f32 v45, v46, v47
v_mfma_f32_16x16x32_bf16 v[228:231], a[56:59], a[224:227], v[228:231]
ds_read_b128 a[224:227], v2 offset:53248
v_cvt_pk_bf16_f32 v134, v224, v225
v_mfma_f32_16x16x32_bf16 v[228:231], a[60:63], a[228:231], v[228:231]
ds_read_b128 a[228:231], v2 offset:54272
v_cvt_pk_bf16_f32 v135, v226, v227
v_mfma_f32_16x16x32_bf16 v[228:231], a[64:67], a[232:235], v[228:231]
ds_read_b128 a[232:235], v2 offset:55296
v_cvt_pk_bf16_f32 v46, v48, v49
v_mfma_f32_16x16x32_bf16 v[228:231], a[68:71], a[236:239], v[228:231]
s_waitcnt lgkmcnt(10)
ds_read_b128 a[236:239], v2 offset:56320
v_cvt_pk_bf16_f32 v47, v50, v51
v_mfma_f32_16x16x32_bf16 v[232:235], a[0:3], a[192:195], 0
s_waitcnt lgkmcnt(10)
v_sub_f32 v60, v60, v74
v_sub_f32 v61, v61, v74
v_mfma_f32_16x16x32_bf16 v[232:235], a[4:7], a[196:199], v[232:235]
s_waitcnt lgkmcnt(9)
v_mul_f32 v52, v52, v58
v_mul_f32 v53, v53, v58
v_mfma_f32_16x16x32_bf16 v[232:235], a[8:11], a[200:203], v[232:235]
s_waitcnt lgkmcnt(8)
v_cvt_pk_bf16_f32 v136, v228, v229
v_cvt_pk_bf16_f32 v137, v230, v231
v_mfma_f32_16x16x32_bf16 v[232:235], a[12:15], a[204:207], v[232:235]
s_waitcnt lgkmcnt(7)
v_sub_f32 v62, v62, v74
v_mul_f32 v54, v54, v58
v_mfma_f32_16x16x32_bf16 v[232:235], a[16:19], a[208:211], v[232:235]
s_waitcnt lgkmcnt(6)
v_exp_f32 v60, v60
v_mfma_f32_16x16x32_bf16 v[232:235], a[20:23], a[212:215], v[232:235]
v_exp_f32 v61, v61
v_mfma_f32_16x16x32_bf16 v[220:223], a[24:27], a[192:195], 0
v_mul_f32 v55, v55, v58
v_cvt_pk_bf16_f32 v52, v52, v53
v_mfma_f32_16x16x32_bf16 v[220:223], a[28:31], a[196:199], v[220:223]
v_sub_f32 v63, v63, v74
v_sub_f32 v64, v64, v74
v_mfma_f32_16x16x32_bf16 v[220:223], a[32:35], a[200:203], v[220:223]
v_cvt_pk_bf16_f32 v140, v232, v233
v_cvt_pk_bf16_f32 v141, v234, v235
v_mfma_f32_16x16x32_bf16 v[220:223], a[36:39], a[204:207], v[220:223]
v_sub_f32 v65, v65, v74
v_sub_f32 v66, v66, v74
v_mfma_f32_16x16x32_bf16 v[220:223], a[40:43], a[208:211], v[220:223]
v_sub_f32 v67, v67, v74
v_sub_f32 v68, v68, v74
v_mfma_f32_16x16x32_bf16 v[220:223], a[44:47], a[212:215], v[220:223]
v_sub_f32 v69, v69, v74
v_sub_f32 v70, v70, v74
v_mfma_f32_16x16x32_bf16 v[224:227], a[48:51], a[192:195], 0
v_sub_f32 v71, v71, v74
v_sub_f32 v86, v86, v74
v_mfma_f32_16x16x32_bf16 v[224:227], a[52:55], a[196:199], v[224:227]
v_exp_f32 v62, v62
v_mfma_f32_16x16x32_bf16 v[224:227], a[56:59], a[200:203], v[224:227]
v_cvt_pk_bf16_f32 v142, v220, v221
v_cvt_pk_bf16_f32 v143, v222, v223
v_mfma_f32_16x16x32_bf16 v[224:227], a[60:63], a[204:207], v[224:227]
v_mul_f32 v82, v82, v58
v_cvt_pk_bf16_f32 v53, v54, v55
v_mfma_f32_16x16x32_bf16 v[224:227], a[64:67], a[208:211], v[224:227]
v_exp_f32 v63, v63
v_mfma_f32_16x16x32_bf16 v[224:227], a[68:71], a[212:215], v[224:227]
s_waitcnt lgkmcnt(5)
v_add_f32 v74, v60, v61
v_cvt_pk_bf16_f32 v54, 0, v82
v_mfma_f32_16x16x32_bf16 v[228:231], a[0:3], a[216:219], 0
s_waitcnt lgkmcnt(4)
v_mov_b32 v55, 0
v_add_f32 v74, v74, v62
v_mfma_f32_16x16x32_bf16 v[228:231], a[4:7], a[220:223], v[228:231]
s_waitcnt lgkmcnt(3)
v_exp_f32 v64, v64
v_mfma_f32_16x16x32_bf16 v[228:231], a[8:11], a[224:227], v[228:231]
s_waitcnt lgkmcnt(2)
v_exp_f32 v65, v65
v_mfma_f32_16x16x32_bf16 v[228:231], a[12:15], a[228:231], v[228:231]
s_waitcnt lgkmcnt(1)
v_add_f32 v74, v74, v63
v_add_f32 v74, v74, v64
v_mfma_f32_16x16x32_bf16 v[228:231], a[16:19], a[232:235], v[228:231]
s_waitcnt lgkmcnt(0)
v_exp_f32 v66, v66
v_mfma_f32_16x16x32_bf16 v[228:231], a[20:23], a[236:239], v[228:231]
v_exp_f32 v67, v67
v_mfma_f32_16x16x32_bf16 v[232:235], a[24:27], a[216:219], 0
v_add_f32 v74, v74, v65
v_add_f32 v74, v74, v66
v_mfma_f32_16x16x32_bf16 v[232:235], a[28:31], a[220:223], v[232:235]
v_exp_f32 v68, v68
v_mfma_f32_16x16x32_bf16 v[232:235], a[32:35], a[224:227], v[232:235]
v_exp_f32 v69, v69
v_mfma_f32_16x16x32_bf16 v[232:235], a[36:39], a[228:231], v[232:235]
v_add_f32 v74, v74, v67
v_add_f32 v74, v74, v68
v_mfma_f32_16x16x32_bf16 v[232:235], a[40:43], a[232:235], v[232:235]
v_exp_f32 v70, v70
v_mfma_f32_16x16x32_bf16 v[232:235], a[44:47], a[236:239], v[232:235]
v_exp_f32 v71, v71
v_mfma_f32_16x16x32_bf16 v[220:223], a[48:51], a[216:219], 0
LW_p7:
s_cbranch_execz LW_p10
v_mov_b64 v[244:245], 0
v_mfma_f32_16x16x32_bf16 v[220:223], a[52:55], a[220:223], v[220:223]
v_add_f32 v74, v74, v69
v_add_f32 v74, v74, v70
v_mfma_f32_16x16x32_bf16 v[220:223], a[56:59], a[224:227], v[220:223]
v_exp_f32 v86, v86
v_mfma_f32_16x16x32_bf16 v[220:223], a[60:63], a[228:231], v[220:223]
v_add_f32 v74, v74, v71
v_add_f32 v74, v74, v86
v_mfma_f32_16x16x32_bf16 v[220:223], a[64:67], a[232:235], v[220:223]
v_mov_b32 v75, v74
v_cvt_pk_bf16_f32 v144, v224, v225
v_mfma_f32_16x16x32_bf16 v[220:223], a[68:71], a[236:239], v[220:223]
v_permlane32_swap_b32 v74, v75
v_mfma_f32_16x16x32_bf16 v[188:191], v[28:31], v[92:95], 0
v_add_f32 v74, v74, v75
v_mov_b32 v75, v74
v_mfma_f32_16x16x32_bf16 v[188:191], v[36:39], v[96:99], v[188:191]
v_cvt_pk_bf16_f32 v145, v226, v227
v_cvt_pk_bf16_f32 v148, v228, v229
v_mfma_f32_16x16x32_bf16 v[192:195], v[28:31], v[100:103], 0
v_permlane16_swap_b32 v74, v75
v_mfma_f32_16x16x32_bf16 v[192:195], v[36:39], v[104:107], v[192:195]
v_add_f32 v74, v74, v75
v_cvt_pk_bf16_f32 v149, v230, v231
v_mfma_f32_16x16x32_bf16 v[196:199], v[28:31], v[108:111], 0
v_rcp_f32 v74, v74
v_mfma_f32_16x16x32_bf16 v[196:199], v[36:39], v[112:115], v[196:199]
v_mul_f32 v60, v60, v74
v_mul_f32 v61, v61, v74
v_mfma_f32_16x16x32_bf16 v[200:203], v[28:31], v[116:119], 0
v_mul_f32 v62, v62, v74
v_mul_f32 v63, v63, v74
v_mfma_f32_16x16x32_bf16 v[200:203], v[36:39], v[120:123], v[200:203]
v_cvt_pk_bf16_f32 v60, v60, v61
v_mul_f32 v64, v64, v74
v_smfmac_f32_16x16x64_bf16 v[244:247], a[240:243], v[92:99], v0
v_mul_f32 v65, v65, v74
v_smfmac_f32_16x16x64_bf16 v[244:247], a[244:247], v[100:107], v0
v_mul_f32 v66, v66, v74
v_smfmac_f32_16x16x64_bf16 v[244:247], a[248:251], v[108:115], v0
v_mul_f32 v67, v67, v74
v_smfmac_f32_16x16x64_bf16 v[244:247], a[252:255], v[116:123], v0
v_cvt_pk_bf16_f32 v61, v62, v63
v_mfma_f32_16x16x32_bf16 v[204:207], v[44:47], v[92:95], 0
v_cvt_pk_bf16_f32 v62, v64, v65
v_cvt_pk_bf16_f32 v63, v66, v67
v_mfma_f32_16x16x32_bf16 v[204:207], v[52:55], v[96:99], v[204:207]
v_mul_f32 v68, v68, v74
v_mul_f32 v69, v69, v74
v_mfma_f32_16x16x32_bf16 v[208:211], v[44:47], v[100:103], 0
v_mul_f32 v70, v70, v74
v_mul_f32 v71, v71, v74
v_mfma_f32_16x16x32_bf16 v[208:211], v[52:55], v[104:107], v[208:211]
v_cvt_pk_bf16_f32 v68, v68, v69
v_cvt_pk_bf16_f32 v64, v188, v192
v_mfma_f32_16x16x32_bf16 v[212:215], v[44:47], v[108:111], 0
v_cvt_pk_bf16_f32 v76, v189, v193
v_cvt_pk_bf16_f32 v78, v190, v194
v_mfma_f32_16x16x32_bf16 v[212:215], v[52:55], v[112:115], v[212:215]
v_cvt_pk_bf16_f32 v80, v191, v195
v_mul_f32 v86, v86, v74
v_mfma_f32_16x16x32_bf16 v[216:219], v[44:47], v[116:119], 0
v_cvt_pk_bf16_f32 v69, v70, v71
v_cvt_pk_bf16_f32 v70, 0, v86
v_mfma_f32_16x16x32_bf16 v[216:219], v[52:55], v[120:123], v[216:219]
v_mov_b32 v71, 0
v_cvt_pk_bf16_f32 v65, v196, v200
v_mfma_f32_16x16x32_bf16 v[188:191], v[60:63], v[92:95], 0
v_cvt_pk_bf16_f32 v77, v197, v201
v_cvt_pk_bf16_f32 v79, v198, v202
v_mfma_f32_16x16x32_bf16 v[188:191], v[68:71], v[96:99], v[188:191]
buffer_store_dwordx2 v[64:65], v14, s[12:15], s28 offen offset:0 sc1
v_cvt_pk_bf16_f32 v81, v199, v203
v_mfma_f32_16x16x32_bf16 v[192:195], v[60:63], v[100:103], 0
buffer_store_dwordx2 v[76:77], v14, s[12:15], s28 offen offset:384 sc1
v_add_f32 v64, v244, v245
v_mfma_f32_16x16x32_bf16 v[192:195], v[68:71], v[104:107], v[192:195]
v_cvt_pk_bf16_f32 v64, v64, v64
buffer_store_short v64, v17, s[12:15], s28 offen offset:0 sc1
v_mfma_f32_16x16x32_bf16 v[196:199], v[60:63], v[108:111], 0
v_cvt_pk_bf16_f32 v64, v204, v208
v_cvt_pk_bf16_f32 v82, v205, v209
v_mfma_f32_16x16x32_bf16 v[196:199], v[68:71], v[112:115], v[196:199]
v_cvt_pk_bf16_f32 v84, v206, v210
v_cvt_pk_bf16_f32 v86, v207, v211
v_mfma_f32_16x16x32_bf16 v[200:203], v[60:63], v[116:119], 0
buffer_store_dwordx2 v[78:79], v14, s[12:15], s28 offen offset:768 sc1
v_cvt_pk_bf16_f32 v65, v212, v216
v_mfma_f32_16x16x32_bf16 v[200:203], v[68:71], v[120:123], v[200:203]
v_cvt_pk_bf16_f32 v83, v213, v217
v_cvt_pk_bf16_f32 v85, v214, v218
v_mfma_f32_16x16x32_bf16 v[204:207], v[28:31], v[124:127], 0
v_cvt_pk_bf16_f32 v87, v215, v219
v_cvt_pk_bf16_f32 v150, v232, v233
v_mfma_f32_16x16x32_bf16 v[204:207], v[36:39], v[128:131], v[204:207]
v_cvt_pk_bf16_f32 v151, v234, v235
v_cvt_pk_bf16_f32 v152, v220, v221
v_mfma_f32_16x16x32_bf16 v[208:211], v[28:31], v[132:135], 0
v_cvt_pk_bf16_f32 v153, v222, v223
v_cvt_pk_bf16_f32 v76, v188, v192
v_mfma_f32_16x16x32_bf16 v[208:211], v[36:39], v[136:139], v[208:211]
buffer_store_dwordx2 v[80:81], v14, s[12:15], s28 offen offset:1152 sc1
v_mov_b64 v[244:245], 0
v_mfma_f32_16x16x32_bf16 v[212:215], v[28:31], v[140:143], 0
v_cvt_pk_bf16_f32 v66, v189, v193
v_cvt_pk_bf16_f32 v88, v190, v194
v_mfma_f32_16x16x32_bf16 v[212:215], v[36:39], v[144:147], v[212:215]
v_cvt_pk_bf16_f32 v90, v191, v195
v_cvt_pk_bf16_f32 v77, v196, v200
v_mfma_f32_16x16x32_bf16 v[216:219], v[28:31], v[148:151], 0
v_cvt_pk_bf16_f32 v67, v197, v201
v_cvt_pk_bf16_f32 v89, v198, v202
v_mfma_f32_16x16x32_bf16 v[216:219], v[36:39], v[152:155], v[216:219]
v_cvt_pk_bf16_f32 v91, v199, v203
v_cvt_pk_bf16_f32 v92, v204, v208
v_smfmac_f32_16x16x64_bf16 v[244:247], a[240:243], v[124:131], v0
ds_read_b128 a[192:195], v2 offset:57344
v_smfmac_f32_16x16x64_bf16 v[244:247], a[244:247], v[132:139], v0
ds_read_b128 a[196:199], v2 offset:58368
v_smfmac_f32_16x16x64_bf16 v[244:247], a[248:251], v[140:147], v0
v_cvt_pk_bf16_f32 v94, v205, v209
v_smfmac_f32_16x16x64_bf16 v[244:247], a[252:255], v[148:155], v0
v_cvt_pk_bf16_f32 v100, v206, v210
v_mfma_f32_16x16x32_bf16 v[188:191], v[44:47], v[124:127], 0
buffer_store_dwordx2 v[64:65], v15, s[12:15], s28 offen offset:0 sc1
v_cvt_pk_bf16_f32 v78, v207, v211
v_mfma_f32_16x16x32_bf16 v[188:191], v[52:55], v[128:131], v[188:191]
ds_read_b128 a[200:203], v2 offset:59392
ds_read_b128 a[204:207], v2 offset:60416
v_mfma_f32_16x16x32_bf16 v[192:195], v[44:47], v[132:135], 0
buffer_store_dwordx2 v[82:83], v15, s[12:15], s29 offen offset:0 sc1
ds_read_b128 a[208:211], v2 offset:61440
v_mfma_f32_16x16x32_bf16 v[192:195], v[52:55], v[136:139], v[192:195]
ds_read_b128 a[212:215], v2 offset:62464
v_cvt_pk_bf16_f32 v93, v212, v216
v_mfma_f32_16x16x32_bf16 v[196:199], v[44:47], v[140:143], 0
v_cvt_pk_bf16_f32 v95, v213, v217
v_cvt_pk_bf16_f32 v101, v214, v218
v_mfma_f32_16x16x32_bf16 v[196:199], v[52:55], v[144:147], v[196:199]
v_cvt_pk_bf16_f32 v79, v215, v219
v_add_f32 v64, v244, v245
v_mfma_f32_16x16x32_bf16 v[200:203], v[44:47], v[148:151], 0
ds_read_b128 a[216:219], v2 offset:63488
ds_read_b128 a[220:223], v2 offset:64512
v_mfma_f32_16x16x32_bf16 v[200:203], v[52:55], v[152:155], v[200:203]
ds_read_b128 a[224:227], v3 offset:0
ds_read_b128 a[228:231], v3 offset:1024
v_mfma_f32_16x16x32_bf16 v[204:207], v[60:63], v[124:127], 0
ds_read_b128 a[232:235], v3 offset:2048
ds_read_b128 a[236:239], v3 offset:3072
v_mfma_f32_16x16x32_bf16 v[204:207], v[68:71], v[128:131], v[204:207]
v_cvt_pk_bf16_f32 v64, v64, v64
v_cvt_pk_bf16_f32 v80, v188, v192
v_mfma_f32_16x16x32_bf16 v[208:211], v[60:63], v[132:135], 0
buffer_store_short v64, v17, s[12:15], s28 offen offset:128 sc1
v_cvt_pk_bf16_f32 v82, v189, v193
v_mfma_f32_16x16x32_bf16 v[208:211], v[68:71], v[136:139], v[208:211]
v_cvt_pk_bf16_f32 v102, v190, v194
v_cvt_pk_bf16_f32 v108, v191, v195
v_mfma_f32_16x16x32_bf16 v[212:215], v[60:63], v[140:143], 0
buffer_store_dwordx2 v[84:85], v15, s[12:15], s30 offen offset:0 sc1
v_cvt_pk_bf16_f32 v81, v196, v200
v_mfma_f32_16x16x32_bf16 v[212:215], v[68:71], v[144:147], v[212:215]
v_cvt_pk_bf16_f32 v83, v197, v201
v_cvt_pk_bf16_f32 v103, v198, v202
v_mfma_f32_16x16x32_bf16 v[216:219], v[60:63], v[148:151], 0
v_cvt_pk_bf16_f32 v64, v204, v208
v_cvt_pk_bf16_f32 v84, v205, v209
v_mfma_f32_16x16x32_bf16 v[216:219], v[68:71], v[152:155], v[216:219]
s_waitcnt lgkmcnt(11)
v_cvt_pk_bf16_f32 v110, v206, v210
v_cvt_pk_bf16_f32 v72, v207, v211
v_mfma_f32_16x16x32_bf16 v[224:227], a[0:3], a[192:195], 0
s_waitcnt lgkmcnt(10)
v_cvt_pk_bf16_f32 v109, v199, v203
v_mfma_f32_16x16x32_bf16 v[224:227], a[4:7], a[196:199], v[224:227]
buffer_store_dwordx2 v[86:87], v15, s[12:15], s31 offen offset:0 sc1
s_waitcnt lgkmcnt(9)
v_mfma_f32_16x16x32_bf16 v[224:227], a[8:11], a[200:203], v[224:227]
s_waitcnt vmcnt(27) lgkmcnt(8)
ds_write_b64 v4, a[72:73] offset:0
v_mfma_f32_16x16x32_bf16 v[224:227], a[12:15], a[204:207], v[224:227]
s_waitcnt lgkmcnt(8)
v_cvt_pk_bf16_f32 v65, v212, v216
v_cvt_pk_bf16_f32 v85, v213, v217
v_mfma_f32_16x16x32_bf16 v[224:227], a[16:19], a[208:211], v[224:227]
s_waitcnt lgkmcnt(7)
v_cvt_pk_bf16_f32 v111, v214, v218
v_cvt_pk_bf16_f32 v73, v215, v219
v_mfma_f32_16x16x32_bf16 v[224:227], a[20:23], a[212:215], v[224:227]
ds_write_b64 v4, a[74:75] offset:8
v_mfma_f32_16x16x32_bf16 v[228:231], a[24:27], a[192:195], 0
buffer_store_dwordx2 v[76:77], v16, s[12:15], s28 offen offset:0 sc1
v_mfma_f32_16x16x32_bf16 v[228:231], a[28:31], a[196:199], v[228:231]
s_waitcnt vmcnt(27)
ds_write_b64 v5, a[76:77] offset:0
v_mfma_f32_16x16x32_bf16 v[228:231], a[32:35], a[200:203], v[228:231]
ds_write_b64 v5, a[78:79] offset:8
v_mfma_f32_16x16x32_bf16 v[228:231], a[36:39], a[204:207], v[228:231]
v_cvt_pk_bf16_f32 v156, v224, v225
v_cvt_pk_bf16_f32 v157, v226, v227
v_mfma_f32_16x16x32_bf16 v[228:231], a[40:43], a[208:211], v[228:231]
ds_read_b128 a[72:75], v6 offset:0
ds_read_b128 a[76:79], v7 offset:0
v_mfma_f32_16x16x32_bf16 v[228:231], a[44:47], a[212:215], v[228:231]
s_waitcnt vmcnt(26)
ds_write_b64 v4, a[96:97] offset:2048
v_mfma_f32_16x16x32_bf16 v[232:235], a[48:51], a[192:195], 0
buffer_store_dwordx2 v[66:67], v16, s[12:15], s28 offen offset:384 sc1
ds_read_b128 a[192:195], v3 offset:4096
v_mfma_f32_16x16x32_bf16 v[232:235], a[52:55], a[196:199], v[232:235]
ds_read_b128 a[196:199], v3 offset:5120
v_mfma_f32_16x16x32_bf16 v[232:235], a[56:59], a[200:203], v[232:235]
ds_read_b128 a[200:203], v3 offset:6144
v_cvt_pk_bf16_f32 v158, v228, v229
v_mfma_f32_16x16x32_bf16 v[232:235], a[60:63], a[204:207], v[232:235]
ds_read_b128 a[204:207], v3 offset:7168
v_cvt_pk_bf16_f32 v159, v230, v231
v_mfma_f32_16x16x32_bf16 v[232:235], a[64:67], a[208:211], v[232:235]
ds_read_b128 a[208:211], v3 offset:8192
v_mfma_f32_16x16x32_bf16 v[232:235], a[68:71], a[212:215], v[232:235]
buffer_store_dwordx2 v[88:89], v16, s[12:15], s29 offen offset:0 sc1
s_waitcnt lgkmcnt(15)
ds_read_b128 a[212:215], v3 offset:9216
v_mfma_f32_16x16x32_bf16 v[220:223], a[0:3], a[216:219], 0
ds_write_b64 v4, a[98:99] offset:2056
v_mfma_f32_16x16x32_bf16 v[220:223], a[4:7], a[220:223], v[220:223]
s_waitcnt vmcnt(27)
ds_write_b64 v5, a[100:101] offset:2048
v_mfma_f32_16x16x32_bf16 v[220:223], a[8:11], a[224:227], v[220:223]
s_waitcnt lgkmcnt(15)
ds_write_b64 v5, a[102:103] offset:2056
v_mfma_f32_16x16x32_bf16 v[220:223], a[12:15], a[228:231], v[220:223]
v_cvt_pk_bf16_f32 v160, v232, v233
v_cvt_pk_bf16_f32 v161, v234, v235
v_mfma_f32_16x16x32_bf16 v[220:223], a[16:19], a[232:235], v[220:223]
buffer_store_dwordx2 v[90:91], v16, s[12:15], s29 offen offset:384 sc1
ds_read_b128 a[96:99], v6 offset:2048
v_mfma_f32_16x16x32_bf16 v[220:223], a[20:23], a[236:239], v[220:223]
ds_read_b128 a[100:103], v7 offset:2048
v_mfma_f32_16x16x32_bf16 v[224:227], a[24:27], a[216:219], 0
s_waitcnt vmcnt(25)
ds_write_b64 v4, a[80:81] offset:2048
v_mfma_f32_16x16x32_bf16 v[224:227], a[28:31], a[220:223], v[224:227]
ds_write_b64 v4, a[82:83] offset:2056
v_mfma_f32_16x16x32_bf16 v[224:227], a[32:35], a[224:227], v[224:227]
s_waitcnt vmcnt(24)
ds_write_b64 v5, a[84:85] offset:2048
v_mfma_f32_16x16x32_bf16 v[224:227], a[36:39], a[228:231], v[224:227]
buffer_store_dwordx2 v[92:93], v14, s[12:15], s28 offen offset:128 sc1
v_cvt_pk_bf16_f32 v164, v220, v221
v_mfma_f32_16x16x32_bf16 v[224:227], a[40:43], a[232:235], v[224:227]
v_cvt_pk_bf16_f32 v165, v222, v223
v_mfma_f32_16x16x32_bf16 v[224:227], a[44:47], a[236:239], v[224:227]
ds_write_b64 v5, a[86:87] offset:2056
v_mfma_f32_16x16x32_bf16 v[228:231], a[48:51], a[216:219], 0
ds_read_b128 a[216:219], v3 offset:10240
ds_read_b128 a[80:83], v6 offset:2048
v_mfma_f32_16x16x32_bf16 v[228:231], a[52:55], a[220:223], v[228:231]
ds_read_b128 a[220:223], v3 offset:11264
ds_read_b128 a[84:87], v7 offset:2048
v_mfma_f32_16x16x32_bf16 v[228:231], a[56:59], a[224:227], v[228:231]
buffer_store_dwordx2 v[94:95], v14, s[12:15], s28 offen offset:512 sc1
ds_read_b128 a[224:227], v3 offset:12288
v_mfma_f32_16x16x32_bf16 v[228:231], a[60:63], a[228:231], v[228:231]
ds_read_b128 a[228:231], v3 offset:13312
v_cvt_pk_bf16_f32 v166, v224, v225
v_mfma_f32_16x16x32_bf16 v[228:231], a[64:67], a[232:235], v[228:231]
v_cvt_pk_bf16_f32 v167, v226, v227
v_mfma_f32_16x16x32_bf16 v[228:231], a[68:71], a[236:239], v[228:231]
s_waitcnt lgkmcnt(15)
ds_read_b128 a[232:235], v3 offset:14336
ds_read_b128 a[236:239], v3 offset:15360
v_mfma_f32_16x16x32_bf16 v[232:235], a[0:3], a[192:195], 0
ds_write_b64 v4, a[120:121] offset:0
v_mfma_f32_16x16x32_bf16 v[232:235], a[4:7], a[196:199], v[232:235]
ds_write_b64 v4, a[122:123] offset:8
v_mfma_f32_16x16x32_bf16 v[232:235], a[8:11], a[200:203], v[232:235]
buffer_store_dwordx2 v[100:101], v14, s[12:15], s28 offen offset:896 sc1
v_cvt_pk_bf16_f32 v168, v228, v229
v_mfma_f32_16x16x32_bf16 v[232:235], a[12:15], a[204:207], v[232:235]
v_cvt_pk_bf16_f32 v169, v230, v231
v_mfma_f32_16x16x32_bf16 v[232:235], a[16:19], a[208:211], v[232:235]
ds_write_b64 v5, a[124:125] offset:0
v_mfma_f32_16x16x32_bf16 v[232:235], a[20:23], a[212:215], v[232:235]
ds_write_b64 v5, a[126:127] offset:8
v_mfma_f32_16x16x32_bf16 v[220:223], a[24:27], a[192:195], 0
ds_read_b128 a[120:123], v6 offset:0
ds_read_b128 a[124:127], v7 offset:0
v_mfma_f32_16x16x32_bf16 v[220:223], a[28:31], a[196:199], v[220:223]
buffer_store_dwordx2 v[78:79], v14, s[12:15], s28 offen offset:1280 sc1
v_mfma_f32_16x16x32_bf16 v[220:223], a[32:35], a[200:203], v[220:223]
s_waitcnt vmcnt(27)
ds_write_b64 v4, a[104:105] offset:0
v_mfma_f32_16x16x32_bf16 v[220:223], a[36:39], a[204:207], v[220:223]
v_cvt_pk_bf16_f32 v172, v232, v233
v_cvt_pk_bf16_f32 v173, v234, v235
v_mfma_f32_16x16x32_bf16 v[220:223], a[40:43], a[208:211], v[220:223]
ds_write_b64 v4, a[106:107] offset:8
v_mfma_f32_16x16x32_bf16 v[220:223], a[44:47], a[212:215], v[220:223]
s_waitcnt vmcnt(26)
ds_write_b64 v5, a[108:109] offset:0
v_mfma_f32_16x16x32_bf16 v[224:227], a[48:51], a[192:195], 0
buffer_store_dwordx2 v[80:81], v15, s[12:15], s28 offen offset:128 sc1
ds_read_b128 a[192:195], v1 offset:0
v_mfma_f32_16x16x32_bf16 v[224:227], a[52:55], a[196:199], v[224:227]
ds_read_b128 a[196:199], v1 offset:1024
v_mfma_f32_16x16x32_bf16 v[224:227], a[56:59], a[200:203], v[224:227]
ds_read_b128 a[200:203], v1 offset:2048
v_cvt_pk_bf16_f32 v174, v220, v221
v_mfma_f32_16x16x32_bf16 v[224:227], a[60:63], a[204:207], v[224:227]
v_cvt_pk_bf16_f32 v175, v222, v223
v_mfma_f32_16x16x32_bf16 v[224:227], a[64:67], a[208:211], v[224:227]
ds_read_b128 a[204:207], v1 offset:3072
ds_read_b128 a[208:211], v1 offset:4096
v_mfma_f32_16x16x32_bf16 v[224:227], a[68:71], a[212:215], v[224:227]
buffer_store_dwordx2 v[82:83], v15, s[12:15], s29 offen offset:128 sc1
s_waitcnt lgkmcnt(15)
ds_read_b128 a[212:215], v1 offset:5120
v_mfma_f32_16x16x32_bf16 v[228:231], a[0:3], a[216:219], 0
ds_write_b64 v5, a[110:111] offset:8
v_mfma_f32_16x16x32_bf16 v[228:231], a[4:7], a[220:223], v[228:231]
ds_read_b128 a[104:107], v6 offset:0
ds_read_b128 a[108:111], v7 offset:0
v_mfma_f32_16x16x32_bf16 v[228:231], a[8:11], a[224:227], v[228:231]
v_cvt_pk_bf16_f32 v176, v224, v225
v_cvt_pk_bf16_f32 v177, v226, v227
v_mfma_f32_16x16x32_bf16 v[228:231], a[12:15], a[228:231], v[228:231]
s_waitcnt vmcnt(25)
ds_write_b64 v4, a[88:89] offset:0
v_mfma_f32_16x16x32_bf16 v[228:231], a[16:19], a[232:235], v[228:231]
s_waitcnt lgkmcnt(15)
ds_write_b64 v4, a[90:91] offset:8
v_mfma_f32_16x16x32_bf16 v[228:231], a[20:23], a[236:239], v[228:231]
buffer_store_dwordx2 v[102:103], v15, s[12:15], s30 offen offset:128 sc1
v_mfma_f32_16x16x32_bf16 v[232:235], a[24:27], a[216:219], 0
s_waitcnt vmcnt(25)
ds_write_b64 v5, a[92:93] offset:0
v_mfma_f32_16x16x32_bf16 v[232:235], a[28:31], a[220:223], v[232:235]
ds_write_b64 v5, a[94:95] offset:8
v_mfma_f32_16x16x32_bf16 v[232:235], a[32:35], a[224:227], v[232:235]
ds_read_b128 a[88:91], v6 offset:0
ds_read_b128 a[92:95], v7 offset:0
v_mfma_f32_16x16x32_bf16 v[232:235], a[36:39], a[228:231], v[232:235]
v_cvt_pk_bf16_f32 v180, v228, v229
v_cvt_pk_bf16_f32 v181, v230, v231
v_mfma_f32_16x16x32_bf16 v[232:235], a[40:43], a[232:235], v[232:235]
buffer_store_dwordx2 v[108:109], v15, s[12:15], s31 offen offset:128 sc1
v_mfma_f32_16x16x32_bf16 v[232:235], a[44:47], a[236:239], v[232:235]
ds_write_b64 v4, a[128:129] offset:2048
v_mfma_f32_16x16x32_bf16 v[220:223], a[48:51], a[216:219], 0
v_mov_b64 v[244:245], 0
v_mfma_f32_16x16x32_bf16 v[220:223], a[52:55], a[220:223], v[220:223]
ds_read_b128 a[216:219], v1 offset:6144
ds_read_b128 a[220:223], v1 offset:7168
v_mfma_f32_16x16x32_bf16 v[220:223], a[56:59], a[224:227], v[220:223]
s_nop 0
v_cvt_pk_bf16_f32 v182, v232, v233
v_cvt_pk_bf16_f32 v183, v234, v235
v_mfma_f32_16x16x32_bf16 v[220:223], a[60:63], a[228:231], v[220:223]
buffer_store_dwordx2 v[64:65], v16, s[12:15], s28 offen offset:128 sc1
ds_read_b128 a[224:227], v1 offset:8192
v_mfma_f32_16x16x32_bf16 v[220:223], a[64:67], a[232:235], v[220:223]
ds_read_b128 a[228:231], v1 offset:9216
ds_read_b128 a[232:235], v1 offset:10240
v_mfma_f32_16x16x32_bf16 v[220:223], a[68:71], a[236:239], v[220:223]
ds_read_b128 a[236:239], v1 offset:11264
v_mfma_f32_16x16x32_bf16 v[204:207], v[28:31], v[156:159], 0
s_nop 0
ds_write_b64 v4, a[130:131] offset:2056
v_mfma_f32_16x16x32_bf16 v[204:207], v[36:39], v[160:163], v[204:207]
s_nop 0
ds_write_b64 v5, a[132:133] offset:2048
v_mfma_f32_16x16x32_bf16 v[208:211], v[28:31], v[164:167], 0
v_cvt_pk_bf16_f32 v184, v220, v221
v_cvt_pk_bf16_f32 v185, v222, v223
v_mfma_f32_16x16x32_bf16 v[208:211], v[36:39], v[168:171], v[208:211]
buffer_store_dwordx2 v[84:85], v16, s[12:15], s28 offen offset:512 sc1
v_mfma_f32_16x16x32_bf16 v[212:215], v[28:31], v[172:175], 0
ds_write_b64 v5, a[134:135] offset:2056
v_mfma_f32_16x16x32_bf16 v[212:215], v[36:39], v[176:179], v[212:215]
ds_read_b128 a[128:131], v6 offset:2048
ds_read_b128 a[132:135], v7 offset:2048
v_mfma_f32_16x16x32_bf16 v[216:219], v[28:31], v[180:183], 0
s_waitcnt vmcnt(27)
ds_write_b64 v4, a[112:113] offset:2048
v_mfma_f32_16x16x32_bf16 v[216:219], v[36:39], v[184:187], v[216:219]
buffer_store_dwordx2 v[110:111], v16, s[12:15], s29 offen offset:128 sc1
v_cvt_pk_bf16_f32 v92, v204, v208
v_smfmac_f32_16x16x64_bf16 v[244:247], a[240:243], v[156:163], v0
v_cvt_pk_bf16_f32 v140, v205, v209
v_smfmac_f32_16x16x64_bf16 v[244:247], a[244:247], v[164:171], v0
v_cvt_pk_bf16_f32 v94, v206, v210
v_smfmac_f32_16x16x64_bf16 v[244:247], a[248:251], v[172:179], v0
v_cvt_pk_bf16_f32 v142, v207, v211
v_smfmac_f32_16x16x64_bf16 v[244:247], a[252:255], v[180:187], v0
v_cvt_pk_bf16_f32 v93, v212, v216
v_mfma_f32_16x16x32_bf16 v[188:191], v[44:47], v[156:159], 0
v_cvt_pk_bf16_f32 v141, v213, v217
v_cvt_pk_bf16_f32 v95, v214, v218
v_mfma_f32_16x16x32_bf16 v[188:191], v[52:55], v[160:163], v[188:191]
buffer_store_dwordx2 v[72:73], v16, s[12:15], s29 offen offset:512 sc1
v_cvt_pk_bf16_f32 v143, v215, v219
v_mfma_f32_16x16x32_bf16 v[192:195], v[44:47], v[164:167], 0
ds_write_b64 v4, a[114:115] offset:2056
v_mfma_f32_16x16x32_bf16 v[192:195], v[52:55], v[168:171], v[192:195]
s_waitcnt vmcnt(28)
ds_write_b64 v5, a[116:117] offset:2048
v_mfma_f32_16x16x32_bf16 v[196:199], v[44:47], v[172:175], 0
ds_write_b64 v5, a[118:119] offset:2056
v_mfma_f32_16x16x32_bf16 v[196:199], v[52:55], v[176:179], v[196:199]
ds_read_b128 a[112:115], v6 offset:2048
ds_read_b128 a[116:119], v7 offset:2048
v_mfma_f32_16x16x32_bf16 v[200:203], v[44:47], v[180:183], 0
v_add_f32 v64, v244, v245
v_cvt_pk_bf16_f32 v64, v64, v64
v_mfma_f32_16x16x32_bf16 v[200:203], v[52:55], v[184:187], v[200:203]
buffer_store_short v64, v17, s[12:15], s28 offen offset:256 sc1
s_mov_b32 s28, s32
v_mfma_f32_16x16x32_bf16 v[204:207], v[60:63], v[156:159], 0
s_add_u32 s32, s34, s35
s_cmp_lt_u32 s33, 5329
s_cselect_b32 s22, 100270464, 0
v_mfma_f32_16x16x32_bf16 v[204:207], v[68:71], v[160:163], v[204:207]
s_lshr_b32 s36, s26, 1
s_lshl_b32 s36, s36, 4
s_lshl_b64 s[98:99], 0xffff, s36
v_mfma_f32_16x16x32_bf16 v[208:211], v[60:63], v[164:167], 0
v_cvt_pk_bf16_f32 v100, v188, v192
v_cvt_pk_bf16_f32 v101, v196, v200
v_mfma_f32_16x16x32_bf16 v[208:211], v[68:71], v[168:171], v[208:211]
v_cvt_pk_bf16_f32 v148, v189, v193
v_cvt_pk_bf16_f32 v149, v197, v201
v_mfma_f32_16x16x32_bf16 v[212:215], v[60:63], v[172:175], 0
v_cvt_pk_bf16_f32 v102, v190, v194
v_cvt_pk_bf16_f32 v103, v198, v202
v_mfma_f32_16x16x32_bf16 v[212:215], v[68:71], v[176:179], v[212:215]
v_cvt_pk_bf16_f32 v150, v191, v195
v_cvt_pk_bf16_f32 v151, v199, v203
v_mfma_f32_16x16x32_bf16 v[216:219], v[60:63], v[180:183], 0
s_waitcnt vmcnt(28)
v_cndmask_b32 v26, v21, v24, s[98:99]
ds_write_b64 v4, a[136:137] offset:0
v_mfma_f32_16x16x32_bf16 v[216:219], v[68:71], v[184:187], v[216:219]
s_waitcnt vmcnt(27)
ds_write_b64 v4, a[138:139] offset:8
ds_write_b64 v5, a[140:141] offset:0
ds_write_b64 v5, a[142:143] offset:8
ds_read_b128 a[136:139], v6 offset:0
ds_read_b128 a[140:143], v7 offset:0
s_cmp_ge_u32 s26, 4
s_cbranch_scc1 L_x4
L_loop1:
s_waitcnt lgkmcnt(15)
v_mfma_f32_16x16x32_bf16 v[224:227], a[192:195], a[72:75], 0
buffer_store_dwordx2 v[92:93], v14, s[12:15], s44 offen offset:256 sc1
v_cvt_pk_bf16_f32 v108, v204, v208
v_mfma_f32_16x16x32_bf16 v[224:227], a[196:199], a[76:79], v[224:227]
s_add_u32 s29, s28, 196224
v_cvt_pk_bf16_f32 v109, v212, v216
v_cvt_pk_bf16_f32 v110, v205, v209
v_mfma_f32_16x16x32_bf16 v[224:227], a[200:203], a[80:83], v[224:227]
s_add_u32 s30, s28, 392448
v_cvt_pk_bf16_f32 v111, v213, v217
v_cvt_pk_bf16_f32 v72, v206, v210
v_mfma_f32_16x16x32_bf16 v[224:227], a[204:207], a[84:87], v[224:227]
s_add_u32 s31, s28, 588672
v_cvt_pk_bf16_f32 v73, v214, v218
v_cvt_pk_bf16_f32 v116, v207, v211
v_mfma_f32_16x16x32_bf16 v[224:227], a[208:211], a[88:91], v[224:227]
s_add_u32 s26, s26, 1
v_cvt_pk_bf16_f32 v117, v215, v219
s_mov_b32 s27, s33
v_mfma_f32_16x16x32_bf16 v[224:227], a[212:215], a[92:95], v[224:227]
buffer_store_dwordx2 v[140:141], v14, s[12:15], s44 offen offset:640 sc1
s_add_u32 s33, s33, 1024
v_mfma_f32_16x16x32_bf16 v[228:231], a[192:195], a[96:99], 0
s_cmp_eq_u32 s26, 4
ds_write_b64 v22, v[24:25] offset:384
v_mfma_f32_16x16x32_bf16 v[228:231], a[196:199], a[100:103], v[228:231]
s_cselect_b32 s33, s87, s33
ds_write_b64 v22, v[24:25] offset:392
v_mfma_f32_16x16x32_bf16 v[228:231], a[200:203], a[104:107], v[228:231]
s_mul_hi_u32 s34, s33, 58835169
v_cvt_pk_bf16_f32 v60, v224, v225
v_cvt_pk_bf16_f32 v61, v226, v227
v_mfma_f32_16x16x32_bf16 v[228:231], a[204:207], a[108:111], v[228:231]
s_waitcnt lgkmcnt(9)
s_mul_i32 s35, s34, 73
s_sub_u32 s35, s33, s35
s_mul_i32 s34, s34, 1373568
v_mfma_f32_16x16x32_bf16 v[228:231], a[208:211], a[112:115], v[228:231]
buffer_store_dwordx2 v[94:95], v14, s[12:15], s44 offen offset:1024 sc1
s_waitcnt lgkmcnt(8)
s_mul_i32 s35, s35, 2688
v_mfma_f32_16x16x32_bf16 v[228:231], a[212:215], a[116:119], v[228:231]
v_mfma_f32_16x16x32_bf16 v[232:235], a[192:195], a[120:123], 0
ds_read_b128 a[192:195], v1 offset:12288
v_mfma_f32_16x16x32_bf16 v[232:235], a[196:199], a[124:127], v[232:235]
ds_read_b128 a[196:199], v1 offset:13312
v_mfma_f32_16x16x32_bf16 v[232:235], a[200:203], a[128:131], v[232:235]
ds_read_b128 a[200:203], v1 offset:14336
v_mfma_f32_16x16x32_bf16 v[232:235], a[204:207], a[132:135], v[232:235]
buffer_store_dwordx2 v[142:143], v14, s[12:15], s44 offen offset:1408 sc1
s_waitcnt lgkmcnt(6)
ds_read_b128 a[204:207], v1 offset:15360
v_mfma_f32_16x16x32_bf16 v[232:235], a[208:211], a[136:139], v[232:235]
s_waitcnt lgkmcnt(6)
v_cvt_pk_bf16_f32 v92, v228, v229
v_cvt_pk_bf16_f32 v93, v230, v231
v_mfma_f32_16x16x32_bf16 v[232:235], a[212:215], a[140:143], v[232:235]
ds_read_b128 a[208:211], v1 offset:16384
ds_read_b128 a[212:215], v1 offset:17408
v_mfma_f32_16x16x32_bf16 v[220:223], a[216:219], a[72:75], 0
v_mfma_f32_16x16x32_bf16 v[220:223], a[220:223], a[76:79], v[220:223]
v_mfma_f32_16x16x32_bf16 v[220:223], a[224:227], a[80:83], v[220:223]
buffer_store_dwordx2 v[100:101], v15, s[12:15], s44 offen offset:256 sc1
v_mfma_f32_16x16x32_bf16 v[220:223], a[228:231], a[84:87], v[220:223]
v_mfma_f32_16x16x32_bf16 v[220:223], a[232:235], a[88:91], v[220:223]
v_cvt_pk_bf16_f32 v140, v232, v233
v_cvt_pk_bf16_f32 v141, v234, v235
v_mfma_f32_16x16x32_bf16 v[220:223], a[236:239], a[92:95], v[220:223]
v_mfma_f32_16x16x32_bf16 v[224:227], a[216:219], a[96:99], 0
v_mfma_f32_16x16x32_bf16 v[224:227], a[220:223], a[100:103], v[224:227]
buffer_store_dwordx2 v[148:149], v15, s[12:15], s45 offen offset:256 sc1
v_mfma_f32_16x16x32_bf16 v[224:227], a[224:227], a[104:107], v[224:227]
v_mfma_f32_16x16x32_bf16 v[224:227], a[228:231], a[108:111], v[224:227]
v_mfma_f32_16x16x32_bf16 v[224:227], a[232:235], a[112:115], v[224:227]
v_mfma_f32_16x16x32_bf16 v[224:227], a[236:239], a[116:119], v[224:227]
v_mfma_f32_16x16x32_bf16 v[228:231], a[216:219], a[120:123], 0
buffer_store_dwordx2 v[102:103], v15, s[12:15], s46 offen offset:256 sc1
v_cvt_pk_bf16_f32 v62, v220, v221
v_mfma_f32_16x16x32_bf16 v[228:231], a[220:223], a[124:127], v[228:231]
s_mov_b32 s46, s30
v_cvt_pk_bf16_f32 v63, v222, v223
v_mfma_f32_16x16x32_bf16 v[228:231], a[224:227], a[128:131], v[228:231]
ds_read_b128 a[216:219], v1 offset:18432
ds_read_b128 a[220:223], v1 offset:19456
v_mfma_f32_16x16x32_bf16 v[228:231], a[228:231], a[132:135], v[228:231]
ds_read_b128 a[224:227], v1 offset:20480
ds_read_b128 a[228:231], v1 offset:21504
v_mfma_f32_16x16x32_bf16 v[228:231], a[232:235], a[136:139], v[228:231]
v_cvt_pk_bf16_f32 v94, v224, v225
v_cvt_pk_bf16_f32 v95, v226, v227
v_mfma_f32_16x16x32_bf16 v[228:231], a[236:239], a[140:143], v[228:231]
buffer_store_dwordx2 v[150:151], v15, s[12:15], s47 offen offset:256 sc1
s_waitcnt lgkmcnt(9)
ds_read_b128 a[232:235], v1 offset:22528
v_mfma_f32_16x16x32_bf16 v[232:235], a[192:195], a[72:75], 0
LW_p8:
s_cbranch_execz LW_p13
s_waitcnt lgkmcnt(9)
s_mov_b32 s47, s31
ds_read_b128 a[236:239], v1 offset:23552
v_mfma_f32_16x16x32_bf16 v[232:235], a[196:199], a[76:79], v[232:235]
s_waitcnt lgkmcnt(9)
v_mfma_f32_16x16x32_bf16 v[232:235], a[200:203], a[80:83], v[232:235]
s_waitcnt lgkmcnt(8)
v_mfma_f32_16x16x32_bf16 v[232:235], a[204:207], a[84:87], v[232:235]
s_waitcnt lgkmcnt(7)
v_cvt_pk_bf16_f32 v142, v228, v229
v_cvt_pk_bf16_f32 v143, v230, v231
v_mfma_f32_16x16x32_bf16 v[232:235], a[208:211], a[88:91], v[232:235]
buffer_store_dwordx2 v[108:109], v16, s[12:15], s44 offen offset:256 sc1
s_waitcnt lgkmcnt(6)
v_mfma_f32_16x16x32_bf16 v[232:235], a[212:215], a[92:95], v[232:235]
v_mfma_f32_16x16x32_bf16 v[220:223], a[192:195], a[96:99], 0
v_mfma_f32_16x16x32_bf16 v[220:223], a[196:199], a[100:103], v[220:223]
v_mfma_f32_16x16x32_bf16 v[220:223], a[200:203], a[104:107], v[220:223]
v_mfma_f32_16x16x32_bf16 v[220:223], a[204:207], a[108:111], v[220:223]
buffer_store_dwordx2 v[110:111], v16, s[12:15], s44 offen offset:640 sc1
s_mov_b32 s44, s28
v_mfma_f32_16x16x32_bf16 v[220:223], a[208:211], a[112:115], v[220:223]
v_mfma_f32_16x16x32_bf16 v[220:223], a[212:215], a[116:119], v[220:223]
v_cvt_pk_bf16_f32 v64, v232, v233
v_cvt_pk_bf16_f32 v65, v234, v235
v_mfma_f32_16x16x32_bf16 v[224:227], a[192:195], a[120:123], 0
ds_read_b128 a[192:195], v1 offset:24576
v_mfma_f32_16x16x32_bf16 v[224:227], a[196:199], a[124:127], v[224:227]
ds_read_b128 a[196:199], v1 offset:25600
v_mfma_f32_16x16x32_bf16 v[224:227], a[200:203], a[128:131], v[224:227]
buffer_store_dwordx2 v[72:73], v16, s[12:15], s45 offen offset:256 sc1
v_cvt_pk_bf16_f32 v100, v220, v221
v_mfma_f32_16x16x32_bf16 v[224:227], a[204:207], a[132:135], v[224:227]
v_cvt_pk_bf16_f32 v101, v222, v223
v_mfma_f32_16x16x32_bf16 v[224:227], a[208:211], a[136:139], v[224:227]
ds_read_b128 a[200:203], v1 offset:26624
ds_read_b128 a[204:207], v1 offset:27648
v_mfma_f32_16x16x32_bf16 v[224:227], a[212:215], a[140:143], v[224:227]
s_waitcnt lgkmcnt(9)
ds_read_b128 a[208:211], v1 offset:28672
ds_read_b128 a[212:215], v1 offset:29696
v_mfma_f32_16x16x32_bf16 v[228:231], a[216:219], a[72:75], 0
s_waitcnt lgkmcnt(10)
v_mfma_f32_16x16x32_bf16 v[228:231], a[220:223], a[76:79], v[228:231]
buffer_store_dwordx2 v[116:117], v16, s[12:15], s45 offen offset:640 sc1
s_waitcnt lgkmcnt(9)
s_mov_b32 s45, s29
v_mfma_f32_16x16x32_bf16 v[228:231], a[224:227], a[80:83], v[228:231]
s_waitcnt lgkmcnt(8)
v_mfma_f32_16x16x32_bf16 v[228:231], a[228:231], a[84:87], v[228:231]
s_waitcnt lgkmcnt(7)
v_cvt_pk_bf16_f32 v148, v224, v225
v_cvt_pk_bf16_f32 v149, v226, v227
v_mfma_f32_16x16x32_bf16 v[228:231], a[232:235], a[88:91], v[228:231]
s_waitcnt lgkmcnt(6)
v_mfma_f32_16x16x32_bf16 v[228:231], a[236:239], a[92:95], v[228:231]
v_mfma_f32_16x16x32_bf16 v[232:235], a[216:219], a[96:99], 0
buffer_load_dwordx4 a[0:3], v8, s[20:23], s32 offen offset:0 nt
v_mfma_f32_16x16x32_bf16 v[232:235], a[220:223], a[100:103], v[232:235]
v_mov_b64 v[76:77], 0
v_mfma_f32_16x16x32_bf16 v[232:235], a[224:227], a[104:107], v[232:235]
v_mov_b64 v[78:79], v[26:27]
v_mfma_f32_16x16x32_bf16 v[232:235], a[228:231], a[108:111], v[232:235]
v_mov_b64 v[80:81], 0
v_mfma_f32_16x16x32_bf16 v[232:235], a[232:235], a[112:115], v[232:235]
v_mov_b64 v[82:83], v[26:27]
v_mfma_f32_16x16x32_bf16 v[232:235], a[236:239], a[116:119], v[232:235]
v_mov_b64 v[84:85], 0
v_mfma_f32_16x16x32_bf16 v[220:223], a[216:219], a[120:123], 0
v_mov_b64 v[86:87], v[26:27]
v_mfma_f32_16x16x32_bf16 v[220:223], a[220:223], a[124:127], v[220:223]
v_cvt_pk_bf16_f32 v66, v228, v229
v_cvt_pk_bf16_f32 v67, v230, v231
v_mfma_f32_16x16x32_bf16 v[220:223], a[224:227], a[128:131], v[220:223]
ds_read_b128 a[216:219], v1 offset:30720
ds_read_b128 a[220:223], v1 offset:31744
v_mfma_f32_16x16x32_bf16 v[220:223], a[228:231], a[132:135], v[220:223]
ds_read_b128 a[224:227], v1 offset:32768
ds_read_b128 a[228:231], v1 offset:33792
v_mfma_f32_16x16x32_bf16 v[220:223], a[232:235], a[136:139], v[220:223]
v_cvt_pk_bf16_f32 v102, v232, v233
v_cvt_pk_bf16_f32 v103, v234, v235
v_mfma_f32_16x16x32_bf16 v[220:223], a[236:239], a[140:143], v[220:223]
ds_read_b128 a[232:235], v1 offset:34816
ds_read_b128 a[236:239], v1 offset:35840
v_smfmac_f32_16x16x64_bf16 v[76:79], a[168:171], a[72:79], v0
v_smfmac_f32_16x16x64_bf16 v[76:79], a[172:175], a[80:87], v0
v_smfmac_f32_16x16x64_bf16 v[76:79], a[176:179], a[88:95], v0
v_smfmac_f32_16x16x64_bf16 v[80:83], a[168:171], a[96:103], v0
v_smfmac_f32_16x16x64_bf16 v[80:83], a[172:175], a[104:111], v0
v_smfmac_f32_16x16x64_bf16 v[80:83], a[176:179], a[112:119], v0
v_cvt_pk_bf16_f32 v150, v220, v221
v_smfmac_f32_16x16x64_bf16 v[84:87], a[168:171], a[120:127], v0
v_cvt_pk_bf16_f32 v151, v222, v223
v_smfmac_f32_16x16x64_bf16 v[84:87], a[172:175], a[128:135], v0
v_smfmac_f32_16x16x64_bf16 v[84:87], a[176:179], a[136:143], v0
s_waitcnt lgkmcnt(11)
v_add_f32 v78, v78, v79
v_mfma_f32_16x16x32_bf16 v[224:227], a[192:195], a[72:75], 0
buffer_load_dwordx4 a[4:7], v9, s[20:23], s32 offen offset:0 nt
s_waitcnt lgkmcnt(10)
v_add_f32 v76, v76, v77
v_mfma_f32_16x16x32_bf16 v[224:227], a[196:199], a[76:79], v[224:227]
s_waitcnt lgkmcnt(9)
v_add_f32 v80, v80, v81
v_max3_f32 v88, v18, v76, v80
v_mfma_f32_16x16x32_bf16 v[224:227], a[200:203], a[80:83], v[224:227]
s_waitcnt lgkmcnt(8)
v_add_f32 v84, v84, v85
v_max_f32 v88, v88, v84
v_mfma_f32_16x16x32_bf16 v[224:227], a[204:207], a[84:87], v[224:227]
s_waitcnt lgkmcnt(7)
v_add_f32 v82, v82, v83
v_max_f32_dpp v88, v88, v88 row_ror:8 row_mask:0xf bank_mask:0xf
v_mfma_f32_16x16x32_bf16 v[224:227], a[208:211], a[88:91], v[224:227]
s_waitcnt lgkmcnt(6)
v_add_f32 v86, v86, v87
v_max_f32_dpp v88, v88, v88 row_ror:4 row_mask:0xf bank_mask:0xf
v_mfma_f32_16x16x32_bf16 v[224:227], a[212:215], a[92:95], v[224:227]
v_mfma_f32_16x16x32_bf16 v[228:231], a[192:195], a[96:99], 0
v_max_f32_dpp v88, v88, v88 row_ror:2 row_mask:0xf bank_mask:0xf
v_mfma_f32_16x16x32_bf16 v[228:231], a[196:199], a[100:103], v[228:231]
v_mfma_f32_16x16x32_bf16 v[228:231], a[200:203], a[104:107], v[228:231]
v_max_f32_dpp v88, v88, v88 row_ror:1 row_mask:0xf bank_mask:0xf
v_sub_f32 v89, v18, v88
v_mfma_f32_16x16x32_bf16 v[228:231], a[204:207], a[108:111], v[228:231]
v_sub_f32 v76, v76, v88
v_cvt_pk_bf16_f32 v68, v224, v225
v_mfma_f32_16x16x32_bf16 v[228:231], a[208:211], a[112:115], v[228:231]
v_cvt_pk_bf16_f32 v69, v226, v227
v_sub_f32 v80, v80, v88
v_mfma_f32_16x16x32_bf16 v[228:231], a[212:215], a[116:119], v[228:231]
v_sub_f32 v84, v84, v88
v_mfma_f32_16x16x32_bf16 v[232:235], a[192:195], a[120:123], 0
ds_read_b128 a[192:195], v1 offset:36864
v_mfma_f32_16x16x32_bf16 v[232:235], a[196:199], a[124:127], v[232:235]
ds_read_b128 a[196:199], v1 offset:37888
v_mfma_f32_16x16x32_bf16 v[232:235], a[200:203], a[128:131], v[232:235]
buffer_load_dwordx4 a[24:27], v10, s[20:23], s32 offen offset:0 nt
ds_read_b128 a[200:203], v1 offset:38912
v_mfma_f32_16x16x32_bf16 v[232:235], a[204:207], a[132:135], v[232:235]
ds_read_b128 a[204:207], v1 offset:39936
v_cvt_pk_bf16_f32 v108, v228, v229
v_mfma_f32_16x16x32_bf16 v[232:235], a[208:211], a[136:139], v[232:235]
v_cvt_pk_bf16_f32 v109, v230, v231
v_mfma_f32_16x16x32_bf16 v[232:235], a[212:215], a[140:143], v[232:235]
s_waitcnt lgkmcnt(9)
ds_read_b128 a[208:211], v1 offset:40960
ds_read_b128 a[212:215], v1 offset:41984
v_mfma_f32_16x16x32_bf16 v[220:223], a[216:219], a[72:75], 0
s_waitcnt lgkmcnt(10)
v_exp_f32 v76, v76
v_mfma_f32_16x16x32_bf16 v[220:223], a[220:223], a[76:79], v[220:223]
s_waitcnt lgkmcnt(9)
v_exp_f32 v80, v80
v_mfma_f32_16x16x32_bf16 v[220:223], a[224:227], a[80:83], v[220:223]
s_waitcnt lgkmcnt(8)
v_exp_f32 v84, v84
v_mfma_f32_16x16x32_bf16 v[220:223], a[228:231], a[84:87], v[220:223]
s_waitcnt lgkmcnt(7)
v_cvt_pk_bf16_f32 v156, v232, v233
v_cvt_pk_bf16_f32 v157, v234, v235
v_mfma_f32_16x16x32_bf16 v[220:223], a[232:235], a[88:91], v[220:223]
s_waitcnt lgkmcnt(6)
v_exp_f32 v89, v89
v_mfma_f32_16x16x32_bf16 v[220:223], a[236:239], a[92:95], v[220:223]
v_add_f32 v88, v76, v80
v_add_f32 v90, v84, v89
v_mfma_f32_16x16x32_bf16 v[224:227], a[216:219], a[96:99], 0
v_add_f32 v88, v88, v90
v_mfma_f32_16x16x32_bf16 v[224:227], a[220:223], a[100:103], v[224:227]
v_mfma_f32_16x16x32_bf16 v[224:227], a[224:227], a[104:107], v[224:227]
v_add_f32_dpp v88, v88, v88 row_ror:8 row_mask:0xf bank_mask:0xf
v_mfma_f32_16x16x32_bf16 v[224:227], a[228:231], a[108:111], v[224:227]
v_cvt_pk_bf16_f32 v70, v220, v221
v_cvt_pk_bf16_f32 v71, v222, v223
v_mfma_f32_16x16x32_bf16 v[224:227], a[232:235], a[112:115], v[224:227]
v_add_f32_dpp v88, v88, v88 row_ror:4 row_mask:0xf bank_mask:0xf
v_mfma_f32_16x16x32_bf16 v[224:227], a[236:239], a[116:119], v[224:227]
v_mfma_f32_16x16x32_bf16 v[228:231], a[216:219], a[120:123], 0
ds_read_b128 a[216:219], v1 offset:43008
v_add_f32_dpp v88, v88, v88 row_ror:2 row_mask:0xf bank_mask:0xf
v_mfma_f32_16x16x32_bf16 v[228:231], a[220:223], a[124:127], v[228:231]
buffer_load_dwordx4 a[28:31], v11, s[20:23], s32 offen offset:0 nt
ds_read_b128 a[220:223], v1 offset:44032
v_mfma_f32_16x16x32_bf16 v[228:231], a[224:227], a[128:131], v[228:231]
ds_read_b128 a[224:227], v1 offset:45056
v_cvt_pk_bf16_f32 v110, v224, v225
v_mfma_f32_16x16x32_bf16 v[228:231], a[228:231], a[132:135], v[228:231]
ds_read_b128 a[228:231], v1 offset:46080
v_cvt_pk_bf16_f32 v111, v226, v227
v_mfma_f32_16x16x32_bf16 v[228:231], a[232:235], a[136:139], v[228:231]
ds_read_b128 a[232:235], v1 offset:47104
v_add_f32_dpp v88, v88, v88 row_ror:1 row_mask:0xf bank_mask:0xf
v_mfma_f32_16x16x32_bf16 v[228:231], a[236:239], a[140:143], v[228:231]
s_waitcnt lgkmcnt(10)
ds_read_b128 a[236:239], v1 offset:48128
v_mfma_f32_16x16x32_bf16 v[232:235], a[192:195], a[72:75], 0
s_waitcnt lgkmcnt(10)
v_rcp_f32 v88, v88
v_mfma_f32_16x16x32_bf16 v[232:235], a[196:199], a[76:79], v[232:235]
s_waitcnt lgkmcnt(9)
v_mul_f32 v76, v76, v88
v_mul_f32 v80, v80, v88
v_mfma_f32_16x16x32_bf16 v[232:235], a[200:203], a[80:83], v[232:235]
s_waitcnt lgkmcnt(8)
v_mul_f32 v84, v84, v88
v_cvt_pk_bf16_f32 v158, v228, v229
v_mfma_f32_16x16x32_bf16 v[232:235], a[204:207], a[84:87], v[232:235]
s_waitcnt lgkmcnt(7)
v_cvt_pk_bf16_f32 v159, v230, v231
v_mul_f32 v89, v89, v88
v_mfma_f32_16x16x32_bf16 v[232:235], a[208:211], a[88:91], v[232:235]
s_waitcnt lgkmcnt(6)
v_cvt_pk_bf16_f32 v90, v76, v80
v_cvt_pk_bf16_f32 v91, v84, v89
v_mfma_f32_16x16x32_bf16 v[232:235], a[212:215], a[92:95], v[232:235]
ds_write_b16 v20, v90 offset:0
v_mfma_f32_16x16x32_bf16 v[220:223], a[192:195], a[96:99], 0
ds_write_b16_d16_hi v20, v90 offset:4
v_mfma_f32_16x16x32_bf16 v[220:223], a[196:199], a[100:103], v[220:223]
ds_write_b16 v20, v91 offset:32
v_mfma_f32_16x16x32_bf16 v[220:223], a[200:203], a[104:107], v[220:223]
ds_write_b16_d16_hi v20, v91 offset:36
v_mfma_f32_16x16x32_bf16 v[220:223], a[204:207], a[108:111], v[220:223]
v_cvt_pk_bf16_f32 v72, v232, v233
v_cvt_pk_bf16_f32 v73, v234, v235
v_mfma_f32_16x16x32_bf16 v[220:223], a[208:211], a[112:115], v[220:223]
ds_read_b128 a[240:243], v22 offset:0
ds_read_b128 a[244:247], v22 offset:128
v_mfma_f32_16x16x32_bf16 v[220:223], a[212:215], a[116:119], v[220:223]
ds_read_b128 a[248:251], v22 offset:256
ds_read_b128 a[252:255], v22 offset:384
v_mfma_f32_16x16x32_bf16 v[224:227], a[192:195], a[120:123], 0
ds_read_b128 a[192:195], v1 offset:49152
v_mfma_f32_16x16x32_bf16 v[224:227], a[196:199], a[124:127], v[224:227]
buffer_load_dwordx4 a[48:51], v12, s[20:23], s32 offen offset:0 nt
ds_read_b128 a[196:199], v1 offset:50176
v_mfma_f32_16x16x32_bf16 v[224:227], a[200:203], a[128:131], v[224:227]
ds_read_b128 a[200:203], v1 offset:51200
v_cvt_pk_bf16_f32 v116, v220, v221
v_mfma_f32_16x16x32_bf16 v[224:227], a[204:207], a[132:135], v[224:227]
ds_read_b128 a[204:207], v1 offset:52224
v_cvt_pk_bf16_f32 v117, v222, v223
v_mfma_f32_16x16x32_bf16 v[224:227], a[208:211], a[136:139], v[224:227]
ds_read_b128 a[208:211], v1 offset:53248
v_mfma_f32_16x16x32_bf16 v[224:227], a[212:215], a[140:143], v[224:227]
s_waitcnt lgkmcnt(15)
ds_read_b128 a[212:215], v1 offset:54272
v_mfma_f32_16x16x32_bf16 v[228:231], a[216:219], a[72:75], 0
v_mfma_f32_16x16x32_bf16 v[228:231], a[220:223], a[76:79], v[228:231]
v_mfma_f32_16x16x32_bf16 v[228:231], a[224:227], a[80:83], v[228:231]
v_mfma_f32_16x16x32_bf16 v[228:231], a[228:231], a[84:87], v[228:231]
s_waitcnt lgkmcnt(15)
v_mfma_f32_16x16x32_bf16 v[228:231], a[232:235], a[88:91], v[228:231]
s_waitcnt lgkmcnt(14)
v_mfma_f32_16x16x32_bf16 v[228:231], a[236:239], a[92:95], v[228:231]
v_mfma_f32_16x16x32_bf16 v[232:235], a[216:219], a[96:99], 0
v_cvt_pk_bf16_f32 v164, v224, v225
v_cvt_pk_bf16_f32 v165, v226, v227
v_mfma_f32_16x16x32_bf16 v[232:235], a[220:223], a[100:103], v[232:235]
v_mfma_f32_16x16x32_bf16 v[232:235], a[224:227], a[104:107], v[232:235]
v_mfma_f32_16x16x32_bf16 v[232:235], a[228:231], a[108:111], v[232:235]
v_mfma_f32_16x16x32_bf16 v[232:235], a[232:235], a[112:115], v[232:235]
v_mfma_f32_16x16x32_bf16 v[232:235], a[236:239], a[116:119], v[232:235]
v_cvt_pk_bf16_f32 v74, v228, v229
v_cvt_pk_bf16_f32 v75, v230, v231
v_mfma_f32_16x16x32_bf16 v[220:223], a[216:219], a[120:123], 0
buffer_load_dwordx4 a[52:55], v13, s[20:23], s32 offen offset:0 nt
ds_read_b128 a[216:219], v1 offset:55296
v_mfma_f32_16x16x32_bf16 v[220:223], a[220:223], a[124:127], v[220:223]
ds_read_b128 a[220:223], v1 offset:56320
v_mfma_f32_16x16x32_bf16 v[220:223], a[224:227], a[128:131], v[220:223]
ds_read_b128 a[224:227], v1 offset:57344
v_cvt_pk_bf16_f32 v118, v232, v233
v_mfma_f32_16x16x32_bf16 v[220:223], a[228:231], a[132:135], v[220:223]
ds_read_b128 a[228:231], v1 offset:58368
v_cvt_pk_bf16_f32 v119, v234, v235
v_mfma_f32_16x16x32_bf16 v[220:223], a[232:235], a[136:139], v[220:223]
ds_read_b128 a[232:235], v1 offset:59392
v_mfma_f32_16x16x32_bf16 v[220:223], a[236:239], a[140:143], v[220:223]
s_waitcnt lgkmcnt(10)
ds_read_b128 a[236:239], v1 offset:60416
v_mfma_f32_16x16x32_bf16 v[224:227], a[192:195], a[72:75], 0
s_waitcnt lgkmcnt(10)
v_mfma_f32_16x16x32_bf16 v[224:227], a[196:199], a[76:79], v[224:227]
s_waitcnt lgkmcnt(9)
v_mfma_f32_16x16x32_bf16 v[224:227], a[200:203], a[80:83], v[224:227]
s_waitcnt lgkmcnt(8)
v_mfma_f32_16x16x32_bf16 v[224:227], a[204:207], a[84:87], v[224:227]
s_waitcnt lgkmcnt(7)
v_mfma_f32_16x16x32_bf16 v[224:227], a[208:211], a[88:91], v[224:227]
s_waitcnt lgkmcnt(6)
v_mfma_f32_16x16x32_bf16 v[224:227], a[212:215], a[92:95], v[224:227]
v_mfma_f32_16x16x32_bf16 v[228:231], a[192:195], a[96:99], 0
v_cvt_pk_bf16_f32 v166, v220, v221
v_cvt_pk_bf16_f32 v167, v222, v223
v_mfma_f32_16x16x32_bf16 v[228:231], a[196:199], a[100:103], v[228:231]
v_mfma_f32_16x16x32_bf16 v[228:231], a[200:203], a[104:107], v[228:231]
v_mfma_f32_16x16x32_bf16 v[228:231], a[204:207], a[108:111], v[228:231]
v_mfma_f32_16x16x32_bf16 v[228:231], a[208:211], a[112:115], v[228:231]
v_mfma_f32_16x16x32_bf16 v[228:231], a[212:215], a[116:119], v[228:231]
v_cvt_pk_bf16_f32 v236, v224, v225
v_cvt_pk_bf16_f32 v237, v226, v227
v_mfma_f32_16x16x32_bf16 v[232:235], a[192:195], a[120:123], 0
buffer_load_dwordx4 a[8:11], v8, s[20:23], s32 offen offset:128 nt
ds_read_b128 a[192:195], v1 offset:61440
v_mfma_f32_16x16x32_bf16 v[232:235], a[196:199], a[124:127], v[232:235]
ds_read_b128 a[196:199], v1 offset:62464
v_mfma_f32_16x16x32_bf16 v[232:235], a[200:203], a[128:131], v[232:235]
ds_read_b128 a[200:203], v1 offset:63488
v_cvt_pk_bf16_f32 v124, v228, v229
v_mfma_f32_16x16x32_bf16 v[232:235], a[204:207], a[132:135], v[232:235]
ds_read_b128 a[204:207], v1 offset:64512
v_cvt_pk_bf16_f32 v125, v230, v231
v_mfma_f32_16x16x32_bf16 v[232:235], a[208:211], a[136:139], v[232:235]
ds_read_b128 a[208:211], v2 offset:0
v_mfma_f32_16x16x32_bf16 v[232:235], a[212:215], a[140:143], v[232:235]
s_waitcnt lgkmcnt(10)
ds_read_b128 a[212:215], v2 offset:1024
v_mfma_f32_16x16x32_bf16 v[220:223], a[216:219], a[72:75], 0
s_waitcnt lgkmcnt(10)
v_mfma_f32_16x16x32_bf16 v[220:223], a[220:223], a[76:79], v[220:223]
s_waitcnt lgkmcnt(9)
v_mfma_f32_16x16x32_bf16 v[220:223], a[224:227], a[80:83], v[220:223]
s_waitcnt lgkmcnt(8)
v_mfma_f32_16x16x32_bf16 v[220:223], a[228:231], a[84:87], v[220:223]
s_waitcnt lgkmcnt(7)
v_mfma_f32_16x16x32_bf16 v[220:223], a[232:235], a[88:91], v[220:223]
s_waitcnt lgkmcnt(6)
v_mfma_f32_16x16x32_bf16 v[220:223], a[236:239], a[92:95], v[220:223]
v_mfma_f32_16x16x32_bf16 v[224:227], a[216:219], a[96:99], 0
v_cvt_pk_bf16_f32 v172, v232, v233
v_cvt_pk_bf16_f32 v173, v234, v235
v_mfma_f32_16x16x32_bf16 v[224:227], a[220:223], a[100:103], v[224:227]
v_mfma_f32_16x16x32_bf16 v[224:227], a[224:227], a[104:107], v[224:227]
v_mfma_f32_16x16x32_bf16 v[224:227], a[228:231], a[108:111], v[224:227]
v_mfma_f32_16x16x32_bf16 v[224:227], a[232:235], a[112:115], v[224:227]
v_mfma_f32_16x16x32_bf16 v[224:227], a[236:239], a[116:119], v[224:227]
buffer_load_dwordx4 a[12:15], v9, s[20:23], s32 offen offset:128 nt
v_cvt_pk_bf16_f32 v238, v220, v221
v_mfma_f32_16x16x32_bf16 v[228:231], a[216:219], a[120:123], 0
v_cvt_pk_bf16_f32 v239, v222, v223
v_mfma_f32_16x16x32_bf16 v[228:231], a[220:223], a[124:127], v[228:231]
ds_read_b128 a[216:219], v2 offset:2048
ds_read_b128 a[220:223], v2 offset:3072
v_mfma_f32_16x16x32_bf16 v[228:231], a[224:227], a[128:131], v[228:231]
ds_read_b128 a[224:227], v2 offset:4096
v_cvt_pk_bf16_f32 v126, v224, v225
v_mfma_f32_16x16x32_bf16 v[228:231], a[228:231], a[132:135], v[228:231]
ds_read_b128 a[228:231], v2 offset:5120
v_cvt_pk_bf16_f32 v127, v226, v227
v_mfma_f32_16x16x32_bf16 v[228:231], a[232:235], a[136:139], v[228:231]
ds_read_b128 a[232:235], v2 offset:6144
v_mfma_f32_16x16x32_bf16 v[228:231], a[236:239], a[140:143], v[228:231]
s_waitcnt lgkmcnt(10)
ds_read_b128 a[236:239], v2 offset:7168
v_mfma_f32_16x16x32_bf16 v[232:235], a[192:195], a[72:75], 0
s_waitcnt lgkmcnt(10)
v_mfma_f32_16x16x32_bf16 v[232:235], a[196:199], a[76:79], v[232:235]
s_waitcnt lgkmcnt(9)
v_mfma_f32_16x16x32_bf16 v[232:235], a[200:203], a[80:83], v[232:235]
s_waitcnt lgkmcnt(8)
v_mfma_f32_16x16x32_bf16 v[232:235], a[204:207], a[84:87], v[232:235]
s_waitcnt lgkmcnt(7)
v_mfma_f32_16x16x32_bf16 v[232:235], a[208:211], a[88:91], v[232:235]
s_waitcnt lgkmcnt(6)
v_mfma_f32_16x16x32_bf16 v[232:235], a[212:215], a[92:95], v[232:235]
v_mfma_f32_16x16x32_bf16 v[220:223], a[192:195], a[96:99], 0
v_cvt_pk_bf16_f32 v174, v228, v229
v_cvt_pk_bf16_f32 v175, v230, v231
v_mfma_f32_16x16x32_bf16 v[220:223], a[196:199], a[100:103], v[220:223]
v_mfma_f32_16x16x32_bf16 v[220:223], a[200:203], a[104:107], v[220:223]
v_mfma_f32_16x16x32_bf16 v[220:223], a[204:207], a[108:111], v[220:223]
v_mfma_f32_16x16x32_bf16 v[220:223], a[208:211], a[112:115], v[220:223]
v_mfma_f32_16x16x32_bf16 v[220:223], a[212:215], a[116:119], v[220:223]
buffer_load_dwordx4 a[32:35], v10, s[20:23], s32 offen offset:128 nt
v_cvt_pk_bf16_f32 v240, v232, v233
v_mfma_f32_16x16x32_bf16 v[224:227], a[192:195], a[120:123], 0
v_cvt_pk_bf16_f32 v241, v234, v235
v_mfma_f32_16x16x32_bf16 v[224:227], a[196:199], a[124:127], v[224:227]
ds_read_b128 a[192:195], v2 offset:8192
ds_read_b128 a[196:199], v2 offset:9216
v_mfma_f32_16x16x32_bf16 v[224:227], a[200:203], a[128:131], v[224:227]
v_cvt_pk_bf16_f32 v132, v220, v221
v_cvt_pk_bf16_f32 v133, v222, v223
v_mfma_f32_16x16x32_bf16 v[224:227], a[204:207], a[132:135], v[224:227]
ds_read_b128 a[200:203], v2 offset:10240
ds_read_b128 a[204:207], v2 offset:11264
v_mfma_f32_16x16x32_bf16 v[224:227], a[208:211], a[136:139], v[224:227]
ds_read_b128 a[208:211], v2 offset:12288
v_mfma_f32_16x16x32_bf16 v[224:227], a[212:215], a[140:143], v[224:227]
s_waitcnt lgkmcnt(10)
ds_read_b128 a[212:215], v2 offset:13312
v_mfma_f32_16x16x32_bf16 v[228:231], a[216:219], a[72:75], 0
s_waitcnt lgkmcnt(10)
v_mfma_f32_16x16x32_bf16 v[228:231], a[220:223], a[76:79], v[228:231]
s_waitcnt lgkmcnt(9)
v_mfma_f32_16x16x32_bf16 v[228:231], a[224:227], a[80:83], v[228:231]
s_waitcnt lgkmcnt(8)
v_mfma_f32_16x16x32_bf16 v[228:231], a[228:231], a[84:87], v[228:231]
s_waitcnt lgkmcnt(7)
v_mfma_f32_16x16x32_bf16 v[228:231], a[232:235], a[88:91], v[228:231]
s_waitcnt lgkmcnt(6)
v_mfma_f32_16x16x32_bf16 v[228:231], a[236:239], a[92:95], v[228:231]
v_mfma_f32_16x16x32_bf16 v[232:235], a[216:219], a[96:99], 0
v_cvt_pk_bf16_f32 v180, v224, v225
v_cvt_pk_bf16_f32 v181, v226, v227
v_mfma_f32_16x16x32_bf16 v[232:235], a[220:223], a[100:103], v[232:235]
v_mfma_f32_16x16x32_bf16 v[232:235], a[224:227], a[104:107], v[232:235]
v_mfma_f32_16x16x32_bf16 v[232:235], a[228:231], a[108:111], v[232:235]
v_mfma_f32_16x16x32_bf16 v[232:235], a[232:235], a[112:115], v[232:235]
buffer_load_dwordx4 a[36:39], v11, s[20:23], s32 offen offset:128 nt
v_cvt_pk_bf16_f32 v242, v228, v229
v_mfma_f32_16x16x32_bf16 v[232:235], a[236:239], a[116:119], v[232:235]
v_cvt_pk_bf16_f32 v243, v230, v231
v_mfma_f32_16x16x32_bf16 v[220:223], a[216:219], a[120:123], 0
ds_read_b128 a[216:219], v2 offset:14336
v_mfma_f32_16x16x32_bf16 v[220:223], a[220:223], a[124:127], v[220:223]
ds_read_b128 a[220:223], v2 offset:15360
v_mfma_f32_16x16x32_bf16 v[220:223], a[224:227], a[128:131], v[220:223]
ds_read_b128 a[224:227], v2 offset:16384
v_mfma_f32_16x16x32_bf16 v[220:223], a[228:231], a[132:135], v[220:223]
v_cvt_pk_bf16_f32 v134, v232, v233
v_cvt_pk_bf16_f32 v135, v234, v235
v_mfma_f32_16x16x32_bf16 v[220:223], a[232:235], a[136:139], v[220:223]
ds_read_b128 a[228:231], v2 offset:17408
ds_read_b128 a[232:235], v2 offset:18432
v_mfma_f32_16x16x32_bf16 v[220:223], a[236:239], a[140:143], v[220:223]
ds_read_b128 a[236:239], v2 offset:19456
v_mfma_f32_16x16x32_bf16 v[28:31], a[72:75], v[60:63], 0
v_mfma_f32_16x16x32_bf16 v[28:31], a[76:79], v[64:67], v[28:31]
v_mfma_f32_16x16x32_bf16 v[28:31], a[80:83], v[68:71], v[28:31]
v_mfma_f32_16x16x32_bf16 v[28:31], a[84:87], v[72:75], v[28:31]
v_mfma_f32_16x16x32_bf16 v[28:31], a[88:91], v[236:239], v[28:31]
v_mfma_f32_16x16x32_bf16 v[28:31], a[92:95], v[240:243], v[28:31]
v_mfma_f32_16x16x32_bf16 v[32:35], a[96:99], v[60:63], 0
v_cvt_pk_bf16_f32 v182, v220, v221
v_cvt_pk_bf16_f32 v183, v222, v223
v_mfma_f32_16x16x32_bf16 v[32:35], a[100:103], v[64:67], v[32:35]
v_mfma_f32_16x16x32_bf16 v[32:35], a[104:107], v[68:71], v[32:35]
v_mfma_f32_16x16x32_bf16 v[32:35], a[108:111], v[72:75], v[32:35]
v_mfma_f32_16x16x32_bf16 v[32:35], a[112:115], v[236:239], v[32:35]
buffer_load_dwordx4 a[56:59], v12, s[20:23], s32 offen offset:128 nt
v_max3_f32 v42, v28, v29, v30
v_mfma_f32_16x16x32_bf16 v[32:35], a[116:119], v[240:243], v[32:35]
v_mfma_f32_16x16x32_bf16 v[36:39], a[120:123], v[60:63], 0
v_mfma_f32_16x16x32_bf16 v[36:39], a[124:127], v[64:67], v[36:39]
v_mfma_f32_16x16x32_bf16 v[36:39], a[128:131], v[68:71], v[36:39]
v_mfma_f32_16x16x32_bf16 v[36:39], a[132:135], v[72:75], v[36:39]
v_mfma_f32_16x16x32_bf16 v[36:39], a[136:139], v[236:239], v[36:39]
v_mfma_f32_16x16x32_bf16 v[36:39], a[140:143], v[240:243], v[36:39]
v_mfma_f32_16x16x32_bf16 v[44:47], a[72:75], v[92:95], 0
v_mfma_f32_16x16x32_bf16 v[44:47], a[76:79], v[100:103], v[44:47]
v_max3_f32 v42, v42, v31, v32
v_max3_f32 v42, v42, v33, v34
v_mfma_f32_16x16x32_bf16 v[44:47], a[80:83], v[108:111], v[44:47]
v_mfma_f32_16x16x32_bf16 v[44:47], a[84:87], v[116:119], v[44:47]
v_mfma_f32_16x16x32_bf16 v[44:47], a[88:91], v[124:127], v[44:47]
v_mfma_f32_16x16x32_bf16 v[44:47], a[92:95], v[132:135], v[44:47]
v_max3_f32 v42, v42, v35, v36
v_max3_f32 v42, v42, v37, v38
v_mfma_f32_16x16x32_bf16 v[48:51], a[96:99], v[92:95], 0
v_max3_f32 v42, v42, v39, v78
v_mov_b32 v43, v42
v_mfma_f32_16x16x32_bf16 v[48:51], a[100:103], v[100:103], v[48:51]
v_mfma_f32_16x16x32_bf16 v[48:51], a[104:107], v[108:111], v[48:51]
v_permlane32_swap_b32 v42, v43
v_mfma_f32_16x16x32_bf16 v[48:51], a[108:111], v[116:119], v[48:51]
buffer_load_dwordx4 a[60:63], v13, s[20:23], s32 offen offset:128 nt
v_max_f32 v42, v42, v43
v_mfma_f32_16x16x32_bf16 v[48:51], a[112:115], v[124:127], v[48:51]
v_mov_b32 v43, v42
v_max3_f32 v58, v44, v45, v46
v_mfma_f32_16x16x32_bf16 v[48:51], a[116:119], v[132:135], v[48:51]
v_permlane16_swap_b32 v42, v43
v_mfma_f32_16x16x32_bf16 v[52:55], a[120:123], v[92:95], 0
v_max_f32 v42, v42, v43
v_sub_f32 v28, v28, v42
v_mfma_f32_16x16x32_bf16 v[52:55], a[124:127], v[100:103], v[52:55]
v_sub_f32 v29, v29, v42
v_sub_f32 v30, v30, v42
v_mfma_f32_16x16x32_bf16 v[52:55], a[128:131], v[108:111], v[52:55]
v_exp_f32 v28, v28
v_mfma_f32_16x16x32_bf16 v[52:55], a[132:135], v[116:119], v[52:55]
v_exp_f32 v29, v29
v_mfma_f32_16x16x32_bf16 v[52:55], a[136:139], v[124:127], v[52:55]
v_sub_f32 v31, v31, v42
v_sub_f32 v32, v32, v42
v_mfma_f32_16x16x32_bf16 v[52:55], a[140:143], v[132:135], v[52:55]
v_sub_f32 v33, v33, v42
v_sub_f32 v34, v34, v42
v_mfma_f32_16x16x32_bf16 v[60:63], a[72:75], v[140:143], 0
v_sub_f32 v35, v35, v42
v_sub_f32 v36, v36, v42
v_mfma_f32_16x16x32_bf16 v[60:63], a[76:79], v[148:151], v[60:63]
v_sub_f32 v37, v37, v42
v_sub_f32 v38, v38, v42
v_mfma_f32_16x16x32_bf16 v[60:63], a[80:83], v[156:159], v[60:63]
v_sub_f32 v39, v39, v42
v_sub_f32 v78, v78, v42
v_mfma_f32_16x16x32_bf16 v[60:63], a[84:87], v[164:167], v[60:63]
v_exp_f32 v30, v30
v_mfma_f32_16x16x32_bf16 v[60:63], a[88:91], v[172:175], v[60:63]
v_exp_f32 v31, v31
v_mfma_f32_16x16x32_bf16 v[60:63], a[92:95], v[180:183], v[60:63]
v_add_f32 v42, v28, v29
v_add_f32 v42, v42, v30
v_mfma_f32_16x16x32_bf16 v[64:67], a[96:99], v[140:143], 0
v_exp_f32 v32, v32
v_mfma_f32_16x16x32_bf16 v[64:67], a[100:103], v[148:151], v[64:67]
v_exp_f32 v33, v33
v_mfma_f32_16x16x32_bf16 v[64:67], a[104:107], v[156:159], v[64:67]
v_add_f32 v42, v42, v31
v_add_f32 v42, v42, v32
v_mfma_f32_16x16x32_bf16 v[64:67], a[108:111], v[164:167], v[64:67]
buffer_load_dwordx4 a[16:19], v8, s[20:23], s32 offen offset:256 nt
v_add_f32 v42, v42, v33
v_mfma_f32_16x16x32_bf16 v[64:67], a[112:115], v[172:175], v[64:67]
v_exp_f32 v34, v34
v_mfma_f32_16x16x32_bf16 v[64:67], a[116:119], v[180:183], v[64:67]
v_exp_f32 v35, v35
v_mfma_f32_16x16x32_bf16 v[68:71], a[120:123], v[140:143], 0
v_exp_f32 v36, v36
v_mfma_f32_16x16x32_bf16 v[68:71], a[124:127], v[148:151], v[68:71]
v_add_f32 v42, v42, v34
v_add_f32 v42, v42, v35
v_mfma_f32_16x16x32_bf16 v[68:71], a[128:131], v[156:159], v[68:71]
v_exp_f32 v37, v37
v_mfma_f32_16x16x32_bf16 v[68:71], a[132:135], v[164:167], v[68:71]
v_exp_f32 v38, v38
v_mfma_f32_16x16x32_bf16 v[68:71], a[136:139], v[172:175], v[68:71]
v_add_f32 v42, v42, v36
v_add_f32 v42, v42, v37
v_mfma_f32_16x16x32_bf16 v[68:71], a[140:143], v[180:183], v[68:71]
s_waitcnt lgkmcnt(11)
v_exp_f32 v39, v39
v_mfma_f32_16x16x32_bf16 v[224:227], a[72:75], a[192:195], 0
s_waitcnt lgkmcnt(10)
v_exp_f32 v78, v78
v_mfma_f32_16x16x32_bf16 v[224:227], a[76:79], a[196:199], v[224:227]
s_waitcnt lgkmcnt(9)
v_add_f32 v42, v42, v38
v_add_f32 v42, v42, v39
v_mfma_f32_16x16x32_bf16 v[224:227], a[80:83], a[200:203], v[224:227]
s_waitcnt lgkmcnt(8)
v_add_f32 v42, v42, v78
v_mov_b32 v43, v42
v_mfma_f32_16x16x32_bf16 v[224:227], a[84:87], a[204:207], v[224:227]
s_waitcnt lgkmcnt(7)
v_max3_f32 v58, v58, v47, v48
v_max3_f32 v58, v58, v49, v50
v_mfma_f32_16x16x32_bf16 v[224:227], a[88:91], a[208:211], v[224:227]
s_waitcnt lgkmcnt(6)
v_permlane32_swap_b32 v42, v43
v_mfma_f32_16x16x32_bf16 v[224:227], a[92:95], a[212:215], v[224:227]
v_add_f32 v42, v42, v43
v_mov_b32 v43, v42
v_mfma_f32_16x16x32_bf16 v[228:231], a[96:99], a[192:195], 0
v_max3_f32 v58, v58, v51, v52
v_max3_f32 v58, v58, v53, v54
v_mfma_f32_16x16x32_bf16 v[228:231], a[100:103], a[196:199], v[228:231]
v_permlane16_swap_b32 v42, v43
v_mfma_f32_16x16x32_bf16 v[228:231], a[104:107], a[200:203], v[228:231]
buffer_load_dwordx4 a[20:23], v9, s[20:23], s32 offen offset:256 nt
v_cvt_pk_bf16_f32 v92, v224, v225
v_mfma_f32_16x16x32_bf16 v[228:231], a[108:111], a[204:207], v[228:231]
v_cvt_pk_bf16_f32 v93, v226, v227
v_add_f32 v42, v42, v43
v_mfma_f32_16x16x32_bf16 v[228:231], a[112:115], a[208:211], v[228:231]
v_rcp_f32 v42, v42
v_mfma_f32_16x16x32_bf16 v[228:231], a[116:119], a[212:215], v[228:231]
v_mul_f32 v28, v28, v42
v_mul_f32 v29, v29, v42
v_mfma_f32_16x16x32_bf16 v[232:235], a[120:123], a[192:195], 0
ds_read_b128 a[192:195], v2 offset:20480
v_mul_f32 v30, v30, v42
v_mfma_f32_16x16x32_bf16 v[232:235], a[124:127], a[196:199], v[232:235]
ds_read_b128 a[196:199], v2 offset:21504
v_mul_f32 v31, v31, v42
v_mfma_f32_16x16x32_bf16 v[232:235], a[128:131], a[200:203], v[232:235]
ds_read_b128 a[200:203], v2 offset:22528
v_cvt_pk_bf16_f32 v94, v228, v229
v_mfma_f32_16x16x32_bf16 v[232:235], a[132:135], a[204:207], v[232:235]
ds_read_b128 a[204:207], v2 offset:23552
v_cvt_pk_bf16_f32 v95, v230, v231
v_mfma_f32_16x16x32_bf16 v[232:235], a[136:139], a[208:211], v[232:235]
LW_p9:
s_cbranch_execz LW_p14
ds_read_b128 a[208:211], v2 offset:24576
v_cvt_pk_bf16_f32 v28, v28, v29
v_mfma_f32_16x16x32_bf16 v[232:235], a[140:143], a[212:215], v[232:235]
s_waitcnt lgkmcnt(10)
ds_read_b128 a[212:215], v2 offset:25600
v_mul_f32 v32, v32, v42
v_mfma_f32_16x16x32_bf16 v[220:223], a[72:75], a[216:219], 0
s_waitcnt lgkmcnt(10)
v_mul_f32 v33, v33, v42
v_mul_f32 v34, v34, v42
v_mfma_f32_16x16x32_bf16 v[220:223], a[76:79], a[220:223], v[220:223]
s_waitcnt lgkmcnt(9)
v_mul_f32 v35, v35, v42
v_cvt_pk_bf16_f32 v29, v30, v31
v_mfma_f32_16x16x32_bf16 v[220:223], a[80:83], a[224:227], v[220:223]
s_waitcnt lgkmcnt(8)
v_cvt_pk_bf16_f32 v96, v232, v233
v_cvt_pk_bf16_f32 v97, v234, v235
v_mfma_f32_16x16x32_bf16 v[220:223], a[84:87], a[228:231], v[220:223]
s_waitcnt lgkmcnt(7)
v_cvt_pk_bf16_f32 v30, v32, v33
v_cvt_pk_bf16_f32 v31, v34, v35
v_mfma_f32_16x16x32_bf16 v[220:223], a[88:91], a[232:235], v[220:223]
s_waitcnt lgkmcnt(6)
v_mul_f32 v36, v36, v42
v_mul_f32 v37, v37, v42
v_mfma_f32_16x16x32_bf16 v[220:223], a[92:95], a[236:239], v[220:223]
v_mul_f32 v38, v38, v42
v_mul_f32 v39, v39, v42
v_mfma_f32_16x16x32_bf16 v[224:227], a[96:99], a[216:219], 0
v_cvt_pk_bf16_f32 v36, v36, v37
v_mul_f32 v78, v78, v42
v_mfma_f32_16x16x32_bf16 v[224:227], a[100:103], a[220:223], v[224:227]
v_cvt_pk_bf16_f32 v37, v38, v39
v_max3_f32 v58, v58, v55, v82
v_mfma_f32_16x16x32_bf16 v[224:227], a[104:107], a[224:227], v[224:227]
buffer_load_dwordx4 a[40:43], v10, s[20:23], s32 offen offset:256 nt
v_cvt_pk_bf16_f32 v100, v220, v221
v_mfma_f32_16x16x32_bf16 v[224:227], a[108:111], a[228:231], v[224:227]
v_cvt_pk_bf16_f32 v101, v222, v223
v_cvt_pk_bf16_f32 v38, v78, 0
v_mfma_f32_16x16x32_bf16 v[224:227], a[112:115], a[232:235], v[224:227]
v_mov_b32 v39, 0
v_mov_b32 v59, v58
v_mfma_f32_16x16x32_bf16 v[224:227], a[116:119], a[236:239], v[224:227]
v_max3_f32 v74, v60, v61, v62
v_max3_f32 v74, v74, v63, v64
v_mfma_f32_16x16x32_bf16 v[228:231], a[120:123], a[216:219], 0
ds_read_b128 a[216:219], v2 offset:26624
v_max3_f32 v74, v74, v65, v66
v_mfma_f32_16x16x32_bf16 v[228:231], a[124:127], a[220:223], v[228:231]
ds_read_b128 a[220:223], v2 offset:27648
v_max3_f32 v74, v74, v67, v68
v_mfma_f32_16x16x32_bf16 v[228:231], a[128:131], a[224:227], v[228:231]
ds_read_b128 a[224:227], v2 offset:28672
v_cvt_pk_bf16_f32 v102, v224, v225
v_mfma_f32_16x16x32_bf16 v[228:231], a[132:135], a[228:231], v[228:231]
ds_read_b128 a[228:231], v2 offset:29696
v_cvt_pk_bf16_f32 v103, v226, v227
v_mfma_f32_16x16x32_bf16 v[228:231], a[136:139], a[232:235], v[228:231]
ds_read_b128 a[232:235], v2 offset:30720
v_max3_f32 v74, v74, v69, v70
v_mfma_f32_16x16x32_bf16 v[228:231], a[140:143], a[236:239], v[228:231]
s_waitcnt lgkmcnt(10)
ds_read_b128 a[236:239], v2 offset:31744
v_max3_f32 v74, v74, v71, v86
v_mfma_f32_16x16x32_bf16 v[232:235], a[72:75], a[192:195], 0
s_waitcnt lgkmcnt(10)
v_permlane32_swap_b32 v58, v59
v_mfma_f32_16x16x32_bf16 v[232:235], a[76:79], a[196:199], v[232:235]
s_waitcnt lgkmcnt(9)
v_max_f32 v58, v58, v59
v_mov_b32 v59, v58
v_mfma_f32_16x16x32_bf16 v[232:235], a[80:83], a[200:203], v[232:235]
s_waitcnt lgkmcnt(8)
v_cvt_pk_bf16_f32 v104, v228, v229
v_cvt_pk_bf16_f32 v105, v230, v231
v_mfma_f32_16x16x32_bf16 v[232:235], a[84:87], a[204:207], v[232:235]
s_waitcnt lgkmcnt(7)
v_permlane16_swap_b32 v58, v59
v_mfma_f32_16x16x32_bf16 v[232:235], a[88:91], a[208:211], v[232:235]
s_waitcnt lgkmcnt(6)
v_max_f32 v58, v58, v59
v_sub_f32 v44, v44, v58
v_mfma_f32_16x16x32_bf16 v[232:235], a[92:95], a[212:215], v[232:235]
v_sub_f32 v45, v45, v58
v_sub_f32 v46, v46, v58
v_mfma_f32_16x16x32_bf16 v[220:223], a[96:99], a[192:195], 0
v_exp_f32 v44, v44
v_mfma_f32_16x16x32_bf16 v[220:223], a[100:103], a[196:199], v[220:223]
buffer_load_dwordx4 a[44:47], v11, s[20:23], s32 offen offset:256 nt
v_sub_f32 v47, v47, v58
v_mfma_f32_16x16x32_bf16 v[220:223], a[104:107], a[200:203], v[220:223]
v_cvt_pk_bf16_f32 v108, v232, v233
v_cvt_pk_bf16_f32 v109, v234, v235
v_mfma_f32_16x16x32_bf16 v[220:223], a[108:111], a[204:207], v[220:223]
v_exp_f32 v45, v45
v_mfma_f32_16x16x32_bf16 v[220:223], a[112:115], a[208:211], v[220:223]
v_sub_f32 v48, v48, v58
v_sub_f32 v49, v49, v58
v_mfma_f32_16x16x32_bf16 v[220:223], a[116:119], a[212:215], v[220:223]
v_sub_f32 v50, v50, v58
v_sub_f32 v51, v51, v58
v_mfma_f32_16x16x32_bf16 v[224:227], a[120:123], a[192:195], 0
ds_read_b128 a[192:195], v2 offset:32768
v_sub_f32 v52, v52, v58
v_mfma_f32_16x16x32_bf16 v[224:227], a[124:127], a[196:199], v[224:227]
ds_read_b128 a[196:199], v2 offset:33792
v_sub_f32 v53, v53, v58
v_mfma_f32_16x16x32_bf16 v[224:227], a[128:131], a[200:203], v[224:227]
ds_read_b128 a[200:203], v2 offset:34816
v_cvt_pk_bf16_f32 v110, v220, v221
v_mfma_f32_16x16x32_bf16 v[224:227], a[132:135], a[204:207], v[224:227]
ds_read_b128 a[204:207], v2 offset:35840
v_cvt_pk_bf16_f32 v111, v222, v223
v_mfma_f32_16x16x32_bf16 v[224:227], a[136:139], a[208:211], v[224:227]
ds_read_b128 a[208:211], v2 offset:36864
v_sub_f32 v54, v54, v58
v_mfma_f32_16x16x32_bf16 v[224:227], a[140:143], a[212:215], v[224:227]
s_waitcnt lgkmcnt(10)
ds_read_b128 a[212:215], v2 offset:37888
v_sub_f32 v55, v55, v58
v_mfma_f32_16x16x32_bf16 v[228:231], a[72:75], a[216:219], 0
s_waitcnt lgkmcnt(10)
v_sub_f32 v82, v82, v58
v_add_f32 v58, v44, v45
v_mfma_f32_16x16x32_bf16 v[228:231], a[76:79], a[220:223], v[228:231]
s_waitcnt lgkmcnt(9)
v_exp_f32 v46, v46
v_mfma_f32_16x16x32_bf16 v[228:231], a[80:83], a[224:227], v[228:231]
s_waitcnt lgkmcnt(8)
v_cvt_pk_bf16_f32 v112, v224, v225
v_cvt_pk_bf16_f32 v113, v226, v227
v_mfma_f32_16x16x32_bf16 v[228:231], a[84:87], a[228:231], v[228:231]
s_waitcnt lgkmcnt(7)
v_exp_f32 v47, v47
v_mfma_f32_16x16x32_bf16 v[228:231], a[88:91], a[232:235], v[228:231]
s_waitcnt lgkmcnt(6)
v_exp_f32 v48, v48
v_mfma_f32_16x16x32_bf16 v[228:231], a[92:95], a[236:239], v[228:231]
v_add_f32 v58, v58, v46
v_add_f32 v58, v58, v47
v_mfma_f32_16x16x32_bf16 v[232:235], a[96:99], a[216:219], 0
v_exp_f32 v49, v49
v_mfma_f32_16x16x32_bf16 v[232:235], a[100:103], a[220:223], v[232:235]
buffer_load_dwordx4 a[64:67], v12, s[20:23], s32 offen offset:256 nt
v_add_f32 v58, v58, v48
v_mfma_f32_16x16x32_bf16 v[232:235], a[104:107], a[224:227], v[232:235]
v_cvt_pk_bf16_f32 v116, v228, v229
v_cvt_pk_bf16_f32 v117, v230, v231
v_mfma_f32_16x16x32_bf16 v[232:235], a[108:111], a[228:231], v[232:235]
v_exp_f32 v50, v50
v_mfma_f32_16x16x32_bf16 v[232:235], a[112:115], a[232:235], v[232:235]
v_exp_f32 v51, v51
v_mfma_f32_16x16x32_bf16 v[232:235], a[116:119], a[236:239], v[232:235]
v_add_f32 v58, v58, v49
v_add_f32 v58, v58, v50
v_mfma_f32_16x16x32_bf16 v[220:223], a[120:123], a[216:219], 0
ds_read_b128 a[216:219], v2 offset:38912
v_add_f32 v58, v58, v51
v_mfma_f32_16x16x32_bf16 v[220:223], a[124:127], a[220:223], v[220:223]
ds_read_b128 a[220:223], v2 offset:39936
v_mov_b32 v75, v74
v_mfma_f32_16x16x32_bf16 v[220:223], a[128:131], a[224:227], v[220:223]
ds_read_b128 a[224:227], v2 offset:40960
v_cvt_pk_bf16_f32 v118, v232, v233
v_mfma_f32_16x16x32_bf16 v[220:223], a[132:135], a[228:231], v[220:223]
ds_read_b128 a[228:231], v2 offset:41984
v_cvt_pk_bf16_f32 v119, v234, v235
v_mfma_f32_16x16x32_bf16 v[220:223], a[136:139], a[232:235], v[220:223]
ds_read_b128 a[232:235], v2 offset:43008
v_mfma_f32_16x16x32_bf16 v[220:223], a[140:143], a[236:239], v[220:223]
s_waitcnt lgkmcnt(10)
ds_read_b128 a[236:239], v2 offset:44032
v_mfma_f32_16x16x32_bf16 v[224:227], a[72:75], a[192:195], 0
s_waitcnt lgkmcnt(10)
v_exp_f32 v52, v52
v_mfma_f32_16x16x32_bf16 v[224:227], a[76:79], a[196:199], v[224:227]
s_waitcnt lgkmcnt(9)
v_exp_f32 v53, v53
v_mfma_f32_16x16x32_bf16 v[224:227], a[80:83], a[200:203], v[224:227]
s_waitcnt lgkmcnt(8)
v_exp_f32 v54, v54
v_mfma_f32_16x16x32_bf16 v[224:227], a[84:87], a[204:207], v[224:227]
s_waitcnt lgkmcnt(7)
v_cvt_pk_bf16_f32 v120, v220, v221
v_cvt_pk_bf16_f32 v121, v222, v223
v_mfma_f32_16x16x32_bf16 v[224:227], a[88:91], a[208:211], v[224:227]
s_waitcnt lgkmcnt(6)
v_add_f32 v58, v58, v52
v_add_f32 v58, v58, v53
v_mfma_f32_16x16x32_bf16 v[224:227], a[92:95], a[212:215], v[224:227]
v_exp_f32 v55, v55
v_mfma_f32_16x16x32_bf16 v[228:231], a[96:99], a[192:195], 0
buffer_load_dwordx4 a[68:71], v13, s[20:23], s32 offen offset:256 nt
v_add_f32 v58, v58, v54
v_mfma_f32_16x16x32_bf16 v[228:231], a[100:103], a[196:199], v[228:231]
v_exp_f32 v82, v82
v_mfma_f32_16x16x32_bf16 v[228:231], a[104:107], a[200:203], v[228:231]
v_add_f32 v58, v58, v55
v_cvt_pk_bf16_f32 v124, v224, v225
v_mfma_f32_16x16x32_bf16 v[228:231], a[108:111], a[204:207], v[228:231]
v_cvt_pk_bf16_f32 v125, v226, v227
v_add_f32 v58, v58, v82
v_mfma_f32_16x16x32_bf16 v[228:231], a[112:115], a[208:211], v[228:231]
v_mov_b32 v59, v58
v_mfma_f32_16x16x32_bf16 v[228:231], a[116:119], a[212:215], v[228:231]
v_permlane32_swap_b32 v74, v75
v_mfma_f32_16x16x32_bf16 v[232:235], a[120:123], a[192:195], 0
ds_read_b128 a[192:195], v2 offset:45056
v_max_f32 v74, v74, v75
v_mfma_f32_16x16x32_bf16 v[232:235], a[124:127], a[196:199], v[232:235]
ds_read_b128 a[196:199], v2 offset:46080
v_mov_b32 v75, v74
v_mfma_f32_16x16x32_bf16 v[232:235], a[128:131], a[200:203], v[232:235]
ds_read_b128 a[200:203], v2 offset:47104
v_cvt_pk_bf16_f32 v126, v228, v229
v_mfma_f32_16x16x32_bf16 v[232:235], a[132:135], a[204:207], v[232:235]
ds_read_b128 a[204:207], v2 offset:48128
v_cvt_pk_bf16_f32 v127, v230, v231
v_mfma_f32_16x16x32_bf16 v[232:235], a[136:139], a[208:211], v[232:235]
ds_read_b128 a[208:211], v2 offset:49152
v_mfma_f32_16x16x32_bf16 v[232:235], a[140:143], a[212:215], v[232:235]
s_waitcnt lgkmcnt(10)
ds_read_b128 a[212:215], v2 offset:50176
v_mfma_f32_16x16x32_bf16 v[220:223], a[72:75], a[216:219], 0
s_waitcnt lgkmcnt(10)
v_permlane32_swap_b32 v58, v59
v_mfma_f32_16x16x32_bf16 v[220:223], a[76:79], a[220:223], v[220:223]
s_waitcnt lgkmcnt(9)
v_add_f32 v58, v58, v59
v_mov_b32 v59, v58
v_mfma_f32_16x16x32_bf16 v[220:223], a[80:83], a[224:227], v[220:223]
s_waitcnt lgkmcnt(8)
v_permlane16_swap_b32 v74, v75
v_mfma_f32_16x16x32_bf16 v[220:223], a[84:87], a[228:231], v[220:223]
s_waitcnt lgkmcnt(7)
v_cvt_pk_bf16_f32 v128, v232, v233
v_cvt_pk_bf16_f32 v129, v234, v235
v_mfma_f32_16x16x32_bf16 v[220:223], a[88:91], a[232:235], v[220:223]
s_waitcnt lgkmcnt(6)
v_permlane16_swap_b32 v58, v59
v_mfma_f32_16x16x32_bf16 v[220:223], a[92:95], a[236:239], v[220:223]
v_add_f32 v58, v58, v59
v_max_f32 v74, v74, v75
v_mfma_f32_16x16x32_bf16 v[224:227], a[96:99], a[216:219], 0
v_rcp_f32 v58, v58
v_mfma_f32_16x16x32_bf16 v[224:227], a[100:103], a[220:223], v[224:227]
v_mul_f32 v44, v44, v58
v_mul_f32 v45, v45, v58
v_mfma_f32_16x16x32_bf16 v[224:227], a[104:107], a[224:227], v[224:227]
v_cvt_pk_bf16_f32 v132, v220, v221
v_cvt_pk_bf16_f32 v133, v222, v223
v_mfma_f32_16x16x32_bf16 v[224:227], a[108:111], a[228:231], v[224:227]
v_mul_f32 v46, v46, v58
v_mul_f32 v47, v47, v58
v_mfma_f32_16x16x32_bf16 v[224:227], a[112:115], a[232:235], v[224:227]
v_cvt_pk_bf16_f32 v44, v44, v45
v_mul_f32 v48, v48, v58
v_mfma_f32_16x16x32_bf16 v[224:227], a[116:119], a[236:239], v[224:227]
v_mul_f32 v49, v49, v58
v_mul_f32 v50, v50, v58
v_mfma_f32_16x16x32_bf16 v[228:231], a[120:123], a[216:219], 0
ds_read_b128 a[216:219], v2 offset:51200
v_mul_f32 v51, v51, v58
v_mfma_f32_16x16x32_bf16 v[228:231], a[124:127], a[220:223], v[228:231]
ds_read_b128 a[220:223], v2 offset:52224
v_cvt_pk_bf16_f32 v45, v46, v47
v_mfma_f32_16x16x32_bf16 v[228:231], a[128:131], a[224:227], v[228:231]
ds_read_b128 a[224:227], v2 offset:53248
v_cvt_pk_bf16_f32 v134, v224, v225
v_mfma_f32_16x16x32_bf16 v[228:231], a[132:135], a[228:231], v[228:231]
ds_read_b128 a[228:231], v2 offset:54272
v_cvt_pk_bf16_f32 v135, v226, v227
v_mfma_f32_16x16x32_bf16 v[228:231], a[136:139], a[232:235], v[228:231]
ds_read_b128 a[232:235], v2 offset:55296
v_cvt_pk_bf16_f32 v46, v48, v49
v_mfma_f32_16x16x32_bf16 v[228:231], a[140:143], a[236:239], v[228:231]
s_waitcnt lgkmcnt(10)
ds_read_b128 a[236:239], v2 offset:56320
v_cvt_pk_bf16_f32 v47, v50, v51
v_mfma_f32_16x16x32_bf16 v[232:235], a[72:75], a[192:195], 0
s_waitcnt lgkmcnt(10)
v_sub_f32 v60, v60, v74
v_sub_f32 v61, v61, v74
v_mfma_f32_16x16x32_bf16 v[232:235], a[76:79], a[196:199], v[232:235]
s_waitcnt lgkmcnt(9)
v_mul_f32 v52, v52, v58
v_mul_f32 v53, v53, v58
v_mfma_f32_16x16x32_bf16 v[232:235], a[80:83], a[200:203], v[232:235]
s_waitcnt lgkmcnt(8)
v_cvt_pk_bf16_f32 v136, v228, v229
v_cvt_pk_bf16_f32 v137, v230, v231
v_mfma_f32_16x16x32_bf16 v[232:235], a[84:87], a[204:207], v[232:235]
s_waitcnt lgkmcnt(7)
v_sub_f32 v62, v62, v74
v_mul_f32 v54, v54, v58
v_mfma_f32_16x16x32_bf16 v[232:235], a[88:91], a[208:211], v[232:235]
s_waitcnt lgkmcnt(6)
v_exp_f32 v60, v60
v_mfma_f32_16x16x32_bf16 v[232:235], a[92:95], a[212:215], v[232:235]
v_exp_f32 v61, v61
v_mfma_f32_16x16x32_bf16 v[220:223], a[96:99], a[192:195], 0
v_mul_f32 v55, v55, v58
v_cvt_pk_bf16_f32 v52, v52, v53
v_mfma_f32_16x16x32_bf16 v[220:223], a[100:103], a[196:199], v[220:223]
v_sub_f32 v63, v63, v74
v_sub_f32 v64, v64, v74
v_mfma_f32_16x16x32_bf16 v[220:223], a[104:107], a[200:203], v[220:223]
v_cvt_pk_bf16_f32 v140, v232, v233
v_cvt_pk_bf16_f32 v141, v234, v235
v_mfma_f32_16x16x32_bf16 v[220:223], a[108:111], a[204:207], v[220:223]
v_sub_f32 v65, v65, v74
v_sub_f32 v66, v66, v74
v_mfma_f32_16x16x32_bf16 v[220:223], a[112:115], a[208:211], v[220:223]
v_sub_f32 v67, v67, v74
v_sub_f32 v68, v68, v74
v_mfma_f32_16x16x32_bf16 v[220:223], a[116:119], a[212:215], v[220:223]
v_sub_f32 v69, v69, v74
v_sub_f32 v70, v70, v74
v_mfma_f32_16x16x32_bf16 v[224:227], a[120:123], a[192:195], 0
v_sub_f32 v71, v71, v74
v_sub_f32 v86, v86, v74
v_mfma_f32_16x16x32_bf16 v[224:227], a[124:127], a[196:199], v[224:227]
v_exp_f32 v62, v62
v_mfma_f32_16x16x32_bf16 v[224:227], a[128:131], a[200:203], v[224:227]
v_cvt_pk_bf16_f32 v142, v220, v221
v_cvt_pk_bf16_f32 v143, v222, v223
v_mfma_f32_16x16x32_bf16 v[224:227], a[132:135], a[204:207], v[224:227]
v_mul_f32 v82, v82, v58
v_cvt_pk_bf16_f32 v53, v54, v55
v_mfma_f32_16x16x32_bf16 v[224:227], a[136:139], a[208:211], v[224:227]
v_exp_f32 v63, v63
v_mfma_f32_16x16x32_bf16 v[224:227], a[140:143], a[212:215], v[224:227]
s_waitcnt lgkmcnt(5)
v_add_f32 v74, v60, v61
v_cvt_pk_bf16_f32 v54, v82, 0
v_mfma_f32_16x16x32_bf16 v[228:231], a[72:75], a[216:219], 0
s_waitcnt lgkmcnt(4)
v_mov_b32 v55, 0
v_add_f32 v74, v74, v62
v_mfma_f32_16x16x32_bf16 v[228:231], a[76:79], a[220:223], v[228:231]
s_waitcnt lgkmcnt(3)
v_exp_f32 v64, v64
v_mfma_f32_16x16x32_bf16 v[228:231], a[80:83], a[224:227], v[228:231]
s_waitcnt lgkmcnt(2)
v_exp_f32 v65, v65
v_mfma_f32_16x16x32_bf16 v[228:231], a[84:87], a[228:231], v[228:231]
s_waitcnt lgkmcnt(1)
v_add_f32 v74, v74, v63
v_add_f32 v74, v74, v64
v_mfma_f32_16x16x32_bf16 v[228:231], a[88:91], a[232:235], v[228:231]
s_waitcnt lgkmcnt(0)
v_exp_f32 v66, v66
v_mfma_f32_16x16x32_bf16 v[228:231], a[92:95], a[236:239], v[228:231]
v_exp_f32 v67, v67
v_mfma_f32_16x16x32_bf16 v[232:235], a[96:99], a[216:219], 0
v_add_f32 v74, v74, v65
v_add_f32 v74, v74, v66
v_mfma_f32_16x16x32_bf16 v[232:235], a[100:103], a[220:223], v[232:235]
v_exp_f32 v68, v68
v_mfma_f32_16x16x32_bf16 v[232:235], a[104:107], a[224:227], v[232:235]
v_exp_f32 v69, v69
v_mfma_f32_16x16x32_bf16 v[232:235], a[108:111], a[228:231], v[232:235]
v_add_f32 v74, v74, v67
v_add_f32 v74, v74, v68
v_mfma_f32_16x16x32_bf16 v[232:235], a[112:115], a[232:235], v[232:235]
v_exp_f32 v70, v70
v_mfma_f32_16x16x32_bf16 v[232:235], a[116:119], a[236:239], v[232:235]
v_exp_f32 v71, v71
v_mfma_f32_16x16x32_bf16 v[220:223], a[120:123], a[216:219], 0
v_mov_b64 v[244:245], 0
v_mfma_f32_16x16x32_bf16 v[220:223], a[124:127], a[220:223], v[220:223]
v_add_f32 v74, v74, v69
v_add_f32 v74, v74, v70
v_mfma_f32_16x16x32_bf16 v[220:223], a[128:131], a[224:227], v[220:223]
v_exp_f32 v86, v86
v_mfma_f32_16x16x32_bf16 v[220:223], a[132:135], a[228:231], v[220:223]
v_add_f32 v74, v74, v71
v_add_f32 v74, v74, v86
v_mfma_f32_16x16x32_bf16 v[220:223], a[136:139], a[232:235], v[220:223]
v_mov_b32 v75, v74
v_cvt_pk_bf16_f32 v144, v224, v225
v_mfma_f32_16x16x32_bf16 v[220:223], a[140:143], a[236:239], v[220:223]
v_permlane32_swap_b32 v74, v75
v_mfma_f32_16x16x32_bf16 v[188:191], v[28:31], v[92:95], 0
v_add_f32 v74, v74, v75
v_mov_b32 v75, v74
v_mfma_f32_16x16x32_bf16 v[188:191], v[36:39], v[96:99], v[188:191]
v_cvt_pk_bf16_f32 v145, v226, v227
v_cvt_pk_bf16_f32 v148, v228, v229
v_mfma_f32_16x16x32_bf16 v[192:195], v[28:31], v[100:103], 0
v_permlane16_swap_b32 v74, v75
v_mfma_f32_16x16x32_bf16 v[192:195], v[36:39], v[104:107], v[192:195]
v_add_f32 v74, v74, v75
v_cvt_pk_bf16_f32 v149, v230, v231
v_mfma_f32_16x16x32_bf16 v[196:199], v[28:31], v[108:111], 0
v_rcp_f32 v74, v74
v_mfma_f32_16x16x32_bf16 v[196:199], v[36:39], v[112:115], v[196:199]
v_mul_f32 v60, v60, v74
v_mul_f32 v61, v61, v74
v_mfma_f32_16x16x32_bf16 v[200:203], v[28:31], v[116:119], 0
v_mul_f32 v62, v62, v74
v_mul_f32 v63, v63, v74
v_mfma_f32_16x16x32_bf16 v[200:203], v[36:39], v[120:123], v[200:203]
v_cvt_pk_bf16_f32 v60, v60, v61
v_mul_f32 v64, v64, v74
v_smfmac_f32_16x16x64_bf16 v[244:247], a[240:243], v[92:99], v0
v_mul_f32 v65, v65, v74
v_smfmac_f32_16x16x64_bf16 v[244:247], a[244:247], v[100:107], v0
v_mul_f32 v66, v66, v74
v_smfmac_f32_16x16x64_bf16 v[244:247], a[248:251], v[108:115], v0
v_mul_f32 v67, v67, v74
v_smfmac_f32_16x16x64_bf16 v[244:247], a[252:255], v[116:123], v0
v_cvt_pk_bf16_f32 v61, v62, v63
v_mfma_f32_16x16x32_bf16 v[204:207], v[44:47], v[92:95], 0
v_cvt_pk_bf16_f32 v62, v64, v65
v_cvt_pk_bf16_f32 v63, v66, v67
v_mfma_f32_16x16x32_bf16 v[204:207], v[52:55], v[96:99], v[204:207]
v_mul_f32 v68, v68, v74
v_mul_f32 v69, v69, v74
v_mfma_f32_16x16x32_bf16 v[208:211], v[44:47], v[100:103], 0
v_mul_f32 v70, v70, v74
v_mul_f32 v71, v71, v74
v_mfma_f32_16x16x32_bf16 v[208:211], v[52:55], v[104:107], v[208:211]
v_cvt_pk_bf16_f32 v68, v68, v69
v_cvt_pk_bf16_f32 v64, v188, v192
v_mfma_f32_16x16x32_bf16 v[212:215], v[44:47], v[108:111], 0
v_cvt_pk_bf16_f32 v76, v189, v193
v_cvt_pk_bf16_f32 v78, v190, v194
v_mfma_f32_16x16x32_bf16 v[212:215], v[52:55], v[112:115], v[212:215]
v_cvt_pk_bf16_f32 v80, v191, v195
v_mul_f32 v86, v86, v74
v_mfma_f32_16x16x32_bf16 v[216:219], v[44:47], v[116:119], 0
v_cvt_pk_bf16_f32 v69, v70, v71
v_cvt_pk_bf16_f32 v70, v86, 0
v_mfma_f32_16x16x32_bf16 v[216:219], v[52:55], v[120:123], v[216:219]
v_mov_b32 v71, 0
v_cvt_pk_bf16_f32 v65, v196, v200
v_mfma_f32_16x16x32_bf16 v[188:191], v[60:63], v[92:95], 0
v_cvt_pk_bf16_f32 v77, v197, v201
v_cvt_pk_bf16_f32 v79, v198, v202
v_mfma_f32_16x16x32_bf16 v[188:191], v[68:71], v[96:99], v[188:191]
buffer_store_dwordx2 v[64:65], v14, s[12:15], s28 offen offset:0 sc1
v_cvt_pk_bf16_f32 v81, v199, v203
v_mfma_f32_16x16x32_bf16 v[192:195], v[60:63], v[100:103], 0
buffer_store_dwordx2 v[76:77], v14, s[12:15], s28 offen offset:384 sc1
v_add_f32 v64, v244, v245
v_mfma_f32_16x16x32_bf16 v[192:195], v[68:71], v[104:107], v[192:195]
v_cvt_pk_bf16_f32 v64, v64, v64
buffer_store_short v64, v17, s[12:15], s28 offen offset:0 sc1
v_mfma_f32_16x16x32_bf16 v[196:199], v[60:63], v[108:111], 0
v_cvt_pk_bf16_f32 v64, v204, v208
v_cvt_pk_bf16_f32 v82, v205, v209
v_mfma_f32_16x16x32_bf16 v[196:199], v[68:71], v[112:115], v[196:199]
v_cvt_pk_bf16_f32 v84, v206, v210
v_cvt_pk_bf16_f32 v86, v207, v211
v_mfma_f32_16x16x32_bf16 v[200:203], v[60:63], v[116:119], 0
buffer_store_dwordx2 v[78:79], v14, s[12:15], s28 offen offset:768 sc1
v_cvt_pk_bf16_f32 v65, v212, v216
v_mfma_f32_16x16x32_bf16 v[200:203], v[68:71], v[120:123], v[200:203]
v_cvt_pk_bf16_f32 v83, v213, v217
v_cvt_pk_bf16_f32 v85, v214, v218
v_mfma_f32_16x16x32_bf16 v[204:207], v[28:31], v[124:127], 0
v_cvt_pk_bf16_f32 v87, v215, v219
v_cvt_pk_bf16_f32 v150, v232, v233
v_mfma_f32_16x16x32_bf16 v[204:207], v[36:39], v[128:131], v[204:207]
v_cvt_pk_bf16_f32 v151, v234, v235
v_cvt_pk_bf16_f32 v152, v220, v221
v_mfma_f32_16x16x32_bf16 v[208:211], v[28:31], v[132:135], 0
v_cvt_pk_bf16_f32 v153, v222, v223
v_cvt_pk_bf16_f32 v76, v188, v192
v_mfma_f32_16x16x32_bf16 v[208:211], v[36:39], v[136:139], v[208:211]
buffer_store_dwordx2 v[80:81], v14, s[12:15], s28 offen offset:1152 sc1
v_mov_b64 v[244:245], 0
v_mfma_f32_16x16x32_bf16 v[212:215], v[28:31], v[140:143], 0
v_cvt_pk_bf16_f32 v66, v189, v193
v_cvt_pk_bf16_f32 v88, v190, v194
v_mfma_f32_16x16x32_bf16 v[212:215], v[36:39], v[144:147], v[212:215]
v_cvt_pk_bf16_f32 v90, v191, v195
v_cvt_pk_bf16_f32 v77, v196, v200
v_mfma_f32_16x16x32_bf16 v[216:219], v[28:31], v[148:151], 0
v_cvt_pk_bf16_f32 v67, v197, v201
v_cvt_pk_bf16_f32 v89, v198, v202
v_mfma_f32_16x16x32_bf16 v[216:219], v[36:39], v[152:155], v[216:219]
v_cvt_pk_bf16_f32 v91, v199, v203
v_cvt_pk_bf16_f32 v92, v204, v208
v_smfmac_f32_16x16x64_bf16 v[244:247], a[240:243], v[124:131], v0
ds_read_b128 a[192:195], v2 offset:57344
v_smfmac_f32_16x16x64_bf16 v[244:247], a[244:247], v[132:139], v0
ds_read_b128 a[196:199], v2 offset:58368
v_smfmac_f32_16x16x64_bf16 v[244:247], a[248:251], v[140:147], v0
v_cvt_pk_bf16_f32 v94, v205, v209
v_smfmac_f32_16x16x64_bf16 v[244:247], a[252:255], v[148:155], v0
v_cvt_pk_bf16_f32 v100, v206, v210
v_mfma_f32_16x16x32_bf16 v[188:191], v[44:47], v[124:127], 0
buffer_store_dwordx2 v[64:65], v15, s[12:15], s28 offen offset:0 sc1
v_cvt_pk_bf16_f32 v78, v207, v211
v_mfma_f32_16x16x32_bf16 v[188:191], v[52:55], v[128:131], v[188:191]
ds_read_b128 a[200:203], v2 offset:59392
ds_read_b128 a[204:207], v2 offset:60416
v_mfma_f32_16x16x32_bf16 v[192:195], v[44:47], v[132:135], 0
buffer_store_dwordx2 v[82:83], v15, s[12:15], s29 offen offset:0 sc1
ds_read_b128 a[208:211], v2 offset:61440
v_mfma_f32_16x16x32_bf16 v[192:195], v[52:55], v[136:139], v[192:195]
ds_read_b128 a[212:215], v2 offset:62464
v_cvt_pk_bf16_f32 v93, v212, v216
v_mfma_f32_16x16x32_bf16 v[196:199], v[44:47], v[140:143], 0
v_cvt_pk_bf16_f32 v95, v213, v217
v_cvt_pk_bf16_f32 v101, v214, v218
v_mfma_f32_16x16x32_bf16 v[196:199], v[52:55], v[144:147], v[196:199]
v_cvt_pk_bf16_f32 v79, v215, v219
v_add_f32 v64, v244, v245
v_mfma_f32_16x16x32_bf16 v[200:203], v[44:47], v[148:151], 0
ds_read_b128 a[216:219], v2 offset:63488
ds_read_b128 a[220:223], v2 offset:64512
v_mfma_f32_16x16x32_bf16 v[200:203], v[52:55], v[152:155], v[200:203]
ds_read_b128 a[224:227], v3 offset:0
ds_read_b128 a[228:231], v3 offset:1024
v_mfma_f32_16x16x32_bf16 v[204:207], v[60:63], v[124:127], 0
ds_read_b128 a[232:235], v3 offset:2048
ds_read_b128 a[236:239], v3 offset:3072
v_mfma_f32_16x16x32_bf16 v[204:207], v[68:71], v[128:131], v[204:207]
v_cvt_pk_bf16_f32 v64, v64, v64
v_cvt_pk_bf16_f32 v80, v188, v192
v_mfma_f32_16x16x32_bf16 v[208:211], v[60:63], v[132:135], 0
buffer_store_short v64, v17, s[12:15], s28 offen offset:128 sc1
v_cvt_pk_bf16_f32 v82, v189, v193
v_mfma_f32_16x16x32_bf16 v[208:211], v[68:71], v[136:139], v[208:211]
v_cvt_pk_bf16_f32 v102, v190, v194
v_cvt_pk_bf16_f32 v108, v191, v195
v_mfma_f32_16x16x32_bf16 v[212:215], v[60:63], v[140:143], 0
buffer_store_dwordx2 v[84:85], v15, s[12:15], s30 offen offset:0 sc1
v_cvt_pk_bf16_f32 v81, v196, v200
v_mfma_f32_16x16x32_bf16 v[212:215], v[68:71], v[144:147], v[212:215]
v_cvt_pk_bf16_f32 v83, v197, v201
v_cvt_pk_bf16_f32 v103, v198, v202
v_mfma_f32_16x16x32_bf16 v[216:219], v[60:63], v[148:151], 0
v_cvt_pk_bf16_f32 v64, v204, v208
v_cvt_pk_bf16_f32 v84, v205, v209
v_mfma_f32_16x16x32_bf16 v[216:219], v[68:71], v[152:155], v[216:219]
s_waitcnt lgkmcnt(11)
v_cvt_pk_bf16_f32 v110, v206, v210
v_cvt_pk_bf16_f32 v72, v207, v211
v_mfma_f32_16x16x32_bf16 v[224:227], a[72:75], a[192:195], 0
s_waitcnt lgkmcnt(10)
v_cvt_pk_bf16_f32 v109, v199, v203
v_mfma_f32_16x16x32_bf16 v[224:227], a[76:79], a[196:199], v[224:227]
buffer_store_dwordx2 v[86:87], v15, s[12:15], s31 offen offset:0 sc1
s_waitcnt lgkmcnt(9)
v_mfma_f32_16x16x32_bf16 v[224:227], a[80:83], a[200:203], v[224:227]
s_waitcnt vmcnt(27) lgkmcnt(8)
ds_write_b64 v4, a[0:1] offset:0
v_mfma_f32_16x16x32_bf16 v[224:227], a[84:87], a[204:207], v[224:227]
s_waitcnt lgkmcnt(8)
v_cvt_pk_bf16_f32 v65, v212, v216
v_cvt_pk_bf16_f32 v85, v213, v217
v_mfma_f32_16x16x32_bf16 v[224:227], a[88:91], a[208:211], v[224:227]
s_waitcnt lgkmcnt(7)
v_cvt_pk_bf16_f32 v111, v214, v218
v_cvt_pk_bf16_f32 v73, v215, v219
v_mfma_f32_16x16x32_bf16 v[224:227], a[92:95], a[212:215], v[224:227]
ds_write_b64 v4, a[2:3] offset:8
v_mfma_f32_16x16x32_bf16 v[228:231], a[96:99], a[192:195], 0
buffer_store_dwordx2 v[76:77], v16, s[12:15], s28 offen offset:0 sc1
v_mfma_f32_16x16x32_bf16 v[228:231], a[100:103], a[196:199], v[228:231]
s_waitcnt vmcnt(27)
ds_write_b64 v5, a[4:5] offset:0
v_mfma_f32_16x16x32_bf16 v[228:231], a[104:107], a[200:203], v[228:231]
ds_write_b64 v5, a[6:7] offset:8
v_mfma_f32_16x16x32_bf16 v[228:231], a[108:111], a[204:207], v[228:231]
v_cvt_pk_bf16_f32 v156, v224, v225
v_cvt_pk_bf16_f32 v157, v226, v227
v_mfma_f32_16x16x32_bf16 v[228:231], a[112:115], a[208:211], v[228:231]
ds_read_b128 a[0:3], v6 offset:0
ds_read_b128 a[4:7], v7 offset:0
v_mfma_f32_16x16x32_bf16 v[228:231], a[116:119], a[212:215], v[228:231]
s_waitcnt vmcnt(26)
ds_write_b64 v4, a[24:25] offset:2048
v_mfma_f32_16x16x32_bf16 v[232:235], a[120:123], a[192:195], 0
buffer_store_dwordx2 v[66:67], v16, s[12:15], s28 offen offset:384 sc1
ds_read_b128 a[192:195], v3 offset:4096
v_mfma_f32_16x16x32_bf16 v[232:235], a[124:127], a[196:199], v[232:235]
ds_read_b128 a[196:199], v3 offset:5120
v_mfma_f32_16x16x32_bf16 v[232:235], a[128:131], a[200:203], v[232:235]
ds_read_b128 a[200:203], v3 offset:6144
v_cvt_pk_bf16_f32 v158, v228, v229
v_mfma_f32_16x16x32_bf16 v[232:235], a[132:135], a[204:207], v[232:235]
ds_read_b128 a[204:207], v3 offset:7168
v_cvt_pk_bf16_f32 v159, v230, v231
v_mfma_f32_16x16x32_bf16 v[232:235], a[136:139], a[208:211], v[232:235]
ds_read_b128 a[208:211], v3 offset:8192
v_mfma_f32_16x16x32_bf16 v[232:235], a[140:143], a[212:215], v[232:235]
buffer_store_dwordx2 v[88:89], v16, s[12:15], s29 offen offset:0 sc1
s_waitcnt lgkmcnt(15)
ds_read_b128 a[212:215], v3 offset:9216
v_mfma_f32_16x16x32_bf16 v[220:223], a[72:75], a[216:219], 0
ds_write_b64 v4, a[26:27] offset:2056
v_mfma_f32_16x16x32_bf16 v[220:223], a[76:79], a[220:223], v[220:223]
s_waitcnt vmcnt(27)
ds_write_b64 v5, a[28:29] offset:2048
v_mfma_f32_16x16x32_bf16 v[220:223], a[80:83], a[224:227], v[220:223]
s_waitcnt lgkmcnt(15)
ds_write_b64 v5, a[30:31] offset:2056
v_mfma_f32_16x16x32_bf16 v[220:223], a[84:87], a[228:231], v[220:223]
v_cvt_pk_bf16_f32 v160, v232, v233
v_cvt_pk_bf16_f32 v161, v234, v235
v_mfma_f32_16x16x32_bf16 v[220:223], a[88:91], a[232:235], v[220:223]
buffer_store_dwordx2 v[90:91], v16, s[12:15], s29 offen offset:384 sc1
ds_read_b128 a[24:27], v6 offset:2048
v_mfma_f32_16x16x32_bf16 v[220:223], a[92:95], a[236:239], v[220:223]
LW_p10:
s_cbranch_execz LW_p15
ds_read_b128 a[28:31], v7 offset:2048
v_mfma_f32_16x16x32_bf16 v[224:227], a[96:99], a[216:219], 0
s_waitcnt vmcnt(25)
ds_write_b64 v4, a[8:9] offset:2048
v_mfma_f32_16x16x32_bf16 v[224:227], a[100:103], a[220:223], v[224:227]
ds_write_b64 v4, a[10:11] offset:2056
v_mfma_f32_16x16x32_bf16 v[224:227], a[104:107], a[224:227], v[224:227]
s_waitcnt vmcnt(24)
ds_write_b64 v5, a[12:13] offset:2048
v_mfma_f32_16x16x32_bf16 v[224:227], a[108:111], a[228:231], v[224:227]
buffer_store_dwordx2 v[92:93], v14, s[12:15], s28 offen offset:128 sc1
v_cvt_pk_bf16_f32 v164, v220, v221
v_mfma_f32_16x16x32_bf16 v[224:227], a[112:115], a[232:235], v[224:227]
v_cvt_pk_bf16_f32 v165, v222, v223
v_mfma_f32_16x16x32_bf16 v[224:227], a[116:119], a[236:239], v[224:227]
ds_write_b64 v5, a[14:15] offset:2056
v_mfma_f32_16x16x32_bf16 v[228:231], a[120:123], a[216:219], 0
ds_read_b128 a[216:219], v3 offset:10240
ds_read_b128 a[8:11], v6 offset:2048
v_mfma_f32_16x16x32_bf16 v[228:231], a[124:127], a[220:223], v[228:231]
ds_read_b128 a[220:223], v3 offset:11264
ds_read_b128 a[12:15], v7 offset:2048
v_mfma_f32_16x16x32_bf16 v[228:231], a[128:131], a[224:227], v[228:231]
buffer_store_dwordx2 v[94:95], v14, s[12:15], s28 offen offset:512 sc1
ds_read_b128 a[224:227], v3 offset:12288
v_mfma_f32_16x16x32_bf16 v[228:231], a[132:135], a[228:231], v[228:231]
ds_read_b128 a[228:231], v3 offset:13312
v_cvt_pk_bf16_f32 v166, v224, v225
v_mfma_f32_16x16x32_bf16 v[228:231], a[136:139], a[232:235], v[228:231]
v_cvt_pk_bf16_f32 v167, v226, v227
v_mfma_f32_16x16x32_bf16 v[228:231], a[140:143], a[236:239], v[228:231]
s_waitcnt lgkmcnt(15)
ds_read_b128 a[232:235], v3 offset:14336
ds_read_b128 a[236:239], v3 offset:15360
v_mfma_f32_16x16x32_bf16 v[232:235], a[72:75], a[192:195], 0
ds_write_b64 v4, a[48:49] offset:0
v_mfma_f32_16x16x32_bf16 v[232:235], a[76:79], a[196:199], v[232:235]
ds_write_b64 v4, a[50:51] offset:8
v_mfma_f32_16x16x32_bf16 v[232:235], a[80:83], a[200:203], v[232:235]
buffer_store_dwordx2 v[100:101], v14, s[12:15], s28 offen offset:896 sc1
v_cvt_pk_bf16_f32 v168, v228, v229
v_mfma_f32_16x16x32_bf16 v[232:235], a[84:87], a[204:207], v[232:235]
v_cvt_pk_bf16_f32 v169, v230, v231
v_mfma_f32_16x16x32_bf16 v[232:235], a[88:91], a[208:211], v[232:235]
ds_write_b64 v5, a[52:53] offset:0
v_mfma_f32_16x16x32_bf16 v[232:235], a[92:95], a[212:215], v[232:235]
ds_write_b64 v5, a[54:55] offset:8
v_mfma_f32_16x16x32_bf16 v[220:223], a[96:99], a[192:195], 0
ds_read_b128 a[48:51], v6 offset:0
ds_read_b128 a[52:55], v7 offset:0
v_mfma_f32_16x16x32_bf16 v[220:223], a[100:103], a[196:199], v[220:223]
buffer_store_dwordx2 v[78:79], v14, s[12:15], s28 offen offset:1280 sc1
v_mfma_f32_16x16x32_bf16 v[220:223], a[104:107], a[200:203], v[220:223]
s_waitcnt vmcnt(27)
ds_write_b64 v4, a[32:33] offset:0
v_mfma_f32_16x16x32_bf16 v[220:223], a[108:111], a[204:207], v[220:223]
v_cvt_pk_bf16_f32 v172, v232, v233
v_cvt_pk_bf16_f32 v173, v234, v235
v_mfma_f32_16x16x32_bf16 v[220:223], a[112:115], a[208:211], v[220:223]
ds_write_b64 v4, a[34:35] offset:8
v_mfma_f32_16x16x32_bf16 v[220:223], a[116:119], a[212:215], v[220:223]
s_waitcnt vmcnt(26)
ds_write_b64 v5, a[36:37] offset:0
v_mfma_f32_16x16x32_bf16 v[224:227], a[120:123], a[192:195], 0
buffer_store_dwordx2 v[80:81], v15, s[12:15], s28 offen offset:128 sc1
ds_read_b128 a[192:195], v1 offset:0
v_mfma_f32_16x16x32_bf16 v[224:227], a[124:127], a[196:199], v[224:227]
ds_read_b128 a[196:199], v1 offset:1024
v_mfma_f32_16x16x32_bf16 v[224:227], a[128:131], a[200:203], v[224:227]
ds_read_b128 a[200:203], v1 offset:2048
v_cvt_pk_bf16_f32 v174, v220, v221
v_mfma_f32_16x16x32_bf16 v[224:227], a[132:135], a[204:207], v[224:227]
v_cvt_pk_bf16_f32 v175, v222, v223
v_mfma_f32_16x16x32_bf16 v[224:227], a[136:139], a[208:211], v[224:227]
ds_read_b128 a[204:207], v1 offset:3072
ds_read_b128 a[208:211], v1 offset:4096
v_mfma_f32_16x16x32_bf16 v[224:227], a[140:143], a[212:215], v[224:227]
buffer_store_dwordx2 v[82:83], v15, s[12:15], s29 offen offset:128 sc1
s_waitcnt lgkmcnt(15)
ds_read_b128 a[212:215], v1 offset:5120
v_mfma_f32_16x16x32_bf16 v[228:231], a[72:75], a[216:219], 0
ds_write_b64 v5, a[38:39] offset:8
v_mfma_f32_16x16x32_bf16 v[228:231], a[76:79], a[220:223], v[228:231]
ds_read_b128 a[32:35], v6 offset:0
ds_read_b128 a[36:39], v7 offset:0
v_mfma_f32_16x16x32_bf16 v[228:231], a[80:83], a[224:227], v[228:231]
v_cvt_pk_bf16_f32 v176, v224, v225
v_cvt_pk_bf16_f32 v177, v226, v227
v_mfma_f32_16x16x32_bf16 v[228:231], a[84:87], a[228:231], v[228:231]
s_waitcnt vmcnt(25)
ds_write_b64 v4, a[16:17] offset:0
v_mfma_f32_16x16x32_bf16 v[228:231], a[88:91], a[232:235], v[228:231]
s_waitcnt lgkmcnt(15)
ds_write_b64 v4, a[18:19] offset:8
v_mfma_f32_16x16x32_bf16 v[228:231], a[92:95], a[236:239], v[228:231]
buffer_store_dwordx2 v[102:103], v15, s[12:15], s30 offen offset:128 sc1
v_mfma_f32_16x16x32_bf16 v[232:235], a[96:99], a[216:219], 0
s_waitcnt vmcnt(25)
ds_write_b64 v5, a[20:21] offset:0
v_mfma_f32_16x16x32_bf16 v[232:235], a[100:103], a[220:223], v[232:235]
ds_write_b64 v5, a[22:23] offset:8
v_mfma_f32_16x16x32_bf16 v[232:235], a[104:107], a[224:227], v[232:235]
ds_read_b128 a[16:19], v6 offset:0
ds_read_b128 a[20:23], v7 offset:0
v_mfma_f32_16x16x32_bf16 v[232:235], a[108:111], a[228:231], v[232:235]
v_cvt_pk_bf16_f32 v180, v228, v229
v_cvt_pk_bf16_f32 v181, v230, v231
v_mfma_f32_16x16x32_bf16 v[232:235], a[112:115], a[232:235], v[232:235]
buffer_store_dwordx2 v[108:109], v15, s[12:15], s31 offen offset:128 sc1
v_mfma_f32_16x16x32_bf16 v[232:235], a[116:119], a[236:239], v[232:235]
ds_write_b64 v4, a[56:57] offset:2048
v_mfma_f32_16x16x32_bf16 v[220:223], a[120:123], a[216:219], 0
v_mov_b64 v[244:245], 0
v_mfma_f32_16x16x32_bf16 v[220:223], a[124:127], a[220:223], v[220:223]
ds_read_b128 a[216:219], v1 offset:6144
ds_read_b128 a[220:223], v1 offset:7168
v_mfma_f32_16x16x32_bf16 v[220:223], a[128:131], a[224:227], v[220:223]
s_nop 0
v_cvt_pk_bf16_f32 v182, v232, v233
v_cvt_pk_bf16_f32 v183, v234, v235
v_mfma_f32_16x16x32_bf16 v[220:223], a[132:135], a[228:231], v[220:223]
buffer_store_dwordx2 v[64:65], v16, s[12:15], s28 offen offset:128 sc1
ds_read_b128 a[224:227], v1 offset:8192
v_mfma_f32_16x16x32_bf16 v[220:223], a[136:139], a[232:235], v[220:223]
ds_read_b128 a[228:231], v1 offset:9216
ds_read_b128 a[232:235], v1 offset:10240
v_mfma_f32_16x16x32_bf16 v[220:223], a[140:143], a[236:239], v[220:223]
ds_read_b128 a[236:239], v1 offset:11264
v_mfma_f32_16x16x32_bf16 v[204:207], v[28:31], v[156:159], 0
s_nop 0
ds_write_b64 v4, a[58:59] offset:2056
v_mfma_f32_16x16x32_bf16 v[204:207], v[36:39], v[160:163], v[204:207]
s_nop 0
ds_write_b64 v5, a[60:61] offset:2048
v_mfma_f32_16x16x32_bf16 v[208:211], v[28:31], v[164:167], 0
v_cvt_pk_bf16_f32 v184, v220, v221
v_cvt_pk_bf16_f32 v185, v222, v223
v_mfma_f32_16x16x32_bf16 v[208:211], v[36:39], v[168:171], v[208:211]
buffer_store_dwordx2 v[84:85], v16, s[12:15], s28 offen offset:512 sc1
v_mfma_f32_16x16x32_bf16 v[212:215], v[28:31], v[172:175], 0
ds_write_b64 v5, a[62:63] offset:2056
v_mfma_f32_16x16x32_bf16 v[212:215], v[36:39], v[176:179], v[212:215]
ds_read_b128 a[56:59], v6 offset:2048
ds_read_b128 a[60:63], v7 offset:2048
v_mfma_f32_16x16x32_bf16 v[216:219], v[28:31], v[180:183], 0
s_waitcnt vmcnt(27)
ds_write_b64 v4, a[40:41] offset:2048
v_mfma_f32_16x16x32_bf16 v[216:219], v[36:39], v[184:187], v[216:219]
buffer_store_dwordx2 v[110:111], v16, s[12:15], s29 offen offset:128 sc1
v_cvt_pk_bf16_f32 v92, v204, v208
v_smfmac_f32_16x16x64_bf16 v[244:247], a[240:243], v[156:163], v0
v_cvt_pk_bf16_f32 v140, v205, v209
v_smfmac_f32_16x16x64_bf16 v[244:247], a[244:247], v[164:171], v0
v_cvt_pk_bf16_f32 v94, v206, v210
v_smfmac_f32_16x16x64_bf16 v[244:247], a[248:251], v[172:179], v0
v_cvt_pk_bf16_f32 v142, v207, v211
v_smfmac_f32_16x16x64_bf16 v[244:247], a[252:255], v[180:187], v0
v_cvt_pk_bf16_f32 v93, v212, v216
v_mfma_f32_16x16x32_bf16 v[188:191], v[44:47], v[156:159], 0
v_cvt_pk_bf16_f32 v141, v213, v217
v_cvt_pk_bf16_f32 v95, v214, v218
v_mfma_f32_16x16x32_bf16 v[188:191], v[52:55], v[160:163], v[188:191]
buffer_store_dwordx2 v[72:73], v16, s[12:15], s29 offen offset:512 sc1
v_cvt_pk_bf16_f32 v143, v215, v219
v_mfma_f32_16x16x32_bf16 v[192:195], v[44:47], v[164:167], 0
ds_write_b64 v4, a[42:43] offset:2056
v_mfma_f32_16x16x32_bf16 v[192:195], v[52:55], v[168:171], v[192:195]
s_waitcnt vmcnt(28)
ds_write_b64 v5, a[44:45] offset:2048
v_mfma_f32_16x16x32_bf16 v[196:199], v[44:47], v[172:175], 0
ds_write_b64 v5, a[46:47] offset:2056
v_mfma_f32_16x16x32_bf16 v[196:199], v[52:55], v[176:179], v[196:199]
ds_read_b128 a[40:43], v6 offset:2048
ds_read_b128 a[44:47], v7 offset:2048
v_mfma_f32_16x16x32_bf16 v[200:203], v[44:47], v[180:183], 0
v_add_f32 v64, v244, v245
v_cvt_pk_bf16_f32 v64, v64, v64
v_mfma_f32_16x16x32_bf16 v[200:203], v[52:55], v[184:187], v[200:203]
buffer_store_short v64, v17, s[12:15], s28 offen offset:256 sc1
s_mov_b32 s28, s32
v_mfma_f32_16x16x32_bf16 v[204:207], v[60:63], v[156:159], 0
s_add_u32 s32, s34, s35
s_cmp_lt_u32 s33, 5329
s_cselect_b32 s22, 100270464, 0
v_mfma_f32_16x16x32_bf16 v[204:207], v[68:71], v[160:163], v[204:207]
s_lshr_b32 s36, s26, 1
s_lshl_b32 s36, s36, 4
s_lshl_b64 s[98:99], 0xffff, s36
v_mfma_f32_16x16x32_bf16 v[208:211], v[60:63], v[164:167], 0
v_cvt_pk_bf16_f32 v100, v188, v192
v_cvt_pk_bf16_f32 v101, v196, v200
v_mfma_f32_16x16x32_bf16 v[208:211], v[68:71], v[168:171], v[208:211]
v_cvt_pk_bf16_f32 v148, v189, v193
v_cvt_pk_bf16_f32 v149, v197, v201
v_mfma_f32_16x16x32_bf16 v[212:215], v[60:63], v[172:175], 0
v_cvt_pk_bf16_f32 v102, v190, v194
v_cvt_pk_bf16_f32 v103, v198, v202
v_mfma_f32_16x16x32_bf16 v[212:215], v[68:71], v[176:179], v[212:215]
v_cvt_pk_bf16_f32 v150, v191, v195
v_cvt_pk_bf16_f32 v151, v199, v203
v_mfma_f32_16x16x32_bf16 v[216:219], v[60:63], v[180:183], 0
s_waitcnt vmcnt(28)
v_cndmask_b32 v26, v21, v24, s[98:99]
ds_write_b64 v4, a[64:65] offset:0
v_mfma_f32_16x16x32_bf16 v[216:219], v[68:71], v[184:187], v[216:219]
s_waitcnt vmcnt(27)
ds_write_b64 v4, a[66:67] offset:8
ds_write_b64 v5, a[68:69] offset:0
ds_write_b64 v5, a[70:71] offset:8
ds_read_b128 a[64:67], v6 offset:0
ds_read_b128 a[68:71], v7 offset:0
s_cmp_lt_u32 s26, 4
s_cbranch_scc1 L_loop
L_dispB:
LW_p11:
s_cbranch_execz LW_p26
s_cmp_ge_u32 s27, 5329
s_cbranch_scc1 L_epiB
s_cmp_eq_u32 s38, 3
s_cbranch_scc1 L_tailL
s_waitcnt lgkmcnt(15)
v_mfma_f32_16x16x32_bf16 v[220:223], a[192:195], a[0:3], 0
s_lshl_b32 s37, s38, 12
ds_read_b128 a[192:195], v1 offset:12288
v_cvt_pk_bf16_f32 v72, v206, v210
v_mfma_f32_16x16x32_bf16 v[220:223], a[196:199], a[4:7], v[220:223]
s_add_u32 s34, s38, 0
ds_read_b128 a[196:199], v1 offset:13312
v_cvt_pk_bf16_f32 v73, v214, v218
v_mfma_f32_16x16x32_bf16 v[220:223], a[200:203], a[8:11], v[220:223]
buffer_store_dwordx2 v[72:73], v16, s[12:15], s45 offen offset:256 sc1
ds_read_b128 a[200:203], v1 offset:14336
v_mfma_f32_16x16x32_bf16 v[220:223], a[204:207], a[12:15], v[220:223]
s_sub_u32 s35, s34, 3
ds_read_b128 a[204:207], v1 offset:15360
s_cmp_ge_u32 s34, 3
v_mfma_f32_16x16x32_bf16 v[220:223], a[208:211], a[16:19], v[220:223]
s_cselect_b32 s34, s35, s34
ds_read_b128 a[208:211], v1 offset:16384
s_lshl_b32 s34, s34, 9
v_mfma_f32_16x16x32_bf16 v[220:223], a[212:215], a[20:23], v[220:223]
buffer_store_dwordx2 v[92:93], v14, s[12:15], s44 offen offset:256 sc1
ds_read_b128 a[212:215], v1 offset:17408
v_mfma_f32_16x16x32_bf16 v[224:227], a[216:219], a[0:3], 0
s_add_u32 s34, s34, 147456
ds_read_b128 a[216:219], v1 offset:18432
v_lshrrev_b32 v23, 1, v1
v_mfma_f32_16x16x32_bf16 v[224:227], a[220:223], a[4:7], v[224:227]
ds_read_b128 a[220:223], v1 offset:19456
v_cvt_pk_bf16_f32 v60, v220, v221
v_mfma_f32_16x16x32_bf16 v[224:227], a[224:227], a[8:11], v[224:227]
ds_read_b128 a[224:227], v1 offset:20480
v_cvt_pk_bf16_f32 v61, v222, v223
v_mfma_f32_16x16x32_bf16 v[224:227], a[228:231], a[12:15], v[224:227]
ds_read_b128 a[228:231], v1 offset:21504
v_add_u32 v8, s34, v23
v_mfma_f32_16x16x32_bf16 v[224:227], a[232:235], a[16:19], v[224:227]
buffer_store_dwordx2 v[140:141], v14, s[12:15], s44 offen offset:640 sc1
ds_read_b128 a[232:235], v1 offset:22528
v_mfma_f32_16x16x32_bf16 v[224:227], a[236:239], a[20:23], v[224:227]
s_waitcnt lgkmcnt(10)
s_add_u32 s34, s38, 1
ds_read_b128 a[236:239], v1 offset:23552
s_sub_u32 s35, s34, 3
v_mfma_f32_16x16x32_bf16 v[228:231], a[192:195], a[0:3], 0
s_waitcnt lgkmcnt(10)
s_cmp_ge_u32 s34, 3
ds_read_b128 a[192:195], v1 offset:24576
s_cselect_b32 s34, s35, s34
v_mfma_f32_16x16x32_bf16 v[228:231], a[196:199], a[4:7], v[228:231]
s_waitcnt lgkmcnt(10)
s_lshl_b32 s34, s34, 9
ds_read_b128 a[196:199], v1 offset:25600
v_cvt_pk_bf16_f32 v62, v224, v225
v_mfma_f32_16x16x32_bf16 v[228:231], a[200:203], a[8:11], v[228:231]
s_waitcnt lgkmcnt(10)
s_add_u32 s34, s34, 147456
ds_read_b128 a[200:203], v1 offset:26624
v_cvt_pk_bf16_f32 v63, v226, v227
v_mfma_f32_16x16x32_bf16 v[228:231], a[204:207], a[12:15], v[228:231]
buffer_store_dwordx2 v[94:95], v14, s[12:15], s44 offen offset:1024 sc1
s_waitcnt lgkmcnt(10)
ds_read_b128 a[204:207], v1 offset:27648
v_mfma_f32_16x16x32_bf16 v[228:231], a[208:211], a[16:19], v[228:231]
s_waitcnt lgkmcnt(10)
ds_read_b128 a[208:211], v1 offset:28672
v_add_u32 v9, s34, v23
v_mfma_f32_16x16x32_bf16 v[228:231], a[212:215], a[20:23], v[228:231]
s_waitcnt lgkmcnt(10)
s_add_u32 s34, s38, 2
ds_read_b128 a[212:215], v1 offset:29696
s_sub_u32 s35, s34, 3
v_mfma_f32_16x16x32_bf16 v[232:235], a[216:219], a[0:3], 0
s_waitcnt lgkmcnt(10)
s_cmp_ge_u32 s34, 3
ds_read_b128 a[216:219], v1 offset:30720
s_cselect_b32 s34, s35, s34
v_mfma_f32_16x16x32_bf16 v[232:235], a[220:223], a[4:7], v[232:235]
s_waitcnt lgkmcnt(10)
s_lshl_b32 s34, s34, 9
ds_read_b128 a[220:223], v1 offset:31744
v_cvt_pk_bf16_f32 v64, v228, v229
v_mfma_f32_16x16x32_bf16 v[232:235], a[224:227], a[8:11], v[232:235]
buffer_store_dwordx2 v[142:143], v14, s[12:15], s44 offen offset:1408 sc1
s_waitcnt lgkmcnt(10)
ds_read_b128 a[224:227], v1 offset:32768
v_mfma_f32_16x16x32_bf16 v[232:235], a[228:231], a[12:15], v[232:235]
s_waitcnt lgkmcnt(10)
s_add_u32 s34, s34, 147456
ds_read_b128 a[228:231], v1 offset:33792
v_cvt_pk_bf16_f32 v65, v230, v231
v_mfma_f32_16x16x32_bf16 v[232:235], a[232:235], a[16:19], v[232:235]
s_waitcnt lgkmcnt(10)
ds_read_b128 a[232:235], v1 offset:34816
v_add_u32 v10, s34, v23
v_mfma_f32_16x16x32_bf16 v[232:235], a[236:239], a[20:23], v[232:235]
s_waitcnt lgkmcnt(10)
s_mov_b32 s34, 148992
ds_read_b128 a[236:239], v1 offset:35840
v_add_u32 v11, s34, v23
v_mfma_f32_16x16x32_bf16 v[220:223], a[192:195], a[0:3], 0
s_waitcnt lgkmcnt(10)
s_mul_i32 s34, s38, 24576
ds_read_b128 a[192:195], v1 offset:36864
s_add_u32 s34, s34, 73728
v_mfma_f32_16x16x32_bf16 v[220:223], a[196:199], a[4:7], v[220:223]
buffer_store_dwordx2 v[100:101], v15, s[12:15], s44 offen offset:256 sc1
s_waitcnt lgkmcnt(10)
ds_read_b128 a[196:199], v1 offset:37888
v_mfma_f32_16x16x32_bf16 v[220:223], a[200:203], a[8:11], v[220:223]
s_waitcnt lgkmcnt(10)
ds_read_b128 a[200:203], v1 offset:38912
v_cvt_pk_bf16_f32 v66, v232, v233
v_mfma_f32_16x16x32_bf16 v[220:223], a[204:207], a[12:15], v[220:223]
s_waitcnt lgkmcnt(10)
ds_read_b128 a[204:207], v1 offset:39936
v_cvt_pk_bf16_f32 v67, v234, v235
v_mfma_f32_16x16x32_bf16 v[220:223], a[208:211], a[16:19], v[220:223]
s_waitcnt lgkmcnt(10)
ds_read_b128 a[208:211], v1 offset:40960
v_add_u32 v6, s34, v1
v_mfma_f32_16x16x32_bf16 v[220:223], a[212:215], a[20:23], v[220:223]
s_waitcnt lgkmcnt(10)
s_lshl_b32 s34, s38, 7
ds_read_b128 a[212:215], v1 offset:41984
v_mov_b32 v25, v26
v_mfma_f32_16x16x32_bf16 v[224:227], a[216:219], a[0:3], 0
buffer_store_dwordx2 v[148:149], v15, s[12:15], s45 offen offset:256 sc1
s_waitcnt lgkmcnt(10)
ds_read_b128 a[216:219], v1 offset:43008
v_mfma_f32_16x16x32_bf16 v[224:227], a[220:223], a[4:7], v[224:227]
s_waitcnt lgkmcnt(10)
s_add_u32 s28, s28, s34
ds_read_b128 a[220:223], v1 offset:44032
v_cvt_pk_bf16_f32 v68, v220, v221
v_mfma_f32_16x16x32_bf16 v[224:227], a[224:227], a[8:11], v[224:227]
s_waitcnt lgkmcnt(10)
s_add_u32 s29, s28, 196224
ds_read_b128 a[224:227], v1 offset:45056
v_cvt_pk_bf16_f32 v69, v222, v223
v_mfma_f32_16x16x32_bf16 v[224:227], a[228:231], a[12:15], v[224:227]
s_waitcnt lgkmcnt(10)
s_add_u32 s30, s28, 392448
ds_read_b128 a[228:231], v1 offset:46080
v_add_u32 v12, s37, v8
v_mfma_f32_16x16x32_bf16 v[224:227], a[232:235], a[16:19], v[224:227]
s_waitcnt lgkmcnt(10)
s_add_u32 s31, s28, 588672
ds_read_b128 a[232:235], v1 offset:47104
v_add_u32 v13, s37, v9
v_mfma_f32_16x16x32_bf16 v[224:227], a[236:239], a[20:23], v[224:227]
buffer_store_dwordx2 v[102:103], v15, s[12:15], s46 offen offset:256 sc1
s_waitcnt lgkmcnt(10)
ds_read_b128 a[236:239], v1 offset:48128
v_mfma_f32_16x16x32_bf16 v[228:231], a[192:195], a[0:3], 0
s_waitcnt lgkmcnt(10)
s_cmp_eq_u32 s38, 1
ds_read_b128 a[192:195], v1 offset:49152
v_add_u32 v4, s37, v10
v_mfma_f32_16x16x32_bf16 v[228:231], a[196:199], a[4:7], v[228:231]
s_waitcnt lgkmcnt(10)
s_cselect_b64 s[4:5], -1, 0
ds_read_b128 a[196:199], v1 offset:50176
v_cvt_pk_bf16_f32 v70, v224, v225
v_mfma_f32_16x16x32_bf16 v[228:231], a[200:203], a[8:11], v[228:231]
s_waitcnt lgkmcnt(10)
s_cmp_eq_u32 s38, 2
ds_read_b128 a[200:203], v1 offset:51200
v_cvt_pk_bf16_f32 v71, v226, v227
v_mfma_f32_16x16x32_bf16 v[228:231], a[204:207], a[12:15], v[228:231]
s_waitcnt lgkmcnt(10)
s_cselect_b64 s[6:7], -1, 0
ds_read_b128 a[204:207], v1 offset:52224
v_add_u32 v5, s37, v11
v_mfma_f32_16x16x32_bf16 v[228:231], a[208:211], a[16:19], v[228:231]
buffer_store_dwordx2 v[150:151], v15, s[12:15], s47 offen offset:256 sc1
s_waitcnt lgkmcnt(10)
ds_read_b128 a[208:211], v1 offset:53248
v_mfma_f32_16x16x32_bf16 v[228:231], a[212:215], a[20:23], v[228:231]
s_waitcnt lgkmcnt(10)
ds_read_b128 a[212:215], v1 offset:54272
v_cvt_pk_bf16_f32 v108, v204, v208
v_mfma_f32_16x16x32_bf16 v[232:235], a[216:219], a[0:3], 0
s_waitcnt lgkmcnt(10)
ds_read_b128 a[216:219], v1 offset:55296
v_cvt_pk_bf16_f32 v109, v212, v216
v_mfma_f32_16x16x32_bf16 v[232:235], a[220:223], a[4:7], v[232:235]
s_waitcnt lgkmcnt(10)
ds_read_b128 a[220:223], v1 offset:56320
v_cvt_pk_bf16_f32 v110, v205, v209
v_mfma_f32_16x16x32_bf16 v[232:235], a[224:227], a[8:11], v[232:235]
s_waitcnt lgkmcnt(10)
ds_read_b128 a[224:227], v1 offset:57344
v_cvt_pk_bf16_f32 v72, v228, v229
v_mfma_f32_16x16x32_bf16 v[232:235], a[228:231], a[12:15], v[232:235]
buffer_store_dwordx2 v[108:109], v16, s[12:15], s44 offen offset:256 sc1
s_waitcnt lgkmcnt(10)
ds_read_b128 a[228:231], v1 offset:58368
v_mfma_f32_16x16x32_bf16 v[232:235], a[232:235], a[16:19], v[232:235]
s_waitcnt lgkmcnt(10)
ds_read_b128 a[232:235], v1 offset:59392
v_cvt_pk_bf16_f32 v73, v230, v231
v_mfma_f32_16x16x32_bf16 v[232:235], a[236:239], a[20:23], v[232:235]
s_waitcnt lgkmcnt(10)
ds_read_b128 a[236:239], v1 offset:60416
v_cvt_pk_bf16_f32 v111, v213, v217
v_mfma_f32_16x16x32_bf16 v[220:223], a[192:195], a[0:3], 0
s_waitcnt lgkmcnt(10)
ds_read_b128 a[192:195], v1 offset:61440
v_cndmask_b32 v98, v98, v130, s[4:5]
v_mfma_f32_16x16x32_bf16 v[220:223], a[196:199], a[4:7], v[220:223]
s_waitcnt lgkmcnt(10)
ds_read_b128 a[196:199], v1 offset:62464
v_cndmask_b32 v98, v98, v162, s[6:7]
v_mfma_f32_16x16x32_bf16 v[220:223], a[200:203], a[8:11], v[220:223]
buffer_store_dwordx2 v[110:111], v16, s[12:15], s44 offen offset:640 sc1
s_waitcnt lgkmcnt(10)
ds_read_b128 a[200:203], v1 offset:63488
v_mfma_f32_16x16x32_bf16 v[220:223], a[204:207], a[12:15], v[220:223]
s_waitcnt lgkmcnt(10)
ds_read_b128 a[204:207], v1 offset:64512
v_cvt_pk_bf16_f32 v74, v232, v233
v_mfma_f32_16x16x32_bf16 v[220:223], a[208:211], a[16:19], v[220:223]
s_waitcnt lgkmcnt(10)
ds_read_b128 a[208:211], v2 offset:0
v_cvt_pk_bf16_f32 v75, v234, v235
v_mfma_f32_16x16x32_bf16 v[220:223], a[212:215], a[20:23], v[220:223]
s_waitcnt lgkmcnt(10)
ds_read_b128 a[212:215], v2 offset:1024
v_cndmask_b32 v106, v106, v138, s[4:5]
v_mfma_f32_16x16x32_bf16 v[224:227], a[216:219], a[0:3], 0
s_waitcnt lgkmcnt(10)
ds_read_b128 a[216:219], v2 offset:2048
v_cndmask_b32 v106, v106, v170, s[6:7]
v_mfma_f32_16x16x32_bf16 v[224:227], a[220:223], a[4:7], v[224:227]
s_waitcnt lgkmcnt(10)
ds_read_b128 a[220:223], v2 offset:3072
v_cndmask_b32 v114, v114, v146, s[4:5]
v_mfma_f32_16x16x32_bf16 v[224:227], a[224:227], a[8:11], v[224:227]
s_waitcnt lgkmcnt(10)
ds_read_b128 a[224:227], v2 offset:4096
v_cvt_pk_bf16_f32 v236, v220, v221
v_mfma_f32_16x16x32_bf16 v[224:227], a[228:231], a[12:15], v[224:227]
s_waitcnt lgkmcnt(10)
ds_read_b128 a[228:231], v2 offset:5120
v_cvt_pk_bf16_f32 v237, v222, v223
v_mfma_f32_16x16x32_bf16 v[224:227], a[232:235], a[16:19], v[224:227]
s_waitcnt lgkmcnt(10)
ds_read_b128 a[232:235], v2 offset:6144
v_cndmask_b32 v114, v114, v178, s[6:7]
v_mfma_f32_16x16x32_bf16 v[224:227], a[236:239], a[20:23], v[224:227]
s_waitcnt lgkmcnt(10)
ds_read_b128 a[236:239], v2 offset:7168
v_cvt_pk_bf16_f32 v116, v207, v211
v_mfma_f32_16x16x32_bf16 v[228:231], a[192:195], a[0:3], 0
s_waitcnt lgkmcnt(10)
ds_read_b128 a[192:195], v6 offset:0
v_cvt_pk_bf16_f32 v117, v215, v219
v_mfma_f32_16x16x32_bf16 v[228:231], a[196:199], a[4:7], v[228:231]
buffer_store_dwordx2 v[116:117], v16, s[12:15], s45 offen offset:640 sc1
s_waitcnt lgkmcnt(10)
ds_read_b128 a[196:199], v6 offset:1024
v_mfma_f32_16x16x32_bf16 v[228:231], a[200:203], a[8:11], v[228:231]
s_waitcnt lgkmcnt(10)
v_cvt_pk_bf16_f32 v238, v224, v225
v_cvt_pk_bf16_f32 v239, v226, v227
v_mfma_f32_16x16x32_bf16 v[228:231], a[204:207], a[12:15], v[228:231]
s_waitcnt lgkmcnt(9)
ds_read_b128 a[200:203], v6 offset:2048
ds_read_b128 a[204:207], v6 offset:3072
v_mfma_f32_16x16x32_bf16 v[228:231], a[208:211], a[16:19], v[228:231]
s_waitcnt lgkmcnt(10)
ds_read_b128 a[208:211], v6 offset:4096
v_cndmask_b32 v122, v122, v154, s[4:5]
v_mfma_f32_16x16x32_bf16 v[228:231], a[212:215], a[20:23], v[228:231]
s_waitcnt lgkmcnt(10)
ds_read_b128 a[212:215], v6 offset:5120
v_cndmask_b32 v122, v122, v186, s[6:7]
v_mfma_f32_16x16x32_bf16 v[232:235], a[216:219], a[0:3], 0
s_waitcnt lgkmcnt(10)
ds_read_b128 a[216:219], v6 offset:6144
v_bfe_u32 v20, v1, 4, 4
v_mfma_f32_16x16x32_bf16 v[232:235], a[220:223], a[4:7], v[232:235]
s_waitcnt lgkmcnt(10)
ds_read_b128 a[220:223], v6 offset:7168
v_lshlrev_b32 v20, 3, v20
v_mfma_f32_16x16x32_bf16 v[232:235], a[224:227], a[8:11], v[232:235]
s_waitcnt lgkmcnt(10)
v_cvt_pk_bf16_f32 v240, v228, v229
v_cvt_pk_bf16_f32 v241, v230, v231
v_mfma_f32_16x16x32_bf16 v[232:235], a[228:231], a[12:15], v[232:235]
s_waitcnt lgkmcnt(9)
ds_read_b128 a[224:227], v6 offset:8192
ds_read_b128 a[228:231], v6 offset:9216
v_mfma_f32_16x16x32_bf16 v[232:235], a[232:235], a[16:19], v[232:235]
s_waitcnt lgkmcnt(10)
ds_read_b128 a[232:235], v6 offset:10240
v_add_u32 v20, 589824, v20
v_mfma_f32_16x16x32_bf16 v[232:235], a[236:239], a[20:23], v[232:235]
ds_read_b128 a[236:239], v6 offset:11264
v_mov_b32 v22, 0x80000000
v_mfma_f32_16x16x32_bf16 v[28:31], a[0:3], v[60:63], 0
s_nop 0
v_cndmask_b32 v20, v22, v20, s[98:99]
s_nop 0
v_mfma_f32_16x16x32_bf16 v[28:31], a[4:7], v[64:67], v[28:31]
s_nop 0
v_cvt_pk_bf16_f32 v242, v232, v233
v_cvt_pk_bf16_f32 v243, v234, v235
v_mfma_f32_16x16x32_bf16 v[28:31], a[8:11], v[68:71], v[28:31]
v_mfma_f32_16x16x32_bf16 v[28:31], a[12:15], v[72:75], v[28:31]
v_mfma_f32_16x16x32_bf16 v[28:31], a[16:19], v[236:239], v[28:31]
v_mfma_f32_16x16x32_bf16 v[28:31], a[20:23], v[240:243], v[28:31]
v_mfma_f32_16x16x32_bf16 v[32:35], a[24:27], v[60:63], 0
v_mfma_f32_16x16x32_bf16 v[32:35], a[28:31], v[64:67], v[32:35]
v_mfma_f32_16x16x32_bf16 v[32:35], a[32:35], v[68:71], v[32:35]
v_mfma_f32_16x16x32_bf16 v[32:35], a[36:39], v[72:75], v[32:35]
v_mfma_f32_16x16x32_bf16 v[32:35], a[40:43], v[236:239], v[32:35]
v_mfma_f32_16x16x32_bf16 v[32:35], a[44:47], v[240:243], v[32:35]
v_mfma_f32_16x16x32_bf16 v[36:39], a[48:51], v[60:63], 0
v_mfma_f32_16x16x32_bf16 v[36:39], a[52:55], v[64:67], v[36:39]
v_mfma_f32_16x16x32_bf16 v[36:39], a[56:59], v[68:71], v[36:39]
v_mfma_f32_16x16x32_bf16 v[36:39], a[60:63], v[72:75], v[36:39]
v_mfma_f32_16x16x32_bf16 v[36:39], a[64:67], v[236:239], v[36:39]
v_mfma_f32_16x16x32_bf16 v[36:39], a[68:71], v[240:243], v[36:39]
v_mfma_f32_16x16x32_bf16 v[40:43], a[144:147], v[60:63], v[24:27]
v_mfma_f32_16x16x32_bf16 v[40:43], a[148:151], v[64:67], v[40:43]
v_mfma_f32_16x16x32_bf16 v[40:43], a[152:155], v[68:71], v[40:43]
v_mfma_f32_16x16x32_bf16 v[40:43], a[156:159], v[72:75], v[40:43]
v_mfma_f32_16x16x32_bf16 v[40:43], a[160:163], v[236:239], v[40:43]
v_mfma_f32_16x16x32_bf16 v[40:43], a[164:167], v[240:243], v[40:43]
s_waitcnt lgkmcnt(11)
v_mfma_f32_16x16x32_bf16 v[220:223], a[0:3], a[192:195], 0
s_waitcnt lgkmcnt(10)
v_mfma_f32_16x16x32_bf16 v[220:223], a[4:7], a[196:199], v[220:223]
s_waitcnt lgkmcnt(9)
v_mfma_f32_16x16x32_bf16 v[220:223], a[8:11], a[200:203], v[220:223]
s_waitcnt lgkmcnt(8)
v_mfma_f32_16x16x32_bf16 v[220:223], a[12:15], a[204:207], v[220:223]
s_waitcnt lgkmcnt(7)
v_mfma_f32_16x16x32_bf16 v[220:223], a[16:19], a[208:211], v[220:223]
s_waitcnt lgkmcnt(6)
v_mfma_f32_16x16x32_bf16 v[220:223], a[20:23], a[212:215], v[220:223]
v_mfma_f32_16x16x32_bf16 v[224:227], a[24:27], a[192:195], 0
v_mfma_f32_16x16x32_bf16 v[224:227], a[28:31], a[196:199], v[224:227]
v_max3_f32 v42, v28, v29, v30
v_max3_f32 v42, v42, v31, v32
v_mfma_f32_16x16x32_bf16 v[224:227], a[32:35], a[200:203], v[224:227]
v_max3_f32 v42, v42, v33, v34
v_max3_f32 v42, v42, v35, v36
v_mfma_f32_16x16x32_bf16 v[224:227], a[36:39], a[204:207], v[224:227]
v_cvt_pk_bf16_f32 v92, v220, v221
v_cvt_pk_bf16_f32 v93, v222, v223
v_mfma_f32_16x16x32_bf16 v[224:227], a[40:43], a[208:211], v[224:227]
v_max3_f32 v42, v42, v37, v38
v_max3_f32 v42, v42, v39, v41
v_mfma_f32_16x16x32_bf16 v[224:227], a[44:47], a[212:215], v[224:227]
v_mov_b32 v43, v42
v_mfma_f32_16x16x32_bf16 v[228:231], a[48:51], a[192:195], 0
LW_p12:
s_cbranch_execz LP_end
ds_read_b128 a[192:195], v6 offset:12288
v_mfma_f32_16x16x32_bf16 v[228:231], a[52:55], a[196:199], v[228:231]
ds_read_b128 a[196:199], v6 offset:13312
v_mfma_f32_16x16x32_bf16 v[228:231], a[56:59], a[200:203], v[228:231]
ds_read_b128 a[200:203], v6 offset:14336
v_mfma_f32_16x16x32_bf16 v[228:231], a[60:63], a[204:207], v[228:231]
ds_read_b128 a[204:207], v6 offset:15360
v_cvt_pk_bf16_f32 v94, v224, v225
v_mfma_f32_16x16x32_bf16 v[228:231], a[64:67], a[208:211], v[228:231]
v_cvt_pk_bf16_f32 v95, v226, v227
v_mfma_f32_16x16x32_bf16 v[228:231], a[68:71], a[212:215], v[228:231]
s_waitcnt lgkmcnt(9)
ds_read_b128 a[208:211], v6 offset:16384
ds_read_b128 a[212:215], v6 offset:17408
v_mfma_f32_16x16x32_bf16 v[232:235], a[0:3], a[216:219], 0
s_waitcnt lgkmcnt(10)
v_permlane32_swap_b32 v42, v43
v_mfma_f32_16x16x32_bf16 v[232:235], a[4:7], a[220:223], v[232:235]
s_waitcnt lgkmcnt(9)
v_max_f32 v42, v42, v43
v_mov_b32 v43, v42
v_mfma_f32_16x16x32_bf16 v[232:235], a[8:11], a[224:227], v[232:235]
s_waitcnt lgkmcnt(8)
v_cvt_pk_bf16_f32 v96, v228, v229
v_cvt_pk_bf16_f32 v97, v230, v231
v_mfma_f32_16x16x32_bf16 v[232:235], a[12:15], a[228:231], v[232:235]
s_waitcnt lgkmcnt(7)
v_permlane16_swap_b32 v42, v43
v_mfma_f32_16x16x32_bf16 v[232:235], a[16:19], a[232:235], v[232:235]
s_waitcnt lgkmcnt(6)
v_max_f32 v42, v42, v43
v_sub_f32 v28, v28, v42
v_mfma_f32_16x16x32_bf16 v[232:235], a[20:23], a[236:239], v[232:235]
v_sub_f32 v29, v29, v42
v_sub_f32 v30, v30, v42
v_mfma_f32_16x16x32_bf16 v[220:223], a[24:27], a[216:219], 0
v_exp_f32 v28, v28
v_mfma_f32_16x16x32_bf16 v[220:223], a[28:31], a[220:223], v[220:223]
v_exp_f32 v29, v29
v_mfma_f32_16x16x32_bf16 v[220:223], a[32:35], a[224:227], v[220:223]
v_sub_f32 v31, v31, v42
v_cvt_pk_bf16_f32 v100, v232, v233
v_mfma_f32_16x16x32_bf16 v[220:223], a[36:39], a[228:231], v[220:223]
v_cvt_pk_bf16_f32 v101, v234, v235
v_sub_f32 v32, v32, v42
v_mfma_f32_16x16x32_bf16 v[220:223], a[40:43], a[232:235], v[220:223]
v_sub_f32 v33, v33, v42
v_sub_f32 v34, v34, v42
v_mfma_f32_16x16x32_bf16 v[220:223], a[44:47], a[236:239], v[220:223]
v_sub_f32 v35, v35, v42
v_sub_f32 v36, v36, v42
v_mfma_f32_16x16x32_bf16 v[224:227], a[48:51], a[216:219], 0
ds_read_b128 a[216:219], v6 offset:18432
v_sub_f32 v37, v37, v42
v_mfma_f32_16x16x32_bf16 v[224:227], a[52:55], a[220:223], v[224:227]
ds_read_b128 a[220:223], v6 offset:19456
v_sub_f32 v38, v38, v42
v_mfma_f32_16x16x32_bf16 v[224:227], a[56:59], a[224:227], v[224:227]
ds_read_b128 a[224:227], v6 offset:20480
v_cvt_pk_bf16_f32 v102, v220, v221
v_mfma_f32_16x16x32_bf16 v[224:227], a[60:63], a[228:231], v[224:227]
ds_read_b128 a[228:231], v6 offset:21504
v_cvt_pk_bf16_f32 v103, v222, v223
v_mfma_f32_16x16x32_bf16 v[224:227], a[64:67], a[232:235], v[224:227]
ds_read_b128 a[232:235], v6 offset:22528
v_sub_f32 v39, v39, v42
v_mfma_f32_16x16x32_bf16 v[224:227], a[68:71], a[236:239], v[224:227]
s_waitcnt lgkmcnt(10)
ds_read_b128 a[236:239], v6 offset:23552
v_sub_f32 v41, v41, v42
v_mfma_f32_16x16x32_bf16 v[228:231], a[0:3], a[192:195], 0
s_waitcnt lgkmcnt(10)
v_exp_f32 v30, v30
v_mfma_f32_16x16x32_bf16 v[228:231], a[4:7], a[196:199], v[228:231]
s_waitcnt lgkmcnt(9)
v_exp_f32 v31, v31
v_mfma_f32_16x16x32_bf16 v[228:231], a[8:11], a[200:203], v[228:231]
s_waitcnt lgkmcnt(8)
v_add_f32 v42, v28, v29
v_add_f32 v42, v42, v30
v_mfma_f32_16x16x32_bf16 v[228:231], a[12:15], a[204:207], v[228:231]
s_waitcnt lgkmcnt(7)
v_exp_f32 v32, v32
v_mfma_f32_16x16x32_bf16 v[228:231], a[16:19], a[208:211], v[228:231]
s_waitcnt lgkmcnt(6)
v_exp_f32 v33, v33
v_mfma_f32_16x16x32_bf16 v[228:231], a[20:23], a[212:215], v[228:231]
v_add_f32 v42, v42, v31
v_add_f32 v42, v42, v32
v_mfma_f32_16x16x32_bf16 v[232:235], a[24:27], a[192:195], 0
v_exp_f32 v34, v34
v_mfma_f32_16x16x32_bf16 v[232:235], a[28:31], a[196:199], v[232:235]
v_exp_f32 v35, v35
v_mfma_f32_16x16x32_bf16 v[232:235], a[32:35], a[200:203], v[232:235]
v_add_f32 v42, v42, v33
v_add_f32 v42, v42, v34
v_mfma_f32_16x16x32_bf16 v[232:235], a[36:39], a[204:207], v[232:235]
v_exp_f32 v36, v36
v_mfma_f32_16x16x32_bf16 v[232:235], a[40:43], a[208:211], v[232:235]
v_exp_f32 v37, v37
v_mfma_f32_16x16x32_bf16 v[232:235], a[44:47], a[212:215], v[232:235]
v_add_f32 v42, v42, v35
v_add_f32 v42, v42, v36
v_mfma_f32_16x16x32_bf16 v[220:223], a[48:51], a[192:195], 0
v_exp_f32 v38, v38
v_mfma_f32_16x16x32_bf16 v[220:223], a[52:55], a[196:199], v[220:223]
v_exp_f32 v39, v39
v_mfma_f32_16x16x32_bf16 v[220:223], a[56:59], a[200:203], v[220:223]
v_add_f32 v42, v42, v37
v_exp_f32 v41, v41
v_mfma_f32_16x16x32_bf16 v[220:223], a[60:63], a[204:207], v[220:223]
v_add_f32 v42, v42, v38
v_add_f32 v42, v42, v39
v_mfma_f32_16x16x32_bf16 v[220:223], a[64:67], a[208:211], v[220:223]
v_add_f32 v42, v42, v41
v_mov_b32 v43, v42
v_mfma_f32_16x16x32_bf16 v[220:223], a[68:71], a[212:215], v[220:223]
s_waitcnt lgkmcnt(5)
v_cvt_pk_bf16_f32 v104, v224, v225
v_cvt_pk_bf16_f32 v105, v226, v227
v_mfma_f32_16x16x32_bf16 v[224:227], a[0:3], a[216:219], 0
s_waitcnt lgkmcnt(4)
v_permlane32_swap_b32 v42, v43
v_mfma_f32_16x16x32_bf16 v[224:227], a[4:7], a[220:223], v[224:227]
s_waitcnt lgkmcnt(3)
v_add_f32 v42, v42, v43
v_mov_b32 v43, v42
v_mfma_f32_16x16x32_bf16 v[224:227], a[8:11], a[224:227], v[224:227]
s_waitcnt lgkmcnt(2)
v_permlane16_swap_b32 v42, v43
v_mfma_f32_16x16x32_bf16 v[224:227], a[12:15], a[228:231], v[224:227]
s_waitcnt lgkmcnt(1)
v_add_f32 v42, v42, v43
v_rcp_f32 v42, v42
v_mfma_f32_16x16x32_bf16 v[224:227], a[16:19], a[232:235], v[224:227]
s_waitcnt lgkmcnt(0)
v_mul_f32 v28, v28, v42
v_mul_f32 v29, v29, v42
v_mfma_f32_16x16x32_bf16 v[224:227], a[20:23], a[236:239], v[224:227]
v_mul_f32 v36, v36, v42
v_mul_f32 v37, v37, v42
v_mul_f32 v30, v30, v42
v_mul_f32 v31, v31, v42
v_mul_f32 v38, v38, v42
v_mul_f32 v39, v39, v42
v_cvt_pk_bf16_f32 v28, v28, v29
v_cvt_pk_bf16_f32 v36, v36, v37
v_mul_f32 v32, v32, v42
v_mul_f32 v33, v33, v42
v_mul_f32 v34, v34, v42
v_mul_f32 v35, v35, v42
v_mul_f32 v41, v41, v42
v_cvt_pk_bf16_f32 v29, v30, v31
v_cvt_pk_bf16_f32 v37, v38, v39
v_cvt_pk_bf16_f32 v30, v32, v33
v_cvt_pk_bf16_f32 v31, v34, v35
v_cvt_pk_bf16_f32 v38, 0, v41
v_mov_b32 v39, 0
ds_write_b64 v12, v[28:29]
ds_write_b64 v13, v[30:31]
ds_write_b64 v4, v[36:37]
ds_write_b64 v5, v[38:39]
v_cvt_pk_bf16_f32 v108, v228, v229
v_cvt_pk_bf16_f32 v109, v230, v231
v_mfma_f32_16x16x32_bf16 v[228:231], a[24:27], a[216:219], 0
v_cvt_pk_bf16_f32 v110, v232, v233
v_cvt_pk_bf16_f32 v111, v234, v235
v_mfma_f32_16x16x32_bf16 v[228:231], a[28:31], a[220:223], v[228:231]
v_cvt_pk_bf16_f32 v112, v220, v221
v_cvt_pk_bf16_f32 v113, v222, v223
v_mfma_f32_16x16x32_bf16 v[228:231], a[32:35], a[224:227], v[228:231]
v_cvt_pk_bf16_f32 v116, v224, v225
v_cvt_pk_bf16_f32 v117, v226, v227
v_mfma_f32_16x16x32_bf16 v[228:231], a[36:39], a[228:231], v[228:231]
s_waitcnt lgkmcnt(0)
s_barrier
ds_read_b64 v[76:77], v8 offset:12288
v_mfma_f32_16x16x32_bf16 v[228:231], a[40:43], a[232:235], v[228:231]
ds_read_b64 v[78:79], v9 offset:12288
ds_read_b64 v[84:85], v10 offset:12288
v_mfma_f32_16x16x32_bf16 v[228:231], a[44:47], a[236:239], v[228:231]
ds_read_b64 v[86:87], v11 offset:12288
ds_read_b64 v[28:29], v8 offset:0
v_mfma_f32_16x16x32_bf16 v[232:235], a[48:51], a[216:219], 0
s_nop 0
ds_read_b64 v[30:31], v9 offset:0
ds_read_b64 v[36:37], v10 offset:0
v_mfma_f32_16x16x32_bf16 v[232:235], a[52:55], a[220:223], v[232:235]
s_nop 0
ds_read_b64 v[38:39], v11 offset:0
v_cvt_pk_bf16_f32 v118, v228, v229
v_mfma_f32_16x16x32_bf16 v[232:235], a[56:59], a[224:227], v[232:235]
v_cvt_pk_bf16_f32 v119, v230, v231
ds_read_b64 v[44:45], v8 offset:4096
v_mfma_f32_16x16x32_bf16 v[232:235], a[60:63], a[228:231], v[232:235]
ds_read_b64 v[46:47], v9 offset:4096
ds_read_b64 v[52:53], v10 offset:4096
v_mfma_f32_16x16x32_bf16 v[232:235], a[64:67], a[232:235], v[232:235]
ds_read_b64 v[54:55], v11 offset:4096
ds_read_b64 v[60:61], v8 offset:8192
v_mfma_f32_16x16x32_bf16 v[232:235], a[68:71], a[236:239], v[232:235]
s_waitcnt lgkmcnt(11)
ds_read_b64 v[62:63], v9 offset:8192
ds_read_b64 v[68:69], v10 offset:8192
ds_read_b64 v[70:71], v11 offset:8192
s_nop 0
s_nop 0
s_nop 0
s_nop 0
v_mfma_f32_16x16x32_bf16 v[188:191], v[76:79], v[92:95], 0
s_waitcnt lgkmcnt(12)
v_cvt_pk_bf16_f32 v120, v232, v233
v_cvt_pk_bf16_f32 v121, v234, v235
v_mfma_f32_16x16x32_bf16 v[188:191], v[84:87], v[96:99], v[188:191]
v_mfma_f32_16x16x32_bf16 v[192:195], v[76:79], v[100:103], 0
v_mfma_f32_16x16x32_bf16 v[192:195], v[84:87], v[104:107], v[192:195]
v_mfma_f32_16x16x32_bf16 v[196:199], v[76:79], v[108:111], 0
s_nop 0
s_nop 0
s_nop 0
v_mfma_f32_16x16x32_bf16 v[196:199], v[84:87], v[112:115], v[196:199]
s_nop 0
s_nop 0
s_nop 0
v_mfma_f32_16x16x32_bf16 v[200:203], v[76:79], v[116:119], 0
v_cvt_pk_bf16_f32 v124, v189, v193
v_mfma_f32_16x16x32_bf16 v[200:203], v[84:87], v[120:123], v[200:203]
s_waitcnt lgkmcnt(10)
v_mfma_f32_16x16x32_bf16 v[204:207], v[28:31], v[92:95], 0
s_waitcnt lgkmcnt(8)
s_nop 0
s_nop 0
v_mfma_f32_16x16x32_bf16 v[204:207], v[36:39], v[96:99], v[204:207]
s_nop 0
s_nop 0
s_nop 0
v_mfma_f32_16x16x32_bf16 v[208:211], v[28:31], v[100:103], 0
v_cvt_pk_bf16_f32 v125, v197, v201
v_mfma_f32_16x16x32_bf16 v[208:211], v[36:39], v[104:107], v[208:211]
v_mfma_f32_16x16x32_bf16 v[212:215], v[28:31], v[108:111], 0
s_nop 0
s_nop 0
s_nop 0
v_mfma_f32_16x16x32_bf16 v[212:215], v[36:39], v[112:115], v[212:215]
s_nop 0
s_nop 0
s_nop 0
v_mfma_f32_16x16x32_bf16 v[216:219], v[28:31], v[116:119], 0
v_cvt_pk_bf16_f32 v126, v204, v208
v_cvt_pk_bf16_f32 v128, v205, v209
v_mfma_f32_16x16x32_bf16 v[216:219], v[36:39], v[120:123], v[216:219]
s_waitcnt lgkmcnt(6)
v_cvt_pk_bf16_f32 v130, v206, v210
v_cvt_pk_bf16_f32 v132, v207, v211
v_mfma_f32_16x16x32_bf16 v[188:191], v[44:47], v[92:95], 0
s_waitcnt lgkmcnt(4)
s_nop 0
s_nop 0
v_mfma_f32_16x16x32_bf16 v[188:191], v[52:55], v[96:99], v[188:191]
s_nop 0
v_cvt_pk_bf16_f32 v127, v212, v216
v_cvt_pk_bf16_f32 v129, v213, v217
v_mfma_f32_16x16x32_bf16 v[192:195], v[44:47], v[100:103], 0
v_cvt_pk_bf16_f32 v131, v214, v218
v_cvt_pk_bf16_f32 v133, v215, v219
v_mfma_f32_16x16x32_bf16 v[192:195], v[52:55], v[104:107], v[192:195]
buffer_store_dwordx2 v[124:125], v20, s[12:15], s28 offen offset:0 sc1
v_mfma_f32_16x16x32_bf16 v[196:199], v[44:47], v[108:111], 0
buffer_store_dwordx2 v[126:127], v14, s[12:15], s28 offen offset:0 sc1
s_nop 0
v_mfma_f32_16x16x32_bf16 v[196:199], v[52:55], v[112:115], v[196:199]
s_nop 0
buffer_store_dwordx2 v[128:129], v14, s[12:15], s28 offen offset:384 sc1
buffer_store_dwordx2 v[130:131], v14, s[12:15], s28 offen offset:768 sc1
v_mfma_f32_16x16x32_bf16 v[200:203], v[44:47], v[116:119], 0
v_cvt_pk_bf16_f32 v134, v188, v192
v_cvt_pk_bf16_f32 v136, v189, v193
v_mfma_f32_16x16x32_bf16 v[200:203], v[52:55], v[120:123], v[200:203]
s_waitcnt lgkmcnt(2)
v_cvt_pk_bf16_f32 v138, v190, v194
v_cvt_pk_bf16_f32 v140, v191, v195
v_mfma_f32_16x16x32_bf16 v[204:207], v[60:63], v[92:95], 0
s_waitcnt lgkmcnt(0)
buffer_store_dwordx2 v[132:133], v14, s[12:15], s28 offen offset:1152 sc1
s_nop 0
v_mfma_f32_16x16x32_bf16 v[204:207], v[68:71], v[96:99], v[204:207]
s_nop 0
v_cvt_pk_bf16_f32 v135, v196, v200
v_cvt_pk_bf16_f32 v137, v197, v201
v_mfma_f32_16x16x32_bf16 v[208:211], v[60:63], v[100:103], 0
v_cvt_pk_bf16_f32 v139, v198, v202
v_cvt_pk_bf16_f32 v141, v199, v203
v_mfma_f32_16x16x32_bf16 v[208:211], v[68:71], v[104:107], v[208:211]
buffer_store_dwordx2 v[134:135], v15, s[12:15], s28 offen offset:0 sc1
buffer_store_dwordx2 v[136:137], v15, s[12:15], s29 offen offset:0 sc1
v_mfma_f32_16x16x32_bf16 v[212:215], v[60:63], v[108:111], 0
s_nop 0
buffer_store_dwordx2 v[138:139], v15, s[12:15], s30 offen offset:0 sc1
buffer_store_dwordx2 v[140:141], v15, s[12:15], s31 offen offset:0 sc1
v_mfma_f32_16x16x32_bf16 v[212:215], v[68:71], v[112:115], v[212:215]
s_nop 0
v_cvt_pk_bf16_f32 v142, v204, v208
v_cvt_pk_bf16_f32 v144, v205, v209
v_mfma_f32_16x16x32_bf16 v[216:219], v[60:63], v[116:119], 0
v_cvt_pk_bf16_f32 v146, v206, v210
v_cvt_pk_bf16_f32 v148, v207, v211
v_mfma_f32_16x16x32_bf16 v[216:219], v[68:71], v[120:123], v[216:219]
s_nop 0
s_nop 0
s_nop 0
s_nop 0
s_nop 0
s_nop 0
s_nop 0
s_nop 0
v_cvt_pk_bf16_f32 v143, v212, v216
v_cvt_pk_bf16_f32 v145, v213, v217
v_cvt_pk_bf16_f32 v147, v214, v218
v_cvt_pk_bf16_f32 v149, v215, v219
buffer_store_dwordx2 v[142:143], v16, s[12:15], s28 offen offset:0 sc1
buffer_store_dwordx2 v[144:145], v16, s[12:15], s28 offen offset:384 sc1
buffer_store_dwordx2 v[146:147], v16, s[12:15], s29 offen offset:0 sc1
buffer_store_dwordx2 v[148:149], v16, s[12:15], s29 offen offset:384 sc1
s_endpgm
L_x4:
s_bitcmp1_b32 s2, 3
s_cbranch_scc1 L_rot
L_disp:
LW_p13:
s_cbranch_execz LW_p24
s_waitcnt lgkmcnt(15)
v_mfma_f32_16x16x32_bf16 v[224:227], a[192:195], a[72:75], 0
buffer_store_dwordx2 v[92:93], v14, s[12:15], s44 offen offset:256 sc1
v_cvt_pk_bf16_f32 v108, v204, v208
v_mfma_f32_16x16x32_bf16 v[224:227], a[196:199], a[76:79], v[224:227]
s_add_u32 s29, s28, 196224
v_cvt_pk_bf16_f32 v109, v212, v216
v_cvt_pk_bf16_f32 v110, v205, v209
v_mfma_f32_16x16x32_bf16 v[224:227], a[200:203], a[80:83], v[224:227]
s_add_u32 s30, s28, 392448
v_cvt_pk_bf16_f32 v111, v213, v217
v_cvt_pk_bf16_f32 v72, v206, v210
v_mfma_f32_16x16x32_bf16 v[224:227], a[204:207], a[84:87], v[224:227]
s_add_u32 s31, s28, 588672
v_cvt_pk_bf16_f32 v73, v214, v218
v_cvt_pk_bf16_f32 v116, v207, v211
v_mfma_f32_16x16x32_bf16 v[224:227], a[208:211], a[88:91], v[224:227]
v_cvt_pk_bf16_f32 v117, v215, v219
v_mfma_f32_16x16x32_bf16 v[224:227], a[212:215], a[92:95], v[224:227]
ds_write_b64 v22, v[24:25] offset:384
v_mfma_f32_16x16x32_bf16 v[228:231], a[192:195], a[96:99], 0
ds_write_b64 v22, v[24:25] offset:392
v_mfma_f32_16x16x32_bf16 v[228:231], a[196:199], a[100:103], v[228:231]
v_mfma_f32_16x16x32_bf16 v[228:231], a[200:203], a[104:107], v[228:231]
v_mfma_f32_16x16x32_bf16 v[228:231], a[204:207], a[108:111], v[228:231]
s_waitcnt lgkmcnt(9)
v_mfma_f32_16x16x32_bf16 v[228:231], a[208:211], a[112:115], v[228:231]
buffer_store_dwordx2 v[140:141], v14, s[12:15], s44 offen offset:640 sc1
s_waitcnt lgkmcnt(8)
v_cvt_pk_bf16_f32 v60, v224, v225
v_mfma_f32_16x16x32_bf16 v[228:231], a[212:215], a[116:119], v[228:231]
v_cvt_pk_bf16_f32 v61, v226, v227
v_mfma_f32_16x16x32_bf16 v[232:235], a[192:195], a[120:123], 0
ds_read_b128 a[192:195], v1 offset:12288
v_mfma_f32_16x16x32_bf16 v[232:235], a[196:199], a[124:127], v[232:235]
ds_read_b128 a[196:199], v1 offset:13312
v_mfma_f32_16x16x32_bf16 v[232:235], a[200:203], a[128:131], v[232:235]
ds_read_b128 a[200:203], v1 offset:14336
v_mfma_f32_16x16x32_bf16 v[232:235], a[204:207], a[132:135], v[232:235]
s_waitcnt lgkmcnt(6)
ds_read_b128 a[204:207], v1 offset:15360
v_cvt_pk_bf16_f32 v92, v228, v229
v_mfma_f32_16x16x32_bf16 v[232:235], a[208:211], a[136:139], v[232:235]
s_waitcnt lgkmcnt(6)
v_cvt_pk_bf16_f32 v93, v230, v231
v_mfma_f32_16x16x32_bf16 v[232:235], a[212:215], a[140:143], v[232:235]
ds_read_b128 a[208:211], v1 offset:16384
ds_read_b128 a[212:215], v1 offset:17408
v_mfma_f32_16x16x32_bf16 v[220:223], a[216:219], a[72:75], 0
v_mfma_f32_16x16x32_bf16 v[220:223], a[220:223], a[76:79], v[220:223]
v_mfma_f32_16x16x32_bf16 v[220:223], a[224:227], a[80:83], v[220:223]
buffer_store_dwordx2 v[94:95], v14, s[12:15], s44 offen offset:1024 sc1
v_mfma_f32_16x16x32_bf16 v[220:223], a[228:231], a[84:87], v[220:223]
v_mfma_f32_16x16x32_bf16 v[220:223], a[232:235], a[88:91], v[220:223]
v_cvt_pk_bf16_f32 v140, v232, v233
v_cvt_pk_bf16_f32 v141, v234, v235
v_mfma_f32_16x16x32_bf16 v[220:223], a[236:239], a[92:95], v[220:223]
v_mfma_f32_16x16x32_bf16 v[224:227], a[216:219], a[96:99], 0
v_mfma_f32_16x16x32_bf16 v[224:227], a[220:223], a[100:103], v[224:227]
v_mfma_f32_16x16x32_bf16 v[224:227], a[224:227], a[104:107], v[224:227]
v_mfma_f32_16x16x32_bf16 v[224:227], a[228:231], a[108:111], v[224:227]
v_mfma_f32_16x16x32_bf16 v[224:227], a[232:235], a[112:115], v[224:227]
v_mfma_f32_16x16x32_bf16 v[224:227], a[236:239], a[116:119], v[224:227]
v_mfma_f32_16x16x32_bf16 v[228:231], a[216:219], a[120:123], 0
buffer_store_dwordx2 v[142:143], v14, s[12:15], s44 offen offset:1408 sc1
v_cvt_pk_bf16_f32 v62, v220, v221
v_mfma_f32_16x16x32_bf16 v[228:231], a[220:223], a[124:127], v[228:231]
v_cvt_pk_bf16_f32 v63, v222, v223
v_mfma_f32_16x16x32_bf16 v[228:231], a[224:227], a[128:131], v[228:231]
ds_read_b128 a[216:219], v1 offset:18432
ds_read_b128 a[220:223], v1 offset:19456
v_mfma_f32_16x16x32_bf16 v[228:231], a[228:231], a[132:135], v[228:231]
ds_read_b128 a[224:227], v1 offset:20480
ds_read_b128 a[228:231], v1 offset:21504
v_mfma_f32_16x16x32_bf16 v[228:231], a[232:235], a[136:139], v[228:231]
v_cvt_pk_bf16_f32 v94, v224, v225
v_cvt_pk_bf16_f32 v95, v226, v227
v_mfma_f32_16x16x32_bf16 v[228:231], a[236:239], a[140:143], v[228:231]
s_waitcnt lgkmcnt(9)
ds_read_b128 a[232:235], v1 offset:22528
ds_read_b128 a[236:239], v1 offset:23552
v_mfma_f32_16x16x32_bf16 v[232:235], a[192:195], a[72:75], 0
s_waitcnt lgkmcnt(10)
v_mfma_f32_16x16x32_bf16 v[232:235], a[196:199], a[76:79], v[232:235]
s_waitcnt lgkmcnt(9)
v_mfma_f32_16x16x32_bf16 v[232:235], a[200:203], a[80:83], v[232:235]
s_waitcnt lgkmcnt(8)
v_mfma_f32_16x16x32_bf16 v[232:235], a[204:207], a[84:87], v[232:235]
s_waitcnt lgkmcnt(7)
v_mfma_f32_16x16x32_bf16 v[232:235], a[208:211], a[88:91], v[232:235]
buffer_store_dwordx2 v[100:101], v15, s[12:15], s44 offen offset:256 sc1
s_waitcnt lgkmcnt(6)
v_cvt_pk_bf16_f32 v142, v228, v229
v_mfma_f32_16x16x32_bf16 v[232:235], a[212:215], a[92:95], v[232:235]
v_cvt_pk_bf16_f32 v143, v230, v231
v_mfma_f32_16x16x32_bf16 v[220:223], a[192:195], a[96:99], 0
v_mfma_f32_16x16x32_bf16 v[220:223], a[196:199], a[100:103], v[220:223]
v_mfma_f32_16x16x32_bf16 v[220:223], a[200:203], a[104:107], v[220:223]
v_mfma_f32_16x16x32_bf16 v[220:223], a[204:207], a[108:111], v[220:223]
v_mfma_f32_16x16x32_bf16 v[220:223], a[208:211], a[112:115], v[220:223]
v_mfma_f32_16x16x32_bf16 v[220:223], a[212:215], a[116:119], v[220:223]
v_mfma_f32_16x16x32_bf16 v[224:227], a[192:195], a[120:123], 0
v_cvt_pk_bf16_f32 v64, v232, v233
v_cvt_pk_bf16_f32 v65, v234, v235
v_mfma_f32_16x16x32_bf16 v[224:227], a[196:199], a[124:127], v[224:227]
ds_read_b128 a[192:195], v1 offset:24576
ds_read_b128 a[196:199], v1 offset:25600
v_mfma_f32_16x16x32_bf16 v[224:227], a[200:203], a[128:131], v[224:227]
buffer_store_dwordx2 v[148:149], v15, s[12:15], s45 offen offset:256 sc1
v_cvt_pk_bf16_f32 v100, v220, v221
v_mfma_f32_16x16x32_bf16 v[224:227], a[204:207], a[132:135], v[224:227]
v_cvt_pk_bf16_f32 v101, v222, v223
v_mfma_f32_16x16x32_bf16 v[224:227], a[208:211], a[136:139], v[224:227]
ds_read_b128 a[200:203], v1 offset:26624
ds_read_b128 a[204:207], v1 offset:27648
v_mfma_f32_16x16x32_bf16 v[224:227], a[212:215], a[140:143], v[224:227]
s_waitcnt lgkmcnt(9)
ds_read_b128 a[208:211], v1 offset:28672
ds_read_b128 a[212:215], v1 offset:29696
v_mfma_f32_16x16x32_bf16 v[228:231], a[216:219], a[72:75], 0
s_waitcnt lgkmcnt(10)
v_mfma_f32_16x16x32_bf16 v[228:231], a[220:223], a[76:79], v[228:231]
s_waitcnt lgkmcnt(9)
v_mfma_f32_16x16x32_bf16 v[228:231], a[224:227], a[80:83], v[228:231]
s_waitcnt lgkmcnt(8)
v_mfma_f32_16x16x32_bf16 v[228:231], a[228:231], a[84:87], v[228:231]
s_waitcnt lgkmcnt(7)
v_mfma_f32_16x16x32_bf16 v[228:231], a[232:235], a[88:91], v[228:231]
s_waitcnt lgkmcnt(6)
v_mfma_f32_16x16x32_bf16 v[228:231], a[236:239], a[92:95], v[228:231]
v_cvt_pk_bf16_f32 v148, v224, v225
v_cvt_pk_bf16_f32 v149, v226, v227
v_mfma_f32_16x16x32_bf16 v[232:235], a[216:219], a[96:99], 0
buffer_store_dwordx2 v[102:103], v15, s[12:15], s46 offen offset:256 sc1
v_mfma_f32_16x16x32_bf16 v[232:235], a[220:223], a[100:103], v[232:235]
v_mov_b64 v[76:77], 0
v_mfma_f32_16x16x32_bf16 v[232:235], a[224:227], a[104:107], v[232:235]
v_mov_b64 v[78:79], v[26:27]
v_mfma_f32_16x16x32_bf16 v[232:235], a[228:231], a[108:111], v[232:235]
v_mov_b64 v[80:81], 0
v_mfma_f32_16x16x32_bf16 v[232:235], a[232:235], a[112:115], v[232:235]
v_mov_b64 v[82:83], v[26:27]
v_mfma_f32_16x16x32_bf16 v[232:235], a[236:239], a[116:119], v[232:235]
v_mov_b64 v[84:85], 0
v_mfma_f32_16x16x32_bf16 v[220:223], a[216:219], a[120:123], 0
v_mov_b64 v[86:87], v[26:27]
v_mfma_f32_16x16x32_bf16 v[220:223], a[220:223], a[124:127], v[220:223]
v_cvt_pk_bf16_f32 v66, v228, v229
v_cvt_pk_bf16_f32 v67, v230, v231
v_mfma_f32_16x16x32_bf16 v[220:223], a[224:227], a[128:131], v[220:223]
ds_read_b128 a[216:219], v1 offset:30720
ds_read_b128 a[220:223], v1 offset:31744
v_mfma_f32_16x16x32_bf16 v[220:223], a[228:231], a[132:135], v[220:223]
ds_read_b128 a[224:227], v1 offset:32768
ds_read_b128 a[228:231], v1 offset:33792
v_mfma_f32_16x16x32_bf16 v[220:223], a[232:235], a[136:139], v[220:223]
buffer_store_dwordx2 v[150:151], v15, s[12:15], s47 offen offset:256 sc1
v_cvt_pk_bf16_f32 v102, v232, v233
v_mfma_f32_16x16x32_bf16 v[220:223], a[236:239], a[140:143], v[220:223]
v_cvt_pk_bf16_f32 v103, v234, v235
v_smfmac_f32_16x16x64_bf16 v[76:79], a[168:171], a[72:79], v0
ds_read_b128 a[232:235], v1 offset:34816
v_smfmac_f32_16x16x64_bf16 v[76:79], a[172:175], a[80:87], v0
ds_read_b128 a[236:239], v1 offset:35840
v_smfmac_f32_16x16x64_bf16 v[76:79], a[176:179], a[88:95], v0
v_smfmac_f32_16x16x64_bf16 v[80:83], a[168:171], a[96:103], v0
v_smfmac_f32_16x16x64_bf16 v[80:83], a[172:175], a[104:111], v0
v_cvt_pk_bf16_f32 v150, v220, v221
v_smfmac_f32_16x16x64_bf16 v[80:83], a[176:179], a[112:119], v0
v_cvt_pk_bf16_f32 v151, v222, v223
v_smfmac_f32_16x16x64_bf16 v[84:87], a[168:171], a[120:127], v0
v_smfmac_f32_16x16x64_bf16 v[84:87], a[172:175], a[128:135], v0
v_smfmac_f32_16x16x64_bf16 v[84:87], a[176:179], a[136:143], v0
s_waitcnt lgkmcnt(11)
v_add_f32 v78, v78, v79
v_mfma_f32_16x16x32_bf16 v[224:227], a[192:195], a[72:75], 0
buffer_store_dwordx2 v[108:109], v16, s[12:15], s44 offen offset:256 sc1
s_waitcnt lgkmcnt(10)
v_add_f32 v76, v76, v77
v_mfma_f32_16x16x32_bf16 v[224:227], a[196:199], a[76:79], v[224:227]
s_waitcnt lgkmcnt(9)
v_add_f32 v80, v80, v81
v_max3_f32 v88, v18, v76, v80
v_mfma_f32_16x16x32_bf16 v[224:227], a[200:203], a[80:83], v[224:227]
s_waitcnt lgkmcnt(8)
v_add_f32 v84, v84, v85
v_max_f32 v88, v88, v84
v_mfma_f32_16x16x32_bf16 v[224:227], a[204:207], a[84:87], v[224:227]
s_waitcnt lgkmcnt(7)
v_add_f32 v82, v82, v83
v_max_f32_dpp v88, v88, v88 row_ror:8 row_mask:0xf bank_mask:0xf
v_mfma_f32_16x16x32_bf16 v[224:227], a[208:211], a[88:91], v[224:227]
s_waitcnt lgkmcnt(6)
v_add_f32 v86, v86, v87
v_max_f32_dpp v88, v88, v88 row_ror:4 row_mask:0xf bank_mask:0xf
v_mfma_f32_16x16x32_bf16 v[224:227], a[212:215], a[92:95], v[224:227]
v_mfma_f32_16x16x32_bf16 v[228:231], a[192:195], a[96:99], 0
v_max_f32_dpp v88, v88, v88 row_ror:2 row_mask:0xf bank_mask:0xf
v_mfma_f32_16x16x32_bf16 v[228:231], a[196:199], a[100:103], v[228:231]
v_mfma_f32_16x16x32_bf16 v[228:231], a[200:203], a[104:107], v[228:231]
v_max_f32_dpp v88, v88, v88 row_ror:1 row_mask:0xf bank_mask:0xf
v_sub_f32 v89, v18, v88
v_mfma_f32_16x16x32_bf16 v[228:231], a[204:207], a[108:111], v[228:231]
buffer_store_dwordx2 v[110:111], v16, s[12:15], s44 offen offset:640 sc1
v_cvt_pk_bf16_f32 v68, v224, v225
v_mfma_f32_16x16x32_bf16 v[228:231], a[208:211], a[112:115], v[228:231]
v_cvt_pk_bf16_f32 v69, v226, v227
v_sub_f32 v76, v76, v88
v_mfma_f32_16x16x32_bf16 v[228:231], a[212:215], a[116:119], v[228:231]
v_sub_f32 v80, v80, v88
v_sub_f32 v84, v84, v88
v_mfma_f32_16x16x32_bf16 v[232:235], a[192:195], a[120:123], 0
ds_read_b128 a[192:195], v1 offset:36864
v_mfma_f32_16x16x32_bf16 v[232:235], a[196:199], a[124:127], v[232:235]
ds_read_b128 a[196:199], v1 offset:37888
v_mfma_f32_16x16x32_bf16 v[232:235], a[200:203], a[128:131], v[232:235]
ds_read_b128 a[200:203], v1 offset:38912
v_cvt_pk_bf16_f32 v108, v228, v229
v_mfma_f32_16x16x32_bf16 v[232:235], a[204:207], a[132:135], v[232:235]
ds_read_b128 a[204:207], v1 offset:39936
v_cvt_pk_bf16_f32 v109, v230, v231
v_mfma_f32_16x16x32_bf16 v[232:235], a[208:211], a[136:139], v[232:235]
ds_read_b128 a[208:211], v1 offset:40960
v_mfma_f32_16x16x32_bf16 v[232:235], a[212:215], a[140:143], v[232:235]
s_waitcnt lgkmcnt(10)
ds_read_b128 a[212:215], v1 offset:41984
v_mfma_f32_16x16x32_bf16 v[220:223], a[216:219], a[72:75], 0
s_waitcnt lgkmcnt(10)
v_exp_f32 v76, v76
v_mfma_f32_16x16x32_bf16 v[220:223], a[220:223], a[76:79], v[220:223]
buffer_store_dwordx2 v[72:73], v16, s[12:15], s45 offen offset:256 sc1
s_waitcnt lgkmcnt(9)
v_mfma_f32_16x16x32_bf16 v[220:223], a[224:227], a[80:83], v[220:223]
s_waitcnt lgkmcnt(8)
v_exp_f32 v80, v80
v_mfma_f32_16x16x32_bf16 v[220:223], a[228:231], a[84:87], v[220:223]
s_waitcnt lgkmcnt(7)
v_cvt_pk_bf16_f32 v156, v232, v233
v_cvt_pk_bf16_f32 v157, v234, v235
v_mfma_f32_16x16x32_bf16 v[220:223], a[232:235], a[88:91], v[220:223]
s_waitcnt lgkmcnt(6)
v_exp_f32 v84, v84
v_mfma_f32_16x16x32_bf16 v[220:223], a[236:239], a[92:95], v[220:223]
v_exp_f32 v89, v89
v_mfma_f32_16x16x32_bf16 v[224:227], a[216:219], a[96:99], 0
v_add_f32 v88, v76, v80
v_add_f32 v90, v84, v89
v_mfma_f32_16x16x32_bf16 v[224:227], a[220:223], a[100:103], v[224:227]
v_add_f32 v88, v88, v90
v_mfma_f32_16x16x32_bf16 v[224:227], a[224:227], a[104:107], v[224:227]
v_mfma_f32_16x16x32_bf16 v[224:227], a[228:231], a[108:111], v[224:227]
v_cvt_pk_bf16_f32 v70, v220, v221
v_cvt_pk_bf16_f32 v71, v222, v223
v_mfma_f32_16x16x32_bf16 v[224:227], a[232:235], a[112:115], v[224:227]
v_add_f32_dpp v88, v88, v88 row_ror:8 row_mask:0xf bank_mask:0xf
v_mfma_f32_16x16x32_bf16 v[224:227], a[236:239], a[116:119], v[224:227]
buffer_store_dwordx2 v[116:117], v16, s[12:15], s45 offen offset:640 sc1
v_add_f32_dpp v88, v88, v88 row_ror:4 row_mask:0xf bank_mask:0xf
v_mfma_f32_16x16x32_bf16 v[228:231], a[216:219], a[120:123], 0
ds_read_b128 a[216:219], v1 offset:43008
v_add_f32_dpp v88, v88, v88 row_ror:2 row_mask:0xf bank_mask:0xf
v_mfma_f32_16x16x32_bf16 v[228:231], a[220:223], a[124:127], v[228:231]
ds_read_b128 a[220:223], v1 offset:44032
v_add_f32_dpp v88, v88, v88 row_ror:1 row_mask:0xf bank_mask:0xf
v_mfma_f32_16x16x32_bf16 v[228:231], a[224:227], a[128:131], v[228:231]
ds_read_b128 a[224:227], v1 offset:45056
v_cvt_pk_bf16_f32 v110, v224, v225
v_mfma_f32_16x16x32_bf16 v[228:231], a[228:231], a[132:135], v[228:231]
ds_read_b128 a[228:231], v1 offset:46080
v_cvt_pk_bf16_f32 v111, v226, v227
v_mfma_f32_16x16x32_bf16 v[228:231], a[232:235], a[136:139], v[228:231]
ds_read_b128 a[232:235], v1 offset:47104
v_mfma_f32_16x16x32_bf16 v[228:231], a[236:239], a[140:143], v[228:231]
s_waitcnt lgkmcnt(10)
ds_read_b128 a[236:239], v1 offset:48128
v_mfma_f32_16x16x32_bf16 v[232:235], a[192:195], a[72:75], 0
s_waitcnt lgkmcnt(10)
v_rcp_f32 v88, v88
v_mfma_f32_16x16x32_bf16 v[232:235], a[196:199], a[76:79], v[232:235]
s_waitcnt lgkmcnt(9)
v_mul_f32 v76, v76, v88
v_mul_f32 v80, v80, v88
v_mfma_f32_16x16x32_bf16 v[232:235], a[200:203], a[80:83], v[232:235]
LW_p14:
s_cbranch_execz LW_p11
s_waitcnt lgkmcnt(8)
v_mul_f32 v84, v84, v88
v_cvt_pk_bf16_f32 v158, v228, v229
v_mfma_f32_16x16x32_bf16 v[232:235], a[204:207], a[84:87], v[232:235]
s_waitcnt lgkmcnt(7)
v_cvt_pk_bf16_f32 v159, v230, v231
v_mul_f32 v89, v89, v88
v_mfma_f32_16x16x32_bf16 v[232:235], a[208:211], a[88:91], v[232:235]
s_waitcnt lgkmcnt(6)
v_cvt_pk_bf16_f32 v90, v76, v80
v_cvt_pk_bf16_f32 v91, v84, v89
v_mfma_f32_16x16x32_bf16 v[232:235], a[212:215], a[92:95], v[232:235]
ds_write_b16 v20, v90 offset:0
v_mfma_f32_16x16x32_bf16 v[220:223], a[192:195], a[96:99], 0
ds_write_b16_d16_hi v20, v90 offset:4
v_mfma_f32_16x16x32_bf16 v[220:223], a[196:199], a[100:103], v[220:223]
ds_write_b16 v20, v91 offset:32
v_mfma_f32_16x16x32_bf16 v[220:223], a[200:203], a[104:107], v[220:223]
ds_write_b16_d16_hi v20, v91 offset:36
v_mfma_f32_16x16x32_bf16 v[220:223], a[204:207], a[108:111], v[220:223]
v_cvt_pk_bf16_f32 v72, v232, v233
v_cvt_pk_bf16_f32 v73, v234, v235
v_mfma_f32_16x16x32_bf16 v[220:223], a[208:211], a[112:115], v[220:223]
ds_read_b128 a[240:243], v22 offset:0
ds_read_b128 a[244:247], v22 offset:128
v_mfma_f32_16x16x32_bf16 v[220:223], a[212:215], a[116:119], v[220:223]
ds_read_b128 a[248:251], v22 offset:256
ds_read_b128 a[252:255], v22 offset:384
v_mfma_f32_16x16x32_bf16 v[224:227], a[192:195], a[120:123], 0
ds_read_b128 a[192:195], v1 offset:49152
v_mfma_f32_16x16x32_bf16 v[224:227], a[196:199], a[124:127], v[224:227]
ds_read_b128 a[196:199], v1 offset:50176
v_mfma_f32_16x16x32_bf16 v[224:227], a[200:203], a[128:131], v[224:227]
ds_read_b128 a[200:203], v1 offset:51200
v_cvt_pk_bf16_f32 v116, v220, v221
v_mfma_f32_16x16x32_bf16 v[224:227], a[204:207], a[132:135], v[224:227]
ds_read_b128 a[204:207], v1 offset:52224
v_cvt_pk_bf16_f32 v117, v222, v223
v_mfma_f32_16x16x32_bf16 v[224:227], a[208:211], a[136:139], v[224:227]
ds_read_b128 a[208:211], v1 offset:53248
v_mfma_f32_16x16x32_bf16 v[224:227], a[212:215], a[140:143], v[224:227]
s_waitcnt lgkmcnt(15)
ds_read_b128 a[212:215], v1 offset:54272
v_mfma_f32_16x16x32_bf16 v[228:231], a[216:219], a[72:75], 0
v_mfma_f32_16x16x32_bf16 v[228:231], a[220:223], a[76:79], v[228:231]
v_mfma_f32_16x16x32_bf16 v[228:231], a[224:227], a[80:83], v[228:231]
v_mfma_f32_16x16x32_bf16 v[228:231], a[228:231], a[84:87], v[228:231]
s_waitcnt lgkmcnt(15)
v_mfma_f32_16x16x32_bf16 v[228:231], a[232:235], a[88:91], v[228:231]
s_waitcnt lgkmcnt(14)
v_mfma_f32_16x16x32_bf16 v[228:231], a[236:239], a[92:95], v[228:231]
v_mfma_f32_16x16x32_bf16 v[232:235], a[216:219], a[96:99], 0
v_cvt_pk_bf16_f32 v164, v224, v225
v_cvt_pk_bf16_f32 v165, v226, v227
v_mfma_f32_16x16x32_bf16 v[232:235], a[220:223], a[100:103], v[232:235]
v_mfma_f32_16x16x32_bf16 v[232:235], a[224:227], a[104:107], v[232:235]
v_mfma_f32_16x16x32_bf16 v[232:235], a[228:231], a[108:111], v[232:235]
v_mfma_f32_16x16x32_bf16 v[232:235], a[232:235], a[112:115], v[232:235]
v_mfma_f32_16x16x32_bf16 v[232:235], a[236:239], a[116:119], v[232:235]
v_cvt_pk_bf16_f32 v74, v228, v229
v_cvt_pk_bf16_f32 v75, v230, v231
v_mfma_f32_16x16x32_bf16 v[220:223], a[216:219], a[120:123], 0
ds_read_b128 a[216:219], v1 offset:55296
v_mfma_f32_16x16x32_bf16 v[220:223], a[220:223], a[124:127], v[220:223]
ds_read_b128 a[220:223], v1 offset:56320
v_mfma_f32_16x16x32_bf16 v[220:223], a[224:227], a[128:131], v[220:223]
ds_read_b128 a[224:227], v1 offset:57344
v_cvt_pk_bf16_f32 v118, v232, v233
v_mfma_f32_16x16x32_bf16 v[220:223], a[228:231], a[132:135], v[220:223]
ds_read_b128 a[228:231], v1 offset:58368
v_cvt_pk_bf16_f32 v119, v234, v235
v_mfma_f32_16x16x32_bf16 v[220:223], a[232:235], a[136:139], v[220:223]
ds_read_b128 a[232:235], v1 offset:59392
v_mfma_f32_16x16x32_bf16 v[220:223], a[236:239], a[140:143], v[220:223]
s_waitcnt lgkmcnt(10)
ds_read_b128 a[236:239], v1 offset:60416
v_mfma_f32_16x16x32_bf16 v[224:227], a[192:195], a[72:75], 0
s_waitcnt lgkmcnt(10)
v_mfma_f32_16x16x32_bf16 v[224:227], a[196:199], a[76:79], v[224:227]
s_waitcnt lgkmcnt(9)
v_mfma_f32_16x16x32_bf16 v[224:227], a[200:203], a[80:83], v[224:227]
s_waitcnt lgkmcnt(8)
v_mfma_f32_16x16x32_bf16 v[224:227], a[204:207], a[84:87], v[224:227]
s_waitcnt lgkmcnt(7)
v_mfma_f32_16x16x32_bf16 v[224:227], a[208:211], a[88:91], v[224:227]
s_waitcnt lgkmcnt(6)
v_mfma_f32_16x16x32_bf16 v[224:227], a[212:215], a[92:95], v[224:227]
v_mfma_f32_16x16x32_bf16 v[228:231], a[192:195], a[96:99], 0
v_cvt_pk_bf16_f32 v166, v220, v221
v_cvt_pk_bf16_f32 v167, v222, v223
v_mfma_f32_16x16x32_bf16 v[228:231], a[196:199], a[100:103], v[228:231]
v_mfma_f32_16x16x32_bf16 v[228:231], a[200:203], a[104:107], v[228:231]
v_mfma_f32_16x16x32_bf16 v[228:231], a[204:207], a[108:111], v[228:231]
v_mfma_f32_16x16x32_bf16 v[228:231], a[208:211], a[112:115], v[228:231]
v_mfma_f32_16x16x32_bf16 v[228:231], a[212:215], a[116:119], v[228:231]
v_cvt_pk_bf16_f32 v236, v224, v225
v_cvt_pk_bf16_f32 v237, v226, v227
v_mfma_f32_16x16x32_bf16 v[232:235], a[192:195], a[120:123], 0
ds_read_b128 a[192:195], v1 offset:61440
v_mfma_f32_16x16x32_bf16 v[232:235], a[196:199], a[124:127], v[232:235]
ds_read_b128 a[196:199], v1 offset:62464
v_mfma_f32_16x16x32_bf16 v[232:235], a[200:203], a[128:131], v[232:235]
ds_read_b128 a[200:203], v1 offset:63488
v_cvt_pk_bf16_f32 v124, v228, v229
v_mfma_f32_16x16x32_bf16 v[232:235], a[204:207], a[132:135], v[232:235]
ds_read_b128 a[204:207], v1 offset:64512
v_cvt_pk_bf16_f32 v125, v230, v231
v_mfma_f32_16x16x32_bf16 v[232:235], a[208:211], a[136:139], v[232:235]
ds_read_b128 a[208:211], v2 offset:0
v_mfma_f32_16x16x32_bf16 v[232:235], a[212:215], a[140:143], v[232:235]
s_waitcnt lgkmcnt(10)
ds_read_b128 a[212:215], v2 offset:1024
v_mfma_f32_16x16x32_bf16 v[220:223], a[216:219], a[72:75], 0
s_waitcnt lgkmcnt(10)
v_mfma_f32_16x16x32_bf16 v[220:223], a[220:223], a[76:79], v[220:223]
s_waitcnt lgkmcnt(9)
v_mfma_f32_16x16x32_bf16 v[220:223], a[224:227], a[80:83], v[220:223]
s_waitcnt lgkmcnt(8)
v_mfma_f32_16x16x32_bf16 v[220:223], a[228:231], a[84:87], v[220:223]
s_waitcnt lgkmcnt(7)
v_mfma_f32_16x16x32_bf16 v[220:223], a[232:235], a[88:91], v[220:223]
s_waitcnt lgkmcnt(6)
v_mfma_f32_16x16x32_bf16 v[220:223], a[236:239], a[92:95], v[220:223]
v_mfma_f32_16x16x32_bf16 v[224:227], a[216:219], a[96:99], 0
v_cvt_pk_bf16_f32 v172, v232, v233
v_cvt_pk_bf16_f32 v173, v234, v235
v_mfma_f32_16x16x32_bf16 v[224:227], a[220:223], a[100:103], v[224:227]
v_mfma_f32_16x16x32_bf16 v[224:227], a[224:227], a[104:107], v[224:227]
v_mfma_f32_16x16x32_bf16 v[224:227], a[228:231], a[108:111], v[224:227]
v_mfma_f32_16x16x32_bf16 v[224:227], a[232:235], a[112:115], v[224:227]
v_mfma_f32_16x16x32_bf16 v[224:227], a[236:239], a[116:119], v[224:227]
v_cvt_pk_bf16_f32 v238, v220, v221
v_cvt_pk_bf16_f32 v239, v222, v223
v_mfma_f32_16x16x32_bf16 v[228:231], a[216:219], a[120:123], 0
ds_read_b128 a[216:219], v2 offset:2048
v_mfma_f32_16x16x32_bf16 v[228:231], a[220:223], a[124:127], v[228:231]
ds_read_b128 a[220:223], v2 offset:3072
v_mfma_f32_16x16x32_bf16 v[228:231], a[224:227], a[128:131], v[228:231]
ds_read_b128 a[224:227], v2 offset:4096
v_cvt_pk_bf16_f32 v126, v224, v225
v_mfma_f32_16x16x32_bf16 v[228:231], a[228:231], a[132:135], v[228:231]
ds_read_b128 a[228:231], v2 offset:5120
v_cvt_pk_bf16_f32 v127, v226, v227
v_mfma_f32_16x16x32_bf16 v[228:231], a[232:235], a[136:139], v[228:231]
ds_read_b128 a[232:235], v2 offset:6144
v_mfma_f32_16x16x32_bf16 v[228:231], a[236:239], a[140:143], v[228:231]
s_waitcnt lgkmcnt(10)
ds_read_b128 a[236:239], v2 offset:7168
v_mfma_f32_16x16x32_bf16 v[232:235], a[192:195], a[72:75], 0
s_waitcnt lgkmcnt(10)
v_mfma_f32_16x16x32_bf16 v[232:235], a[196:199], a[76:79], v[232:235]
s_waitcnt lgkmcnt(9)
v_mfma_f32_16x16x32_bf16 v[232:235], a[200:203], a[80:83], v[232:235]
s_waitcnt lgkmcnt(8)
v_mfma_f32_16x16x32_bf16 v[232:235], a[204:207], a[84:87], v[232:235]
s_waitcnt lgkmcnt(7)
v_mfma_f32_16x16x32_bf16 v[232:235], a[208:211], a[88:91], v[232:235]
s_waitcnt lgkmcnt(6)
v_mfma_f32_16x16x32_bf16 v[232:235], a[212:215], a[92:95], v[232:235]
v_mfma_f32_16x16x32_bf16 v[220:223], a[192:195], a[96:99], 0
v_cvt_pk_bf16_f32 v174, v228, v229
v_cvt_pk_bf16_f32 v175, v230, v231
v_mfma_f32_16x16x32_bf16 v[220:223], a[196:199], a[100:103], v[220:223]
v_mfma_f32_16x16x32_bf16 v[220:223], a[200:203], a[104:107], v[220:223]
v_mfma_f32_16x16x32_bf16 v[220:223], a[204:207], a[108:111], v[220:223]
v_mfma_f32_16x16x32_bf16 v[220:223], a[208:211], a[112:115], v[220:223]
v_mfma_f32_16x16x32_bf16 v[220:223], a[212:215], a[116:119], v[220:223]
v_cvt_pk_bf16_f32 v240, v232, v233
v_cvt_pk_bf16_f32 v241, v234, v235
v_mfma_f32_16x16x32_bf16 v[224:227], a[192:195], a[120:123], 0
ds_read_b128 a[192:195], v2 offset:8192
v_mfma_f32_16x16x32_bf16 v[224:227], a[196:199], a[124:127], v[224:227]
ds_read_b128 a[196:199], v2 offset:9216
v_mfma_f32_16x16x32_bf16 v[224:227], a[200:203], a[128:131], v[224:227]
ds_read_b128 a[200:203], v2 offset:10240
v_cvt_pk_bf16_f32 v132, v220, v221
v_mfma_f32_16x16x32_bf16 v[224:227], a[204:207], a[132:135], v[224:227]
v_cvt_pk_bf16_f32 v133, v222, v223
v_mfma_f32_16x16x32_bf16 v[224:227], a[208:211], a[136:139], v[224:227]
ds_read_b128 a[204:207], v2 offset:11264
ds_read_b128 a[208:211], v2 offset:12288
v_mfma_f32_16x16x32_bf16 v[224:227], a[212:215], a[140:143], v[224:227]
s_waitcnt lgkmcnt(10)
ds_read_b128 a[212:215], v2 offset:13312
v_mfma_f32_16x16x32_bf16 v[228:231], a[216:219], a[72:75], 0
s_waitcnt lgkmcnt(10)
v_mfma_f32_16x16x32_bf16 v[228:231], a[220:223], a[76:79], v[228:231]
s_waitcnt lgkmcnt(9)
v_mfma_f32_16x16x32_bf16 v[228:231], a[224:227], a[80:83], v[228:231]
s_waitcnt lgkmcnt(8)
v_mfma_f32_16x16x32_bf16 v[228:231], a[228:231], a[84:87], v[228:231]
s_waitcnt lgkmcnt(7)
v_mfma_f32_16x16x32_bf16 v[228:231], a[232:235], a[88:91], v[228:231]
s_waitcnt lgkmcnt(6)
v_mfma_f32_16x16x32_bf16 v[228:231], a[236:239], a[92:95], v[228:231]
v_mfma_f32_16x16x32_bf16 v[232:235], a[216:219], a[96:99], 0
v_cvt_pk_bf16_f32 v180, v224, v225
v_cvt_pk_bf16_f32 v181, v226, v227
v_mfma_f32_16x16x32_bf16 v[232:235], a[220:223], a[100:103], v[232:235]
v_mfma_f32_16x16x32_bf16 v[232:235], a[224:227], a[104:107], v[232:235]
v_mfma_f32_16x16x32_bf16 v[232:235], a[228:231], a[108:111], v[232:235]
v_mfma_f32_16x16x32_bf16 v[232:235], a[232:235], a[112:115], v[232:235]
v_mfma_f32_16x16x32_bf16 v[232:235], a[236:239], a[116:119], v[232:235]
v_cvt_pk_bf16_f32 v242, v228, v229
v_cvt_pk_bf16_f32 v243, v230, v231
v_mfma_f32_16x16x32_bf16 v[220:223], a[216:219], a[120:123], 0
ds_read_b128 a[216:219], v2 offset:14336
v_mfma_f32_16x16x32_bf16 v[220:223], a[220:223], a[124:127], v[220:223]
ds_read_b128 a[220:223], v2 offset:15360
v_mfma_f32_16x16x32_bf16 v[220:223], a[224:227], a[128:131], v[220:223]
ds_read_b128 a[224:227], v2 offset:16384
v_cvt_pk_bf16_f32 v134, v232, v233
v_mfma_f32_16x16x32_bf16 v[220:223], a[228:231], a[132:135], v[220:223]
v_cvt_pk_bf16_f32 v135, v234, v235
v_mfma_f32_16x16x32_bf16 v[220:223], a[232:235], a[136:139], v[220:223]
ds_read_b128 a[228:231], v2 offset:17408
ds_read_b128 a[232:235], v2 offset:18432
v_mfma_f32_16x16x32_bf16 v[220:223], a[236:239], a[140:143], v[220:223]
ds_read_b128 a[236:239], v2 offset:19456
v_mfma_f32_16x16x32_bf16 v[28:31], a[72:75], v[60:63], 0
v_mfma_f32_16x16x32_bf16 v[28:31], a[76:79], v[64:67], v[28:31]
v_mfma_f32_16x16x32_bf16 v[28:31], a[80:83], v[68:71], v[28:31]
v_mfma_f32_16x16x32_bf16 v[28:31], a[84:87], v[72:75], v[28:31]
v_mfma_f32_16x16x32_bf16 v[28:31], a[88:91], v[236:239], v[28:31]
v_mfma_f32_16x16x32_bf16 v[28:31], a[92:95], v[240:243], v[28:31]
v_mfma_f32_16x16x32_bf16 v[32:35], a[96:99], v[60:63], 0
v_cvt_pk_bf16_f32 v182, v220, v221
v_cvt_pk_bf16_f32 v183, v222, v223
v_mfma_f32_16x16x32_bf16 v[32:35], a[100:103], v[64:67], v[32:35]
v_mfma_f32_16x16x32_bf16 v[32:35], a[104:107], v[68:71], v[32:35]
v_mfma_f32_16x16x32_bf16 v[32:35], a[108:111], v[72:75], v[32:35]
v_mfma_f32_16x16x32_bf16 v[32:35], a[112:115], v[236:239], v[32:35]
v_mfma_f32_16x16x32_bf16 v[32:35], a[116:119], v[240:243], v[32:35]
v_max3_f32 v42, v28, v29, v30
v_mfma_f32_16x16x32_bf16 v[36:39], a[120:123], v[60:63], 0
v_mfma_f32_16x16x32_bf16 v[36:39], a[124:127], v[64:67], v[36:39]
v_mfma_f32_16x16x32_bf16 v[36:39], a[128:131], v[68:71], v[36:39]
v_mfma_f32_16x16x32_bf16 v[36:39], a[132:135], v[72:75], v[36:39]
v_mfma_f32_16x16x32_bf16 v[36:39], a[136:139], v[236:239], v[36:39]
v_mfma_f32_16x16x32_bf16 v[36:39], a[140:143], v[240:243], v[36:39]
v_mfma_f32_16x16x32_bf16 v[44:47], a[72:75], v[92:95], 0
v_max3_f32 v42, v42, v31, v32
v_max3_f32 v42, v42, v33, v34
v_mfma_f32_16x16x32_bf16 v[44:47], a[76:79], v[100:103], v[44:47]
v_mfma_f32_16x16x32_bf16 v[44:47], a[80:83], v[108:111], v[44:47]
v_mfma_f32_16x16x32_bf16 v[44:47], a[84:87], v[116:119], v[44:47]
v_mfma_f32_16x16x32_bf16 v[44:47], a[88:91], v[124:127], v[44:47]
v_mfma_f32_16x16x32_bf16 v[44:47], a[92:95], v[132:135], v[44:47]
v_max3_f32 v42, v42, v35, v36
v_max3_f32 v42, v42, v37, v38
v_mfma_f32_16x16x32_bf16 v[48:51], a[96:99], v[92:95], 0
v_max3_f32 v42, v42, v39, v78
v_mov_b32 v43, v42
v_mfma_f32_16x16x32_bf16 v[48:51], a[100:103], v[100:103], v[48:51]
v_mfma_f32_16x16x32_bf16 v[48:51], a[104:107], v[108:111], v[48:51]
v_permlane32_swap_b32 v42, v43
v_mfma_f32_16x16x32_bf16 v[48:51], a[108:111], v[116:119], v[48:51]
v_max_f32 v42, v42, v43
v_mov_b32 v43, v42
v_mfma_f32_16x16x32_bf16 v[48:51], a[112:115], v[124:127], v[48:51]
v_max3_f32 v58, v44, v45, v46
v_mfma_f32_16x16x32_bf16 v[48:51], a[116:119], v[132:135], v[48:51]
v_permlane16_swap_b32 v42, v43
v_mfma_f32_16x16x32_bf16 v[52:55], a[120:123], v[92:95], 0
v_max_f32 v42, v42, v43
v_sub_f32 v28, v28, v42
v_mfma_f32_16x16x32_bf16 v[52:55], a[124:127], v[100:103], v[52:55]
v_sub_f32 v29, v29, v42
v_sub_f32 v30, v30, v42
v_mfma_f32_16x16x32_bf16 v[52:55], a[128:131], v[108:111], v[52:55]
v_exp_f32 v28, v28
v_mfma_f32_16x16x32_bf16 v[52:55], a[132:135], v[116:119], v[52:55]
v_exp_f32 v29, v29
v_mfma_f32_16x16x32_bf16 v[52:55], a[136:139], v[124:127], v[52:55]
v_sub_f32 v31, v31, v42
v_sub_f32 v32, v32, v42
v_mfma_f32_16x16x32_bf16 v[52:55], a[140:143], v[132:135], v[52:55]
v_sub_f32 v33, v33, v42
v_sub_f32 v34, v34, v42
v_mfma_f32_16x16x32_bf16 v[60:63], a[72:75], v[140:143], 0
v_sub_f32 v35, v35, v42
v_sub_f32 v36, v36, v42
v_mfma_f32_16x16x32_bf16 v[60:63], a[76:79], v[148:151], v[60:63]
v_sub_f32 v37, v37, v42
v_sub_f32 v38, v38, v42
v_mfma_f32_16x16x32_bf16 v[60:63], a[80:83], v[156:159], v[60:63]
v_sub_f32 v39, v39, v42
v_sub_f32 v78, v78, v42
v_mfma_f32_16x16x32_bf16 v[60:63], a[84:87], v[164:167], v[60:63]
v_exp_f32 v30, v30
v_mfma_f32_16x16x32_bf16 v[60:63], a[88:91], v[172:175], v[60:63]
v_exp_f32 v31, v31
v_mfma_f32_16x16x32_bf16 v[60:63], a[92:95], v[180:183], v[60:63]
v_add_f32 v42, v28, v29
v_add_f32 v42, v42, v30
v_mfma_f32_16x16x32_bf16 v[64:67], a[96:99], v[140:143], 0
v_exp_f32 v32, v32
v_mfma_f32_16x16x32_bf16 v[64:67], a[100:103], v[148:151], v[64:67]
v_exp_f32 v33, v33
v_mfma_f32_16x16x32_bf16 v[64:67], a[104:107], v[156:159], v[64:67]
v_add_f32 v42, v42, v31
v_add_f32 v42, v42, v32
v_mfma_f32_16x16x32_bf16 v[64:67], a[108:111], v[164:167], v[64:67]
v_exp_f32 v34, v34
v_mfma_f32_16x16x32_bf16 v[64:67], a[112:115], v[172:175], v[64:67]
v_exp_f32 v35, v35
v_mfma_f32_16x16x32_bf16 v[64:67], a[116:119], v[180:183], v[64:67]
v_add_f32 v42, v42, v33
v_add_f32 v42, v42, v34
v_mfma_f32_16x16x32_bf16 v[68:71], a[120:123], v[140:143], 0
v_exp_f32 v36, v36
v_mfma_f32_16x16x32_bf16 v[68:71], a[124:127], v[148:151], v[68:71]
v_exp_f32 v37, v37
v_mfma_f32_16x16x32_bf16 v[68:71], a[128:131], v[156:159], v[68:71]
v_add_f32 v42, v42, v35
v_add_f32 v42, v42, v36
v_mfma_f32_16x16x32_bf16 v[68:71], a[132:135], v[164:167], v[68:71]
v_exp_f32 v38, v38
v_mfma_f32_16x16x32_bf16 v[68:71], a[136:139], v[172:175], v[68:71]
v_exp_f32 v39, v39
v_mfma_f32_16x16x32_bf16 v[68:71], a[140:143], v[180:183], v[68:71]
s_waitcnt lgkmcnt(11)
v_add_f32 v42, v42, v37
v_add_f32 v42, v42, v38
v_mfma_f32_16x16x32_bf16 v[224:227], a[72:75], a[192:195], 0
s_waitcnt lgkmcnt(10)
v_exp_f32 v78, v78
v_mfma_f32_16x16x32_bf16 v[224:227], a[76:79], a[196:199], v[224:227]
s_waitcnt lgkmcnt(9)
v_add_f32 v42, v42, v39
v_add_f32 v42, v42, v78
v_mfma_f32_16x16x32_bf16 v[224:227], a[80:83], a[200:203], v[224:227]
s_waitcnt lgkmcnt(8)
v_mov_b32 v43, v42
v_max3_f32 v58, v58, v47, v48
v_mfma_f32_16x16x32_bf16 v[224:227], a[84:87], a[204:207], v[224:227]
s_waitcnt lgkmcnt(7)
v_permlane32_swap_b32 v42, v43
v_mfma_f32_16x16x32_bf16 v[224:227], a[88:91], a[208:211], v[224:227]
s_waitcnt lgkmcnt(6)
v_add_f32 v42, v42, v43
v_mov_b32 v43, v42
v_mfma_f32_16x16x32_bf16 v[224:227], a[92:95], a[212:215], v[224:227]
v_max3_f32 v58, v58, v49, v50
v_max3_f32 v58, v58, v51, v52
v_mfma_f32_16x16x32_bf16 v[228:231], a[96:99], a[192:195], 0
v_permlane16_swap_b32 v42, v43
v_mfma_f32_16x16x32_bf16 v[228:231], a[100:103], a[196:199], v[228:231]
v_add_f32 v42, v42, v43
v_max3_f32 v58, v58, v53, v54
v_mfma_f32_16x16x32_bf16 v[228:231], a[104:107], a[200:203], v[228:231]
v_cvt_pk_bf16_f32 v92, v224, v225
v_cvt_pk_bf16_f32 v93, v226, v227
v_mfma_f32_16x16x32_bf16 v[228:231], a[108:111], a[204:207], v[228:231]
v_rcp_f32 v42, v42
v_mfma_f32_16x16x32_bf16 v[228:231], a[112:115], a[208:211], v[228:231]
v_mul_f32 v28, v28, v42
v_mul_f32 v29, v29, v42
v_mfma_f32_16x16x32_bf16 v[228:231], a[116:119], a[212:215], v[228:231]
v_mul_f32 v30, v30, v42
v_mul_f32 v31, v31, v42
v_mfma_f32_16x16x32_bf16 v[232:235], a[120:123], a[192:195], 0
ds_read_b128 a[192:195], v2 offset:20480
v_cvt_pk_bf16_f32 v28, v28, v29
v_mfma_f32_16x16x32_bf16 v[232:235], a[124:127], a[196:199], v[232:235]
ds_read_b128 a[196:199], v2 offset:21504
v_mul_f32 v32, v32, v42
v_mfma_f32_16x16x32_bf16 v[232:235], a[128:131], a[200:203], v[232:235]
ds_read_b128 a[200:203], v2 offset:22528
v_cvt_pk_bf16_f32 v94, v228, v229
v_mfma_f32_16x16x32_bf16 v[232:235], a[132:135], a[204:207], v[232:235]
ds_read_b128 a[204:207], v2 offset:23552
v_cvt_pk_bf16_f32 v95, v230, v231
v_mfma_f32_16x16x32_bf16 v[232:235], a[136:139], a[208:211], v[232:235]
ds_read_b128 a[208:211], v2 offset:24576
v_mul_f32 v33, v33, v42
v_mfma_f32_16x16x32_bf16 v[232:235], a[140:143], a[212:215], v[232:235]
s_waitcnt lgkmcnt(10)
ds_read_b128 a[212:215], v2 offset:25600
v_mul_f32 v34, v34, v42
v_mfma_f32_16x16x32_bf16 v[220:223], a[72:75], a[216:219], 0
s_waitcnt lgkmcnt(10)
v_mul_f32 v35, v35, v42
v_cvt_pk_bf16_f32 v29, v30, v31
v_mfma_f32_16x16x32_bf16 v[220:223], a[76:79], a[220:223], v[220:223]
s_waitcnt lgkmcnt(9)
v_cvt_pk_bf16_f32 v30, v32, v33
v_cvt_pk_bf16_f32 v31, v34, v35
v_mfma_f32_16x16x32_bf16 v[220:223], a[80:83], a[224:227], v[220:223]
s_waitcnt lgkmcnt(8)
v_cvt_pk_bf16_f32 v96, v232, v233
v_cvt_pk_bf16_f32 v97, v234, v235
v_mfma_f32_16x16x32_bf16 v[220:223], a[84:87], a[228:231], v[220:223]
s_waitcnt lgkmcnt(7)
v_mul_f32 v36, v36, v42
v_mul_f32 v37, v37, v42
v_mfma_f32_16x16x32_bf16 v[220:223], a[88:91], a[232:235], v[220:223]
s_waitcnt lgkmcnt(6)
v_mul_f32 v38, v38, v42
v_mul_f32 v39, v39, v42
v_mfma_f32_16x16x32_bf16 v[220:223], a[92:95], a[236:239], v[220:223]
v_cvt_pk_bf16_f32 v36, v36, v37
v_mul_f32 v78, v78, v42
v_mfma_f32_16x16x32_bf16 v[224:227], a[96:99], a[216:219], 0
v_cvt_pk_bf16_f32 v37, v38, v39
v_max3_f32 v58, v58, v55, v82
v_mfma_f32_16x16x32_bf16 v[224:227], a[100:103], a[220:223], v[224:227]
v_cvt_pk_bf16_f32 v38, v78, 0
v_mov_b32 v39, 0
v_mfma_f32_16x16x32_bf16 v[224:227], a[104:107], a[224:227], v[224:227]
v_cvt_pk_bf16_f32 v100, v220, v221
v_cvt_pk_bf16_f32 v101, v222, v223
v_mfma_f32_16x16x32_bf16 v[224:227], a[108:111], a[228:231], v[224:227]
v_mov_b32 v59, v58
v_max3_f32 v74, v60, v61, v62
v_mfma_f32_16x16x32_bf16 v[224:227], a[112:115], a[232:235], v[224:227]
v_permlane32_swap_b32 v58, v59
v_mfma_f32_16x16x32_bf16 v[224:227], a[116:119], a[236:239], v[224:227]
v_max_f32 v58, v58, v59
v_mov_b32 v59, v58
v_mfma_f32_16x16x32_bf16 v[228:231], a[120:123], a[216:219], 0
ds_read_b128 a[216:219], v2 offset:26624
v_max3_f32 v74, v74, v63, v64
v_mfma_f32_16x16x32_bf16 v[228:231], a[124:127], a[220:223], v[228:231]
ds_read_b128 a[220:223], v2 offset:27648
v_max3_f32 v74, v74, v65, v66
v_mfma_f32_16x16x32_bf16 v[228:231], a[128:131], a[224:227], v[228:231]
ds_read_b128 a[224:227], v2 offset:28672
v_cvt_pk_bf16_f32 v102, v224, v225
v_mfma_f32_16x16x32_bf16 v[228:231], a[132:135], a[228:231], v[228:231]
ds_read_b128 a[228:231], v2 offset:29696
v_cvt_pk_bf16_f32 v103, v226, v227
v_mfma_f32_16x16x32_bf16 v[228:231], a[136:139], a[232:235], v[228:231]
ds_read_b128 a[232:235], v2 offset:30720
v_max3_f32 v74, v74, v67, v68
v_mfma_f32_16x16x32_bf16 v[228:231], a[140:143], a[236:239], v[228:231]
s_waitcnt lgkmcnt(10)
ds_read_b128 a[236:239], v2 offset:31744
v_max3_f32 v74, v74, v69, v70
v_mfma_f32_16x16x32_bf16 v[232:235], a[72:75], a[192:195], 0
s_waitcnt lgkmcnt(10)
v_permlane16_swap_b32 v58, v59
v_mfma_f32_16x16x32_bf16 v[232:235], a[76:79], a[196:199], v[232:235]
s_waitcnt lgkmcnt(9)
v_max_f32 v58, v58, v59
v_sub_f32 v44, v44, v58
v_mfma_f32_16x16x32_bf16 v[232:235], a[80:83], a[200:203], v[232:235]
s_waitcnt lgkmcnt(8)
v_cvt_pk_bf16_f32 v104, v228, v229
v_cvt_pk_bf16_f32 v105, v230, v231
v_mfma_f32_16x16x32_bf16 v[232:235], a[84:87], a[204:207], v[232:235]
s_waitcnt lgkmcnt(7)
v_sub_f32 v45, v45, v58
v_sub_f32 v46, v46, v58
v_mfma_f32_16x16x32_bf16 v[232:235], a[88:91], a[208:211], v[232:235]
s_waitcnt lgkmcnt(6)
v_exp_f32 v44, v44
v_mfma_f32_16x16x32_bf16 v[232:235], a[92:95], a[212:215], v[232:235]
v_exp_f32 v45, v45
v_mfma_f32_16x16x32_bf16 v[220:223], a[96:99], a[192:195], 0
v_sub_f32 v47, v47, v58
v_sub_f32 v48, v48, v58
v_mfma_f32_16x16x32_bf16 v[220:223], a[100:103], a[196:199], v[220:223]
v_sub_f32 v49, v49, v58
v_sub_f32 v50, v50, v58
v_mfma_f32_16x16x32_bf16 v[220:223], a[104:107], a[200:203], v[220:223]
v_cvt_pk_bf16_f32 v108, v232, v233
v_cvt_pk_bf16_f32 v109, v234, v235
v_mfma_f32_16x16x32_bf16 v[220:223], a[108:111], a[204:207], v[220:223]
v_sub_f32 v51, v51, v58
v_sub_f32 v52, v52, v58
v_mfma_f32_16x16x32_bf16 v[220:223], a[112:115], a[208:211], v[220:223]
v_sub_f32 v53, v53, v58
v_sub_f32 v54, v54, v58
v_mfma_f32_16x16x32_bf16 v[220:223], a[116:119], a[212:215], v[220:223]
v_sub_f32 v55, v55, v58
v_sub_f32 v82, v82, v58
v_mfma_f32_16x16x32_bf16 v[224:227], a[120:123], a[192:195], 0
ds_read_b128 a[192:195], v2 offset:32768
v_add_f32 v58, v44, v45
v_mfma_f32_16x16x32_bf16 v[224:227], a[124:127], a[196:199], v[224:227]
ds_read_b128 a[196:199], v2 offset:33792
v_max3_f32 v74, v74, v71, v86
v_mfma_f32_16x16x32_bf16 v[224:227], a[128:131], a[200:203], v[224:227]
ds_read_b128 a[200:203], v2 offset:34816
v_cvt_pk_bf16_f32 v110, v220, v221
v_mfma_f32_16x16x32_bf16 v[224:227], a[132:135], a[204:207], v[224:227]
ds_read_b128 a[204:207], v2 offset:35840
v_cvt_pk_bf16_f32 v111, v222, v223
v_mfma_f32_16x16x32_bf16 v[224:227], a[136:139], a[208:211], v[224:227]
ds_read_b128 a[208:211], v2 offset:36864
v_mov_b32 v75, v74
v_mfma_f32_16x16x32_bf16 v[224:227], a[140:143], a[212:215], v[224:227]
s_waitcnt lgkmcnt(10)
ds_read_b128 a[212:215], v2 offset:37888
v_mfma_f32_16x16x32_bf16 v[228:231], a[72:75], a[216:219], 0
s_waitcnt lgkmcnt(10)
v_exp_f32 v46, v46
v_mfma_f32_16x16x32_bf16 v[228:231], a[76:79], a[220:223], v[228:231]
s_waitcnt lgkmcnt(9)
v_exp_f32 v47, v47
v_mfma_f32_16x16x32_bf16 v[228:231], a[80:83], a[224:227], v[228:231]
s_waitcnt lgkmcnt(8)
v_exp_f32 v48, v48
v_mfma_f32_16x16x32_bf16 v[228:231], a[84:87], a[228:231], v[228:231]
s_waitcnt lgkmcnt(7)
v_cvt_pk_bf16_f32 v112, v224, v225
v_cvt_pk_bf16_f32 v113, v226, v227
v_mfma_f32_16x16x32_bf16 v[228:231], a[88:91], a[232:235], v[228:231]
s_waitcnt lgkmcnt(6)
v_add_f32 v58, v58, v46
v_add_f32 v58, v58, v47
v_mfma_f32_16x16x32_bf16 v[228:231], a[92:95], a[236:239], v[228:231]
v_exp_f32 v49, v49
v_mfma_f32_16x16x32_bf16 v[232:235], a[96:99], a[216:219], 0
v_exp_f32 v50, v50
v_mfma_f32_16x16x32_bf16 v[232:235], a[100:103], a[220:223], v[232:235]
v_add_f32 v58, v58, v48
v_add_f32 v58, v58, v49
v_mfma_f32_16x16x32_bf16 v[232:235], a[104:107], a[224:227], v[232:235]
v_exp_f32 v51, v51
v_mfma_f32_16x16x32_bf16 v[232:235], a[108:111], a[228:231], v[232:235]
v_cvt_pk_bf16_f32 v116, v228, v229
v_cvt_pk_bf16_f32 v117, v230, v231
v_mfma_f32_16x16x32_bf16 v[232:235], a[112:115], a[232:235], v[232:235]
v_exp_f32 v52, v52
v_mfma_f32_16x16x32_bf16 v[232:235], a[116:119], a[236:239], v[232:235]
v_add_f32 v58, v58, v50
v_add_f32 v58, v58, v51
v_mfma_f32_16x16x32_bf16 v[220:223], a[120:123], a[216:219], 0
ds_read_b128 a[216:219], v2 offset:38912
v_add_f32 v58, v58, v52
v_mfma_f32_16x16x32_bf16 v[220:223], a[124:127], a[220:223], v[220:223]
ds_read_b128 a[220:223], v2 offset:39936
v_mfma_f32_16x16x32_bf16 v[220:223], a[128:131], a[224:227], v[220:223]
ds_read_b128 a[224:227], v2 offset:40960
v_cvt_pk_bf16_f32 v118, v232, v233
v_mfma_f32_16x16x32_bf16 v[220:223], a[132:135], a[228:231], v[220:223]
ds_read_b128 a[228:231], v2 offset:41984
v_cvt_pk_bf16_f32 v119, v234, v235
v_mfma_f32_16x16x32_bf16 v[220:223], a[136:139], a[232:235], v[220:223]
ds_read_b128 a[232:235], v2 offset:43008
v_mfma_f32_16x16x32_bf16 v[220:223], a[140:143], a[236:239], v[220:223]
s_waitcnt lgkmcnt(10)
ds_read_b128 a[236:239], v2 offset:44032
v_mfma_f32_16x16x32_bf16 v[224:227], a[72:75], a[192:195], 0
s_waitcnt lgkmcnt(10)
v_exp_f32 v53, v53
v_mfma_f32_16x16x32_bf16 v[224:227], a[76:79], a[196:199], v[224:227]
s_waitcnt lgkmcnt(9)
v_exp_f32 v54, v54
v_mfma_f32_16x16x32_bf16 v[224:227], a[80:83], a[200:203], v[224:227]
s_waitcnt lgkmcnt(8)
v_exp_f32 v55, v55
v_mfma_f32_16x16x32_bf16 v[224:227], a[84:87], a[204:207], v[224:227]
s_waitcnt lgkmcnt(7)
v_cvt_pk_bf16_f32 v120, v220, v221
v_cvt_pk_bf16_f32 v121, v222, v223
v_mfma_f32_16x16x32_bf16 v[224:227], a[88:91], a[208:211], v[224:227]
s_waitcnt lgkmcnt(6)
v_add_f32 v58, v58, v53
v_add_f32 v58, v58, v54
v_mfma_f32_16x16x32_bf16 v[224:227], a[92:95], a[212:215], v[224:227]
v_exp_f32 v82, v82
v_mfma_f32_16x16x32_bf16 v[228:231], a[96:99], a[192:195], 0
v_add_f32 v58, v58, v55
v_add_f32 v58, v58, v82
v_mfma_f32_16x16x32_bf16 v[228:231], a[100:103], a[196:199], v[228:231]
v_mov_b32 v59, v58
v_mfma_f32_16x16x32_bf16 v[228:231], a[104:107], a[200:203], v[228:231]
v_permlane32_swap_b32 v74, v75
v_mfma_f32_16x16x32_bf16 v[228:231], a[108:111], a[204:207], v[228:231]
v_cvt_pk_bf16_f32 v124, v224, v225
v_cvt_pk_bf16_f32 v125, v226, v227
v_mfma_f32_16x16x32_bf16 v[228:231], a[112:115], a[208:211], v[228:231]
v_permlane32_swap_b32 v58, v59
v_mfma_f32_16x16x32_bf16 v[228:231], a[116:119], a[212:215], v[228:231]
v_add_f32 v58, v58, v59
v_mov_b32 v59, v58
v_mfma_f32_16x16x32_bf16 v[232:235], a[120:123], a[192:195], 0
ds_read_b128 a[192:195], v2 offset:45056
v_max_f32 v74, v74, v75
v_mfma_f32_16x16x32_bf16 v[232:235], a[124:127], a[196:199], v[232:235]
ds_read_b128 a[196:199], v2 offset:46080
v_mov_b32 v75, v74
v_mfma_f32_16x16x32_bf16 v[232:235], a[128:131], a[200:203], v[232:235]
ds_read_b128 a[200:203], v2 offset:47104
v_cvt_pk_bf16_f32 v126, v228, v229
v_mfma_f32_16x16x32_bf16 v[232:235], a[132:135], a[204:207], v[232:235]
ds_read_b128 a[204:207], v2 offset:48128
v_cvt_pk_bf16_f32 v127, v230, v231
v_mfma_f32_16x16x32_bf16 v[232:235], a[136:139], a[208:211], v[232:235]
ds_read_b128 a[208:211], v2 offset:49152
v_mfma_f32_16x16x32_bf16 v[232:235], a[140:143], a[212:215], v[232:235]
s_waitcnt lgkmcnt(10)
ds_read_b128 a[212:215], v2 offset:50176
v_mfma_f32_16x16x32_bf16 v[220:223], a[72:75], a[216:219], 0
s_waitcnt lgkmcnt(10)
v_permlane16_swap_b32 v58, v59
v_mfma_f32_16x16x32_bf16 v[220:223], a[76:79], a[220:223], v[220:223]
s_waitcnt lgkmcnt(9)
v_add_f32 v58, v58, v59
v_mfma_f32_16x16x32_bf16 v[220:223], a[80:83], a[224:227], v[220:223]
LW_p15:
s_cbranch_execz LW_p12
s_waitcnt lgkmcnt(8)
v_rcp_f32 v58, v58
v_mfma_f32_16x16x32_bf16 v[220:223], a[84:87], a[228:231], v[220:223]
s_waitcnt lgkmcnt(7)
v_cvt_pk_bf16_f32 v128, v232, v233
v_cvt_pk_bf16_f32 v129, v234, v235
v_mfma_f32_16x16x32_bf16 v[220:223], a[88:91], a[232:235], v[220:223]
s_waitcnt lgkmcnt(6)
v_mul_f32 v44, v44, v58
v_mul_f32 v45, v45, v58
v_mfma_f32_16x16x32_bf16 v[220:223], a[92:95], a[236:239], v[220:223]
v_permlane16_swap_b32 v74, v75
v_mfma_f32_16x16x32_bf16 v[224:227], a[96:99], a[216:219], 0
v_mul_f32 v46, v46, v58
v_mul_f32 v47, v47, v58
v_mfma_f32_16x16x32_bf16 v[224:227], a[100:103], a[220:223], v[224:227]
v_cvt_pk_bf16_f32 v44, v44, v45
v_mul_f32 v48, v48, v58
v_mfma_f32_16x16x32_bf16 v[224:227], a[104:107], a[224:227], v[224:227]
v_cvt_pk_bf16_f32 v132, v220, v221
v_cvt_pk_bf16_f32 v133, v222, v223
v_mfma_f32_16x16x32_bf16 v[224:227], a[108:111], a[228:231], v[224:227]
v_mul_f32 v49, v49, v58
v_mul_f32 v50, v50, v58
v_mfma_f32_16x16x32_bf16 v[224:227], a[112:115], a[232:235], v[224:227]
v_mul_f32 v51, v51, v58
v_cvt_pk_bf16_f32 v45, v46, v47
v_mfma_f32_16x16x32_bf16 v[224:227], a[116:119], a[236:239], v[224:227]
v_max_f32 v74, v74, v75
v_cvt_pk_bf16_f32 v46, v48, v49
v_mfma_f32_16x16x32_bf16 v[228:231], a[120:123], a[216:219], 0
ds_read_b128 a[216:219], v2 offset:51200
v_cvt_pk_bf16_f32 v47, v50, v51
v_mfma_f32_16x16x32_bf16 v[228:231], a[124:127], a[220:223], v[228:231]
ds_read_b128 a[220:223], v2 offset:52224
v_sub_f32 v60, v60, v74
v_mfma_f32_16x16x32_bf16 v[228:231], a[128:131], a[224:227], v[228:231]
ds_read_b128 a[224:227], v2 offset:53248
v_cvt_pk_bf16_f32 v134, v224, v225
v_mfma_f32_16x16x32_bf16 v[228:231], a[132:135], a[228:231], v[228:231]
ds_read_b128 a[228:231], v2 offset:54272
v_cvt_pk_bf16_f32 v135, v226, v227
v_mfma_f32_16x16x32_bf16 v[228:231], a[136:139], a[232:235], v[228:231]
ds_read_b128 a[232:235], v2 offset:55296
v_sub_f32 v61, v61, v74
v_mfma_f32_16x16x32_bf16 v[228:231], a[140:143], a[236:239], v[228:231]
s_waitcnt lgkmcnt(10)
ds_read_b128 a[236:239], v2 offset:56320
v_mul_f32 v52, v52, v58
v_mfma_f32_16x16x32_bf16 v[232:235], a[72:75], a[192:195], 0
s_waitcnt lgkmcnt(10)
v_mul_f32 v53, v53, v58
v_sub_f32 v62, v62, v74
v_mfma_f32_16x16x32_bf16 v[232:235], a[76:79], a[196:199], v[232:235]
s_waitcnt lgkmcnt(9)
v_exp_f32 v60, v60
v_mfma_f32_16x16x32_bf16 v[232:235], a[80:83], a[200:203], v[232:235]
s_waitcnt lgkmcnt(8)
v_cvt_pk_bf16_f32 v136, v228, v229
v_cvt_pk_bf16_f32 v137, v230, v231
v_mfma_f32_16x16x32_bf16 v[232:235], a[84:87], a[204:207], v[232:235]
s_waitcnt lgkmcnt(7)
v_exp_f32 v61, v61
v_mfma_f32_16x16x32_bf16 v[232:235], a[88:91], a[208:211], v[232:235]
s_waitcnt lgkmcnt(6)
v_mul_f32 v54, v54, v58
v_mul_f32 v55, v55, v58
v_mfma_f32_16x16x32_bf16 v[232:235], a[92:95], a[212:215], v[232:235]
v_cvt_pk_bf16_f32 v52, v52, v53
v_sub_f32 v63, v63, v74
v_mfma_f32_16x16x32_bf16 v[220:223], a[96:99], a[192:195], 0
v_sub_f32 v64, v64, v74
v_sub_f32 v65, v65, v74
v_mfma_f32_16x16x32_bf16 v[220:223], a[100:103], a[196:199], v[220:223]
v_sub_f32 v66, v66, v74
v_sub_f32 v67, v67, v74
v_mfma_f32_16x16x32_bf16 v[220:223], a[104:107], a[200:203], v[220:223]
v_cvt_pk_bf16_f32 v140, v232, v233
v_cvt_pk_bf16_f32 v141, v234, v235
v_mfma_f32_16x16x32_bf16 v[220:223], a[108:111], a[204:207], v[220:223]
v_sub_f32 v68, v68, v74
v_sub_f32 v69, v69, v74
v_mfma_f32_16x16x32_bf16 v[220:223], a[112:115], a[208:211], v[220:223]
v_sub_f32 v70, v70, v74
v_sub_f32 v71, v71, v74
v_mfma_f32_16x16x32_bf16 v[220:223], a[116:119], a[212:215], v[220:223]
v_sub_f32 v86, v86, v74
v_mul_f32 v82, v82, v58
v_mfma_f32_16x16x32_bf16 v[224:227], a[120:123], a[192:195], 0
v_exp_f32 v62, v62
v_mfma_f32_16x16x32_bf16 v[224:227], a[124:127], a[196:199], v[224:227]
v_cvt_pk_bf16_f32 v53, v54, v55
v_add_f32 v74, v60, v61
v_mfma_f32_16x16x32_bf16 v[224:227], a[128:131], a[200:203], v[224:227]
v_cvt_pk_bf16_f32 v142, v220, v221
v_cvt_pk_bf16_f32 v143, v222, v223
v_mfma_f32_16x16x32_bf16 v[224:227], a[132:135], a[204:207], v[224:227]
v_exp_f32 v63, v63
v_mfma_f32_16x16x32_bf16 v[224:227], a[136:139], a[208:211], v[224:227]
v_cvt_pk_bf16_f32 v54, v82, 0
v_mov_b32 v55, 0
v_mfma_f32_16x16x32_bf16 v[224:227], a[140:143], a[212:215], v[224:227]
s_waitcnt lgkmcnt(5)
v_exp_f32 v64, v64
v_mfma_f32_16x16x32_bf16 v[228:231], a[72:75], a[216:219], 0
s_waitcnt lgkmcnt(4)
v_add_f32 v74, v74, v62
v_add_f32 v74, v74, v63
v_mfma_f32_16x16x32_bf16 v[228:231], a[76:79], a[220:223], v[228:231]
s_waitcnt lgkmcnt(3)
v_exp_f32 v65, v65
v_mfma_f32_16x16x32_bf16 v[228:231], a[80:83], a[224:227], v[228:231]
s_waitcnt lgkmcnt(2)
v_exp_f32 v66, v66
v_mfma_f32_16x16x32_bf16 v[228:231], a[84:87], a[228:231], v[228:231]
s_waitcnt lgkmcnt(1)
v_add_f32 v74, v74, v64
v_add_f32 v74, v74, v65
v_mfma_f32_16x16x32_bf16 v[228:231], a[88:91], a[232:235], v[228:231]
s_waitcnt lgkmcnt(0)
v_exp_f32 v67, v67
v_mfma_f32_16x16x32_bf16 v[228:231], a[92:95], a[236:239], v[228:231]
v_exp_f32 v68, v68
v_mfma_f32_16x16x32_bf16 v[232:235], a[96:99], a[216:219], 0
v_add_f32 v74, v74, v66
v_add_f32 v74, v74, v67
v_mfma_f32_16x16x32_bf16 v[232:235], a[100:103], a[220:223], v[232:235]
v_exp_f32 v69, v69
v_mfma_f32_16x16x32_bf16 v[232:235], a[104:107], a[224:227], v[232:235]
v_exp_f32 v70, v70
v_mfma_f32_16x16x32_bf16 v[232:235], a[108:111], a[228:231], v[232:235]
v_add_f32 v74, v74, v68
v_add_f32 v74, v74, v69
v_mfma_f32_16x16x32_bf16 v[232:235], a[112:115], a[232:235], v[232:235]
v_exp_f32 v71, v71
v_mfma_f32_16x16x32_bf16 v[232:235], a[116:119], a[236:239], v[232:235]
v_exp_f32 v86, v86
v_mfma_f32_16x16x32_bf16 v[220:223], a[120:123], a[216:219], 0
v_mov_b64 v[244:245], 0
v_mfma_f32_16x16x32_bf16 v[220:223], a[124:127], a[220:223], v[220:223]
v_add_f32 v74, v74, v70
v_add_f32 v74, v74, v71
v_mfma_f32_16x16x32_bf16 v[220:223], a[128:131], a[224:227], v[220:223]
v_add_f32 v74, v74, v86
v_mov_b32 v75, v74
v_mfma_f32_16x16x32_bf16 v[220:223], a[132:135], a[228:231], v[220:223]
v_cvt_pk_bf16_f32 v144, v224, v225
v_cvt_pk_bf16_f32 v145, v226, v227
v_mfma_f32_16x16x32_bf16 v[220:223], a[136:139], a[232:235], v[220:223]
v_permlane32_swap_b32 v74, v75
v_mfma_f32_16x16x32_bf16 v[220:223], a[140:143], a[236:239], v[220:223]
v_add_f32 v74, v74, v75
v_mov_b32 v75, v74
v_mfma_f32_16x16x32_bf16 v[188:191], v[28:31], v[92:95], 0
v_cvt_pk_bf16_f32 v148, v228, v229
v_cvt_pk_bf16_f32 v149, v230, v231
v_mfma_f32_16x16x32_bf16 v[188:191], v[36:39], v[96:99], v[188:191]
v_permlane16_swap_b32 v74, v75
v_mfma_f32_16x16x32_bf16 v[192:195], v[28:31], v[100:103], 0
v_add_f32 v74, v74, v75
v_cvt_pk_bf16_f32 v150, v232, v233
v_mfma_f32_16x16x32_bf16 v[192:195], v[36:39], v[104:107], v[192:195]
v_rcp_f32 v74, v74
v_mfma_f32_16x16x32_bf16 v[196:199], v[28:31], v[108:111], 0
v_mul_f32 v60, v60, v74
v_mul_f32 v61, v61, v74
v_mfma_f32_16x16x32_bf16 v[196:199], v[36:39], v[112:115], v[196:199]
v_mul_f32 v62, v62, v74
v_mul_f32 v63, v63, v74
v_mfma_f32_16x16x32_bf16 v[200:203], v[28:31], v[116:119], 0
v_cvt_pk_bf16_f32 v60, v60, v61
v_mul_f32 v64, v64, v74
v_mfma_f32_16x16x32_bf16 v[200:203], v[36:39], v[120:123], v[200:203]
v_mul_f32 v65, v65, v74
v_mul_f32 v66, v66, v74
v_smfmac_f32_16x16x64_bf16 v[244:247], a[240:243], v[92:99], v0
v_mul_f32 v67, v67, v74
v_smfmac_f32_16x16x64_bf16 v[244:247], a[244:247], v[100:107], v0
v_cvt_pk_bf16_f32 v61, v62, v63
v_smfmac_f32_16x16x64_bf16 v[244:247], a[248:251], v[108:115], v0
v_cvt_pk_bf16_f32 v62, v64, v65
v_smfmac_f32_16x16x64_bf16 v[244:247], a[252:255], v[116:123], v0
v_cvt_pk_bf16_f32 v63, v66, v67
v_mfma_f32_16x16x32_bf16 v[204:207], v[44:47], v[92:95], 0
v_mul_f32 v68, v68, v74
v_mul_f32 v69, v69, v74
v_mfma_f32_16x16x32_bf16 v[204:207], v[52:55], v[96:99], v[204:207]
v_mul_f32 v70, v70, v74
v_mul_f32 v71, v71, v74
v_mfma_f32_16x16x32_bf16 v[208:211], v[44:47], v[100:103], 0
v_cvt_pk_bf16_f32 v68, v68, v69
v_cvt_pk_bf16_f32 v64, v188, v192
v_mfma_f32_16x16x32_bf16 v[208:211], v[52:55], v[104:107], v[208:211]
v_cvt_pk_bf16_f32 v76, v189, v193
v_cvt_pk_bf16_f32 v78, v190, v194
v_mfma_f32_16x16x32_bf16 v[212:215], v[44:47], v[108:111], 0
v_cvt_pk_bf16_f32 v80, v191, v195
v_mul_f32 v86, v86, v74
v_mfma_f32_16x16x32_bf16 v[212:215], v[52:55], v[112:115], v[212:215]
v_cvt_pk_bf16_f32 v69, v70, v71
v_cvt_pk_bf16_f32 v70, v86, 0
v_mfma_f32_16x16x32_bf16 v[216:219], v[44:47], v[116:119], 0
v_mov_b32 v71, 0
v_cvt_pk_bf16_f32 v65, v196, v200
v_mfma_f32_16x16x32_bf16 v[216:219], v[52:55], v[120:123], v[216:219]
buffer_store_dwordx2 v[64:65], v14, s[12:15], s28 offen offset:0 sc1
v_cvt_pk_bf16_f32 v77, v197, v201
v_mfma_f32_16x16x32_bf16 v[188:191], v[60:63], v[92:95], 0
v_cvt_pk_bf16_f32 v79, v198, v202
v_cvt_pk_bf16_f32 v81, v199, v203
v_mfma_f32_16x16x32_bf16 v[188:191], v[68:71], v[96:99], v[188:191]
buffer_store_dwordx2 v[76:77], v14, s[12:15], s28 offen offset:384 sc1
v_add_f32 v64, v244, v245
v_mfma_f32_16x16x32_bf16 v[192:195], v[60:63], v[100:103], 0
v_cvt_pk_bf16_f32 v64, v64, v64
v_cvt_pk_bf16_f32 v82, v205, v209
v_mfma_f32_16x16x32_bf16 v[192:195], v[68:71], v[104:107], v[192:195]
buffer_store_short v64, v17, s[12:15], s28 offen offset:0 sc1
v_cvt_pk_bf16_f32 v64, v204, v208
v_mfma_f32_16x16x32_bf16 v[196:199], v[60:63], v[108:111], 0
v_cvt_pk_bf16_f32 v84, v206, v210
v_cvt_pk_bf16_f32 v86, v207, v211
v_mfma_f32_16x16x32_bf16 v[196:199], v[68:71], v[112:115], v[196:199]
buffer_store_dwordx2 v[78:79], v14, s[12:15], s28 offen offset:768 sc1
v_cvt_pk_bf16_f32 v65, v212, v216
v_mfma_f32_16x16x32_bf16 v[200:203], v[60:63], v[116:119], 0
v_cvt_pk_bf16_f32 v83, v213, v217
v_cvt_pk_bf16_f32 v85, v214, v218
v_mfma_f32_16x16x32_bf16 v[200:203], v[68:71], v[120:123], v[200:203]
v_cvt_pk_bf16_f32 v87, v215, v219
v_cvt_pk_bf16_f32 v151, v234, v235
v_mfma_f32_16x16x32_bf16 v[204:207], v[28:31], v[124:127], 0
buffer_store_dwordx2 v[80:81], v14, s[12:15], s28 offen offset:1152 sc1
v_cvt_pk_bf16_f32 v152, v220, v221
v_mfma_f32_16x16x32_bf16 v[204:207], v[36:39], v[128:131], v[204:207]
v_cvt_pk_bf16_f32 v153, v222, v223
v_cvt_pk_bf16_f32 v76, v188, v192
v_mfma_f32_16x16x32_bf16 v[208:211], v[28:31], v[132:135], 0
v_mov_b64 v[244:245], 0
v_mfma_f32_16x16x32_bf16 v[208:211], v[36:39], v[136:139], v[208:211]
v_cvt_pk_bf16_f32 v78, v189, v193
v_cvt_pk_bf16_f32 v66, v190, v194
v_mfma_f32_16x16x32_bf16 v[212:215], v[28:31], v[140:143], 0
v_cvt_pk_bf16_f32 v88, v191, v195
v_cvt_pk_bf16_f32 v77, v196, v200
v_mfma_f32_16x16x32_bf16 v[212:215], v[36:39], v[144:147], v[212:215]
buffer_store_dwordx2 v[64:65], v15, s[12:15], s28 offen offset:0 sc1
v_cvt_pk_bf16_f32 v79, v197, v201
v_mfma_f32_16x16x32_bf16 v[216:219], v[28:31], v[148:151], 0
v_cvt_pk_bf16_f32 v67, v198, v202
v_cvt_pk_bf16_f32 v89, v199, v203
v_mfma_f32_16x16x32_bf16 v[216:219], v[36:39], v[152:155], v[216:219]
ds_read_b128 a[192:195], v2 offset:57344
ds_read_b128 a[196:199], v2 offset:58368
v_smfmac_f32_16x16x64_bf16 v[244:247], a[240:243], v[124:131], v0
v_cvt_pk_bf16_f32 v92, v204, v208
v_smfmac_f32_16x16x64_bf16 v[244:247], a[244:247], v[132:139], v0
v_cvt_pk_bf16_f32 v94, v205, v209
v_smfmac_f32_16x16x64_bf16 v[244:247], a[248:251], v[140:147], v0
v_cvt_pk_bf16_f32 v64, v206, v210
v_smfmac_f32_16x16x64_bf16 v[244:247], a[252:255], v[148:155], v0
v_cvt_pk_bf16_f32 v100, v207, v211
v_mfma_f32_16x16x32_bf16 v[188:191], v[44:47], v[124:127], 0
buffer_store_dwordx2 v[82:83], v15, s[12:15], s29 offen offset:0 sc1
ds_read_b128 a[200:203], v2 offset:59392
v_mfma_f32_16x16x32_bf16 v[188:191], v[52:55], v[128:131], v[188:191]
buffer_store_dwordx2 v[84:85], v15, s[12:15], s30 offen offset:0 sc1
ds_read_b128 a[204:207], v2 offset:60416
v_mfma_f32_16x16x32_bf16 v[192:195], v[44:47], v[132:135], 0
ds_read_b128 a[208:211], v2 offset:61440
ds_read_b128 a[212:215], v2 offset:62464
v_mfma_f32_16x16x32_bf16 v[192:195], v[52:55], v[136:139], v[192:195]
v_cvt_pk_bf16_f32 v93, v212, v216
v_cvt_pk_bf16_f32 v95, v213, v217
v_mfma_f32_16x16x32_bf16 v[196:199], v[44:47], v[140:143], 0
v_cvt_pk_bf16_f32 v65, v214, v218
v_cvt_pk_bf16_f32 v101, v215, v219
v_mfma_f32_16x16x32_bf16 v[196:199], v[52:55], v[144:147], v[196:199]
ds_read_b128 a[216:219], v2 offset:63488
ds_read_b128 a[220:223], v2 offset:64512
v_mfma_f32_16x16x32_bf16 v[200:203], v[44:47], v[148:151], 0
ds_read_b128 a[224:227], v3 offset:0
ds_read_b128 a[228:231], v3 offset:1024
v_mfma_f32_16x16x32_bf16 v[200:203], v[52:55], v[152:155], v[200:203]
ds_read_b128 a[232:235], v3 offset:2048
ds_read_b128 a[236:239], v3 offset:3072
v_mfma_f32_16x16x32_bf16 v[204:207], v[60:63], v[124:127], 0
v_add_f32 v80, v244, v245
v_cvt_pk_bf16_f32 v80, v80, v80
v_mfma_f32_16x16x32_bf16 v[204:207], v[68:71], v[128:131], v[204:207]
buffer_store_short v80, v17, s[12:15], s28 offen offset:128 sc1
v_cvt_pk_bf16_f32 v82, v188, v192
v_mfma_f32_16x16x32_bf16 v[208:211], v[60:63], v[132:135], 0
buffer_store_dwordx2 v[86:87], v15, s[12:15], s31 offen offset:0 sc1
v_cvt_pk_bf16_f32 v84, v189, v193
v_mfma_f32_16x16x32_bf16 v[208:211], v[68:71], v[136:139], v[208:211]
v_cvt_pk_bf16_f32 v102, v190, v194
v_cvt_pk_bf16_f32 v90, v191, v195
v_mfma_f32_16x16x32_bf16 v[212:215], v[60:63], v[140:143], 0
v_cvt_pk_bf16_f32 v83, v196, v200
v_cvt_pk_bf16_f32 v85, v197, v201
v_mfma_f32_16x16x32_bf16 v[212:215], v[68:71], v[144:147], v[212:215]
v_cvt_pk_bf16_f32 v103, v198, v202
v_cvt_pk_bf16_f32 v91, v199, v203
v_mfma_f32_16x16x32_bf16 v[216:219], v[60:63], v[148:151], 0
buffer_store_dwordx2 v[76:77], v16, s[12:15], s28 offen offset:0 sc1
v_cvt_pk_bf16_f32 v80, v204, v208
v_mfma_f32_16x16x32_bf16 v[216:219], v[68:71], v[152:155], v[216:219]
s_waitcnt lgkmcnt(11)
v_cvt_pk_bf16_f32 v86, v205, v209
v_cvt_pk_bf16_f32 v108, v206, v210
v_mfma_f32_16x16x32_bf16 v[224:227], a[72:75], a[192:195], 0
s_waitcnt lgkmcnt(10)
v_cvt_pk_bf16_f32 v110, v207, v211
v_mfma_f32_16x16x32_bf16 v[224:227], a[76:79], a[196:199], v[224:227]
s_waitcnt lgkmcnt(9)
v_mfma_f32_16x16x32_bf16 v[224:227], a[80:83], a[200:203], v[224:227]
s_waitcnt lgkmcnt(8)
v_mfma_f32_16x16x32_bf16 v[224:227], a[84:87], a[204:207], v[224:227]
buffer_store_dwordx2 v[78:79], v16, s[12:15], s28 offen offset:384 sc1
s_waitcnt lgkmcnt(7)
v_cvt_pk_bf16_f32 v81, v212, v216
v_mfma_f32_16x16x32_bf16 v[224:227], a[88:91], a[208:211], v[224:227]
s_waitcnt lgkmcnt(6)
v_cvt_pk_bf16_f32 v87, v213, v217
v_cvt_pk_bf16_f32 v109, v214, v218
v_mfma_f32_16x16x32_bf16 v[224:227], a[92:95], a[212:215], v[224:227]
v_cvt_pk_bf16_f32 v111, v215, v219
v_mfma_f32_16x16x32_bf16 v[228:231], a[96:99], a[192:195], 0
v_mfma_f32_16x16x32_bf16 v[228:231], a[100:103], a[196:199], v[228:231]
buffer_store_dwordx2 v[66:67], v16, s[12:15], s29 offen offset:0 sc1
v_mfma_f32_16x16x32_bf16 v[228:231], a[104:107], a[200:203], v[228:231]
v_mfma_f32_16x16x32_bf16 v[228:231], a[108:111], a[204:207], v[228:231]
v_mfma_f32_16x16x32_bf16 v[228:231], a[112:115], a[208:211], v[228:231]
v_mfma_f32_16x16x32_bf16 v[228:231], a[116:119], a[212:215], v[228:231]
buffer_store_dwordx2 v[88:89], v16, s[12:15], s29 offen offset:384 sc1
v_cvt_pk_bf16_f32 v156, v224, v225
v_mfma_f32_16x16x32_bf16 v[232:235], a[120:123], a[192:195], 0
v_cvt_pk_bf16_f32 v157, v226, v227
v_mfma_f32_16x16x32_bf16 v[232:235], a[124:127], a[196:199], v[232:235]
ds_read_b128 a[192:195], v3 offset:4096
ds_read_b128 a[196:199], v3 offset:5120
v_mfma_f32_16x16x32_bf16 v[232:235], a[128:131], a[200:203], v[232:235]
ds_read_b128 a[200:203], v3 offset:6144
v_cvt_pk_bf16_f32 v158, v228, v229
v_mfma_f32_16x16x32_bf16 v[232:235], a[132:135], a[204:207], v[232:235]
buffer_store_dwordx2 v[92:93], v14, s[12:15], s28 offen offset:128 sc1
ds_read_b128 a[204:207], v3 offset:7168
v_mfma_f32_16x16x32_bf16 v[232:235], a[136:139], a[208:211], v[232:235]
v_cvt_pk_bf16_f32 v159, v230, v231
v_mfma_f32_16x16x32_bf16 v[232:235], a[140:143], a[212:215], v[232:235]
s_waitcnt lgkmcnt(9)
ds_read_b128 a[208:211], v3 offset:8192
ds_read_b128 a[212:215], v3 offset:9216
v_mfma_f32_16x16x32_bf16 v[220:223], a[72:75], a[216:219], 0
s_waitcnt lgkmcnt(10)
v_mfma_f32_16x16x32_bf16 v[220:223], a[76:79], a[220:223], v[220:223]
s_waitcnt lgkmcnt(9)
v_mfma_f32_16x16x32_bf16 v[220:223], a[80:83], a[224:227], v[220:223]
buffer_store_dwordx2 v[94:95], v14, s[12:15], s28 offen offset:512 sc1
s_waitcnt lgkmcnt(8)
v_mfma_f32_16x16x32_bf16 v[220:223], a[84:87], a[228:231], v[220:223]
s_waitcnt lgkmcnt(7)
v_mfma_f32_16x16x32_bf16 v[220:223], a[88:91], a[232:235], v[220:223]
s_waitcnt lgkmcnt(6)
v_cvt_pk_bf16_f32 v160, v232, v233
v_cvt_pk_bf16_f32 v161, v234, v235
v_mfma_f32_16x16x32_bf16 v[220:223], a[92:95], a[236:239], v[220:223]
v_mfma_f32_16x16x32_bf16 v[224:227], a[96:99], a[216:219], 0
buffer_store_dwordx2 v[64:65], v14, s[12:15], s28 offen offset:896 sc1
v_mfma_f32_16x16x32_bf16 v[224:227], a[100:103], a[220:223], v[224:227]
v_mfma_f32_16x16x32_bf16 v[224:227], a[104:107], a[224:227], v[224:227]
v_mfma_f32_16x16x32_bf16 v[224:227], a[108:111], a[228:231], v[224:227]
v_mfma_f32_16x16x32_bf16 v[224:227], a[112:115], a[232:235], v[224:227]
buffer_store_dwordx2 v[100:101], v14, s[12:15], s28 offen offset:1280 sc1
v_mfma_f32_16x16x32_bf16 v[224:227], a[116:119], a[236:239], v[224:227]
v_cvt_pk_bf16_f32 v164, v220, v221
v_cvt_pk_bf16_f32 v165, v222, v223
v_mfma_f32_16x16x32_bf16 v[228:231], a[120:123], a[216:219], 0
ds_read_b128 a[216:219], v3 offset:10240
v_mfma_f32_16x16x32_bf16 v[228:231], a[124:127], a[220:223], v[228:231]
ds_read_b128 a[220:223], v3 offset:11264
v_mfma_f32_16x16x32_bf16 v[228:231], a[128:131], a[224:227], v[228:231]
ds_read_b128 a[224:227], v3 offset:12288
v_cvt_pk_bf16_f32 v166, v224, v225
v_mfma_f32_16x16x32_bf16 v[228:231], a[132:135], a[228:231], v[228:231]
buffer_store_dwordx2 v[82:83], v15, s[12:15], s28 offen offset:128 sc1
ds_read_b128 a[228:231], v3 offset:13312
v_mfma_f32_16x16x32_bf16 v[228:231], a[136:139], a[232:235], v[228:231]
v_cvt_pk_bf16_f32 v167, v226, v227
v_mfma_f32_16x16x32_bf16 v[228:231], a[140:143], a[236:239], v[228:231]
s_waitcnt lgkmcnt(9)
ds_read_b128 a[232:235], v3 offset:14336
ds_read_b128 a[236:239], v3 offset:15360
v_mfma_f32_16x16x32_bf16 v[232:235], a[72:75], a[192:195], 0
s_waitcnt lgkmcnt(10)
v_mfma_f32_16x16x32_bf16 v[232:235], a[76:79], a[196:199], v[232:235]
buffer_store_dwordx2 v[84:85], v15, s[12:15], s29 offen offset:128 sc1
s_waitcnt lgkmcnt(9)
v_mfma_f32_16x16x32_bf16 v[232:235], a[80:83], a[200:203], v[232:235]
s_waitcnt lgkmcnt(8)
v_mfma_f32_16x16x32_bf16 v[232:235], a[84:87], a[204:207], v[232:235]
s_waitcnt lgkmcnt(7)
v_mfma_f32_16x16x32_bf16 v[232:235], a[88:91], a[208:211], v[232:235]
s_waitcnt lgkmcnt(6)
v_cvt_pk_bf16_f32 v168, v228, v229
v_cvt_pk_bf16_f32 v169, v230, v231
v_mfma_f32_16x16x32_bf16 v[232:235], a[92:95], a[212:215], v[232:235]
buffer_store_dwordx2 v[102:103], v15, s[12:15], s30 offen offset:128 sc1
v_mfma_f32_16x16x32_bf16 v[220:223], a[96:99], a[192:195], 0
v_mfma_f32_16x16x32_bf16 v[220:223], a[100:103], a[196:199], v[220:223]
v_mfma_f32_16x16x32_bf16 v[220:223], a[104:107], a[200:203], v[220:223]
v_mfma_f32_16x16x32_bf16 v[220:223], a[108:111], a[204:207], v[220:223]
v_mfma_f32_16x16x32_bf16 v[220:223], a[112:115], a[208:211], v[220:223]
buffer_store_dwordx2 v[90:91], v15, s[12:15], s31 offen offset:128 sc1
v_mfma_f32_16x16x32_bf16 v[220:223], a[116:119], a[212:215], v[220:223]
v_cvt_pk_bf16_f32 v172, v232, v233
v_cvt_pk_bf16_f32 v173, v234, v235
v_mfma_f32_16x16x32_bf16 v[224:227], a[120:123], a[192:195], 0
v_mfma_f32_16x16x32_bf16 v[224:227], a[124:127], a[196:199], v[224:227]
v_mfma_f32_16x16x32_bf16 v[224:227], a[128:131], a[200:203], v[224:227]
buffer_store_dwordx2 v[80:81], v16, s[12:15], s28 offen offset:128 sc1
v_mfma_f32_16x16x32_bf16 v[224:227], a[132:135], a[204:207], v[224:227]
v_mfma_f32_16x16x32_bf16 v[224:227], a[136:139], a[208:211], v[224:227]
v_cvt_pk_bf16_f32 v174, v220, v221
v_cvt_pk_bf16_f32 v175, v222, v223
v_mfma_f32_16x16x32_bf16 v[224:227], a[140:143], a[212:215], v[224:227]
s_waitcnt lgkmcnt(5)
v_mfma_f32_16x16x32_bf16 v[228:231], a[72:75], a[216:219], 0
buffer_store_dwordx2 v[86:87], v16, s[12:15], s28 offen offset:512 sc1
s_waitcnt lgkmcnt(4)
v_mfma_f32_16x16x32_bf16 v[228:231], a[76:79], a[220:223], v[228:231]
s_waitcnt lgkmcnt(3)
v_mfma_f32_16x16x32_bf16 v[228:231], a[80:83], a[224:227], v[228:231]
s_waitcnt lgkmcnt(2)
v_mfma_f32_16x16x32_bf16 v[228:231], a[84:87], a[228:231], v[228:231]
s_waitcnt lgkmcnt(1)
v_mfma_f32_16x16x32_bf16 v[228:231], a[88:91], a[232:235], v[228:231]
buffer_store_dwordx2 v[108:109], v16, s[12:15], s29 offen offset:128 sc1
s_waitcnt lgkmcnt(0)
v_mfma_f32_16x16x32_bf16 v[228:231], a[92:95], a[236:239], v[228:231]
v_cvt_pk_bf16_f32 v176, v224, v225
v_cvt_pk_bf16_f32 v177, v226, v227
v_mfma_f32_16x16x32_bf16 v[232:235], a[96:99], a[216:219], 0
v_mfma_f32_16x16x32_bf16 v[232:235], a[100:103], a[220:223], v[232:235]
v_mfma_f32_16x16x32_bf16 v[232:235], a[104:107], a[224:227], v[232:235]
v_mfma_f32_16x16x32_bf16 v[232:235], a[108:111], a[228:231], v[232:235]
buffer_store_dwordx2 v[110:111], v16, s[12:15], s29 offen offset:512 sc1
v_mfma_f32_16x16x32_bf16 v[232:235], a[112:115], a[232:235], v[232:235]
v_cvt_pk_bf16_f32 v180, v228, v229
v_cvt_pk_bf16_f32 v181, v230, v231
v_mfma_f32_16x16x32_bf16 v[232:235], a[116:119], a[236:239], v[232:235]
v_mfma_f32_16x16x32_bf16 v[220:223], a[120:123], a[216:219], 0
v_mov_b64 v[244:245], 0
v_mfma_f32_16x16x32_bf16 v[220:223], a[124:127], a[220:223], v[220:223]
s_nop 0
s_nop 0
s_nop 0
v_mfma_f32_16x16x32_bf16 v[220:223], a[128:131], a[224:227], v[220:223]
s_nop 0
v_cvt_pk_bf16_f32 v182, v232, v233
v_cvt_pk_bf16_f32 v183, v234, v235
v_mfma_f32_16x16x32_bf16 v[220:223], a[132:135], a[228:231], v[220:223]
v_mfma_f32_16x16x32_bf16 v[220:223], a[136:139], a[232:235], v[220:223]
v_mfma_f32_16x16x32_bf16 v[220:223], a[140:143], a[236:239], v[220:223]
v_mfma_f32_16x16x32_bf16 v[204:207], v[28:31], v[156:159], 0
s_nop 0
s_nop 0
s_nop 0
v_mfma_f32_16x16x32_bf16 v[204:207], v[36:39], v[160:163], v[204:207]
s_nop 0
s_nop 0
s_nop 0
v_mfma_f32_16x16x32_bf16 v[208:211], v[28:31], v[164:167], 0
v_cvt_pk_bf16_f32 v184, v220, v221
v_cvt_pk_bf16_f32 v185, v222, v223
v_mfma_f32_16x16x32_bf16 v[208:211], v[36:39], v[168:171], v[208:211]
v_mfma_f32_16x16x32_bf16 v[212:215], v[28:31], v[172:175], 0
v_mfma_f32_16x16x32_bf16 v[212:215], v[36:39], v[176:179], v[212:215]
v_mfma_f32_16x16x32_bf16 v[216:219], v[28:31], v[180:183], 0
v_mfma_f32_16x16x32_bf16 v[216:219], v[36:39], v[184:187], v[216:219]
v_smfmac_f32_16x16x64_bf16 v[244:247], a[240:243], v[156:163], v0
v_smfmac_f32_16x16x64_bf16 v[244:247], a[244:247], v[164:171], v0
s_nop 0
s_nop 0
v_smfmac_f32_16x16x64_bf16 v[244:247], a[248:251], v[172:179], v0
v_cvt_pk_bf16_f32 v92, v204, v208
v_smfmac_f32_16x16x64_bf16 v[244:247], a[252:255], v[180:187], v0
v_cvt_pk_bf16_f32 v140, v205, v209
v_mfma_f32_16x16x32_bf16 v[188:191], v[44:47], v[156:159], 0
v_cvt_pk_bf16_f32 v94, v206, v210
v_cvt_pk_bf16_f32 v142, v207, v211
v_mfma_f32_16x16x32_bf16 v[188:191], v[52:55], v[160:163], v[188:191]
v_cvt_pk_bf16_f32 v93, v212, v216
v_cvt_pk_bf16_f32 v141, v213, v217
v_mfma_f32_16x16x32_bf16 v[192:195], v[44:47], v[164:167], 0
v_cvt_pk_bf16_f32 v95, v214, v218
v_cvt_pk_bf16_f32 v143, v215, v219
v_mfma_f32_16x16x32_bf16 v[192:195], v[52:55], v[168:171], v[192:195]
buffer_store_dwordx2 v[92:93], v14, s[12:15], s28 offen offset:256 sc1
v_add_f32 v92, v244, v245
v_mfma_f32_16x16x32_bf16 v[196:199], v[44:47], v[172:175], 0
buffer_store_dwordx2 v[140:141], v14, s[12:15], s28 offen offset:640 sc1
v_cvt_pk_bf16_f32 v92, v92, v92
v_mfma_f32_16x16x32_bf16 v[196:199], v[52:55], v[176:179], v[196:199]
buffer_store_dwordx2 v[94:95], v14, s[12:15], s28 offen offset:1024 sc1
v_mfma_f32_16x16x32_bf16 v[200:203], v[44:47], v[180:183], 0
buffer_store_dwordx2 v[142:143], v14, s[12:15], s28 offen offset:1408 sc1
buffer_store_short v92, v17, s[12:15], s28 offen offset:256 sc1
v_mfma_f32_16x16x32_bf16 v[200:203], v[52:55], v[184:187], v[200:203]
v_cvt_pk_bf16_f32 v92, v188, v192
v_cvt_pk_bf16_f32 v140, v189, v193
v_mfma_f32_16x16x32_bf16 v[204:207], v[60:63], v[156:159], 0
s_nop 0
v_cvt_pk_bf16_f32 v94, v190, v194
v_cvt_pk_bf16_f32 v142, v191, v195
v_mfma_f32_16x16x32_bf16 v[204:207], v[68:71], v[160:163], v[204:207]
s_nop 0
v_cvt_pk_bf16_f32 v93, v196, v200
v_cvt_pk_bf16_f32 v141, v197, v201
v_mfma_f32_16x16x32_bf16 v[208:211], v[60:63], v[164:167], 0
v_cvt_pk_bf16_f32 v95, v198, v202
v_cvt_pk_bf16_f32 v143, v199, v203
v_mfma_f32_16x16x32_bf16 v[208:211], v[68:71], v[168:171], v[208:211]
buffer_store_dwordx2 v[92:93], v15, s[12:15], s28 offen offset:256 sc1
buffer_store_dwordx2 v[140:141], v15, s[12:15], s29 offen offset:256 sc1
v_mfma_f32_16x16x32_bf16 v[212:215], v[60:63], v[172:175], 0
s_nop 0
buffer_store_dwordx2 v[94:95], v15, s[12:15], s30 offen offset:256 sc1
buffer_store_dwordx2 v[142:143], v15, s[12:15], s31 offen offset:256 sc1
v_mfma_f32_16x16x32_bf16 v[212:215], v[68:71], v[176:179], v[212:215]
s_nop 0
v_cvt_pk_bf16_f32 v92, v204, v208
v_cvt_pk_bf16_f32 v140, v205, v209
v_mfma_f32_16x16x32_bf16 v[216:219], v[60:63], v[180:183], 0
v_cvt_pk_bf16_f32 v94, v206, v210
v_cvt_pk_bf16_f32 v142, v207, v211
v_mfma_f32_16x16x32_bf16 v[216:219], v[68:71], v[184:187], v[216:219]
s_nop 0
s_nop 0
s_nop 0
s_nop 0
s_nop 0
s_nop 0
s_nop 0
s_nop 0
v_cvt_pk_bf16_f32 v93, v212, v216
v_cvt_pk_bf16_f32 v141, v213, v217
v_cvt_pk_bf16_f32 v95, v214, v218
v_cvt_pk_bf16_f32 v143, v215, v219
buffer_store_dwordx2 v[92:93], v16, s[12:15], s28 offen offset:256 sc1
buffer_store_dwordx2 v[140:141], v16, s[12:15], s28 offen offset:640 sc1
buffer_store_dwordx2 v[94:95], v16, s[12:15], s29 offen offset:256 sc1
buffer_store_dwordx2 v[142:143], v16, s[12:15], s29 offen offset:640 sc1
s_endpgm
L_co2w:
LW_p16:
s_cbranch_execz LW_p4
v_lshrrev_b32 v91, 4, v1
v_and_b32 v91, 48, v91
s_nop 1
v_cvt_pk_bf16_f32 v252, v192, v193
v_cvt_pk_bf16_f32 v253, v194, v195
v_xor_b32 v248, v8, v91
ds_write_b64 v67, v[252:253] offset:1024
v_xor_b32 v249, v9, v91
v_xor_b32 v249, 64, v249
v_subrev_u32 v252, s86, v6
v_xor_b32 v253, 64, v252
v_cvt_pk_bf16_f32 v250, v188, v189
v_cvt_pk_bf16_f32 v251, v190, v191
v_cvt_pk_bf16_f32 v244, v196, v197
v_cvt_pk_bf16_f32 v245, v198, v199
v_cvt_pk_bf16_f32 v246, v200, v201
v_cvt_pk_bf16_f32 v247, v202, v203
ds_write_b64 v67, v[250:251] offset:0
ds_write_b64 v67, v[244:245] offset:2048
ds_write_b64 v67, v[246:247] offset:3072
v_subrev_u32 v250, s85, v6
ds_read_b128 a[192:195], v1 offset:0
v_xor_b32 v251, 64, v250
ds_read_b128 a[196:199], v1 offset:1024
ds_read_b128 a[200:203], v1 offset:2048
ds_read_b128 a[204:207], v1 offset:3072
ds_read_b128 a[208:211], v1 offset:4096
ds_read_b128 a[212:215], v1 offset:5120
ds_read_b128 a[216:219], v1 offset:6144
ds_read_b128 a[220:223], v1 offset:7168
ds_read_b128 a[224:227], v1 offset:8192
ds_read_b128 a[228:231], v1 offset:9216
ds_read_b128 a[232:235], v1 offset:10240
ds_read_b128 a[236:239], v1 offset:11264
s_mov_b32 s98, 0x11111111
s_mov_b32 s99, 0x11111111
s_waitcnt vmcnt(20) lgkmcnt(12)
s_barrier
ds_read_b128 v[156:159], v68 offset:0
LW_p17:
s_cbranch_execz LW_p5
ds_read_b128 v[160:163], v68 offset:4096
ds_read_b128 v[164:167], v68 offset:8192
ds_read_b128 v[168:171], v68 offset:12288
ds_read_b128 v[172:175], v68 offset:16384
ds_read_b128 v[176:179], v68 offset:20480
s_add_u32 m0, s43, 0
s_nop 0
buffer_load_dwordx4 v248, s[20:23], s28 offen offset:0 nt lds
ds_read_b128 a[144:147], v250 offset:6144
ds_read_b128 a[148:151], v251 offset:6144
s_add_u32 m0, s43, 1024
ds_read_b128 a[152:155], v250 offset:8192
ds_read_b128 a[156:159], v251 offset:8192
buffer_load_dwordx4 v249, s[20:23], s28 offen offset:0 nt lds
ds_read_b128 a[160:163], v250 offset:10240
s_waitcnt lgkmcnt(10)
v_mfma_f32_16x16x32_bf16 v[28:31], a[0:3], v[156:159], 0
ds_read_b128 a[164:167], v251 offset:10240
v_mfma_f32_16x16x32_bf16 v[32:35], a[24:27], v[156:159], 0
s_add_u32 m0, s43, 1920
v_mfma_f32_16x16x32_bf16 v[36:39], a[48:51], v[156:159], 0
v_mfma_f32_16x16x32_bf16 v[40:43], a[168:171], v[156:159], v[24:27]
buffer_load_dwordx4 v248, s[20:23], s28 offen offset:128 nt lds
s_waitcnt lgkmcnt(10)
v_mfma_f32_16x16x32_bf16 v[28:31], a[4:7], v[160:163], v[28:31]
v_mfma_f32_16x16x32_bf16 v[32:35], a[28:31], v[160:163], v[32:35]
s_add_u32 m0, s43, 2944
v_mfma_f32_16x16x32_bf16 v[36:39], a[52:55], v[160:163], v[36:39]
v_mfma_f32_16x16x32_bf16 v[40:43], a[172:175], v[160:163], v[40:43]
buffer_load_dwordx4 v249, s[20:23], s28 offen offset:128 nt lds
s_waitcnt lgkmcnt(9)
v_mfma_f32_16x16x32_bf16 v[28:31], a[8:11], v[164:167], v[28:31]
v_mfma_f32_16x16x32_bf16 v[32:35], a[32:35], v[164:167], v[32:35]
s_add_u32 m0, s43, 3840
v_mfma_f32_16x16x32_bf16 v[36:39], a[56:59], v[164:167], v[36:39]
v_mfma_f32_16x16x32_bf16 v[40:43], a[176:179], v[164:167], v[40:43]
buffer_load_dwordx4 v248, s[20:23], s28 offen offset:256 nt lds
s_waitcnt lgkmcnt(8)
v_xor_b32 v248, v10, v91
v_mfma_f32_16x16x32_bf16 v[28:31], a[12:15], v[168:171], v[28:31]
v_mfma_f32_16x16x32_bf16 v[32:35], a[36:39], v[168:171], v[32:35]
s_add_u32 m0, s43, 4864
v_mfma_f32_16x16x32_bf16 v[36:39], a[60:63], v[168:171], v[36:39]
v_mfma_f32_16x16x32_bf16 v[40:43], a[180:183], v[168:171], v[40:43]
buffer_load_dwordx4 v249, s[20:23], s28 offen offset:256 nt lds
s_waitcnt lgkmcnt(7)
v_xor_b32 v249, v11, v91
v_mfma_f32_16x16x32_bf16 v[28:31], a[16:19], v[172:175], v[28:31]
v_xor_b32 v249, 64, v249
v_mfma_f32_16x16x32_bf16 v[32:35], a[40:43], v[172:175], v[32:35]
v_mfma_f32_16x16x32_bf16 v[36:39], a[64:67], v[172:175], v[36:39]
s_waitcnt vmcnt(15)
ds_read_b128 v[180:183], v250 offset:0
v_mfma_f32_16x16x32_bf16 v[40:43], a[184:187], v[172:175], v[40:43]
s_waitcnt vmcnt(14) lgkmcnt(7)
ds_read_b128 v[184:187], v251 offset:0
v_mfma_f32_16x16x32_bf16 v[28:31], a[20:23], v[176:179], v[28:31]
ds_read_b128 v[164:167], v250 offset:2048
v_mfma_f32_16x16x32_bf16 v[32:35], a[44:47], v[176:179], v[32:35]
ds_read_b128 v[168:171], v251 offset:2048
v_mfma_f32_16x16x32_bf16 v[36:39], a[68:71], v[176:179], v[36:39]
ds_read_b128 v[172:175], v250 offset:4096
v_mfma_f32_16x16x32_bf16 v[40:43], a[188:191], v[176:179], v[40:43]
s_waitcnt lgkmcnt(10)
ds_read_b128 v[176:179], v251 offset:4096
v_mfma_f32_16x16x32_bf16 v[188:191], a[192:195], a[144:147], 0
s_waitcnt lgkmcnt(10)
v_mfma_f32_16x16x32_bf16 v[188:191], a[196:199], a[148:151], v[188:191]
s_waitcnt lgkmcnt(9)
v_mfma_f32_16x16x32_bf16 v[188:191], a[200:203], a[152:155], v[188:191]
s_waitcnt lgkmcnt(8)
v_mfma_f32_16x16x32_bf16 v[188:191], a[204:207], a[156:159], v[188:191]
s_waitcnt lgkmcnt(7)
v_mfma_f32_16x16x32_bf16 v[188:191], a[208:211], a[160:163], v[188:191]
s_waitcnt lgkmcnt(6)
v_mfma_f32_16x16x32_bf16 v[188:191], a[212:215], a[164:167], v[188:191]
s_waitcnt lgkmcnt(5)
v_mfma_f32_16x16x32_bf16 v[192:195], a[192:195], v[180:183], 0
s_waitcnt lgkmcnt(4)
ds_read_b128 a[192:195], v1 offset:12288
v_max3_f32 v42, v28, v29, v30
v_mfma_f32_16x16x32_bf16 v[192:195], a[196:199], v[184:187], v[192:195]
s_waitcnt lgkmcnt(4)
ds_read_b128 a[196:199], v1 offset:13312
v_max3_f32 v42, v42, v31, v32
v_mfma_f32_16x16x32_bf16 v[192:195], a[200:203], v[164:167], v[192:195]
s_waitcnt lgkmcnt(4)
ds_read_b128 a[200:203], v1 offset:14336
v_max3_f32 v42, v42, v33, v34
v_mfma_f32_16x16x32_bf16 v[192:195], a[204:207], v[168:171], v[192:195]
s_waitcnt lgkmcnt(4)
ds_read_b128 a[204:207], v1 offset:15360
v_max3_f32 v42, v42, v35, v36
v_mfma_f32_16x16x32_bf16 v[192:195], a[208:211], v[172:175], v[192:195]
s_waitcnt lgkmcnt(4)
ds_read_b128 a[208:211], v1 offset:16384
v_max3_f32 v42, v42, v37, v38
v_mfma_f32_16x16x32_bf16 v[192:195], a[212:215], v[176:179], v[192:195]
ds_read_b128 a[212:215], v1 offset:17408
v_max3_f32 v42, v42, v39, v40
v_mfma_f32_16x16x32_bf16 v[196:199], a[216:219], a[144:147], 0
v_mov_b32 v43, v42
v_cvt_pk_bf16_f32 v188, v188, v189
v_mfma_f32_16x16x32_bf16 v[196:199], a[220:223], a[148:151], v[196:199]
v_permlane32_swap_b32 v42, v43
v_mfma_f32_16x16x32_bf16 v[196:199], a[224:227], a[152:155], v[196:199]
v_max_f32 v42, v42, v43
v_mov_b32 v43, v42
v_mfma_f32_16x16x32_bf16 v[196:199], a[228:231], a[156:159], v[196:199]
s_nop 0
v_permlane16_swap_b32 v42, v43
v_mfma_f32_16x16x32_bf16 v[196:199], a[232:235], a[160:163], v[196:199]
v_max_f32 v42, v42, v43
v_sub_f32 v28, v28, v42
v_mfma_f32_16x16x32_bf16 v[196:199], a[236:239], a[164:167], v[196:199]
v_sub_f32 v29, v29, v42
v_sub_f32 v30, v30, v42
v_mfma_f32_16x16x32_bf16 v[200:203], a[216:219], v[180:183], 0
ds_read_b128 a[216:219], v1 offset:18432
v_exp_f32 v28, v28
v_mfma_f32_16x16x32_bf16 v[200:203], a[220:223], v[184:187], v[200:203]
ds_read_b128 a[220:223], v1 offset:19456
v_exp_f32 v29, v29
v_mfma_f32_16x16x32_bf16 v[200:203], a[224:227], v[164:167], v[200:203]
ds_read_b128 a[224:227], v1 offset:20480
v_sub_f32 v31, v31, v42
v_mfma_f32_16x16x32_bf16 v[200:203], a[228:231], v[168:171], v[200:203]
ds_read_b128 a[228:231], v1 offset:21504
v_sub_f32 v32, v32, v42
v_mfma_f32_16x16x32_bf16 v[200:203], a[232:235], v[172:175], v[200:203]
ds_read_b128 a[232:235], v1 offset:22528
v_sub_f32 v33, v33, v42
v_mfma_f32_16x16x32_bf16 v[200:203], a[236:239], v[176:179], v[200:203]
s_waitcnt lgkmcnt(10)
ds_read_b128 a[236:239], v1 offset:23552
v_sub_f32 v34, v34, v42
v_mfma_f32_16x16x32_bf16 v[204:207], a[192:195], a[144:147], 0
s_waitcnt lgkmcnt(10)
v_sub_f32 v35, v35, v42
v_sub_f32 v36, v36, v42
v_mfma_f32_16x16x32_bf16 v[204:207], a[196:199], a[148:151], v[204:207]
s_waitcnt lgkmcnt(9)
v_sub_f32 v37, v37, v42
v_sub_f32 v38, v38, v42
v_mfma_f32_16x16x32_bf16 v[204:207], a[200:203], a[152:155], v[204:207]
s_waitcnt lgkmcnt(8)
v_sub_f32 v39, v39, v42
v_sub_f32 v40, v40, v42
v_mfma_f32_16x16x32_bf16 v[204:207], a[204:207], a[156:159], v[204:207]
s_waitcnt lgkmcnt(7)
v_exp_f32 v30, v30
v_mfma_f32_16x16x32_bf16 v[204:207], a[208:211], a[160:163], v[204:207]
s_waitcnt lgkmcnt(6)
v_exp_f32 v31, v31
v_mfma_f32_16x16x32_bf16 v[204:207], a[212:215], a[164:167], v[204:207]
v_add_f32 v42, v28, v29
v_exp_f32 v32, v32
v_mfma_f32_16x16x32_bf16 v[208:211], a[192:195], v[180:183], 0
v_add_f32 v42, v42, v30
v_exp_f32 v33, v33
v_mfma_f32_16x16x32_bf16 v[208:211], a[196:199], v[184:187], v[208:211]
v_add_f32 v42, v42, v31
v_exp_f32 v34, v34
v_mfma_f32_16x16x32_bf16 v[208:211], a[200:203], v[164:167], v[208:211]
v_add_f32 v42, v42, v32
v_exp_f32 v35, v35
v_mfma_f32_16x16x32_bf16 v[208:211], a[204:207], v[168:171], v[208:211]
v_add_f32 v42, v42, v33
v_exp_f32 v36, v36
v_mfma_f32_16x16x32_bf16 v[208:211], a[208:211], v[172:175], v[208:211]
v_add_f32 v42, v42, v34
v_exp_f32 v37, v37
v_mfma_f32_16x16x32_bf16 v[208:211], a[212:215], v[176:179], v[208:211]
s_waitcnt lgkmcnt(5)
v_add_f32 v42, v42, v35
v_exp_f32 v38, v38
v_mfma_f32_16x16x32_bf16 v[212:215], a[216:219], a[144:147], 0
s_waitcnt lgkmcnt(4)
v_add_f32 v42, v42, v36
v_exp_f32 v39, v39
v_mfma_f32_16x16x32_bf16 v[212:215], a[220:223], a[148:151], v[212:215]
s_waitcnt lgkmcnt(3)
v_add_f32 v42, v42, v37
v_exp_f32 v40, v40
v_mfma_f32_16x16x32_bf16 v[212:215], a[224:227], a[152:155], v[212:215]
s_waitcnt lgkmcnt(2)
v_add_f32 v42, v42, v38
v_add_f32 v42, v42, v39
v_mfma_f32_16x16x32_bf16 v[212:215], a[228:231], a[156:159], v[212:215]
s_waitcnt lgkmcnt(1)
v_add_f32 v42, v42, v40
v_mov_b32 v43, v42
v_mfma_f32_16x16x32_bf16 v[212:215], a[232:235], a[160:163], v[212:215]
s_waitcnt lgkmcnt(0)
v_permlane32_swap_b32 v42, v43
v_mfma_f32_16x16x32_bf16 v[212:215], a[236:239], a[164:167], v[212:215]
v_add_f32 v42, v42, v43
v_mov_b32 v43, v42
v_mfma_f32_16x16x32_bf16 v[216:219], a[216:219], v[180:183], 0
s_nop 0
ds_read_b128 a[192:195], v1 offset:24576
v_permlane16_swap_b32 v42, v43
v_mfma_f32_16x16x32_bf16 v[216:219], a[220:223], v[184:187], v[216:219]
ds_read_b128 a[196:199], v1 offset:25600
v_add_f32 v42, v42, v43
v_mfma_f32_16x16x32_bf16 v[216:219], a[224:227], v[164:167], v[216:219]
v_rcp_f32 v42, v42
v_mfma_f32_16x16x32_bf16 v[216:219], a[228:231], v[168:171], v[216:219]
ds_read_b128 a[200:203], v1 offset:26624
v_mul_f32 v28, v28, v42
v_mfma_f32_16x16x32_bf16 v[216:219], a[232:235], v[172:175], v[216:219]
v_mul_f32 v29, v29, v42
v_mul_f32 v36, v36, v42
v_mfma_f32_16x16x32_bf16 v[216:219], a[236:239], v[176:179], v[216:219]
s_waitcnt lgkmcnt(2)
v_mul_f32 v37, v37, v42
v_mul_f32 v30, v30, v42
v_mul_f32 v31, v31, v42
v_mul_f32 v38, v38, v42
v_mul_f32 v39, v39, v42
v_cvt_pk_bf16_f32 v28, v28, v29
v_cvt_pk_bf16_f32 v36, v36, v37
v_mul_f32 v32, v32, v42
v_mul_f32 v33, v33, v42
v_mul_f32 v34, v34, v42
v_mul_f32 v35, v35, v42
v_mul_f32 v40, v40, v42
v_cvt_pk_bf16_f32 v29, v30, v31
v_cvt_pk_bf16_f32 v37, v38, v39
v_cvt_pk_bf16_f32 v30, v32, v33
v_mfma_f32_16x16x32_bf16 v[220:223], a[192:195], a[144:147], 0
s_waitcnt lgkmcnt(1)
v_cvt_pk_bf16_f32 v31, v34, v35
v_cvt_pk_bf16_f32 v38, v40, 0
v_mov_b32 v39, 0
v_mfma_f32_16x16x32_bf16 v[220:223], a[196:199], a[148:151], v[220:223]
s_waitcnt lgkmcnt(0)
ds_read_b128 a[204:207], v1 offset:27648
ds_write_b64 v69, v[28:29] offset:0
ds_write_b64 v69, v[30:31] offset:4096
ds_write_b64 v69, v[36:37] offset:8192
v_mfma_f32_16x16x32_bf16 v[220:223], a[200:203], a[152:155], v[220:223]
ds_write_b64 v69, v[38:39] offset:12288
ds_read_b128 a[208:211], v1 offset:28672
ds_read_b128 a[212:215], v1 offset:29696
ds_read_b128 a[216:219], v1 offset:30720
ds_read_b128 a[220:223], v1 offset:31744
ds_read_b128 a[224:227], v1 offset:32768
ds_read_b128 a[228:231], v1 offset:33792
ds_read_b128 a[232:235], v1 offset:34816
ds_read_b128 a[236:239], v1 offset:35840
v_cvt_pk_bf16_f32 v189, v190, v191
s_mov_b64 exec, s[98:99]
ds_write2_b32 v90, v188, v189 offset0:0 offset1:48
s_mov_b64 exec, -1
v_cvt_pk_bf16_f32 v192, v192, v193
v_cvt_pk_bf16_f32 v193, v194, v195
ds_write2_b32 v83, v192, v193 offset0:0 offset1:48
v_cvt_pk_bf16_f32 v196, v196, v197
s_waitcnt lgkmcnt(10)
s_barrier
v_cvt_pk_bf16_f32 v197, v198, v199
v_cvt_pk_bf16_f32 v200, v200, v201
v_cvt_pk_bf16_f32 v201, v202, v203
v_cvt_pk_bf16_f32 v204, v204, v205
s_mov_b64 exec, s[98:99]
ds_write2_b32 v90, v196, v197 offset0:1 offset1:49
s_mov_b64 exec, -1
v_cvt_pk_bf16_f32 v205, v206, v207
v_cvt_pk_bf16_f32 v208, v208, v209
v_mfma_f32_16x16x32_bf16 v[220:223], a[204:207], a[156:159], v[220:223]
s_waitcnt lgkmcnt(10)
ds_write2_b32 v83, v200, v201 offset0:1 offset1:49
s_mov_b64 exec, s[98:99]
ds_write2_b32 v90, v204, v205 offset0:8 offset1:56
s_mov_b64 exec, -1
v_cvt_pk_bf16_f32 v209, v210, v211
v_cvt_pk_bf16_f32 v212, v212, v213
v_cvt_pk_bf16_f32 v213, v214, v215
v_cvt_pk_bf16_f32 v216, v216, v217
v_cvt_pk_bf16_f32 v217, v218, v219
v_mfma_f32_16x16x32_bf16 v[220:223], a[208:211], a[160:163], v[220:223]
s_waitcnt vmcnt(4) lgkmcnt(11)
ds_read_b128 a[72:75], v252 offset:0
v_mfma_f32_16x16x32_bf16 v[220:223], a[212:215], a[164:167], v[220:223]
ds_read_b128 a[76:79], v253 offset:0
v_mfma_f32_16x16x32_bf16 v[224:227], a[192:195], v[180:183], 0
s_waitcnt vmcnt(2)
ds_read_b128 a[80:83], v252 offset:2048
ds_read_b128 a[192:195], v1 offset:36864
v_mfma_f32_16x16x32_bf16 v[224:227], a[196:199], v[184:187], v[224:227]
s_add_u32 m0, s43, 0
ds_read_b128 a[84:87], v253 offset:2048
ds_read_b128 a[196:199], v1 offset:37888
v_mfma_f32_16x16x32_bf16 v[224:227], a[200:203], v[164:167], v[224:227]
s_waitcnt vmcnt(0)
ds_read_b128 a[88:91], v252 offset:4096
ds_read_b128 a[200:203], v1 offset:38912
v_mfma_f32_16x16x32_bf16 v[224:227], a[204:207], v[168:171], v[224:227]
ds_read_b128 a[92:95], v253 offset:4096
ds_read_b128 a[204:207], v1 offset:39936
v_mfma_f32_16x16x32_bf16 v[224:227], a[208:211], v[172:175], v[224:227]
ds_read_b128 a[208:211], v1 offset:40960
v_cvt_pk_bf16_f32 v220, v220, v221
v_mfma_f32_16x16x32_bf16 v[224:227], a[212:215], v[176:179], v[224:227]
s_waitcnt lgkmcnt(15)
ds_read_b128 a[212:215], v1 offset:41984
v_cvt_pk_bf16_f32 v221, v222, v223
v_mfma_f32_16x16x32_bf16 v[228:231], a[216:219], a[144:147], 0
ds_write2_b32 v83, v208, v209 offset0:8 offset1:56
v_mfma_f32_16x16x32_bf16 v[228:231], a[220:223], a[148:151], v[228:231]
s_mov_b64 exec, s[98:99]
ds_write2_b32 v90, v212, v213 offset0:9 offset1:57
s_mov_b64 exec, -1
v_mfma_f32_16x16x32_bf16 v[228:231], a[224:227], a[152:155], v[228:231]
s_waitcnt lgkmcnt(12)
buffer_load_dwordx4 v248, s[20:23], s28 offen offset:0 nt lds
s_add_u32 m0, s43, 1024
v_mfma_f32_16x16x32_bf16 v[228:231], a[228:231], a[156:159], v[228:231]
buffer_load_dwordx4 v249, s[20:23], s28 offen offset:0 nt lds
s_add_u32 m0, s43, 1920
v_mfma_f32_16x16x32_bf16 v[228:231], a[232:235], a[160:163], v[228:231]
s_waitcnt lgkmcnt(9)
buffer_load_dwordx4 v248, s[20:23], s28 offen offset:128 nt lds
s_add_u32 m0, s43, 2944
v_mfma_f32_16x16x32_bf16 v[228:231], a[236:239], a[164:167], v[228:231]
buffer_load_dwordx4 v249, s[20:23], s28 offen offset:128 nt lds
s_add_u32 m0, s43, 3840
v_mfma_f32_16x16x32_bf16 v[232:235], a[216:219], v[180:183], 0
s_waitcnt lgkmcnt(5)
buffer_load_dwordx4 v248, s[20:23], s28 offen offset:256 nt lds
s_add_u32 m0, s43, 4864
v_mfma_f32_16x16x32_bf16 v[232:235], a[220:223], v[184:187], v[232:235]
buffer_load_dwordx4 v249, s[20:23], s28 offen offset:256 nt lds
ds_read_b128 a[216:219], v1 offset:43008
v_mfma_f32_16x16x32_bf16 v[232:235], a[224:227], v[164:167], v[232:235]
ds_read_b128 a[220:223], v1 offset:44032
ds_read_b128 a[224:227], v1 offset:45056
v_mfma_f32_16x16x32_bf16 v[232:235], a[228:231], v[168:171], v[232:235]
ds_read_b128 a[228:231], v1 offset:46080
v_cvt_pk_bf16_f32 v224, v224, v225
v_mfma_f32_16x16x32_bf16 v[232:235], a[232:235], v[172:175], v[232:235]
ds_read_b128 a[232:235], v1 offset:47104
v_cvt_pk_bf16_f32 v225, v226, v227
v_mfma_f32_16x16x32_bf16 v[232:235], a[236:239], v[176:179], v[232:235]
ds_read_b128 a[236:239], v1 offset:48128
v_cvt_pk_bf16_f32 v228, v228, v229
v_mfma_f32_16x16x32_bf16 v[188:191], a[192:195], a[144:147], 0
ds_write2_b32 v83, v216, v217 offset0:9 offset1:57
v_mfma_f32_16x16x32_bf16 v[188:191], a[196:199], a[148:151], v[188:191]
s_mov_b64 exec, s[98:99]
ds_write2_b32 v90, v220, v221 offset0:16 offset1:64
s_mov_b64 exec, -1
v_mfma_f32_16x16x32_bf16 v[188:191], a[200:203], a[152:155], v[188:191]
s_waitcnt lgkmcnt(12)
ds_write2_b32 v83, v224, v225 offset0:16 offset1:64
v_mfma_f32_16x16x32_bf16 v[188:191], a[204:207], a[156:159], v[188:191]
s_waitcnt lgkmcnt(12)
v_cvt_pk_bf16_f32 v229, v230, v231
v_cvt_pk_bf16_f32 v232, v232, v233
v_mfma_f32_16x16x32_bf16 v[188:191], a[208:211], a[160:163], v[188:191]
s_waitcnt lgkmcnt(11)
s_mov_b64 exec, s[98:99]
ds_write2_b32 v90, v228, v229 offset0:17 offset1:65
s_mov_b64 exec, -1
v_mfma_f32_16x16x32_bf16 v[188:191], a[212:215], a[164:167], v[188:191]
v_cvt_pk_bf16_f32 v233, v234, v235
v_xor_b32 v249, v13, v91
v_mfma_f32_16x16x32_bf16 v[192:195], a[192:195], v[180:183], 0
ds_read_b128 a[192:195], v1 offset:49152
v_xor_b32 v248, v12, v91
v_mfma_f32_16x16x32_bf16 v[192:195], a[196:199], v[184:187], v[192:195]
ds_read_b128 a[196:199], v1 offset:50176
v_xor_b32 v249, 64, v249
v_mfma_f32_16x16x32_bf16 v[192:195], a[200:203], v[164:167], v[192:195]
ds_read_b128 a[200:203], v1 offset:51200
v_cvt_pk_bf16_f32 v188, v188, v189
v_mfma_f32_16x16x32_bf16 v[192:195], a[204:207], v[168:171], v[192:195]
ds_read_b128 a[204:207], v1 offset:52224
v_cvt_pk_bf16_f32 v189, v190, v191
v_mfma_f32_16x16x32_bf16 v[192:195], a[208:211], v[172:175], v[192:195]
ds_read_b128 a[208:211], v1 offset:53248
v_mfma_f32_16x16x32_bf16 v[192:195], a[212:215], v[176:179], v[192:195]
s_waitcnt lgkmcnt(14)
ds_read_b128 a[212:215], v1 offset:54272
v_mfma_f32_16x16x32_bf16 v[196:199], a[216:219], a[144:147], 0
s_waitcnt lgkmcnt(14)
ds_write2_b32 v83, v232, v233 offset0:17 offset1:65
v_mfma_f32_16x16x32_bf16 v[196:199], a[220:223], a[148:151], v[196:199]
s_waitcnt lgkmcnt(14)
s_mov_b64 exec, s[98:99]
ds_write2_b32 v90, v188, v189 offset0:24 offset1:72
s_mov_b64 exec, -1
v_mfma_f32_16x16x32_bf16 v[196:199], a[224:227], a[152:155], v[196:199]
s_waitcnt lgkmcnt(14)
v_mfma_f32_16x16x32_bf16 v[196:199], a[228:231], a[156:159], v[196:199]
s_waitcnt lgkmcnt(13)
v_mfma_f32_16x16x32_bf16 v[196:199], a[232:235], a[160:163], v[196:199]
s_waitcnt lgkmcnt(12)
v_cvt_pk_bf16_f32 v192, v192, v193
v_cvt_pk_bf16_f32 v193, v194, v195
v_mfma_f32_16x16x32_bf16 v[196:199], a[236:239], a[164:167], v[196:199]
ds_write2_b32 v83, v192, v193 offset0:24 offset1:72
v_mfma_f32_16x16x32_bf16 v[200:203], a[216:219], v[180:183], 0
ds_read_b128 a[216:219], v1 offset:55296
v_mfma_f32_16x16x32_bf16 v[200:203], a[220:223], v[184:187], v[200:203]
ds_read_b128 a[220:223], v1 offset:56320
v_mfma_f32_16x16x32_bf16 v[200:203], a[224:227], v[164:167], v[200:203]
ds_read_b128 a[224:227], v1 offset:57344
v_mfma_f32_16x16x32_bf16 v[200:203], a[228:231], v[168:171], v[200:203]
ds_read_b128 a[228:231], v1 offset:58368
v_cvt_pk_bf16_f32 v196, v196, v197
v_mfma_f32_16x16x32_bf16 v[200:203], a[232:235], v[172:175], v[200:203]
ds_read_b128 a[232:235], v1 offset:59392
v_cvt_pk_bf16_f32 v197, v198, v199
v_mfma_f32_16x16x32_bf16 v[200:203], a[236:239], v[176:179], v[200:203]
s_waitcnt lgkmcnt(13)
ds_read_b128 a[236:239], v1 offset:60416
v_mfma_f32_16x16x32_bf16 v[204:207], a[192:195], a[144:147], 0
s_waitcnt lgkmcnt(13)
s_mov_b64 exec, s[98:99]
ds_write2_b32 v90, v196, v197 offset0:25 offset1:73
s_mov_b64 exec, -1
v_mfma_f32_16x16x32_bf16 v[204:207], a[196:199], a[148:151], v[204:207]
s_waitcnt lgkmcnt(13)
v_mfma_f32_16x16x32_bf16 v[204:207], a[200:203], a[152:155], v[204:207]
s_waitcnt lgkmcnt(12)
v_mfma_f32_16x16x32_bf16 v[204:207], a[204:207], a[156:159], v[204:207]
s_waitcnt lgkmcnt(11)
v_mfma_f32_16x16x32_bf16 v[204:207], a[208:211], a[160:163], v[204:207]
s_waitcnt lgkmcnt(10)
v_mfma_f32_16x16x32_bf16 v[204:207], a[212:215], a[164:167], v[204:207]
v_cvt_pk_bf16_f32 v200, v200, v201
v_cvt_pk_bf16_f32 v201, v202, v203
v_mfma_f32_16x16x32_bf16 v[208:211], a[192:195], v[180:183], 0
ds_read_b128 a[192:195], v1 offset:61440
v_mfma_f32_16x16x32_bf16 v[208:211], a[196:199], v[184:187], v[208:211]
ds_read_b128 a[196:199], v1 offset:62464
v_mfma_f32_16x16x32_bf16 v[208:211], a[200:203], v[164:167], v[208:211]
ds_read_b128 a[200:203], v1 offset:63488
v_cvt_pk_bf16_f32 v204, v204, v205
v_mfma_f32_16x16x32_bf16 v[208:211], a[204:207], v[168:171], v[208:211]
ds_read_b128 a[204:207], v1 offset:64512
v_cvt_pk_bf16_f32 v205, v206, v207
v_mfma_f32_16x16x32_bf16 v[208:211], a[208:211], v[172:175], v[208:211]
ds_read_b128 a[208:211], v2 offset:0
v_mfma_f32_16x16x32_bf16 v[208:211], a[212:215], v[176:179], v[208:211]
s_waitcnt lgkmcnt(11)
ds_read_b128 a[212:215], v2 offset:1024
v_mfma_f32_16x16x32_bf16 v[212:215], a[216:219], a[144:147], 0
s_waitcnt lgkmcnt(11)
ds_write2_b32 v83, v200, v201 offset0:25 offset1:73
v_mfma_f32_16x16x32_bf16 v[212:215], a[220:223], a[148:151], v[212:215]
s_waitcnt lgkmcnt(11)
s_mov_b64 exec, s[98:99]
ds_write2_b32 v90, v204, v205 offset0:32 offset1:80
s_mov_b64 exec, -1
v_mfma_f32_16x16x32_bf16 v[212:215], a[224:227], a[152:155], v[212:215]
s_waitcnt lgkmcnt(11)
s_nop 0
v_cvt_pk_bf16_f32 v208, v208, v209
v_mfma_f32_16x16x32_bf16 v[212:215], a[228:231], a[156:159], v[212:215]
s_waitcnt lgkmcnt(10)
v_cvt_pk_bf16_f32 v209, v210, v211
ds_write2_b32 v83, v208, v209 offset0:32 offset1:80
v_mfma_f32_16x16x32_bf16 v[212:215], a[232:235], a[160:163], v[212:215]
s_waitcnt lgkmcnt(10)
v_mfma_f32_16x16x32_bf16 v[212:215], a[236:239], a[164:167], v[212:215]
v_mfma_f32_16x16x32_bf16 v[216:219], a[216:219], v[180:183], 0
s_nop 0
ds_read_b128 a[216:219], v2 offset:2048
s_nop 0
v_mfma_f32_16x16x32_bf16 v[216:219], a[220:223], v[184:187], v[216:219]
s_nop 0
ds_read_b128 a[220:223], v2 offset:3072
s_nop 0
v_mfma_f32_16x16x32_bf16 v[216:219], a[224:227], v[164:167], v[216:219]
ds_read_b128 a[224:227], v2 offset:4096
v_cvt_pk_bf16_f32 v212, v212, v213
v_mfma_f32_16x16x32_bf16 v[216:219], a[228:231], v[168:171], v[216:219]
ds_read_b128 a[228:231], v2 offset:5120
v_cvt_pk_bf16_f32 v213, v214, v215
v_mfma_f32_16x16x32_bf16 v[216:219], a[232:235], v[172:175], v[216:219]
ds_read_b128 a[232:235], v2 offset:6144
s_mov_b64 exec, s[98:99]
ds_write2_b32 v90, v212, v213 offset0:33 offset1:81
s_mov_b64 exec, -1
v_mfma_f32_16x16x32_bf16 v[216:219], a[236:239], v[176:179], v[216:219]
s_waitcnt lgkmcnt(14)
ds_read_b128 a[236:239], v2 offset:7168
v_mfma_f32_16x16x32_bf16 v[220:223], a[192:195], a[144:147], 0
s_waitcnt lgkmcnt(14)
s_nop 0
s_nop 0
v_mfma_f32_16x16x32_bf16 v[220:223], a[196:199], a[148:151], v[220:223]
s_waitcnt lgkmcnt(13)
s_nop 0
v_cvt_pk_bf16_f32 v216, v216, v217
v_mfma_f32_16x16x32_bf16 v[220:223], a[200:203], a[152:155], v[220:223]
s_waitcnt lgkmcnt(12)
v_cvt_pk_bf16_f32 v217, v218, v219
ds_write2_b32 v83, v216, v217 offset0:33 offset1:81
v_mfma_f32_16x16x32_bf16 v[220:223], a[204:207], a[156:159], v[220:223]
s_waitcnt lgkmcnt(12)
v_mfma_f32_16x16x32_bf16 v[220:223], a[208:211], a[160:163], v[220:223]
s_waitcnt lgkmcnt(11)
v_mfma_f32_16x16x32_bf16 v[220:223], a[212:215], a[164:167], v[220:223]
v_mfma_f32_16x16x32_bf16 v[224:227], a[192:195], v[180:183], 0
s_nop 0
ds_read_b128 a[192:195], v1 offset:6144
s_nop 0
v_mfma_f32_16x16x32_bf16 v[224:227], a[196:199], v[184:187], v[224:227]
s_nop 0
ds_read_b128 a[196:199], v1 offset:7168
s_nop 0
v_mfma_f32_16x16x32_bf16 v[224:227], a[200:203], v[164:167], v[224:227]
ds_read_b128 a[200:203], v1 offset:8192
v_cvt_pk_bf16_f32 v220, v220, v221
v_mfma_f32_16x16x32_bf16 v[224:227], a[204:207], v[168:171], v[224:227]
ds_read_b128 a[204:207], v1 offset:9216
v_cvt_pk_bf16_f32 v221, v222, v223
v_mfma_f32_16x16x32_bf16 v[224:227], a[208:211], v[172:175], v[224:227]
ds_read_b128 a[208:211], v1 offset:10240
s_mov_b64 exec, s[98:99]
ds_write2_b32 v90, v220, v221 offset0:40 offset1:88
s_mov_b64 exec, -1
v_mfma_f32_16x16x32_bf16 v[224:227], a[212:215], v[176:179], v[224:227]
s_waitcnt lgkmcnt(13)
ds_read_b128 a[212:215], v1 offset:11264
v_mfma_f32_16x16x32_bf16 v[228:231], a[216:219], a[144:147], 0
s_waitcnt lgkmcnt(13)
s_nop 0
s_nop 0
v_mfma_f32_16x16x32_bf16 v[228:231], a[220:223], a[148:151], v[228:231]
s_waitcnt lgkmcnt(12)
s_nop 0
v_cvt_pk_bf16_f32 v224, v224, v225
v_mfma_f32_16x16x32_bf16 v[228:231], a[224:227], a[152:155], v[228:231]
s_waitcnt lgkmcnt(11)
v_cvt_pk_bf16_f32 v225, v226, v227
ds_write2_b32 v83, v224, v225 offset0:40 offset1:88
v_mfma_f32_16x16x32_bf16 v[228:231], a[228:231], a[156:159], v[228:231]
s_waitcnt lgkmcnt(11)
v_mfma_f32_16x16x32_bf16 v[228:231], a[232:235], a[160:163], v[228:231]
s_waitcnt vmcnt(4) lgkmcnt(9)
ds_read_b128 a[96:99], v252 offset:0
v_mfma_f32_16x16x32_bf16 v[228:231], a[236:239], a[164:167], v[228:231]
ds_read_b128 a[100:103], v253 offset:0
v_mfma_f32_16x16x32_bf16 v[232:235], a[216:219], v[180:183], 0
s_waitcnt vmcnt(2)
ds_read_b128 a[104:107], v252 offset:2048
ds_read_b128 a[216:219], v1 offset:0
v_mfma_f32_16x16x32_bf16 v[232:235], a[220:223], v[184:187], v[232:235]
s_nop 0
ds_read_b128 a[108:111], v253 offset:2048
ds_read_b128 a[220:223], v1 offset:1024
v_mfma_f32_16x16x32_bf16 v[232:235], a[224:227], v[164:167], v[232:235]
s_waitcnt vmcnt(0)
ds_read_b128 a[112:115], v252 offset:4096
ds_read_b128 a[224:227], v1 offset:2048
v_mfma_f32_16x16x32_bf16 v[232:235], a[228:231], v[168:171], v[232:235]
ds_read_b128 a[116:119], v253 offset:4096
ds_read_b128 a[228:231], v1 offset:3072
v_mfma_f32_16x16x32_bf16 v[232:235], a[232:235], v[172:175], v[232:235]
ds_read_b128 a[232:235], v1 offset:4096
v_cvt_pk_bf16_f32 v228, v228, v229
v_mfma_f32_16x16x32_bf16 v[232:235], a[236:239], v[176:179], v[232:235]
ds_read_b128 a[236:239], v1 offset:5120
v_cvt_pk_bf16_f32 v229, v230, v231
s_mov_b64 exec, s[98:99]
ds_write2_b32 v90, v228, v229 offset0:41 offset1:89
s_mov_b64 exec, -1
s_nop 0
s_nop 0
s_nop 0
s_nop 0
s_nop 0
v_cvt_pk_bf16_f32 v232, v232, v233
v_cvt_pk_bf16_f32 v233, v234, v235
ds_write2_b32 v83, v232, v233 offset0:41 offset1:89
s_branch L_b0
L_pB:
LW_p18:
s_cbranch_execz LW_p17
v_lshrrev_b32 v220, 6, v0
v_and_b32 v0, 63, v0
v_readfirstlane_b32 s38, v220
v_and_b32 v221, 15, v0
v_lshrrev_b32 v222, 4, v0
v_lshlrev_b32 v1, 4, v0
s_lshl_b32 s39, s2, 2
s_add_u32 s39, s39, s38
s_mul_i32 s42, s38, 1024
s_lshr_b32 s90, s2, 3
s_lshl_b32 s90, s90, 2
s_add_u32 s90, s90, s38
s_mul_i32 s36, s90, 1152
v_lshlrev_b32 v235, 7, v0
v_add_u32 v235, s36, v235
v_cmp_gt_u32 vcc, 9, v0
s_nop 1
v_cndmask_b32 v235, -1, v235, vcc
s_lshr_b32 s87, s2, 4
s_lshl_b32 s87, s87, 3
s_and_b32 s34, s2, 7
s_add_u32 s87, s87, s34
s_add_u32 s87, s87, 5248
v_lshrrev_b32 v224, 5, v0
v_bfe_u32 v225, v0, 3, 2
v_and_b32 v226, 7, v0
v_lshlrev_b32 v226, 4, v226
s_mov_b32 s41, 196224
s_movk_i32 s40, 384
s_mul_hi_u32 s34, s39, 58835169
s_mul_i32 s35, s34, 73
s_sub_u32 s35, s39, s35
s_mul_i32 s34, s34, 1373568
s_mul_i32 s35, s35, 2688
s_add_u32 s28, s34, s35
v_mad_u32_u24 v230, v225, s40, v226
v_mad_u32_u24 v231, v225, s41, v226
v_lshrrev_b32 v232, 1, v225
v_mad_u32_u24 v232, v232, s41, v226
v_and_b32 v233, 1, v225
v_mad_u32_u24 v232, v233, s40, v232
v_lshlrev_b32 v227, 3, v224
s_mov_b32 s34, 588253184
v_lshrrev_b32 v228, v227, s34
v_bfe_u32 v229, v228, 3, 3
LW_p19:
s_cbranch_execz LW_p3
v_and_b32 v228, 7, v228
v_mul_u32_u24 v229, 196224, v229
v_mad_u32_u24 v8, v228, s40, v229
v_add_u32 v8, v8, v230
v_lshlrev_b32 v234, 4, v222
v_xor_b32 v44, v8, v234
v_lshlrev_b32 v227, 3, v224
v_add_u32 v227, 16, v227
s_mov_b32 s34, 588253184
v_lshrrev_b32 v228, v227, s34
v_bfe_u32 v229, v228, 3, 3
v_and_b32 v228, 7, v228
v_mul_u32_u24 v229, 196224, v229
v_mad_u32_u24 v9, v228, s40, v229
v_add_u32 v9, v9, v230
v_xor_b32 v45, v9, v234
v_xor_b32 v45, 64, v45
s_mul_i32 s43, s38, 18432
s_add_u32 s43, s43, 73728
v_lshlrev_b32 v227, 3, v224
s_mov_b32 s34, 403047684
v_lshrrev_b32 v228, v227, s34
v_bfe_u32 v229, v228, 3, 3
v_and_b32 v228, 7, v228
v_mul_u32_u24 v229, 196224, v229
v_mad_u32_u24 v10, v228, s40, v229
v_add_u32 v10, v10, v231
v_xor_b32 v46, v10, v234
s_mov_b32 s34, 689515819
v_lshrrev_b32 v228, v227, s34
v_bfe_u32 v229, v228, 3, 3
v_and_b32 v228, 7, v228
v_mul_u32_u24 v229, 196224, v229
v_mad_u32_u24 v12, v228, s40, v229
v_add_u32 v12, v12, v232
v_xor_b32 v48, v12, v234
v_lshlrev_b32 v227, 3, v224
v_add_u32 v227, 16, v227
s_mov_b32 s34, 403047684
v_lshrrev_b32 v228, v227, s34
v_bfe_u32 v229, v228, 3, 3
v_and_b32 v228, 7, v228
v_mul_u32_u24 v229, 196224, v229
v_mad_u32_u24 v11, v228, s40, v229
v_add_u32 v11, v11, v231
v_xor_b32 v47, v11, v234
v_xor_b32 v47, 64, v47
s_mov_b32 s34, 689515819
s_waitcnt lgkmcnt(0)
s_mov_b32 s16, s24
s_mov_b32 s17, s25
s_mov_b32 s18, 147456
s_mov_b32 s19, 0x20000
buffer_load_dword v235, v235, s[16:19], 0 offen offset:0
s_mov_b32 s20, s4
s_mov_b32 s21, s5
s_mov_b32 s22, 100270464
s_mov_b32 s23, 0x20000
s_add_u32 m0, s43, 0
s_nop 0
buffer_load_dwordx4 v44, s[20:23], s28 offen offset:0 nt lds
v_lshrrev_b32 v228, v227, s34
v_bfe_u32 v229, v228, 3, 3
v_and_b32 v228, 7, v228
v_mul_u32_u24 v229, 196224, v229
v_mad_u32_u24 v13, v228, s40, v229
v_add_u32 v13, v13, v232
v_xor_b32 v49, v13, v234
v_xor_b32 v49, 64, v49
s_mov_b32 s27, s39
s_mov_b32 s26, 0
s_lshr_b32 s10, s2, 3
s_add_u32 m0, s43, 1024
s_nop 0
buffer_load_dwordx4 v45, s[20:23], s28 offen offset:0 nt lds
s_and_b32 s10, s10, 15
s_lshl_b32 s10, s10, 12
s_lshl_b32 s34, s38, 10
s_add_u32 s10, s10, s34
s_add_u32 s96, s34, 139264
s_add_u32 s97, s34, 143360
s_lshl_b32 s34, s38, 12
s_add_u32 s34, s34, 147456
v_and_b32 v228, 7, v0
v_xor_b32 v228, v228, v222
v_lshlrev_b32 v228, 4, v228
s_add_u32 m0, s43, 1920
s_nop 0
buffer_load_dwordx4 v44, s[20:23], s28 offen offset:128 nt lds
v_lshrrev_b32 v229, 3, v0
v_lshlrev_b32 v229, 7, v229
v_add3_u32 v4, v228, v229, s34
v_xor_b32 v5, 64, v4
v_add_u32 v5, 0x400, v5
v_lshrrev_b32 v228, 1, v221
v_xor_b32 v228, v228, v222
v_lshlrev_b32 v228, 4, v228
v_lshlrev_b32 v229, 7, v221
v_add3_u32 v6, v228, v229, s34
v_xor_b32 v7, 64, v6
s_add_u32 m0, s43, 2944
s_nop 0
buffer_load_dwordx4 v45, s[20:23], s28 offen offset:128 nt lds
v_add3_u32 v50, v228, v229, s43
v_xor_b32 v51, 64, v50
s_mul_i32 s91, s90, 704
s_min_u32 s91, s91, L_end-standalone__swin_window_attn__vision_kernel-704+64
s_add_u32 s92, s88, s91
s_addc_u32 s93, s89, 0
s_load_dword s94, s[92:93], 0
s_load_dword s94, s[92:93], 64
s_load_dword s94, s[92:93], 128
s_load_dword s94, s[92:93], 192
s_load_dword s94, s[92:93], 256
s_add_u32 m0, s43, 3840
s_nop 0
buffer_load_dwordx4 v44, s[20:23], s28 offen offset:256 nt lds
s_load_dword s94, s[92:93], 320
s_load_dword s94, s[92:93], 384
s_load_dword s94, s[92:93], 448
s_load_dword s94, s[92:93], 512
s_load_dword s94, s[92:93], 576
s_load_dword s94, s[92:93], 640
v_mov_b32 v22, 0x80000000
s_and_b32 s36, s38, 1
s_lshl_b32 s35, s36, 1
s_lshl_b32 s37, s2, 2
s_add_u32 s35, s35, s37
s_add_u32 m0, s43, 4864
s_nop 0
buffer_load_dwordx4 v45, s[20:23], s28 offen offset:256 nt lds
s_lshl_b32 s3, s36, 10
s_lshl_b32 s36, s36, 6
v_lshrrev_b32 v224, 5, v0
v_bfe_u32 v225, v0, 3, 2
s_cmp_ge_u32 s38, 2
s_cselect_b32 s37, 4096, 0
s_cselect_b32 s34, 0, 1024
s_cselect_b32 s4, 6144, 0
s_cselect_b32 s5, 1, 9
s_add_u32 s35, s35, s37
s_add_u32 s3, s3, s4
s_add_u32 m0, s42, 0
s_nop 0
buffer_load_dwordx4 v1, s[16:19], m0 offen lds
v_add_u32 v224, s35, v224
v_mad_u32_u24 v224, v225, s34, v224
s_cmp_lt_u32 s87, 5329
s_cselect_b32 s5, s5, 9
v_cmp_eq_u32 vcc, s5, v225
v_mov_b32 v226, s87
s_nop 0
v_cndmask_b32 v224, v224, v226, vcc
s_add_u32 s3, s3, 147456
s_mov_b32 s34, 58835169
v_mul_hi_u32 v228, v224, s34
v_mul_u32_u24 v229, 73, v228
s_add_u32 m0, s42, 4096
s_nop 0
buffer_load_dwordx4 v1, s[16:19], m0 offen lds
v_sub_u32 v229, v224, v229
v_mul_u32_u24 v228, 1373568, v228
v_mul_u32_u24 v229, 2688, v229
v_and_b32 v226, 7, v0
v_xor_b32 v226, v226, v222
v_lshlrev_b32 v226, 4, v226
v_xor_b32 v226, s36, v226
v_add_u32 v226, 589824, v226
v_add3_u32 v91, v228, v229, v226
s_mov_b32 s12, s6
s_mov_b32 s13, s7
s_add_u32 m0, s42, 8192
s_nop 0
buffer_load_dwordx4 v1, s[16:19], m0 offen lds
s_mov_b32 s14, 100270464
s_mov_b32 s15, 0x20000
v_mov_b32 v21, 0xff800000
v_lshlrev_b32 v227, 3, v222
v_lshlrev_b32 v234, 3, v221
s_mov_b32 s34, 588253184
v_lshrrev_b32 v228, v227, s34
v_bfe_u32 v229, v228, 3, 3
v_and_b32 v228, 7, v228
v_mul_u32_u24 v229, 196224, v229
v_mad_u32_u24 v14, v228, s40, v229
s_add_u32 m0, s42, 12288
s_nop 0
buffer_load_dwordx4 v1, s[16:19], m0 offen lds
v_add_u32 v14, v14, v234
s_mov_b32 s34, 403047684
v_lshrrev_b32 v228, v227, s34
v_bfe_u32 v229, v228, 3, 3
v_and_b32 v228, 7, v228
v_mul_u32_u24 v229, 196224, v229
v_mad_u32_u24 v15, v228, s40, v229
v_add_u32 v15, v15, v234
s_mov_b32 s34, 689515819
v_lshrrev_b32 v228, v227, s34
v_bfe_u32 v229, v228, 3, 3
s_add_u32 m0, s42, 16384
s_nop 0
buffer_load_dwordx4 v1, s[16:19], m0 offen lds
v_and_b32 v228, 7, v228
v_mul_u32_u24 v229, 196224, v229
v_mad_u32_u24 v16, v228, s40, v229
v_add_u32 v16, v16, v234
v_add_u32 v19, 589824, v234
v_lshlrev_b32 v20, 1, v222
v_add_u32 v2, 0x10000, v1
v_add_u32 v3, 0x20000, v1
v_mov_b32 v26, 0
v_mov_b32 v27, 0
v_mov_b32 v22, 0x80000000
s_add_u32 m0, s42, 20480
s_nop 0
buffer_load_dwordx4 v1, s[16:19], m0 offen lds
s_add_u32 s33, s39, 1024
s_mul_hi_u32 s34, s33, 58835169
s_mul_i32 s35, s34, 73
s_sub_u32 s35, s33, s35
s_mul_i32 s34, s34, 1373568
s_mul_i32 s35, s35, 2688
s_add_u32 s32, s34, s35
s_sub_u32 s36, s26, 1
v_cmp_eq_u32 vcc, s26, v20
s_nop 1
v_cndmask_b32 v24, v21, v26, vcc
v_cndmask_b32 v17, v22, v19, vcc
s_add_u32 m0, s42, 24576
s_nop 0
buffer_load_dwordx4 v1, s[16:19], m0 offen lds
v_cmp_eq_u32 vcc, s36, v20
s_nop 1
v_cndmask_b32 v25, v21, v26, vcc
v_cndmask_b32 v18, v22, v19, vcc
v_bfe_u32 v84, v1, 4, 2
v_bfe_u32 v85, v1, 6, 2
v_lshrrev_b32 v86, 8, v1
s_mov_b32 s7, 75728
v_lshl_add_u32 v87, v86, 3, s7
v_mul_u32_u24 v83, 18496, v85
v_mul_u32_u24 v88, 400, v84
v_add3_u32 v83, v83, v88, v87
s_add_u32 m0, s42, 28672
s_nop 0
buffer_load_dwordx4 v1, s[16:19], m0 offen lds
v_add_u32 v90, 1600, v83
s_mul_i32 s6, s38, 18496
v_lshl_add_u32 v87, v86, 3, v87
v_mul_u32_u24 v88, 800, v85
v_add3_u32 v88, v88, v87, s6
v_and_b32 v87, 1, v84
v_mul_u32_u24 v87, 192, v87
v_add_u32 v88, v88, v87
v_lshrrev_b32 v87, 1, v84
v_mul_u32_u24 v87, 2000, v87
v_sub_u32 v88, v88, v87
s_add_u32 m0, s42, 32768
s_nop 0
buffer_load_dwordx4 v1, s[16:19], m0 offen lds
v_lshlrev_b32 v84, 8, v84
v_lshl_add_u32 v84, v86, 6, v84
v_lshl_add_u32 v84, v85, 4, v84
v_bfe_u32 v85, v1, 4, 1
v_lshl_add_u32 v84, v85, 3, v84
s_mul_i32 s4, s38, 3
s_add_u32 s4, s4, 0
s_lshr_b32 s5, s4, 1
s_and_b32 s4, s4, 1
s_lshl_b32 s4, s4, 3
s_lshl_b32 s7, s5, 10
s_add_u32 m0, s42, 36864
s_nop 0
buffer_load_dwordx4 v1, s[16:19], m0 offen lds
s_add_u32 s7, s7, s4
v_xor_b32 v80, s7, v84
s_lshl_b32 s5, s5, 6
s_add_u32 s8, s5, s4
s_lshr_b32 s8, s8, 1
s_sub_u32 s90, s8, 2000
s_mul_i32 s4, s38, 3
s_add_u32 s4, s4, 1
s_lshr_b32 s5, s4, 1
s_and_b32 s4, s4, 1
s_lshl_b32 s4, s4, 3
s_add_u32 m0, s42, 40960
s_nop 0
buffer_load_dwordx4 v1, s[16:19], m0 offen lds
s_lshl_b32 s7, s5, 10
s_add_u32 s7, s7, s4
v_xor_b32 v81, s7, v84
s_lshl_b32 s5, s5, 6
s_add_u32 s9, s5, s4
s_lshr_b32 s9, s9, 1
s_sub_u32 s91, s9, 2000
s_mul_i32 s4, s38, 3
s_add_u32 s4, s4, 2
s_lshr_b32 s5, s4, 1
s_and_b32 s4, s4, 1
s_add_u32 m0, s42, 45056
s_nop 0
buffer_load_dwordx4 v1, s[16:19], m0 offen lds
s_lshl_b32 s4, s4, 3
s_lshl_b32 s7, s5, 10
s_add_u32 s7, s7, s4
v_xor_b32 v82, s7, v84
s_lshl_b32 s5, s5, 6
s_add_u32 s95, s5, s4
s_lshr_b32 s95, s95, 1
s_sub_u32 s92, s95, 2000
s_mul_i32 s7, s38, 18432
v_add_u32 v254, s7, v1
v_and_b32 v85, 1, v86
s_add_u32 m0, s42, 49152
s_nop 0
buffer_load_dwordx4 v1, s[16:19], m0 offen lds
s_waitcnt vmcnt(17)
ds_read_b128 a[72:75], v50 offset:0
v_lshlrev_b32 v85, 3, v85
v_lshl_add_u32 v85, v86, 6, v85
s_lshl_b32 s7, s38, 4
v_add_u32 v89, s7, v85
s_lshl_b32 s85, s38, 12
v_bfe_u32 v76, v1, 4, 2
v_bfe_u32 v77, v1, 6, 2
v_lshrrev_b32 v78, 8, v1
v_mov_b32 v22, 151040
v_lshl_add_u32 v22, s38, 12, v22
v_min_u32 v79, 2, v78
s_add_u32 m0, s42, 53248
s_nop 0
buffer_load_dwordx4 v1, s[16:19], m0 offen lds
ds_read_b128 a[76:79], v51 offset:0
v_lshlrev_b32 v79, 9, v79
v_sub_u32 v20, v22, v79
v_lshl_add_u32 v22, v78, 4, v22
v_lshl_add_u32 v20, v77, 3, v20
v_and_b32 v79, 1, v76
v_lshl_add_u32 v20, v79, 1, v20
v_lshl_add_u32 v22, v79, 6, v22
v_mul_u32_u24 v0, 0xaaaa, v79
v_add_u32 v0, 0x4444, v0
v_lshrrev_b32 v79, 1, v76
v_lshl_add_u32 v20, v79, 6, v20
s_add_u32 m0, s42, 57344
s_nop 0
buffer_load_dwordx4 v1, s[16:19], m0 offen lds
s_waitcnt vmcnt(17)
ds_read_b128 a[80:83], v50 offset:2048
v_lshl_add_u32 v79, v79, 2, v77
v_lshlrev_b32 v79, 7, v79
v_sub_u32 v22, v22, v79
v_lshl_add_u32 v76, v77, 2, v76
v_lshlrev_b32 v76, 3, v76
v_lshl_add_u32 v76, v78, 1, v76
v_add_u32 v17, 589824, v76
s_add_u32 m0, s42, 61440
s_nop 0
buffer_load_dwordx4 v1, s[16:19], m0 offen lds
ds_read_b128 a[84:87], v51 offset:2048
s_add_u32 m0, s42, 65536
s_nop 0
buffer_load_dwordx4 v1, s[16:19], m0 offen lds
s_waitcnt vmcnt(17)
ds_read_b128 a[88:91], v50 offset:4096
s_add_u32 m0, s42, 69632
s_nop 0
buffer_load_dwordx4 v1, s[16:19], m0 offen lds
ds_read_b128 a[92:95], v51 offset:4096
s_add_u32 m0, s3, 0
s_nop 0
buffer_load_dwordx4 v91, s[20:23], 0 offen offset:0 lds
s_add_u32 m0, s3, 1920
s_nop 0
buffer_load_dwordx4 v91, s[20:23], 0 offen offset:128 lds
s_add_u32 m0, s3, 3840
s_nop 0
buffer_load_dwordx4 v91, s[20:23], 0 offen offset:256 lds
s_waitcnt vmcnt(12)
s_barrier
ds_read_b128 a[192:195], v1 offset:0
ds_read_b128 a[196:199], v1 offset:1024
ds_read_b128 a[200:203], v1 offset:2048
ds_read_b128 a[204:207], v1 offset:3072
ds_read_b128 a[208:211], v1 offset:4096
ds_read_b128 a[212:215], v1 offset:5120
ds_read_b128 a[216:219], v1 offset:6144
ds_read_b128 a[220:223], v1 offset:7168
ds_read_b128 a[224:227], v1 offset:8192
ds_read_b128 a[228:231], v1 offset:9216
ds_read_b128 a[232:235], v1 offset:10240
ds_read_b128 a[236:239], v1 offset:11264
s_branch L_b0B
L_b0B:
s_waitcnt lgkmcnt(11)
v_mfma_f32_16x16x32_bf16 v[224:227], a[192:195], a[72:75], 0
s_waitcnt lgkmcnt(10)
s_add_u32 m0, s43, 6144
s_mov_b32 s6, 0x100001
buffer_load_dwordx4 v46, s[20:23], s28 offen offset:0 nt lds
v_mfma_f32_16x16x32_bf16 v[224:227], a[196:199], a[76:79], v[224:227]
s_waitcnt lgkmcnt(9)
s_add_u32 m0, s43, 7168
ds_read_b128 a[192:195], v1 offset:12288
ds_read_b128 a[196:199], v1 offset:13312
v_mfma_f32_16x16x32_bf16 v[224:227], a[200:203], a[80:83], v[224:227]
buffer_load_dwordx4 v47, s[20:23], s28 offen offset:0 nt lds
s_waitcnt lgkmcnt(10)
s_add_u32 m0, s43, 8064
v_mfma_f32_16x16x32_bf16 v[224:227], a[204:207], a[84:87], v[224:227]
s_waitcnt lgkmcnt(9)
s_mov_b32 s93, 0xffff0000
ds_read_b128 a[200:203], v1 offset:14336
ds_read_b128 a[204:207], v1 offset:15360
v_mfma_f32_16x16x32_bf16 v[224:227], a[208:211], a[88:91], v[224:227]
buffer_load_dwordx4 v46, s[20:23], s28 offen offset:128 nt lds
s_waitcnt lgkmcnt(10)
s_add_u32 m0, s43, 9088
v_mfma_f32_16x16x32_bf16 v[224:227], a[212:215], a[92:95], v[224:227]
s_waitcnt lgkmcnt(9)
s_mov_b32 s27, s33
ds_read_b128 a[208:211], v1 offset:16384
ds_read_b128 a[212:215], v1 offset:17408
v_mfma_f32_16x16x32_bf16 v[228:231], a[216:219], a[72:75], 0
buffer_load_dwordx4 v47, s[20:23], s28 offen offset:128 nt lds
s_waitcnt lgkmcnt(10)
s_add_u32 m0, s43, 9984
v_mfma_f32_16x16x32_bf16 v[228:231], a[220:223], a[76:79], v[228:231]
s_waitcnt lgkmcnt(9)
s_mov_b32 s44, s28
ds_read_b128 a[216:219], v1 offset:18432
ds_read_b128 a[220:223], v1 offset:19456
v_mfma_f32_16x16x32_bf16 v[228:231], a[224:227], a[80:83], v[228:231]
buffer_load_dwordx4 v46, s[20:23], s28 offen offset:256 nt lds
s_waitcnt lgkmcnt(10)
s_add_u32 m0, s43, 11008
v_mfma_f32_16x16x32_bf16 v[228:231], a[228:231], a[84:87], v[228:231]
s_waitcnt lgkmcnt(9)
ds_read_b128 a[224:227], v1 offset:20480
ds_read_b128 a[228:231], v1 offset:21504
v_mfma_f32_16x16x32_bf16 v[228:231], a[232:235], a[88:91], v[228:231]
buffer_load_dwordx4 v47, s[20:23], s28 offen offset:256 nt lds
s_waitcnt lgkmcnt(10)
ds_read_b128 a[232:235], v1 offset:22528
v_mfma_f32_16x16x32_bf16 v[228:231], a[236:239], a[92:95], v[228:231]
s_waitcnt lgkmcnt(10)
ds_read_b128 a[236:239], v1 offset:23552
v_cvt_pk_bf16_f32 v60, v224, v225
v_mfma_f32_16x16x32_bf16 v[232:235], a[192:195], a[72:75], 0
s_waitcnt lgkmcnt(10)
ds_read_b128 a[192:195], v1 offset:24576
v_cvt_pk_bf16_f32 v61, v226, v227
v_mfma_f32_16x16x32_bf16 v[232:235], a[196:199], a[76:79], v[232:235]
s_waitcnt lgkmcnt(10)
ds_read_b128 a[196:199], v1 offset:25600
v_mfma_f32_16x16x32_bf16 v[232:235], a[200:203], a[80:83], v[232:235]
s_waitcnt lgkmcnt(10)
ds_read_b128 a[200:203], v1 offset:26624
v_cvt_pk_bf16_f32 v62, v228, v229
v_mfma_f32_16x16x32_bf16 v[232:235], a[204:207], a[84:87], v[232:235]
s_waitcnt lgkmcnt(10)
ds_read_b128 a[204:207], v1 offset:27648
v_cvt_pk_bf16_f32 v63, v230, v231
v_mfma_f32_16x16x32_bf16 v[232:235], a[208:211], a[88:91], v[232:235]
s_waitcnt lgkmcnt(10)
ds_read_b128 a[208:211], v1 offset:28672
v_mfma_f32_16x16x32_bf16 v[232:235], a[212:215], a[92:95], v[232:235]
s_waitcnt lgkmcnt(10)
ds_read_b128 a[212:215], v1 offset:29696
v_mfma_f32_16x16x32_bf16 v[220:223], a[216:219], a[72:75], 0
s_waitcnt lgkmcnt(10)
ds_read_b128 a[216:219], v1 offset:30720
v_mfma_f32_16x16x32_bf16 v[220:223], a[220:223], a[76:79], v[220:223]
s_waitcnt lgkmcnt(10)
ds_read_b128 a[220:223], v1 offset:31744
v_mfma_f32_16x16x32_bf16 v[220:223], a[224:227], a[80:83], v[220:223]
s_waitcnt lgkmcnt(10)
ds_read_b128 a[224:227], v1 offset:32768
v_mfma_f32_16x16x32_bf16 v[220:223], a[228:231], a[84:87], v[220:223]
s_waitcnt lgkmcnt(10)
ds_read_b128 a[228:231], v1 offset:33792
v_cvt_pk_bf16_f32 v64, v232, v233
v_mfma_f32_16x16x32_bf16 v[220:223], a[232:235], a[88:91], v[220:223]
s_waitcnt vmcnt(6) lgkmcnt(10)
s_barrier
ds_read_b128 a[232:235], v1 offset:34816
v_cvt_pk_bf16_f32 v65, v234, v235
v_mfma_f32_16x16x32_bf16 v[220:223], a[236:239], a[92:95], v[220:223]
s_waitcnt lgkmcnt(10)
ds_read_b128 a[236:239], v1 offset:35840
v_mfma_f32_16x16x32_bf16 v[224:227], a[192:195], a[72:75], 0
s_waitcnt lgkmcnt(10)
ds_read_b128 a[192:195], v1 offset:36864
v_mfma_f32_16x16x32_bf16 v[224:227], a[196:199], a[76:79], v[224:227]
s_waitcnt lgkmcnt(10)
ds_read_b128 a[196:199], v1 offset:37888
v_mfma_f32_16x16x32_bf16 v[224:227], a[200:203], a[80:83], v[224:227]
s_waitcnt lgkmcnt(10)
ds_read_b128 a[200:203], v1 offset:38912
v_mfma_f32_16x16x32_bf16 v[224:227], a[204:207], a[84:87], v[224:227]
s_waitcnt lgkmcnt(10)
ds_read_b128 a[204:207], v1 offset:39936
v_cvt_pk_bf16_f32 v66, v220, v221
v_mfma_f32_16x16x32_bf16 v[224:227], a[208:211], a[88:91], v[224:227]
s_waitcnt lgkmcnt(10)
ds_read_b128 a[208:211], v1 offset:40960
v_cvt_pk_bf16_f32 v67, v222, v223
v_mfma_f32_16x16x32_bf16 v[224:227], a[212:215], a[92:95], v[224:227]
s_waitcnt lgkmcnt(10)
ds_read_b128 a[212:215], v1 offset:41984
v_mfma_f32_16x16x32_bf16 v[228:231], a[216:219], a[72:75], 0
s_waitcnt lgkmcnt(10)
ds_read_b128 a[216:219], v1 offset:43008
v_mfma_f32_16x16x32_bf16 v[228:231], a[220:223], a[76:79], v[228:231]
s_waitcnt lgkmcnt(10)
ds_read_b128 a[220:223], v1 offset:44032
v_mfma_f32_16x16x32_bf16 v[228:231], a[224:227], a[80:83], v[228:231]
s_waitcnt lgkmcnt(10)
ds_read_b128 a[224:227], v1 offset:45056
v_mfma_f32_16x16x32_bf16 v[228:231], a[228:231], a[84:87], v[228:231]
s_waitcnt lgkmcnt(10)
ds_read_b128 a[228:231], v1 offset:46080
v_cvt_pk_bf16_f32 v68, v224, v225
v_mfma_f32_16x16x32_bf16 v[228:231], a[232:235], a[88:91], v[228:231]
s_waitcnt lgkmcnt(10)
ds_read_b128 a[232:235], v1 offset:47104
v_cvt_pk_bf16_f32 v69, v226, v227
v_mfma_f32_16x16x32_bf16 v[228:231], a[236:239], a[92:95], v[228:231]
s_waitcnt lgkmcnt(10)
ds_read_b128 a[236:239], v1 offset:48128
v_mfma_f32_16x16x32_bf16 v[232:235], a[192:195], a[72:75], 0
s_waitcnt lgkmcnt(10)
ds_read_b128 a[192:195], v1 offset:49152
v_mfma_f32_16x16x32_bf16 v[232:235], a[196:199], a[76:79], v[232:235]
s_waitcnt lgkmcnt(10)
ds_read_b128 a[196:199], v1 offset:50176
v_mfma_f32_16x16x32_bf16 v[232:235], a[200:203], a[80:83], v[232:235]
s_waitcnt lgkmcnt(10)
ds_read_b128 a[200:203], v1 offset:51200
v_mfma_f32_16x16x32_bf16 v[232:235], a[204:207], a[84:87], v[232:235]
s_waitcnt lgkmcnt(10)
ds_read_b128 a[204:207], v1 offset:52224
v_cvt_pk_bf16_f32 v70, v228, v229
v_mfma_f32_16x16x32_bf16 v[232:235], a[208:211], a[88:91], v[232:235]
s_waitcnt lgkmcnt(10)
ds_read_b128 a[208:211], v1 offset:53248
v_cvt_pk_bf16_f32 v71, v230, v231
v_mfma_f32_16x16x32_bf16 v[232:235], a[212:215], a[92:95], v[232:235]
s_waitcnt lgkmcnt(10)
ds_read_b128 a[212:215], v1 offset:54272
v_mfma_f32_16x16x32_bf16 v[220:223], a[216:219], a[72:75], 0
s_waitcnt lgkmcnt(10)
ds_read_b128 a[216:219], v1 offset:55296
v_mfma_f32_16x16x32_bf16 v[220:223], a[220:223], a[76:79], v[220:223]
s_waitcnt lgkmcnt(10)
ds_read_b128 a[220:223], v1 offset:56320
v_mfma_f32_16x16x32_bf16 v[220:223], a[224:227], a[80:83], v[220:223]
s_waitcnt lgkmcnt(10)
v_subrev_u32 v250, s85, v6
v_mfma_f32_16x16x32_bf16 v[220:223], a[228:231], a[84:87], v[220:223]
s_waitcnt lgkmcnt(9)
ds_read_b128 a[224:227], v1 offset:57344
ds_read_b128 a[228:231], v1 offset:58368
v_mfma_f32_16x16x32_bf16 v[220:223], a[232:235], a[88:91], v[220:223]
s_waitcnt lgkmcnt(10)
v_xor_b32 v251, 64, v250
v_cvt_pk_bf16_f32 v72, v232, v233
v_mfma_f32_16x16x32_bf16 v[220:223], a[236:239], a[92:95], v[220:223]
s_waitcnt lgkmcnt(9)
ds_read_b128 a[232:235], v1 offset:59392
ds_read_b128 a[236:239], v1 offset:60416
v_mfma_f32_16x16x32_bf16 v[224:227], a[192:195], a[72:75], 0
s_waitcnt lgkmcnt(10)
ds_read_b128 a[192:195], v1 offset:61440
v_cvt_pk_bf16_f32 v73, v234, v235
v_mfma_f32_16x16x32_bf16 v[224:227], a[196:199], a[76:79], v[224:227]
s_waitcnt lgkmcnt(10)
ds_read_b128 a[196:199], v1 offset:62464
v_mfma_f32_16x16x32_bf16 v[224:227], a[200:203], a[80:83], v[224:227]
s_waitcnt lgkmcnt(10)
ds_read_b128 a[200:203], v1 offset:63488
v_cvt_pk_bf16_f32 v74, v220, v221
v_mfma_f32_16x16x32_bf16 v[224:227], a[204:207], a[84:87], v[224:227]
s_waitcnt lgkmcnt(10)
ds_read_b128 a[204:207], v1 offset:64512
v_cvt_pk_bf16_f32 v75, v222, v223
v_mfma_f32_16x16x32_bf16 v[224:227], a[208:211], a[88:91], v[224:227]
s_waitcnt lgkmcnt(10)
ds_read_b128 a[208:211], v2 offset:0
v_mfma_f32_16x16x32_bf16 v[224:227], a[212:215], a[92:95], v[224:227]
s_waitcnt lgkmcnt(10)
ds_read_b128 a[212:215], v2 offset:1024
v_mfma_f32_16x16x32_bf16 v[228:231], a[216:219], a[72:75], 0
s_waitcnt lgkmcnt(10)
ds_read_b128 a[216:219], v2 offset:2048
v_mfma_f32_16x16x32_bf16 v[228:231], a[220:223], a[76:79], v[228:231]
s_waitcnt lgkmcnt(10)
ds_read_b128 a[220:223], v2 offset:3072
v_mfma_f32_16x16x32_bf16 v[228:231], a[224:227], a[80:83], v[228:231]
s_waitcnt lgkmcnt(10)
ds_read_b128 a[224:227], v2 offset:4096
ds_read_b128 v[180:183], v250 offset:0
v_mfma_f32_16x16x32_bf16 v[228:231], a[228:231], a[84:87], v[228:231]
s_waitcnt lgkmcnt(11)
ds_read_b128 v[184:187], v251 offset:0
ds_read_b128 a[228:231], v2 offset:5120
v_mfma_f32_16x16x32_bf16 v[228:231], a[232:235], a[88:91], v[228:231]
s_waitcnt lgkmcnt(12)
ds_read_b128 a[232:235], v2 offset:6144
ds_read_b128 v[164:167], v250 offset:2048
v_mfma_f32_16x16x32_bf16 v[228:231], a[236:239], a[92:95], v[228:231]
s_waitcnt lgkmcnt(13)
ds_read_b128 v[168:171], v251 offset:2048
ds_read_b128 a[236:239], v2 offset:7168
v_mfma_f32_16x16x32_bf16 v[232:235], a[192:195], a[72:75], 0
s_waitcnt lgkmcnt(14)
ds_read_b128 a[192:195], v254 offset:0
ds_read_b128 v[172:175], v250 offset:4096
v_mfma_f32_16x16x32_bf16 v[232:235], a[196:199], a[76:79], v[232:235]
s_waitcnt lgkmcnt(15)
ds_read_b128 v[176:179], v251 offset:4096
ds_read_b128 a[196:199], v254 offset:1024
v_mfma_f32_16x16x32_bf16 v[232:235], a[200:203], a[80:83], v[232:235]
s_waitcnt lgkmcnt(15)
ds_read_b128 a[200:203], v254 offset:2048
ds_read_b128 a[144:147], v250 offset:6144
v_mfma_f32_16x16x32_bf16 v[232:235], a[204:207], a[84:87], v[232:235]
ds_read_b128 a[204:207], v254 offset:3072
ds_read_b128 a[148:151], v251 offset:6144
v_mfma_f32_16x16x32_bf16 v[232:235], a[208:211], a[88:91], v[232:235]
s_waitcnt lgkmcnt(15)
ds_read_b128 a[208:211], v254 offset:4096
ds_read_b128 a[152:155], v250 offset:8192
v_mfma_f32_16x16x32_bf16 v[232:235], a[212:215], a[92:95], v[232:235]
ds_read_b128 a[212:215], v254 offset:5120
ds_read_b128 a[156:159], v251 offset:8192
v_mfma_f32_16x16x32_bf16 v[220:223], a[216:219], a[72:75], 0
LW_p20:
s_cbranch_execz LW_p23
ds_read_b128 a[160:163], v250 offset:10240
ds_read_b128 a[216:219], v254 offset:6144
v_mfma_f32_16x16x32_bf16 v[220:223], a[220:223], a[76:79], v[220:223]
ds_read_b128 a[164:167], v251 offset:10240
ds_read_b128 a[220:223], v254 offset:7168
v_mfma_f32_16x16x32_bf16 v[220:223], a[224:227], a[80:83], v[220:223]
s_waitcnt lgkmcnt(15)
ds_read_b128 a[224:227], v254 offset:8192
v_cvt_pk_bf16_f32 v236, v224, v225
v_mfma_f32_16x16x32_bf16 v[220:223], a[228:231], a[84:87], v[220:223]
ds_read_b128 a[228:231], v254 offset:9216
v_cvt_pk_bf16_f32 v237, v226, v227
v_mfma_f32_16x16x32_bf16 v[220:223], a[232:235], a[88:91], v[220:223]
ds_read_b128 a[232:235], v254 offset:10240
v_cvt_pk_bf16_f32 v238, v228, v229
v_mfma_f32_16x16x32_bf16 v[220:223], a[236:239], a[92:95], v[220:223]
ds_read_b128 a[236:239], v254 offset:11264
v_cvt_pk_bf16_f32 v239, v230, v231
v_mfma_f32_16x16x32_bf16 v[192:195], a[192:195], v[180:183], 0
s_waitcnt lgkmcnt(15)
s_mov_b32 s98, 0x11111111
v_lshrrev_b32 v86, 6, v1
v_and_b32 v86, 4, v86
v_mfma_f32_16x16x32_bf16 v[192:195], a[196:199], v[184:187], v[192:195]
s_mov_b32 s99, 0x11111111
s_mov_b32 s4, 0x33333333
s_mov_b32 s5, 0x33333333
v_mfma_f32_16x16x32_bf16 v[192:195], a[200:203], v[164:167], v[192:195]
s_waitcnt lgkmcnt(13)
s_add_u32 m0, s43, 12288
v_cvt_pk_bf16_f32 v240, v232, v233
v_mfma_f32_16x16x32_bf16 v[192:195], a[204:207], v[168:171], v[192:195]
s_waitcnt lgkmcnt(11)
v_cvt_pk_bf16_f32 v241, v234, v235
v_cvt_pk_bf16_f32 v242, v220, v221
v_mfma_f32_16x16x32_bf16 v[192:195], a[208:211], v[172:175], v[192:195]
buffer_load_dwordx4 v48, s[20:23], s28 offen offset:0 nt lds
s_waitcnt lgkmcnt(9)
s_add_u32 m0, s43, 13312
v_mfma_f32_16x16x32_bf16 v[192:195], a[212:215], v[176:179], v[192:195]
v_cvt_pk_bf16_f32 v243, v222, v223
v_mfma_f32_16x16x32_bf16 v[196:199], a[192:195], a[144:147], 0
buffer_load_dwordx4 v49, s[20:23], s28 offen offset:0 nt lds
s_add_u32 m0, s43, 14208
v_mfma_f32_16x16x32_bf16 v[196:199], a[196:199], a[148:151], v[196:199]
s_nop 0
ds_read_b128 a[192:195], v254 offset:12288
ds_read_b128 a[196:199], v254 offset:13312
v_mfma_f32_16x16x32_bf16 v[196:199], a[200:203], a[152:155], v[196:199]
s_waitcnt lgkmcnt(10)
v_cvt_pk_bf16_f32 v192, v192, v193
v_cvt_pk_bf16_f32 v193, v194, v195
v_mfma_f32_16x16x32_bf16 v[196:199], a[204:207], a[156:159], v[196:199]
s_waitcnt lgkmcnt(9)
v_add_u32 v194, s8, v83
ds_write2_b32 v194, v192, v193 offset1:48
v_mfma_f32_16x16x32_bf16 v[196:199], a[208:211], a[160:163], v[196:199]
buffer_load_dwordx4 v48, s[20:23], s28 offen offset:128 nt lds
s_waitcnt lgkmcnt(8)
s_add_u32 m0, s43, 15232
v_mfma_f32_16x16x32_bf16 v[196:199], a[212:215], a[164:167], v[196:199]
ds_read_b64_tr_b16 a[240:241], v80 offset:0
ds_read_b64_tr_b16 a[242:243], v80 offset:6144
v_mfma_f32_16x16x32_bf16 v[200:203], a[216:219], v[180:183], 0
s_waitcnt lgkmcnt(9)
s_mul_i32 s7, s38, 576
ds_read_b64_tr_b16 a[244:245], v80 offset:12288
ds_read_b64_tr_b16 a[246:247], v80 offset:18432
v_mfma_f32_16x16x32_bf16 v[200:203], a[220:223], v[184:187], v[200:203]
s_waitcnt lgkmcnt(10)
v_cvt_pk_bf16_f32 v196, v196, v197
v_cvt_pk_bf16_f32 v197, v198, v199
v_mfma_f32_16x16x32_bf16 v[200:203], a[224:227], v[164:167], v[200:203]
s_waitcnt lgkmcnt(9)
v_add_u32 v198, s8, v90
s_mov_b64 exec, s[4:5]
ds_write2_b32 v198, v196, v197 offset1:48
s_mov_b64 exec, -1
v_mfma_f32_16x16x32_bf16 v[200:203], a[228:231], v[168:171], v[200:203]
s_waitcnt lgkmcnt(9)
ds_read_b64_tr_b16 a[248:249], v80 offset:24576
ds_read_b64_tr_b16 a[250:251], v80 offset:30720
v_mfma_f32_16x16x32_bf16 v[200:203], a[232:235], v[172:175], v[200:203]
s_waitcnt lgkmcnt(10)
ds_read_b64_tr_b16 a[252:253], v80 offset:36864
ds_read_b64_tr_b16 a[254:255], v80 offset:43008
v_mfma_f32_16x16x32_bf16 v[200:203], a[236:239], v[176:179], v[200:203]
ds_read_b64_tr_b16 a[168:169], v80 offset:49152
ds_read_b64_tr_b16 a[170:171], v80 offset:55296
v_mfma_f32_16x16x32_bf16 v[204:207], a[216:219], a[144:147], 0
s_nop 0
ds_read_b64_tr_b16 a[172:173], v80 offset:61440
buffer_load_dwordx4 v49, s[20:23], s28 offen offset:128 nt lds
v_mfma_f32_16x16x32_bf16 v[204:207], a[220:223], a[148:151], v[204:207]
s_add_u32 m0, s43, 16128
v_cvt_pk_bf16_f32 v200, v200, v201
v_cvt_pk_bf16_f32 v201, v202, v203
v_mfma_f32_16x16x32_bf16 v[204:207], a[224:227], a[152:155], v[204:207]
v_add_u32 v202, s9, v83
ds_write2_b32 v202, v200, v201 offset1:48
v_mfma_f32_16x16x32_bf16 v[204:207], a[228:231], a[156:159], v[204:207]
ds_read_b64_tr_b16 a[176:177], v81 offset:0
ds_read_b64_tr_b16 a[178:179], v81 offset:6144
v_mfma_f32_16x16x32_bf16 v[204:207], a[232:235], a[160:163], v[204:207]
ds_read_b64_tr_b16 a[180:181], v81 offset:12288
v_add_u32 v80, 0x10000, v80
v_mfma_f32_16x16x32_bf16 v[204:207], a[236:239], a[164:167], v[204:207]
s_waitcnt lgkmcnt(15)
ds_read_b64_tr_b16 a[174:175], v80 offset:2048
ds_read_b64_tr_b16 a[182:183], v81 offset:18432
v_mfma_f32_16x16x32_bf16 v[208:211], a[192:195], v[180:183], 0
s_nop 0
buffer_load_dwordx4 v48, s[20:23], s28 offen offset:256 nt lds
ds_read_b64_tr_b16 a[184:185], v81 offset:24576
v_mfma_f32_16x16x32_bf16 v[208:211], a[196:199], v[184:187], v[208:211]
s_add_u32 m0, s43, 17152
v_cvt_pk_bf16_f32 v204, v204, v205
v_cvt_pk_bf16_f32 v205, v206, v207
v_add_u32 v206, s9, v90
s_mov_b64 exec, s[4:5]
ds_write2_b32 v206, v204, v205 offset1:48
s_mov_b64 exec, -1
buffer_load_dwordx4 v49, s[20:23], s28 offen offset:256 nt lds
ds_read_b64_tr_b16 a[186:187], v81 offset:30720
s_add_u32 s29, s28, 196224
s_add_u32 s30, s28, 392448
s_add_u32 s31, s28, 588672
v_bfe_u32 v84, v1, 2, 6
v_lshrrev_b32 v85, 8, v1
s_add_u32 s7, s7, 147456
v_lshl_add_u32 v252, v85, 12, v84
v_add_u32 v252, s7, v252
s_lshl_b32 s7, s38, 12
s_add_u32 s7, s7, 147456
v_min_u32 v85, 2, v85
ds_read_b128 a[200:203], v254 offset:14336
ds_read_b128 a[204:207], v254 offset:15360
ds_read_b128 a[208:211], v254 offset:16384
ds_read_b128 a[212:215], v254 offset:17408
v_add_u32 v254, 73728, v254
s_mov_b32 s45, s29
s_mov_b32 s46, s30
s_mov_b32 s47, s31
s_waitcnt lgkmcnt(3)
v_mfma_f32_16x16x32_bf16 v[208:211], a[200:203], v[164:167], v[208:211]
s_waitcnt lgkmcnt(2)
ds_read_b64_tr_b16 a[188:189], v81 offset:36864
ds_read_b64_tr_b16 a[190:191], v81 offset:43008
v_mfma_f32_16x16x32_bf16 v[208:211], a[204:207], v[168:171], v[208:211]
s_waitcnt lgkmcnt(3)
v_lshl_add_u32 v253, v85, 6, v84
v_mfma_f32_16x16x32_bf16 v[208:211], a[208:211], v[172:175], v[208:211]
s_waitcnt lgkmcnt(2)
v_add_u32 v253, s7, v253
s_mov_b32 s7, 0x10000100
v_mfma_f32_16x16x32_bf16 v[208:211], a[212:215], v[176:179], v[208:211]
ds_read_b128 a[216:219], v1 offset:0
ds_read_b128 a[220:223], v1 offset:1024
v_mfma_f32_16x16x32_bf16 v[212:215], a[192:195], a[144:147], 0
s_nop 0
v_mov_b32 v26, v24
s_nop 0
v_mfma_f32_16x16x32_bf16 v[212:215], a[196:199], a[148:151], v[212:215]
s_nop 0
v_cvt_pk_bf16_f32 v208, v208, v209
v_cvt_pk_bf16_f32 v209, v210, v211
v_mfma_f32_16x16x32_bf16 v[212:215], a[200:203], a[152:155], v[212:215]
v_add_u32 v210, s95, v83
ds_write2_b32 v210, v208, v209 offset1:48
v_mfma_f32_16x16x32_bf16 v[212:215], a[204:207], a[156:159], v[212:215]
v_mov_b32 v24, 0
v_mfma_f32_16x16x32_bf16 v[212:215], a[208:211], a[160:163], v[212:215]
v_mov_b32 v25, 0
v_mfma_f32_16x16x32_bf16 v[212:215], a[212:215], a[164:167], v[212:215]
ds_read_b128 a[224:227], v1 offset:2048
ds_read_b128 a[228:231], v1 offset:3072
v_mfma_f32_16x16x32_bf16 v[216:219], a[240:243], v[180:183], 0
s_nop 0
ds_read_b128 a[232:235], v1 offset:4096
ds_read_b128 a[236:239], v1 offset:5120
v_mfma_f32_16x16x32_bf16 v[188:191], a[240:243], a[144:147], 0
s_nop 0
v_cvt_pk_bf16_f32 v212, v212, v213
v_cvt_pk_bf16_f32 v213, v214, v215
v_mfma_f32_16x16x32_bf16 v[216:219], a[244:247], v[184:187], v[216:219]
v_add_u32 v214, s95, v90
s_mov_b64 exec, s[4:5]
ds_write2_b32 v214, v212, v213 offset1:48
s_mov_b64 exec, -1
v_mfma_f32_16x16x32_bf16 v[188:191], a[244:247], a[148:151], v[188:191]
s_mov_b32 s4, 0
s_mov_b32 s5, 0xffff
ds_read_b64_tr_b16 a[240:241], v81 offset:49152
v_mfma_f32_16x16x32_bf16 v[216:219], a[248:251], v[164:167], v[216:219]
ds_read_b64_tr_b16 a[242:243], v81 offset:55296
ds_read_b64_tr_b16 a[244:245], v81 offset:61440
v_mfma_f32_16x16x32_bf16 v[188:191], a[248:251], a[152:155], v[188:191]
ds_read_b64_tr_b16 a[248:249], v82 offset:0
ds_read_b64_tr_b16 a[250:251], v82 offset:6144
v_mfma_f32_16x16x32_bf16 v[216:219], a[252:255], v[168:171], v[216:219]
v_add_u32 v81, 0x10000, v81
ds_read_b64_tr_b16 a[246:247], v81 offset:2048
v_mfma_f32_16x16x32_bf16 v[188:191], a[252:255], a[156:159], v[188:191]
ds_read_b64_tr_b16 a[252:253], v82 offset:12288
ds_read_b64_tr_b16 a[254:255], v82 offset:18432
v_mfma_f32_16x16x32_bf16 v[216:219], a[168:171], v[172:175], v[216:219]
ds_read_b128 a[192:195], v1 offset:6144
ds_read_b128 a[196:199], v1 offset:7168
v_mfma_f32_16x16x32_bf16 v[188:191], a[168:171], a[160:163], v[188:191]
ds_read_b64_tr_b16 a[168:169], v82 offset:24576
ds_read_b64_tr_b16 a[170:171], v82 offset:30720
v_mfma_f32_16x16x32_bf16 v[216:219], a[172:175], v[176:179], v[216:219]
ds_read_b128 a[200:203], v1 offset:8192
ds_read_b128 a[204:207], v1 offset:9216
v_mfma_f32_16x16x32_bf16 v[188:191], a[172:175], a[164:167], v[188:191]
s_nop 0
ds_read_b64_tr_b16 a[172:173], v82 offset:36864
ds_read_b64_tr_b16 a[174:175], v82 offset:43008
v_mfma_f32_16x16x32_bf16 v[192:195], a[176:179], v[180:183], 0
s_nop 0
v_cvt_pk_bf16_f32 v216, v216, v217
v_cvt_pk_bf16_f32 v217, v218, v219
v_mfma_f32_16x16x32_bf16 v[196:199], a[176:179], a[144:147], 0
v_cvt_pk_bf16_f32 v188, v188, v189
v_cvt_pk_bf16_f32 v189, v190, v191
v_mfma_f32_16x16x32_bf16 v[192:195], a[180:183], v[184:187], v[192:195]
v_xad_u32 v218, s90, v86, v83
v_xad_u32 v190, s90, v86, v90
v_mfma_f32_16x16x32_bf16 v[196:199], a[180:183], a[148:151], v[196:199]
ds_write2_b32 v218, v216, v217 offset1:48
v_mfma_f32_16x16x32_bf16 v[192:195], a[184:187], v[164:167], v[192:195]
s_mov_b64 exec, s[98:99]
ds_write2_b32 v190, v188, v189 offset1:48
s_mov_b64 exec, -1
v_mfma_f32_16x16x32_bf16 v[196:199], a[184:187], a[152:155], v[196:199]
s_waitcnt lgkmcnt(15)
ds_read_b64_tr_b16 a[176:177], v82 offset:49152
ds_read_b64_tr_b16 a[178:179], v82 offset:55296
v_mfma_f32_16x16x32_bf16 v[192:195], a[188:191], v[168:171], v[192:195]
s_waitcnt vmcnt(10)
ds_read_b64_tr_b16 a[180:181], v82 offset:61440
ds_read_b128 a[96:99], v50 offset:6144
v_mfma_f32_16x16x32_bf16 v[196:199], a[188:191], a[156:159], v[196:199]
ds_read_b128 a[100:103], v51 offset:6144
v_add_u32 v82, 0x10000, v82
v_mfma_f32_16x16x32_bf16 v[192:195], a[240:243], v[172:175], v[192:195]
ds_read_b64_tr_b16 a[182:183], v82 offset:2048
ds_read_b128 a[208:211], v1 offset:10240
v_mfma_f32_16x16x32_bf16 v[196:199], a[240:243], a[160:163], v[196:199]
s_waitcnt vmcnt(8) lgkmcnt(15)
ds_read_b128 a[104:107], v50 offset:8192
ds_read_b128 a[212:215], v1 offset:11264
v_mfma_f32_16x16x32_bf16 v[192:195], a[244:247], v[176:179], v[192:195]
ds_read_b128 a[108:111], v51 offset:8192
v_mov_b32 v99, 0
v_mfma_f32_16x16x32_bf16 v[196:199], a[244:247], a[164:167], v[196:199]
s_nop 0
v_mov_b32 v107, 0
v_mov_b32 v115, 0
v_mfma_f32_16x16x32_bf16 v[200:203], a[248:251], v[180:183], 0
s_nop 0
v_cvt_pk_bf16_f32 v192, v192, v193
v_cvt_pk_bf16_f32 v193, v194, v195
v_mfma_f32_16x16x32_bf16 v[204:207], a[248:251], a[144:147], 0
v_cvt_pk_bf16_f32 v196, v196, v197
v_cvt_pk_bf16_f32 v197, v198, v199
v_mfma_f32_16x16x32_bf16 v[200:203], a[252:255], v[184:187], v[200:203]
v_xad_u32 v194, s91, v86, v83
v_xad_u32 v198, s91, v86, v90
v_mfma_f32_16x16x32_bf16 v[204:207], a[252:255], a[148:151], v[204:207]
s_waitcnt lgkmcnt(15)
ds_write2_b32 v194, v192, v193 offset1:48
v_mfma_f32_16x16x32_bf16 v[200:203], a[168:171], v[164:167], v[200:203]
s_mov_b64 exec, s[98:99]
ds_write2_b32 v198, v196, v197 offset1:48
s_mov_b64 exec, -1
v_mfma_f32_16x16x32_bf16 v[204:207], a[168:171], a[152:155], v[204:207]
s_waitcnt vmcnt(6) lgkmcnt(14)
ds_read_b128 a[112:115], v50 offset:10240
ds_read_b128 a[116:119], v51 offset:10240
v_mfma_f32_16x16x32_bf16 v[200:203], a[172:175], v[168:171], v[200:203]
v_mov_b32 v123, 0
v_mov_b32 v131, 0
v_mfma_f32_16x16x32_bf16 v[204:207], a[172:175], a[156:159], v[204:207]
s_waitcnt lgkmcnt(12)
v_mov_b32 v139, 0
v_mfma_f32_16x16x32_bf16 v[200:203], a[176:179], v[172:175], v[200:203]
v_mfma_f32_16x16x32_bf16 v[204:207], a[176:179], a[160:163], v[204:207]
s_waitcnt lgkmcnt(8)
v_mfma_f32_16x16x32_bf16 v[200:203], a[180:183], v[176:179], v[200:203]
v_mfma_f32_16x16x32_bf16 v[204:207], a[180:183], a[164:167], v[204:207]
s_nop 0
s_nop 0
s_nop 0
v_mfma_f32_16x16x32_bf16 v[224:227], a[216:219], a[96:99], 0
s_nop 0
ds_read_b128 a[216:219], v1 offset:12288
s_nop 0
v_mfma_f32_16x16x32_bf16 v[224:227], a[220:223], a[100:103], v[224:227]
s_waitcnt lgkmcnt(7)
v_cvt_pk_bf16_f32 v200, v200, v201
v_cvt_pk_bf16_f32 v204, v204, v205
v_mfma_f32_16x16x32_bf16 v[224:227], a[224:227], a[104:107], v[224:227]
s_waitcnt lgkmcnt(5)
v_cvt_pk_bf16_f32 v201, v202, v203
v_cvt_pk_bf16_f32 v205, v206, v207
v_mfma_f32_16x16x32_bf16 v[224:227], a[228:231], a[108:111], v[224:227]
s_waitcnt lgkmcnt(2)
v_xad_u32 v202, s92, v86, v83
v_xad_u32 v206, s92, v86, v90
v_mfma_f32_16x16x32_bf16 v[224:227], a[232:235], a[112:115], v[224:227]
s_waitcnt lgkmcnt(1)
s_mov_b32 s92, 0
ds_write2_b32 v202, v200, v201 offset1:48
v_mfma_f32_16x16x32_bf16 v[224:227], a[236:239], a[116:119], v[224:227]
s_mov_b64 exec, s[98:99]
ds_write2_b32 v206, v204, v205 offset1:48
s_mov_b64 exec, -1
v_mfma_f32_16x16x32_bf16 v[228:231], a[192:195], a[96:99], 0
ds_read_b128 a[220:223], v1 offset:13312
ds_read_b128 a[224:227], v1 offset:14336
v_mfma_f32_16x16x32_bf16 v[228:231], a[196:199], a[100:103], v[228:231]
ds_read_b128 a[228:231], v1 offset:15360
ds_read_b128 a[232:235], v1 offset:16384
v_mfma_f32_16x16x32_bf16 v[228:231], a[200:203], a[104:107], v[228:231]
ds_read_b128 a[236:239], v1 offset:17408
ds_read_b128 a[192:195], v1 offset:18432
v_mfma_f32_16x16x32_bf16 v[228:231], a[204:207], a[108:111], v[228:231]
ds_read_b128 a[196:199], v1 offset:19456
ds_read_b128 a[200:203], v1 offset:20480
v_mfma_f32_16x16x32_bf16 v[228:231], a[208:211], a[112:115], v[228:231]
ds_read_b128 a[204:207], v1 offset:21504
ds_read_b128 a[208:211], v1 offset:22528
v_mfma_f32_16x16x32_bf16 v[228:231], a[212:215], a[116:119], v[228:231]
s_waitcnt lgkmcnt(12)
ds_read_b128 a[212:215], v1 offset:23552
v_cvt_pk_bf16_f32 v92, v224, v225
v_mfma_f32_16x16x32_bf16 v[232:235], a[216:219], a[96:99], 0
s_waitcnt lgkmcnt(10)
ds_read_b128 a[216:219], v1 offset:24576
v_cvt_pk_bf16_f32 v93, v226, v227
s_nop 0
s_nop 0
v_cvt_pk_bf16_f32 v94, v228, v229
v_mfma_f32_16x16x32_bf16 v[232:235], a[220:223], a[100:103], v[232:235]
s_waitcnt lgkmcnt(10)
ds_read_b128 a[220:223], v1 offset:25600
v_cvt_pk_bf16_f32 v95, v230, v231
v_mfma_f32_16x16x32_bf16 v[232:235], a[224:227], a[104:107], v[232:235]
s_waitcnt lgkmcnt(10)
ds_read_b128 a[224:227], v1 offset:26624
v_mfma_f32_16x16x32_bf16 v[232:235], a[228:231], a[108:111], v[232:235]
s_waitcnt lgkmcnt(10)
ds_read_b128 a[228:231], v1 offset:27648
v_mfma_f32_16x16x32_bf16 v[232:235], a[232:235], a[112:115], v[232:235]
s_waitcnt lgkmcnt(10)
s_barrier
ds_read_b128 a[168:171], v88 offset:0
ds_read_b128 a[232:235], v1 offset:28672
v_mfma_f32_16x16x32_bf16 v[232:235], a[236:239], a[116:119], v[232:235]
s_waitcnt lgkmcnt(11)
ds_read_b128 a[236:239], v1 offset:29696
v_mfma_f32_16x16x32_bf16 v[220:223], a[192:195], a[96:99], 0
s_waitcnt lgkmcnt(11)
ds_read_b128 a[172:175], v88 offset:64
ds_read_b128 a[192:195], v1 offset:30720
v_mfma_f32_16x16x32_bf16 v[220:223], a[196:199], a[100:103], v[220:223]
s_waitcnt lgkmcnt(12)
ds_read_b128 a[196:199], v1 offset:31744
v_cvt_pk_bf16_f32 v100, v232, v233
v_mfma_f32_16x16x32_bf16 v[220:223], a[200:203], a[104:107], v[220:223]
s_waitcnt lgkmcnt(12)
ds_read_b128 a[176:179], v88 offset:128
ds_read_b128 a[200:203], v1 offset:32768
v_mfma_f32_16x16x32_bf16 v[220:223], a[204:207], a[108:111], v[220:223]
s_waitcnt lgkmcnt(13)
ds_read_b128 a[204:207], v1 offset:33792
v_cvt_pk_bf16_f32 v101, v234, v235
v_mfma_f32_16x16x32_bf16 v[220:223], a[208:211], a[112:115], v[220:223]
s_waitcnt lgkmcnt(13)
ds_read_b128 a[180:183], v88 offset:400
ds_read_b128 a[208:211], v1 offset:34816
v_mfma_f32_16x16x32_bf16 v[220:223], a[212:215], a[116:119], v[220:223]
s_waitcnt lgkmcnt(14)
ds_read_b128 a[212:215], v1 offset:35840
v_mfma_f32_16x16x32_bf16 v[224:227], a[216:219], a[96:99], 0
s_waitcnt lgkmcnt(14)
ds_read_b128 a[184:187], v88 offset:464
ds_read_b128 a[216:219], v1 offset:36864
v_mfma_f32_16x16x32_bf16 v[224:227], a[220:223], a[100:103], v[224:227]
s_waitcnt lgkmcnt(15)
ds_read_b128 a[220:223], v1 offset:37888
v_cvt_pk_bf16_f32 v102, v220, v221
v_mfma_f32_16x16x32_bf16 v[224:227], a[224:227], a[104:107], v[224:227]
s_waitcnt lgkmcnt(15)
ds_read_b128 a[188:191], v88 offset:528
ds_read_b128 a[224:227], v1 offset:38912
v_mfma_f32_16x16x32_bf16 v[224:227], a[228:231], a[108:111], v[224:227]
s_waitcnt lgkmcnt(15)
ds_read_b128 a[228:231], v1 offset:39936
v_cvt_pk_bf16_f32 v103, v222, v223
v_mfma_f32_16x16x32_bf16 v[224:227], a[232:235], a[112:115], v[224:227]
s_waitcnt lgkmcnt(15)
ds_read_b128 a[232:235], v1 offset:40960
v_mfma_f32_16x16x32_bf16 v[224:227], a[236:239], a[116:119], v[224:227]
s_waitcnt lgkmcnt(14)
ds_read_b128 a[236:239], v1 offset:41984
v_mfma_f32_16x16x32_bf16 v[228:231], a[192:195], a[96:99], 0
s_waitcnt lgkmcnt(14)
ds_read_b128 a[192:195], v1 offset:43008
s_nop 0
v_mfma_f32_16x16x32_bf16 v[228:231], a[196:199], a[100:103], v[228:231]
s_waitcnt lgkmcnt(13)
ds_read_b128 a[196:199], v1 offset:44032
v_cvt_pk_bf16_f32 v108, v224, v225
v_mfma_f32_16x16x32_bf16 v[228:231], a[200:203], a[104:107], v[228:231]
s_waitcnt lgkmcnt(13)
ds_read_b128 a[200:203], v1 offset:45056
v_cvt_pk_bf16_f32 v109, v226, v227
v_mfma_f32_16x16x32_bf16 v[228:231], a[204:207], a[108:111], v[228:231]
s_waitcnt lgkmcnt(12)
ds_read_b128 a[204:207], v1 offset:46080
v_mfma_f32_16x16x32_bf16 v[228:231], a[208:211], a[112:115], v[228:231]
s_waitcnt lgkmcnt(12)
ds_read_b128 a[208:211], v1 offset:47104
v_mfma_f32_16x16x32_bf16 v[228:231], a[212:215], a[116:119], v[228:231]
s_waitcnt lgkmcnt(11)
ds_read_b128 a[212:215], v1 offset:48128
v_mfma_f32_16x16x32_bf16 v[232:235], a[216:219], a[96:99], 0
s_waitcnt lgkmcnt(11)
ds_read_b128 a[216:219], v1 offset:49152
s_nop 0
v_mfma_f32_16x16x32_bf16 v[232:235], a[220:223], a[100:103], v[232:235]
s_waitcnt lgkmcnt(10)
ds_read_b128 a[220:223], v1 offset:50176
v_cvt_pk_bf16_f32 v110, v228, v229
v_mfma_f32_16x16x32_bf16 v[232:235], a[224:227], a[104:107], v[232:235]
s_waitcnt lgkmcnt(10)
ds_read_b128 a[224:227], v1 offset:51200
v_cvt_pk_bf16_f32 v111, v230, v231
v_mfma_f32_16x16x32_bf16 v[232:235], a[228:231], a[108:111], v[232:235]
s_waitcnt lgkmcnt(10)
ds_read_b128 a[228:231], v1 offset:52224
v_mfma_f32_16x16x32_bf16 v[232:235], a[232:235], a[112:115], v[232:235]
s_waitcnt lgkmcnt(10)
ds_read_b128 a[232:235], v1 offset:53248
v_mfma_f32_16x16x32_bf16 v[232:235], a[236:239], a[116:119], v[232:235]
s_waitcnt lgkmcnt(10)
ds_read_b128 a[236:239], v1 offset:54272
v_mfma_f32_16x16x32_bf16 v[220:223], a[192:195], a[96:99], 0
s_waitcnt lgkmcnt(10)
ds_read_b128 a[192:195], v1 offset:55296
s_nop 0
v_mfma_f32_16x16x32_bf16 v[220:223], a[196:199], a[100:103], v[220:223]
s_waitcnt lgkmcnt(10)
ds_read_b128 a[196:199], v1 offset:56320
v_cvt_pk_bf16_f32 v116, v232, v233
v_mfma_f32_16x16x32_bf16 v[220:223], a[200:203], a[104:107], v[220:223]
s_waitcnt lgkmcnt(10)
ds_read_b128 a[200:203], v1 offset:57344
v_cvt_pk_bf16_f32 v117, v234, v235
v_mfma_f32_16x16x32_bf16 v[220:223], a[204:207], a[108:111], v[220:223]
s_waitcnt lgkmcnt(10)
ds_read_b128 a[204:207], v1 offset:58368
v_mfma_f32_16x16x32_bf16 v[220:223], a[208:211], a[112:115], v[220:223]
s_waitcnt lgkmcnt(10)
ds_read_b128 a[208:211], v1 offset:59392
v_mfma_f32_16x16x32_bf16 v[220:223], a[212:215], a[116:119], v[220:223]
s_waitcnt lgkmcnt(10)
ds_read_b128 a[212:215], v1 offset:60416
v_mfma_f32_16x16x32_bf16 v[224:227], a[216:219], a[96:99], 0
s_waitcnt lgkmcnt(10)
ds_read_b128 a[216:219], v1 offset:61440
s_nop 0
v_mfma_f32_16x16x32_bf16 v[224:227], a[220:223], a[100:103], v[224:227]
s_waitcnt lgkmcnt(10)
ds_read_b128 a[220:223], v1 offset:62464
v_cvt_pk_bf16_f32 v118, v220, v221
v_mfma_f32_16x16x32_bf16 v[224:227], a[224:227], a[104:107], v[224:227]
s_waitcnt lgkmcnt(10)
ds_read_b128 a[224:227], v1 offset:63488
v_cvt_pk_bf16_f32 v119, v222, v223
v_mfma_f32_16x16x32_bf16 v[224:227], a[228:231], a[108:111], v[224:227]
s_waitcnt lgkmcnt(10)
ds_read_b128 a[228:231], v1 offset:64512
v_mfma_f32_16x16x32_bf16 v[224:227], a[232:235], a[112:115], v[224:227]
s_waitcnt lgkmcnt(10)
ds_read_b128 a[232:235], v2 offset:0
v_mfma_f32_16x16x32_bf16 v[224:227], a[236:239], a[116:119], v[224:227]
s_waitcnt vmcnt(4) lgkmcnt(10)
ds_read_b128 a[120:123], v50 offset:12288
ds_read_b128 a[236:239], v2 offset:1024
v_mfma_f32_16x16x32_bf16 v[228:231], a[192:195], a[96:99], 0
s_waitcnt lgkmcnt(11)
ds_read_b128 a[124:127], v51 offset:12288
ds_read_b128 a[192:195], v2 offset:2048
v_mfma_f32_16x16x32_bf16 v[228:231], a[196:199], a[100:103], v[228:231]
s_waitcnt lgkmcnt(12)
ds_read_b128 a[196:199], v2 offset:3072
v_cvt_pk_bf16_f32 v124, v224, v225
v_mfma_f32_16x16x32_bf16 v[228:231], a[200:203], a[104:107], v[228:231]
s_waitcnt lgkmcnt(12)
ds_read_b128 a[200:203], v2 offset:4096
v_cvt_pk_bf16_f32 v125, v226, v227
v_mfma_f32_16x16x32_bf16 v[228:231], a[204:207], a[108:111], v[228:231]
s_waitcnt vmcnt(2) lgkmcnt(12)
ds_read_b128 a[128:131], v50 offset:14336
ds_read_b128 a[204:207], v2 offset:5120
v_mfma_f32_16x16x32_bf16 v[228:231], a[208:211], a[112:115], v[228:231]
s_waitcnt lgkmcnt(13)
ds_read_b128 a[132:135], v51 offset:14336
ds_read_b128 a[208:211], v2 offset:6144
v_mfma_f32_16x16x32_bf16 v[228:231], a[212:215], a[116:119], v[228:231]
s_waitcnt lgkmcnt(14)
ds_read_b128 a[212:215], v2 offset:7168
v_mfma_f32_16x16x32_bf16 v[232:235], a[216:219], a[96:99], 0
s_waitcnt lgkmcnt(14)
ds_read_b128 a[216:219], v1 offset:0
s_nop 0
v_mfma_f32_16x16x32_bf16 v[232:235], a[220:223], a[100:103], v[232:235]
s_waitcnt vmcnt(0) lgkmcnt(14)
ds_read_b128 a[136:139], v50 offset:16384
s_xor_b32 s11, s10, 0
v_mfma_f32_16x16x32_bf16 v[232:235], a[224:227], a[104:107], v[232:235]
s_waitcnt lgkmcnt(14)
s_add_u32 m0, s11, 73728
ds_read_b128 a[140:143], v51 offset:16384
ds_read_b128 a[220:223], v1 offset:1024
v_mfma_f32_16x16x32_bf16 v[232:235], a[228:231], a[108:111], v[232:235]
s_waitcnt lgkmcnt(15)
ds_read_b128 a[224:227], v1 offset:2048
ds_read_b128 a[228:231], v1 offset:3072
v_mfma_f32_16x16x32_bf16 v[232:235], a[232:235], a[112:115], v[232:235]
s_waitcnt lgkmcnt(15)
ds_read_b128 a[232:235], v1 offset:4096
v_cvt_pk_bf16_f32 v126, v228, v229
v_mfma_f32_16x16x32_bf16 v[232:235], a[236:239], a[116:119], v[232:235]
s_waitcnt lgkmcnt(14)
ds_read_b128 a[236:239], v1 offset:5120
s_xor_b32 s11, s10, 4096
v_mfma_f32_16x16x32_bf16 v[220:223], a[192:195], a[96:99], 0
s_waitcnt lgkmcnt(14)
ds_read_b128 a[192:195], v1 offset:6144
v_cvt_pk_bf16_f32 v127, v230, v231
v_mfma_f32_16x16x32_bf16 v[220:223], a[196:199], a[100:103], v[220:223]
s_waitcnt lgkmcnt(14)
ds_read_b128 a[196:199], v1 offset:7168
v_cvt_pk_bf16_f32 v132, v232, v233
v_mfma_f32_16x16x32_bf16 v[220:223], a[200:203], a[104:107], v[220:223]
s_waitcnt lgkmcnt(13)
ds_read_b128 a[200:203], v1 offset:8192
v_cvt_pk_bf16_f32 v133, v234, v235
v_mfma_f32_16x16x32_bf16 v[220:223], a[204:207], a[108:111], v[220:223]
s_waitcnt lgkmcnt(12)
ds_read_b128 a[204:207], v1 offset:9216
v_mfma_f32_16x16x32_bf16 v[220:223], a[208:211], a[112:115], v[220:223]
s_waitcnt lgkmcnt(12)
ds_read_b128 a[208:211], v1 offset:10240
v_mfma_f32_16x16x32_bf16 v[220:223], a[212:215], a[116:119], v[220:223]
s_waitcnt lgkmcnt(10)
s_barrier
buffer_load_dwordx4 v1, s[16:19], m0 offen lds
v_mfma_f32_16x16x32_bf16 v[224:227], a[216:219], a[120:123], 0
s_waitcnt lgkmcnt(9)
s_add_u32 m0, s11, 73728
s_xor_b32 s11, s10, 8192
buffer_load_dwordx4 v1, s[16:19], m0 offen lds
v_mfma_f32_16x16x32_bf16 v[224:227], a[220:223], a[124:127], v[224:227]
s_waitcnt lgkmcnt(8)
s_add_u32 m0, s11, 73728
ds_read_b128 a[212:215], v1 offset:11264
buffer_load_dwordx4 v1, s[16:19], m0 offen lds
v_mfma_f32_16x16x32_bf16 v[224:227], a[224:227], a[128:131], v[224:227]
s_waitcnt lgkmcnt(8)
s_xor_b32 s11, s10, 12288
s_add_u32 m0, s11, 73728
ds_read_b128 a[216:219], v1 offset:12288
v_mfma_f32_16x16x32_bf16 v[224:227], a[228:231], a[132:135], v[224:227]
buffer_load_dwordx4 v1, s[16:19], m0 offen lds
s_waitcnt lgkmcnt(8)
ds_read_b128 a[220:223], v1 offset:13312
v_mfma_f32_16x16x32_bf16 v[224:227], a[232:235], a[136:139], v[224:227]
s_waitcnt lgkmcnt(8)
ds_read_b128 a[224:227], v1 offset:14336
ds_read_b128 a[228:231], v1 offset:15360
v_mfma_f32_16x16x32_bf16 v[224:227], a[236:239], a[140:143], v[224:227]
s_waitcnt lgkmcnt(9)
ds_read_b128 a[232:235], v1 offset:16384
s_xor_b32 s11, s10, 16384
v_mfma_f32_16x16x32_bf16 v[228:231], a[192:195], a[120:123], 0
s_waitcnt lgkmcnt(9)
s_add_u32 m0, s11, 73728
ds_read_b128 a[236:239], v1 offset:17408
ds_read_b128 a[192:195], v1 offset:18432
v_mfma_f32_16x16x32_bf16 v[228:231], a[196:199], a[124:127], v[228:231]
LW_p21:
s_cbranch_execz LW_p6
s_waitcnt lgkmcnt(10)
buffer_load_dwordx4 v1, s[16:19], m0 offen lds
ds_read_b128 a[196:199], v1 offset:19456
v_mfma_f32_16x16x32_bf16 v[228:231], a[200:203], a[128:131], v[228:231]
s_waitcnt lgkmcnt(10)
ds_read_b128 a[200:203], v1 offset:20480
v_cvt_pk_bf16_f32 v134, v220, v221
v_mfma_f32_16x16x32_bf16 v[228:231], a[204:207], a[132:135], v[228:231]
s_waitcnt lgkmcnt(10)
ds_read_b128 a[204:207], v1 offset:21504
s_xor_b32 s11, s10, 20480
v_mfma_f32_16x16x32_bf16 v[228:231], a[208:211], a[136:139], v[228:231]
s_waitcnt lgkmcnt(10)
s_add_u32 m0, s11, 73728
ds_read_b128 a[208:211], v1 offset:22528
v_cvt_pk_bf16_f32 v135, v222, v223
v_mfma_f32_16x16x32_bf16 v[228:231], a[212:215], a[140:143], v[228:231]
buffer_load_dwordx4 v1, s[16:19], m0 offen lds
s_waitcnt lgkmcnt(10)
ds_read_b128 a[212:215], v1 offset:23552
v_mfma_f32_16x16x32_bf16 v[232:235], a[216:219], a[120:123], 0
s_waitcnt lgkmcnt(10)
ds_read_b128 a[216:219], v1 offset:24576
v_cvt_pk_bf16_f32 v140, v224, v225
v_mfma_f32_16x16x32_bf16 v[232:235], a[220:223], a[124:127], v[232:235]
s_waitcnt lgkmcnt(10)
ds_read_b128 a[220:223], v1 offset:25600
s_xor_b32 s11, s10, 24576
v_mfma_f32_16x16x32_bf16 v[232:235], a[224:227], a[128:131], v[232:235]
s_waitcnt lgkmcnt(10)
s_add_u32 m0, s11, 73728
ds_read_b128 a[224:227], v1 offset:26624
v_cvt_pk_bf16_f32 v141, v226, v227
v_mfma_f32_16x16x32_bf16 v[232:235], a[228:231], a[132:135], v[232:235]
buffer_load_dwordx4 v1, s[16:19], m0 offen lds
s_waitcnt lgkmcnt(10)
ds_read_b128 a[228:231], v1 offset:27648
v_mfma_f32_16x16x32_bf16 v[232:235], a[232:235], a[136:139], v[232:235]
s_waitcnt lgkmcnt(10)
ds_read_b128 a[232:235], v1 offset:28672
v_cvt_pk_bf16_f32 v142, v228, v229
v_mfma_f32_16x16x32_bf16 v[232:235], a[236:239], a[140:143], v[232:235]
s_waitcnt lgkmcnt(10)
ds_read_b128 a[236:239], v1 offset:29696
s_xor_b32 s11, s10, 28672
v_mfma_f32_16x16x32_bf16 v[220:223], a[192:195], a[120:123], 0
s_waitcnt lgkmcnt(10)
s_add_u32 m0, s11, 73728
ds_read_b128 a[192:195], v1 offset:30720
v_cvt_pk_bf16_f32 v143, v230, v231
v_mfma_f32_16x16x32_bf16 v[220:223], a[196:199], a[124:127], v[220:223]
s_waitcnt lgkmcnt(10)
buffer_load_dwordx4 v1, s[16:19], m0 offen lds
ds_read_b128 a[196:199], v1 offset:31744
v_mfma_f32_16x16x32_bf16 v[220:223], a[200:203], a[128:131], v[220:223]
s_waitcnt lgkmcnt(10)
ds_read_b128 a[200:203], v1 offset:32768
v_cvt_pk_bf16_f32 v144, v232, v233
v_mfma_f32_16x16x32_bf16 v[220:223], a[204:207], a[132:135], v[220:223]
s_waitcnt lgkmcnt(10)
ds_read_b128 a[204:207], v1 offset:33792
s_xor_b32 s11, s10, 32768
v_mfma_f32_16x16x32_bf16 v[220:223], a[208:211], a[136:139], v[220:223]
s_waitcnt lgkmcnt(10)
s_add_u32 m0, s11, 73728
ds_read_b128 a[208:211], v1 offset:34816
v_cvt_pk_bf16_f32 v145, v234, v235
v_mfma_f32_16x16x32_bf16 v[220:223], a[212:215], a[140:143], v[220:223]
buffer_load_dwordx4 v1, s[16:19], m0 offen lds
s_waitcnt lgkmcnt(10)
ds_read_b128 a[212:215], v1 offset:35840
v_mfma_f32_16x16x32_bf16 v[224:227], a[216:219], a[120:123], 0
s_waitcnt lgkmcnt(10)
ds_read_b128 a[216:219], v1 offset:36864
s_nop 0
v_mfma_f32_16x16x32_bf16 v[224:227], a[220:223], a[124:127], v[224:227]
s_waitcnt lgkmcnt(10)
v_cvt_pk_bf16_f32 v146, v220, v221
s_xor_b32 s11, s10, 36864
v_mfma_f32_16x16x32_bf16 v[224:227], a[224:227], a[128:131], v[224:227]
s_waitcnt lgkmcnt(9)
s_add_u32 m0, s11, 73728
ds_read_b128 a[220:223], v1 offset:37888
ds_read_b128 a[224:227], v1 offset:38912
v_mfma_f32_16x16x32_bf16 v[224:227], a[228:231], a[132:135], v[224:227]
buffer_load_dwordx4 v1, s[16:19], m0 offen lds
s_waitcnt lgkmcnt(10)
ds_read_b128 a[228:231], v1 offset:39936
v_mfma_f32_16x16x32_bf16 v[224:227], a[232:235], a[136:139], v[224:227]
s_waitcnt lgkmcnt(10)
ds_read_b128 a[232:235], v1 offset:40960
v_cvt_pk_bf16_f32 v147, v222, v223
v_mfma_f32_16x16x32_bf16 v[224:227], a[236:239], a[140:143], v[224:227]
s_waitcnt lgkmcnt(10)
ds_read_b128 a[236:239], v1 offset:41984
s_xor_b32 s11, s10, 40960
v_mfma_f32_16x16x32_bf16 v[228:231], a[192:195], a[120:123], 0
s_waitcnt lgkmcnt(10)
s_add_u32 m0, s11, 73728
ds_read_b128 a[192:195], v1 offset:43008
v_mfma_f32_16x16x32_bf16 v[228:231], a[196:199], a[124:127], v[228:231]
s_waitcnt lgkmcnt(10)
buffer_load_dwordx4 v1, s[16:19], m0 offen lds
ds_read_b128 a[196:199], v1 offset:44032
v_mfma_f32_16x16x32_bf16 v[228:231], a[200:203], a[128:131], v[228:231]
s_waitcnt lgkmcnt(10)
ds_read_b128 a[200:203], v1 offset:45056
v_cvt_pk_bf16_f32 v148, v224, v225
v_mfma_f32_16x16x32_bf16 v[228:231], a[204:207], a[132:135], v[228:231]
s_waitcnt lgkmcnt(10)
ds_read_b128 a[204:207], v1 offset:46080
s_xor_b32 s11, s10, 45056
v_mfma_f32_16x16x32_bf16 v[228:231], a[208:211], a[136:139], v[228:231]
s_waitcnt lgkmcnt(10)
s_add_u32 m0, s11, 73728
ds_read_b128 a[208:211], v1 offset:47104
v_cvt_pk_bf16_f32 v149, v226, v227
v_mfma_f32_16x16x32_bf16 v[228:231], a[212:215], a[140:143], v[228:231]
buffer_load_dwordx4 v1, s[16:19], m0 offen lds
s_waitcnt lgkmcnt(10)
ds_read_b128 a[212:215], v1 offset:48128
v_mfma_f32_16x16x32_bf16 v[232:235], a[216:219], a[120:123], 0
s_waitcnt lgkmcnt(10)
ds_read_b128 a[216:219], v1 offset:49152
s_nop 0
v_mfma_f32_16x16x32_bf16 v[232:235], a[220:223], a[124:127], v[232:235]
s_waitcnt lgkmcnt(10)
ds_read_b128 a[220:223], v1 offset:50176
s_xor_b32 s11, s10, 49152
v_mfma_f32_16x16x32_bf16 v[232:235], a[224:227], a[128:131], v[232:235]
s_waitcnt lgkmcnt(10)
s_add_u32 m0, s11, 73728
ds_read_b128 a[224:227], v1 offset:51200
v_cvt_pk_bf16_f32 v150, v228, v229
v_mfma_f32_16x16x32_bf16 v[232:235], a[228:231], a[132:135], v[232:235]
buffer_load_dwordx4 v1, s[16:19], m0 offen lds
s_waitcnt lgkmcnt(10)
ds_read_b128 a[228:231], v1 offset:52224
v_mfma_f32_16x16x32_bf16 v[232:235], a[232:235], a[136:139], v[232:235]
s_waitcnt lgkmcnt(10)
ds_read_b128 a[232:235], v1 offset:53248
v_cvt_pk_bf16_f32 v151, v230, v231
v_mfma_f32_16x16x32_bf16 v[232:235], a[236:239], a[140:143], v[232:235]
s_waitcnt lgkmcnt(10)
ds_read_b128 a[236:239], v1 offset:54272
s_xor_b32 s11, s10, 53248
v_mfma_f32_16x16x32_bf16 v[220:223], a[192:195], a[120:123], 0
s_waitcnt lgkmcnt(10)
s_add_u32 m0, s11, 73728
ds_read_b128 a[192:195], v1 offset:55296
v_mfma_f32_16x16x32_bf16 v[220:223], a[196:199], a[124:127], v[220:223]
s_waitcnt lgkmcnt(10)
buffer_load_dwordx4 v1, s[16:19], m0 offen lds
ds_read_b128 a[196:199], v1 offset:56320
v_mfma_f32_16x16x32_bf16 v[220:223], a[200:203], a[128:131], v[220:223]
s_waitcnt lgkmcnt(10)
ds_read_b128 a[200:203], v1 offset:57344
v_cvt_pk_bf16_f32 v152, v232, v233
v_mfma_f32_16x16x32_bf16 v[220:223], a[204:207], a[132:135], v[220:223]
s_waitcnt lgkmcnt(10)
ds_read_b128 a[204:207], v1 offset:58368
s_xor_b32 s11, s10, 57344
v_mfma_f32_16x16x32_bf16 v[220:223], a[208:211], a[136:139], v[220:223]
s_waitcnt lgkmcnt(10)
s_add_u32 m0, s11, 73728
ds_read_b128 a[208:211], v1 offset:59392
v_cvt_pk_bf16_f32 v153, v234, v235
v_mfma_f32_16x16x32_bf16 v[220:223], a[212:215], a[140:143], v[220:223]
buffer_load_dwordx4 v1, s[16:19], m0 offen lds
s_waitcnt lgkmcnt(10)
ds_read_b128 a[212:215], v1 offset:60416
v_mfma_f32_16x16x32_bf16 v[224:227], a[216:219], a[120:123], 0
s_waitcnt lgkmcnt(10)
ds_read_b128 a[216:219], v1 offset:61440
s_nop 0
v_mfma_f32_16x16x32_bf16 v[224:227], a[220:223], a[124:127], v[224:227]
s_waitcnt lgkmcnt(10)
v_cvt_pk_bf16_f32 v154, v220, v221
s_xor_b32 s11, s10, 61440
v_mfma_f32_16x16x32_bf16 v[224:227], a[224:227], a[128:131], v[224:227]
s_waitcnt lgkmcnt(9)
s_add_u32 m0, s11, 73728
ds_read_b128 a[220:223], v1 offset:62464
ds_read_b128 a[224:227], v1 offset:63488
v_mfma_f32_16x16x32_bf16 v[224:227], a[228:231], a[132:135], v[224:227]
s_waitcnt lgkmcnt(10)
s_add_u32 s26, s26, 1
buffer_load_dwordx4 v1, s[16:19], m0 offen lds
ds_read_b128 a[228:231], v1 offset:64512
v_mfma_f32_16x16x32_bf16 v[224:227], a[232:235], a[136:139], v[224:227]
s_waitcnt lgkmcnt(10)
s_add_u32 s33, s33, 1024
ds_read_b128 a[232:235], v2 offset:0
v_cvt_pk_bf16_f32 v155, v222, v223
v_mfma_f32_16x16x32_bf16 v[224:227], a[236:239], a[140:143], v[224:227]
s_waitcnt lgkmcnt(10)
s_cmp_eq_u32 s26, 4
ds_read_b128 a[236:239], v2 offset:1024
s_mov_b32 m0, s96
v_mfma_f32_16x16x32_bf16 v[228:231], a[192:195], a[120:123], 0
s_waitcnt lgkmcnt(10)
s_cselect_b32 s33, s87, s33
ds_read_b128 a[192:195], v2 offset:2048
v_mov_b64 v[188:189], 0
v_mfma_f32_16x16x32_bf16 v[228:231], a[196:199], a[124:127], v[228:231]
buffer_load_dwordx4 v1, s[16:19], m0 offen lds
s_waitcnt lgkmcnt(10)
ds_read_b128 a[196:199], v2 offset:3072
v_mfma_f32_16x16x32_bf16 v[228:231], a[200:203], a[128:131], v[228:231]
s_waitcnt lgkmcnt(10)
s_mul_hi_u32 s34, s33, 58835169
ds_read_b128 a[200:203], v2 offset:4096
v_mov_b64 v[192:193], 0
v_mfma_f32_16x16x32_bf16 v[228:231], a[204:207], a[132:135], v[228:231]
s_waitcnt lgkmcnt(10)
s_mov_b32 m0, s97
ds_read_b128 a[204:207], v2 offset:5120
v_cvt_pk_bf16_f32 v156, v224, v225
v_mfma_f32_16x16x32_bf16 v[228:231], a[208:211], a[136:139], v[228:231]
s_waitcnt lgkmcnt(10)
s_mul_i32 s35, s34, 73
ds_read_b128 a[208:211], v2 offset:6144
buffer_load_dwordx4 v1, s[16:19], m0 offen lds
v_mfma_f32_16x16x32_bf16 v[228:231], a[212:215], a[140:143], v[228:231]
s_waitcnt lgkmcnt(10)
s_sub_u32 s35, s33, s35
ds_read_b128 a[212:215], v2 offset:7168
v_mov_b64 v[196:197], 0
v_mfma_f32_16x16x32_bf16 v[232:235], a[216:219], a[120:123], 0
s_waitcnt lgkmcnt(10)
s_mul_i32 s34, s34, 1373568
v_mov_b64 v[200:201], 0
v_mfma_f32_16x16x32_bf16 v[232:235], a[220:223], a[124:127], v[232:235]
s_waitcnt lgkmcnt(9)
s_mul_i32 s35, s35, 2688
v_mov_b64 v[76:77], 0
v_mfma_f32_16x16x32_bf16 v[232:235], a[224:227], a[128:131], v[232:235]
s_waitcnt lgkmcnt(8)
v_mov_b64 v[78:79], v[26:27]
v_mfma_f32_16x16x32_bf16 v[232:235], a[228:231], a[132:135], v[232:235]
s_waitcnt lgkmcnt(7)
v_mov_b64 v[80:81], 0
v_mfma_f32_16x16x32_bf16 v[232:235], a[232:235], a[136:139], v[232:235]
s_waitcnt lgkmcnt(6)
v_mov_b64 v[82:83], v[26:27]
v_mfma_f32_16x16x32_bf16 v[232:235], a[236:239], a[140:143], v[232:235]
s_waitcnt lgkmcnt(5)
v_mov_b64 v[84:85], 0
v_mfma_f32_16x16x32_bf16 v[220:223], a[192:195], a[120:123], 0
s_waitcnt lgkmcnt(4)
v_mov_b64 v[86:87], v[26:27]
v_mfma_f32_16x16x32_bf16 v[220:223], a[196:199], a[124:127], v[220:223]
s_waitcnt lgkmcnt(3)
v_cvt_pk_bf16_f32 v157, v226, v227
v_cvt_pk_bf16_f32 v158, v228, v229
v_mfma_f32_16x16x32_bf16 v[220:223], a[200:203], a[128:131], v[220:223]
s_waitcnt lgkmcnt(2)
v_cvt_pk_bf16_f32 v159, v230, v231
v_cvt_pk_bf16_f32 v160, v232, v233
v_mfma_f32_16x16x32_bf16 v[220:223], a[204:207], a[132:135], v[220:223]
s_waitcnt lgkmcnt(1)
v_cvt_pk_bf16_f32 v161, v234, v235
v_mfma_f32_16x16x32_bf16 v[220:223], a[208:211], a[136:139], v[220:223]
s_waitcnt lgkmcnt(0)
v_mfma_f32_16x16x32_bf16 v[220:223], a[212:215], a[140:143], v[220:223]
v_smfmac_f32_16x16x64_bf16 v[188:191], a[168:171], v[180:187], v0
s_nop 0
s_nop 0
s_nop 0
v_smfmac_f32_16x16x64_bf16 v[188:191], a[172:175], v[164:171], v0
s_nop 0
s_nop 0
s_nop 0
v_smfmac_f32_16x16x64_bf16 v[188:191], a[176:179], v[172:179], v0
v_cvt_pk_bf16_f32 v162, v220, v221
v_smfmac_f32_16x16x64_bf16 v[192:195], a[168:171], a[144:151], v0
s_nop 0
s_nop 0
v_cvt_pk_bf16_f32 v163, v222, v223
v_smfmac_f32_16x16x64_bf16 v[192:195], a[172:175], a[152:159], v0
s_nop 0
s_nop 0
v_add_f32 v188, v188, v189
v_smfmac_f32_16x16x64_bf16 v[192:195], a[176:179], a[160:167], v0
v_smfmac_f32_16x16x64_bf16 v[196:199], a[180:183], v[180:187], v0
s_nop 0
s_nop 0
s_nop 0
v_smfmac_f32_16x16x64_bf16 v[196:199], a[184:187], v[164:171], v0
s_nop 0
s_nop 0
s_nop 0
v_smfmac_f32_16x16x64_bf16 v[196:199], a[188:191], v[172:179], v0
v_add_f32 v192, v192, v193
v_smfmac_f32_16x16x64_bf16 v[200:203], a[180:183], a[144:151], v0
s_nop 0
s_nop 0
v_cndmask_b32 v188, v188, v192, s[4:5]
v_smfmac_f32_16x16x64_bf16 v[200:203], a[184:187], a[152:159], v0
s_nop 0
s_nop 0
ds_bpermute_b32 v189, v89, v188 offset:0
v_smfmac_f32_16x16x64_bf16 v[200:203], a[188:191], a[160:167], v0
v_add_f32 v196, v196, v197
v_smfmac_f32_16x16x64_bf16 v[76:79], a[168:171], a[72:79], v0
s_nop 0
s_nop 0
ds_write_b64 v22, v[24:25] offset:384
v_smfmac_f32_16x16x64_bf16 v[76:79], a[172:175], a[80:87], v0
s_nop 0
s_nop 0
v_add_f32 v200, v200, v201
v_smfmac_f32_16x16x64_bf16 v[76:79], a[176:179], a[88:95], v0
v_cndmask_b32 v196, v196, v200, s[4:5]
v_smfmac_f32_16x16x64_bf16 v[80:83], a[168:171], a[96:103], v0
s_nop 0
s_nop 0
ds_bpermute_b32 v197, v89, v196 offset:4
v_smfmac_f32_16x16x64_bf16 v[80:83], a[172:175], a[104:111], v0
s_nop 0
s_nop 0
v_add_f32 v76, v76, v77
v_smfmac_f32_16x16x64_bf16 v[80:83], a[176:179], a[112:119], v0
ds_write_b64 v22, v[24:25] offset:392
v_smfmac_f32_16x16x64_bf16 v[84:87], a[168:171], a[120:127], v0
s_nop 0
s_nop 0
v_add_f32 v78, v78, v79
v_smfmac_f32_16x16x64_bf16 v[84:87], a[172:175], a[128:135], v0
s_waitcnt lgkmcnt(3)
s_nop 0
v_cndmask_b32 v18, v21, v189, s[6:7]
v_smfmac_f32_16x16x64_bf16 v[84:87], a[176:179], a[136:143], v0
s_mov_b32 s6, 0x200002
s_mov_b32 s7, 0x20000200
v_add_f32 v80, v80, v81
v_mfma_f32_16x16x32_bf16 v[28:31], a[72:75], v[60:63], 0
s_nop 0
v_max3_f32 v88, v18, v76, v80
v_add_f32 v82, v82, v83
v_mfma_f32_16x16x32_bf16 v[28:31], a[76:79], v[64:67], v[28:31]
buffer_load_dwordx4 a[0:3], v8, s[20:23], s32 offen offset:0 nt
v_add_f32 v84, v84, v85
v_mfma_f32_16x16x32_bf16 v[28:31], a[80:83], v[68:71], v[28:31]
buffer_load_dwordx4 a[4:7], v9, s[20:23], s32 offen offset:0 nt
v_max_f32 v88, v88, v84
v_mfma_f32_16x16x32_bf16 v[28:31], a[84:87], v[72:75], v[28:31]
buffer_load_dwordx4 a[24:27], v10, s[20:23], s32 offen offset:0 nt
v_max_f32_dpp v88, v88, v88 row_ror:8 row_mask:0xf bank_mask:0xf
v_mfma_f32_16x16x32_bf16 v[28:31], a[88:91], v[236:239], v[28:31]
s_waitcnt lgkmcnt(1)
v_max_f32_dpp v88, v88, v88 row_ror:4 row_mask:0xf bank_mask:0xf
v_cndmask_b32 v19, v21, v197, s[6:7]
v_mfma_f32_16x16x32_bf16 v[28:31], a[92:95], v[240:243], v[28:31]
v_max_f32_dpp v88, v88, v88 row_ror:2 row_mask:0xf bank_mask:0xf
v_add_f32 v86, v86, v87
v_mfma_f32_16x16x32_bf16 v[32:35], a[96:99], v[60:63], 0
v_max_f32_dpp v88, v88, v88 row_ror:1 row_mask:0xf bank_mask:0xf
v_sub_f32 v89, v18, v88
v_mfma_f32_16x16x32_bf16 v[32:35], a[100:103], v[64:67], v[32:35]
v_sub_f32 v76, v76, v88
v_sub_f32 v80, v80, v88
v_mfma_f32_16x16x32_bf16 v[32:35], a[104:107], v[68:71], v[32:35]
v_sub_f32 v84, v84, v88
v_exp_f32 v76, v76
v_mfma_f32_16x16x32_bf16 v[32:35], a[108:111], v[72:75], v[32:35]
v_exp_f32 v80, v80
v_mfma_f32_16x16x32_bf16 v[32:35], a[112:115], v[236:239], v[32:35]
v_exp_f32 v84, v84
v_mfma_f32_16x16x32_bf16 v[32:35], a[116:119], v[240:243], v[32:35]
s_waitcnt vmcnt(3)
s_barrier
v_exp_f32 v89, v89
v_mfma_f32_16x16x32_bf16 v[36:39], a[120:123], v[60:63], 0
v_add_f32 v88, v76, v80
v_add_f32 v90, v84, v89
v_mfma_f32_16x16x32_bf16 v[36:39], a[124:127], v[64:67], v[36:39]
buffer_load_dwordx4 a[28:31], v11, s[20:23], s32 offen offset:0 nt
v_add_f32 v88, v88, v90
v_mfma_f32_16x16x32_bf16 v[36:39], a[128:131], v[68:71], v[36:39]
s_nop 0
v_add_f32_dpp v88, v88, v88 row_ror:8 row_mask:0xf bank_mask:0xf
v_max3_f32 v42, v28, v29, v30
v_mfma_f32_16x16x32_bf16 v[36:39], a[132:135], v[72:75], v[36:39]
buffer_load_dwordx4 a[48:51], v12, s[20:23], s32 offen offset:0 nt
v_add_f32_dpp v88, v88, v88 row_ror:4 row_mask:0xf bank_mask:0xf
v_mfma_f32_16x16x32_bf16 v[36:39], a[136:139], v[236:239], v[36:39]
s_nop 0
v_add_f32_dpp v88, v88, v88 row_ror:2 row_mask:0xf bank_mask:0xf
v_max3_f32 v42, v42, v31, v32
v_mfma_f32_16x16x32_bf16 v[36:39], a[140:143], v[240:243], v[36:39]
v_add_f32_dpp v88, v88, v88 row_ror:1 row_mask:0xf bank_mask:0xf
v_rcp_f32 v88, v88
v_mfma_f32_16x16x32_bf16 v[44:47], a[72:75], v[92:95], 0
v_mul_f32 v76, v76, v88
v_mul_f32 v80, v80, v88
v_mfma_f32_16x16x32_bf16 v[44:47], a[76:79], v[100:103], v[44:47]
v_mul_f32 v84, v84, v88
v_mul_f32 v89, v89, v88
v_mfma_f32_16x16x32_bf16 v[44:47], a[80:83], v[108:111], v[44:47]
v_cvt_pk_bf16_f32 v90, v76, v80
v_cvt_pk_bf16_f32 v91, v84, v89
v_mfma_f32_16x16x32_bf16 v[44:47], a[84:87], v[116:119], v[44:47]
ds_write_b16 v20, v90 offset:0
v_mfma_f32_16x16x32_bf16 v[44:47], a[88:91], v[124:127], v[44:47]
ds_write_b16_d16_hi v20, v90 offset:4
v_mfma_f32_16x16x32_bf16 v[44:47], a[92:95], v[132:135], v[44:47]
ds_write_b16 v20, v91 offset:32
v_mfma_f32_16x16x32_bf16 v[48:51], a[96:99], v[92:95], 0
buffer_load_dwordx4 a[52:55], v13, s[20:23], s32 offen offset:0 nt
ds_write_b16_d16_hi v20, v91 offset:36
v_mfma_f32_16x16x32_bf16 v[48:51], a[100:103], v[100:103], v[48:51]
ds_read_b128 a[216:219], v254 offset:0
ds_read_b128 a[220:223], v254 offset:1024
v_mfma_f32_16x16x32_bf16 v[48:51], a[104:107], v[108:111], v[48:51]
ds_read_b128 a[224:227], v254 offset:2048
ds_read_b128 a[228:231], v254 offset:3072
v_mfma_f32_16x16x32_bf16 v[48:51], a[108:111], v[116:119], v[48:51]
ds_read_b128 a[232:235], v254 offset:4096
ds_read_b128 a[236:239], v254 offset:5120
v_mfma_f32_16x16x32_bf16 v[48:51], a[112:115], v[124:127], v[48:51]
ds_read_b128 a[192:195], v254 offset:6144
ds_read_b128 a[196:199], v254 offset:7168
v_mfma_f32_16x16x32_bf16 v[48:51], a[116:119], v[132:135], v[48:51]
ds_read_b128 a[200:203], v254 offset:8192
ds_read_b128 a[204:207], v254 offset:9216
v_mfma_f32_16x16x32_bf16 v[52:55], a[120:123], v[92:95], 0
ds_read_b128 a[208:211], v254 offset:10240
ds_read_b128 a[212:215], v254 offset:11264
v_mfma_f32_16x16x32_bf16 v[52:55], a[124:127], v[100:103], v[52:55]
buffer_load_dwordx4 a[8:11], v8, s[20:23], s32 offen offset:128 nt
v_max3_f32 v42, v42, v33, v34
v_mfma_f32_16x16x32_bf16 v[52:55], a[128:131], v[108:111], v[52:55]
v_max3_f32 v42, v42, v35, v36
v_max3_f32 v42, v42, v37, v38
v_mfma_f32_16x16x32_bf16 v[52:55], a[132:135], v[116:119], v[52:55]
v_max3_f32 v42, v42, v39, v78
v_mov_b32 v43, v42
v_mfma_f32_16x16x32_bf16 v[52:55], a[136:139], v[124:127], v[52:55]
ds_read_b128 a[240:243], v22 offset:0
v_max3_f32 v58, v44, v45, v46
v_mfma_f32_16x16x32_bf16 v[52:55], a[140:143], v[132:135], v[52:55]
v_permlane32_swap_b32 v42, v43
v_mfma_f32_16x16x32_bf16 v[60:63], a[72:75], v[140:143], 0
v_max_f32 v42, v42, v43
v_mov_b32 v43, v42
v_mfma_f32_16x16x32_bf16 v[60:63], a[76:79], v[144:147], v[60:63]
v_max3_f32 v58, v58, v47, v48
v_max3_f32 v58, v58, v49, v50
v_mfma_f32_16x16x32_bf16 v[60:63], a[80:83], v[148:151], v[60:63]
v_permlane16_swap_b32 v42, v43
v_mfma_f32_16x16x32_bf16 v[60:63], a[84:87], v[152:155], v[60:63]
buffer_load_dwordx4 a[12:15], v9, s[20:23], s32 offen offset:128 nt
v_max_f32 v42, v42, v43
v_mfma_f32_16x16x32_bf16 v[60:63], a[88:91], v[156:159], v[60:63]
v_sub_f32 v28, v28, v42
v_sub_f32 v29, v29, v42
v_mfma_f32_16x16x32_bf16 v[60:63], a[92:95], v[160:163], v[60:63]
v_sub_f32 v30, v30, v42
v_sub_f32 v31, v31, v42
v_mfma_f32_16x16x32_bf16 v[64:67], a[96:99], v[140:143], 0
v_exp_f32 v28, v28
v_mfma_f32_16x16x32_bf16 v[64:67], a[100:103], v[144:147], v[64:67]
v_exp_f32 v29, v29
v_mfma_f32_16x16x32_bf16 v[64:67], a[104:107], v[148:151], v[64:67]
v_sub_f32 v32, v32, v42
v_sub_f32 v33, v33, v42
v_mfma_f32_16x16x32_bf16 v[64:67], a[108:111], v[152:155], v[64:67]
v_sub_f32 v34, v34, v42
v_sub_f32 v35, v35, v42
v_mfma_f32_16x16x32_bf16 v[64:67], a[112:115], v[156:159], v[64:67]
v_sub_f32 v36, v36, v42
v_sub_f32 v37, v37, v42
v_mfma_f32_16x16x32_bf16 v[64:67], a[116:119], v[160:163], v[64:67]
buffer_load_dwordx4 a[32:35], v10, s[20:23], s32 offen offset:128 nt
v_sub_f32 v38, v38, v42
v_mfma_f32_16x16x32_bf16 v[68:71], a[120:123], v[140:143], 0
v_sub_f32 v39, v39, v42
v_sub_f32 v78, v78, v42
v_mfma_f32_16x16x32_bf16 v[68:71], a[124:127], v[144:147], v[68:71]
v_exp_f32 v30, v30
v_mfma_f32_16x16x32_bf16 v[68:71], a[128:131], v[148:151], v[68:71]
v_exp_f32 v31, v31
v_mfma_f32_16x16x32_bf16 v[68:71], a[132:135], v[152:155], v[68:71]
v_add_f32 v42, v28, v29
v_add_f32 v42, v42, v30
v_mfma_f32_16x16x32_bf16 v[68:71], a[136:139], v[156:159], v[68:71]
v_exp_f32 v32, v32
v_mfma_f32_16x16x32_bf16 v[68:71], a[140:143], v[160:163], v[68:71]
s_waitcnt lgkmcnt(12)
v_exp_f32 v33, v33
v_mfma_f32_16x16x32_bf16 v[216:219], v[180:183], a[216:219], 0
s_waitcnt lgkmcnt(11)
v_add_f32 v42, v42, v31
v_add_f32 v42, v42, v32
v_mfma_f32_16x16x32_bf16 v[216:219], v[184:187], a[220:223], v[216:219]
buffer_load_dwordx4 a[36:39], v11, s[20:23], s32 offen offset:128 nt
s_waitcnt lgkmcnt(10)
v_add_f32 v42, v42, v33
v_mfma_f32_16x16x32_bf16 v[216:219], v[164:167], a[224:227], v[216:219]
s_waitcnt lgkmcnt(9)
v_exp_f32 v34, v34
v_mfma_f32_16x16x32_bf16 v[216:219], v[168:171], a[228:231], v[216:219]
s_waitcnt lgkmcnt(8)
v_exp_f32 v35, v35
v_mfma_f32_16x16x32_bf16 v[216:219], v[172:175], a[232:235], v[216:219]
s_waitcnt lgkmcnt(7)
v_exp_f32 v36, v36
v_mfma_f32_16x16x32_bf16 v[216:219], v[176:179], a[236:239], v[216:219]
v_add_f32 v42, v42, v34
v_add_f32 v42, v42, v35
v_mfma_f32_16x16x32_bf16 v[188:191], a[144:147], a[216:219], 0
s_nop 0
ds_read_b128 a[216:219], v254 offset:12288
v_add_f32 v42, v42, v36
v_mfma_f32_16x16x32_bf16 v[188:191], a[148:151], a[220:223], v[188:191]
s_nop 0
v_cvt_pk_bf16_f32 v216, v216, v217
v_cvt_pk_bf16_f32 v217, v218, v219
v_mfma_f32_16x16x32_bf16 v[188:191], a[152:155], a[224:227], v[188:191]
ds_write2_b32 v252, v216, v217 offset0:0 offset1:16
v_mfma_f32_16x16x32_bf16 v[188:191], a[156:159], a[228:231], v[188:191]
ds_read_b128 a[220:223], v254 offset:13312
ds_read_b128 a[224:227], v254 offset:14336
v_mfma_f32_16x16x32_bf16 v[188:191], a[160:163], a[232:235], v[188:191]
ds_read_b128 a[228:231], v254 offset:15360
ds_read_b128 a[232:235], v254 offset:16384
v_mfma_f32_16x16x32_bf16 v[188:191], a[164:167], a[236:239], v[188:191]
s_waitcnt lgkmcnt(12)
ds_read_b128 a[236:239], v254 offset:17408
ds_read_b128 a[244:247], v22 offset:128
v_mfma_f32_16x16x32_bf16 v[192:195], v[180:183], a[192:195], 0
buffer_load_dwordx4 a[56:59], v12, s[20:23], s32 offen offset:128 nt
s_waitcnt lgkmcnt(13)
v_max3_f32 v58, v58, v51, v52
v_mfma_f32_16x16x32_bf16 v[192:195], v[184:187], a[196:199], v[192:195]
s_waitcnt lgkmcnt(12)
v_exp_f32 v37, v37
v_mfma_f32_16x16x32_bf16 v[192:195], v[164:167], a[200:203], v[192:195]
s_waitcnt lgkmcnt(11)
v_cvt_pk_bf16_f32 v188, v188, v189
ds_write_b32 v252, v188 offset:128
v_mfma_f32_16x16x32_bf16 v[192:195], v[168:171], a[204:207], v[192:195]
s_waitcnt lgkmcnt(11)
v_exp_f32 v38, v38
v_mfma_f32_16x16x32_bf16 v[192:195], v[172:175], a[208:211], v[192:195]
s_waitcnt lgkmcnt(10)
v_exp_f32 v39, v39
v_mfma_f32_16x16x32_bf16 v[192:195], v[176:179], a[212:215], v[192:195]
buffer_load_dwordx4 a[60:63], v13, s[20:23], s32 offen offset:128 nt
v_add_f32 v42, v42, v37
v_mfma_f32_16x16x32_bf16 v[196:199], a[144:147], a[192:195], 0
s_nop 0
ds_read_b128 a[192:195], v2 offset:8192
v_add_f32 v42, v42, v38
v_mfma_f32_16x16x32_bf16 v[196:199], a[148:151], a[196:199], v[196:199]
s_nop 0
v_cvt_pk_bf16_f32 v192, v192, v193
v_cvt_pk_bf16_f32 v193, v194, v195
v_mfma_f32_16x16x32_bf16 v[196:199], a[152:155], a[200:203], v[196:199]
ds_write2_b32 v252, v192, v193 offset0:48 offset1:64
v_mfma_f32_16x16x32_bf16 v[196:199], a[156:159], a[204:207], v[196:199]
ds_read_b128 a[196:199], v2 offset:9216
ds_read_b128 a[200:203], v2 offset:10240
v_mfma_f32_16x16x32_bf16 v[196:199], a[160:163], a[208:211], v[196:199]
ds_read_b128 a[204:207], v2 offset:11264
ds_read_b128 a[208:211], v2 offset:12288
v_mfma_f32_16x16x32_bf16 v[196:199], a[164:167], a[212:215], v[196:199]
s_waitcnt lgkmcnt(14)
ds_read_b128 a[212:215], v2 offset:13312
v_add_f32 v42, v42, v39
v_mfma_f32_16x16x32_bf16 v[200:203], v[180:183], a[216:219], 0
s_waitcnt lgkmcnt(13)
v_exp_f32 v78, v78
v_mfma_f32_16x16x32_bf16 v[200:203], v[184:187], a[220:223], v[200:203]
buffer_load_dwordx4 a[16:19], v8, s[20:23], s32 offen offset:256 nt
s_waitcnt lgkmcnt(12)
v_add_f32 v42, v42, v78
v_mfma_f32_16x16x32_bf16 v[200:203], v[164:167], a[224:227], v[200:203]
s_waitcnt lgkmcnt(11)
v_cvt_pk_bf16_f32 v196, v196, v197
ds_write_b32 v252, v196 offset:320
v_mfma_f32_16x16x32_bf16 v[200:203], v[168:171], a[228:231], v[200:203]
s_waitcnt lgkmcnt(11)
v_mov_b32 v43, v42
v_max3_f32 v58, v58, v53, v54
v_mfma_f32_16x16x32_bf16 v[200:203], v[172:175], a[232:235], v[200:203]
s_waitcnt lgkmcnt(10)
v_permlane32_swap_b32 v42, v43
v_mfma_f32_16x16x32_bf16 v[200:203], v[176:179], a[236:239], v[200:203]
v_add_f32 v42, v42, v43
v_mov_b32 v43, v42
v_mfma_f32_16x16x32_bf16 v[204:207], a[144:147], a[216:219], 0
s_nop 0
ds_read_b128 a[216:219], v2 offset:14336
v_max3_f32 v58, v58, v55, v82
v_mfma_f32_16x16x32_bf16 v[204:207], a[148:151], a[220:223], v[204:207]
s_nop 0
v_cvt_pk_bf16_f32 v200, v200, v201
v_cvt_pk_bf16_f32 v201, v202, v203
v_mfma_f32_16x16x32_bf16 v[204:207], a[152:155], a[224:227], v[204:207]
ds_write2_b32 v252, v200, v201 offset0:96 offset1:112
v_mfma_f32_16x16x32_bf16 v[204:207], a[156:159], a[228:231], v[204:207]
ds_read_b128 a[220:223], v2 offset:15360
ds_read_b128 a[224:227], v2 offset:16384
v_mfma_f32_16x16x32_bf16 v[204:207], a[160:163], a[232:235], v[204:207]
ds_read_b128 a[228:231], v2 offset:17408
ds_read_b128 a[232:235], v2 offset:18432
v_mfma_f32_16x16x32_bf16 v[204:207], a[164:167], a[236:239], v[204:207]
s_waitcnt lgkmcnt(13)
ds_read_b128 a[236:239], v2 offset:19456
ds_read_b128 a[248:251], v22 offset:256
v_mfma_f32_16x16x32_bf16 v[224:227], a[72:75], a[192:195], 0
buffer_load_dwordx4 a[20:23], v9, s[20:23], s32 offen offset:256 nt
s_waitcnt lgkmcnt(13)
v_mov_b32 v59, v58
v_mfma_f32_16x16x32_bf16 v[224:227], a[76:79], a[196:199], v[224:227]
s_waitcnt lgkmcnt(12)
v_permlane16_swap_b32 v42, v43
v_mfma_f32_16x16x32_bf16 v[224:227], a[80:83], a[200:203], v[224:227]
s_waitcnt lgkmcnt(11)
v_cvt_pk_bf16_f32 v204, v204, v205
ds_write_b32 v252, v204 offset:512
v_mfma_f32_16x16x32_bf16 v[224:227], a[84:87], a[204:207], v[224:227]
LW_p22:
s_cbranch_execz LW_p7
s_waitcnt lgkmcnt(11)
v_add_f32 v42, v42, v43
v_max3_f32 v74, v60, v61, v62
v_mfma_f32_16x16x32_bf16 v[224:227], a[88:91], a[208:211], v[224:227]
s_waitcnt lgkmcnt(10)
v_rcp_f32 v42, v42
v_mfma_f32_16x16x32_bf16 v[224:227], a[92:95], a[212:215], v[224:227]
v_mul_f32 v28, v28, v42
v_mul_f32 v29, v29, v42
v_mfma_f32_16x16x32_bf16 v[228:231], a[96:99], a[192:195], 0
s_nop 0
v_mul_f32 v30, v30, v42
v_mul_f32 v31, v31, v42
v_mfma_f32_16x16x32_bf16 v[228:231], a[100:103], a[196:199], v[228:231]
s_nop 0
v_cvt_pk_bf16_f32 v92, v224, v225
v_cvt_pk_bf16_f32 v93, v226, v227
v_mfma_f32_16x16x32_bf16 v[228:231], a[104:107], a[200:203], v[228:231]
buffer_load_dwordx4 a[40:43], v10, s[20:23], s32 offen offset:256 nt
v_cvt_pk_bf16_f32 v28, v28, v29
v_mfma_f32_16x16x32_bf16 v[228:231], a[108:111], a[204:207], v[228:231]
v_mul_f32 v32, v32, v42
v_mul_f32 v33, v33, v42
v_mfma_f32_16x16x32_bf16 v[228:231], a[112:115], a[208:211], v[228:231]
v_mul_f32 v34, v34, v42
v_mul_f32 v35, v35, v42
v_mfma_f32_16x16x32_bf16 v[228:231], a[116:119], a[212:215], v[228:231]
v_cvt_pk_bf16_f32 v29, v30, v31
v_cvt_pk_bf16_f32 v30, v32, v33
v_mfma_f32_16x16x32_bf16 v[232:235], a[120:123], a[192:195], 0
s_waitcnt lgkmcnt(0)
s_barrier
ds_read_b32 v98, v253 offset:0
ds_read_b128 a[192:195], v2 offset:20480
v_mfma_f32_16x16x32_bf16 v[232:235], a[124:127], a[196:199], v[232:235]
s_nop 0
ds_read_b128 a[196:199], v2 offset:21504
v_cvt_pk_bf16_f32 v94, v228, v229
v_mfma_f32_16x16x32_bf16 v[232:235], a[128:131], a[200:203], v[232:235]
ds_read_b128 a[200:203], v2 offset:22528
v_cvt_pk_bf16_f32 v95, v230, v231
v_mfma_f32_16x16x32_bf16 v[232:235], a[132:135], a[204:207], v[232:235]
ds_read_b32 v106, v253 offset:192
ds_read_b128 a[204:207], v2 offset:23552
v_mfma_f32_16x16x32_bf16 v[232:235], a[136:139], a[208:211], v[232:235]
buffer_load_dwordx4 a[44:47], v11, s[20:23], s32 offen offset:256 nt
ds_read_b128 a[208:211], v2 offset:24576
v_mfma_f32_16x16x32_bf16 v[232:235], a[140:143], a[212:215], v[232:235]
ds_read_b128 a[212:215], v2 offset:25600
v_cvt_pk_bf16_f32 v31, v34, v35
v_mfma_f32_16x16x32_bf16 v[220:223], a[72:75], a[216:219], 0
s_nop 0
ds_read_b32 v114, v253 offset:384
v_mul_f32 v36, v36, v42
v_mfma_f32_16x16x32_bf16 v[220:223], a[76:79], a[220:223], v[220:223]
s_nop 0
v_cvt_pk_bf16_f32 v96, v232, v233
v_cvt_pk_bf16_f32 v97, v234, v235
v_mfma_f32_16x16x32_bf16 v[220:223], a[80:83], a[224:227], v[220:223]
v_mul_f32 v37, v37, v42
v_mul_f32 v38, v38, v42
v_mfma_f32_16x16x32_bf16 v[220:223], a[84:87], a[228:231], v[220:223]
buffer_load_dwordx4 a[64:67], v12, s[20:23], s32 offen offset:256 nt
ds_read_b32 v122, v253 offset:576
v_mfma_f32_16x16x32_bf16 v[220:223], a[88:91], a[232:235], v[220:223]
v_mul_f32 v39, v39, v42
v_cvt_pk_bf16_f32 v36, v36, v37
v_mfma_f32_16x16x32_bf16 v[220:223], a[92:95], a[236:239], v[220:223]
v_mul_f32 v78, v78, v42
v_cvt_pk_bf16_f32 v37, v38, v39
v_mfma_f32_16x16x32_bf16 v[224:227], a[96:99], a[216:219], 0
s_nop 0
ds_read_b32 v130, v253 offset:768
v_cvt_pk_bf16_f32 v38, v78, 0
v_mfma_f32_16x16x32_bf16 v[224:227], a[100:103], a[220:223], v[224:227]
s_nop 0
v_cvt_pk_bf16_f32 v100, v220, v221
v_cvt_pk_bf16_f32 v101, v222, v223
v_mfma_f32_16x16x32_bf16 v[224:227], a[104:107], a[224:227], v[224:227]
v_mov_b32 v39, 0
v_max3_f32 v74, v74, v63, v64
v_mfma_f32_16x16x32_bf16 v[224:227], a[108:111], a[228:231], v[224:227]
ds_read_b32 v138, v253 offset:960
ds_read_b128 a[252:255], v22 offset:384
v_mfma_f32_16x16x32_bf16 v[224:227], a[112:115], a[232:235], v[224:227]
v_permlane32_swap_b32 v58, v59
v_mfma_f32_16x16x32_bf16 v[224:227], a[116:119], a[236:239], v[224:227]
v_max_f32 v58, v58, v59
v_mov_b32 v59, v58
v_mfma_f32_16x16x32_bf16 v[228:231], a[120:123], a[216:219], 0
s_nop 0
ds_read_b32 v146, v253 offset:1152
ds_read_b128 a[216:219], v2 offset:26624
v_mfma_f32_16x16x32_bf16 v[228:231], a[124:127], a[220:223], v[228:231]
s_nop 0
ds_read_b128 a[220:223], v2 offset:27648
v_cvt_pk_bf16_f32 v102, v224, v225
v_mfma_f32_16x16x32_bf16 v[228:231], a[128:131], a[224:227], v[228:231]
ds_read_b128 a[224:227], v2 offset:28672
v_cvt_pk_bf16_f32 v103, v226, v227
v_mfma_f32_16x16x32_bf16 v[228:231], a[132:135], a[228:231], v[228:231]
ds_read_b32 v154, v253 offset:1344
ds_read_b128 a[228:231], v2 offset:29696
v_mfma_f32_16x16x32_bf16 v[228:231], a[136:139], a[232:235], v[228:231]
buffer_load_dwordx4 a[68:71], v13, s[20:23], s32 offen offset:256 nt
ds_read_b128 a[232:235], v2 offset:30720
v_mfma_f32_16x16x32_bf16 v[228:231], a[140:143], a[236:239], v[228:231]
s_waitcnt lgkmcnt(15)
ds_read_b128 a[236:239], v2 offset:31744
v_max3_f32 v74, v74, v65, v66
v_mfma_f32_16x16x32_bf16 v[232:235], a[72:75], a[192:195], 0
s_nop 0
ds_read_b32 v162, v253 offset:1536
v_max3_f32 v74, v74, v67, v68
v_mfma_f32_16x16x32_bf16 v[232:235], a[76:79], a[196:199], v[232:235]
s_nop 0
v_cvt_pk_bf16_f32 v104, v228, v229
v_cvt_pk_bf16_f32 v105, v230, v231
v_mfma_f32_16x16x32_bf16 v[232:235], a[80:83], a[200:203], v[232:235]
s_waitcnt lgkmcnt(15)
v_permlane16_swap_b32 v58, v59
v_mfma_f32_16x16x32_bf16 v[232:235], a[84:87], a[204:207], v[232:235]
ds_read_b32 v170, v253 offset:1728
v_max_f32 v58, v58, v59
v_mfma_f32_16x16x32_bf16 v[232:235], a[88:91], a[208:211], v[232:235]
s_waitcnt lgkmcnt(15)
v_sub_f32 v44, v44, v58
v_sub_f32 v45, v45, v58
v_mfma_f32_16x16x32_bf16 v[232:235], a[92:95], a[212:215], v[232:235]
v_sub_f32 v46, v46, v58
v_sub_f32 v47, v47, v58
v_mfma_f32_16x16x32_bf16 v[220:223], a[96:99], a[192:195], 0
s_nop 0
ds_read_b32 v178, v253 offset:1920
v_sub_f32 v48, v48, v58
v_mfma_f32_16x16x32_bf16 v[220:223], a[100:103], a[196:199], v[220:223]
s_nop 0
v_cvt_pk_bf16_f32 v108, v232, v233
v_cvt_pk_bf16_f32 v109, v234, v235
v_mfma_f32_16x16x32_bf16 v[220:223], a[104:107], a[200:203], v[220:223]
v_exp_f32 v44, v44
v_mfma_f32_16x16x32_bf16 v[220:223], a[108:111], a[204:207], v[220:223]
ds_read_b32 v186, v253 offset:2112
v_sub_f32 v49, v49, v58
v_mfma_f32_16x16x32_bf16 v[220:223], a[112:115], a[208:211], v[220:223]
v_exp_f32 v45, v45
v_mfma_f32_16x16x32_bf16 v[220:223], a[116:119], a[212:215], v[220:223]
v_sub_f32 v50, v50, v58
v_sub_f32 v51, v51, v58
v_mfma_f32_16x16x32_bf16 v[224:227], a[120:123], a[192:195], 0
s_nop 0
ds_read_b128 a[192:195], v2 offset:32768
v_sub_f32 v52, v52, v58
v_mfma_f32_16x16x32_bf16 v[224:227], a[124:127], a[196:199], v[224:227]
s_nop 0
ds_read_b128 a[196:199], v2 offset:33792
v_cvt_pk_bf16_f32 v110, v220, v221
v_mfma_f32_16x16x32_bf16 v[224:227], a[128:131], a[200:203], v[224:227]
ds_read_b128 a[200:203], v2 offset:34816
v_cvt_pk_bf16_f32 v111, v222, v223
v_mfma_f32_16x16x32_bf16 v[224:227], a[132:135], a[204:207], v[224:227]
ds_read_b128 a[204:207], v2 offset:35840
v_sub_f32 v53, v53, v58
v_mfma_f32_16x16x32_bf16 v[224:227], a[136:139], a[208:211], v[224:227]
ds_read_b128 a[208:211], v2 offset:36864
v_sub_f32 v54, v54, v58
v_mfma_f32_16x16x32_bf16 v[224:227], a[140:143], a[212:215], v[224:227]
s_waitcnt lgkmcnt(15)
ds_read_b128 a[212:215], v2 offset:37888
v_sub_f32 v55, v55, v58
v_mfma_f32_16x16x32_bf16 v[228:231], a[72:75], a[216:219], 0
s_waitcnt lgkmcnt(15)
v_sub_f32 v82, v82, v58
v_add_f32 v58, v44, v45
v_mfma_f32_16x16x32_bf16 v[228:231], a[76:79], a[220:223], v[228:231]
s_waitcnt lgkmcnt(14)
v_cvt_pk_bf16_f32 v112, v224, v225
v_cvt_pk_bf16_f32 v113, v226, v227
v_mfma_f32_16x16x32_bf16 v[228:231], a[80:83], a[224:227], v[228:231]
s_waitcnt lgkmcnt(12)
v_exp_f32 v46, v46
v_mfma_f32_16x16x32_bf16 v[228:231], a[84:87], a[228:231], v[228:231]
s_waitcnt lgkmcnt(11)
v_exp_f32 v47, v47
v_mfma_f32_16x16x32_bf16 v[228:231], a[88:91], a[232:235], v[228:231]
s_waitcnt lgkmcnt(10)
v_exp_f32 v48, v48
v_mfma_f32_16x16x32_bf16 v[228:231], a[92:95], a[236:239], v[228:231]
v_add_f32 v58, v58, v46
v_add_f32 v58, v58, v47
v_mfma_f32_16x16x32_bf16 v[232:235], a[96:99], a[216:219], 0
s_nop 0
v_exp_f32 v49, v49
v_mfma_f32_16x16x32_bf16 v[232:235], a[100:103], a[220:223], v[232:235]
s_nop 0
v_exp_f32 v50, v50
v_mfma_f32_16x16x32_bf16 v[232:235], a[104:107], a[224:227], v[232:235]
v_cvt_pk_bf16_f32 v116, v228, v229
v_cvt_pk_bf16_f32 v117, v230, v231
v_mfma_f32_16x16x32_bf16 v[232:235], a[108:111], a[228:231], v[232:235]
v_add_f32 v58, v58, v48
v_add_f32 v58, v58, v49
v_mfma_f32_16x16x32_bf16 v[232:235], a[112:115], a[232:235], v[232:235]
v_exp_f32 v51, v51
v_mfma_f32_16x16x32_bf16 v[232:235], a[116:119], a[236:239], v[232:235]
v_exp_f32 v52, v52
v_mfma_f32_16x16x32_bf16 v[220:223], a[120:123], a[216:219], 0
s_nop 0
ds_read_b128 a[216:219], v2 offset:38912
v_add_f32 v58, v58, v50
v_mfma_f32_16x16x32_bf16 v[220:223], a[124:127], a[220:223], v[220:223]
s_nop 0
ds_read_b128 a[220:223], v2 offset:39936
v_cvt_pk_bf16_f32 v118, v232, v233
v_mfma_f32_16x16x32_bf16 v[220:223], a[128:131], a[224:227], v[220:223]
ds_read_b128 a[224:227], v2 offset:40960
v_cvt_pk_bf16_f32 v119, v234, v235
v_mfma_f32_16x16x32_bf16 v[220:223], a[132:135], a[228:231], v[220:223]
ds_read_b128 a[228:231], v2 offset:41984
v_add_f32 v58, v58, v51
v_mfma_f32_16x16x32_bf16 v[220:223], a[136:139], a[232:235], v[220:223]
ds_read_b128 a[232:235], v2 offset:43008
v_add_f32 v58, v58, v52
v_mfma_f32_16x16x32_bf16 v[220:223], a[140:143], a[236:239], v[220:223]
s_waitcnt lgkmcnt(10)
ds_read_b128 a[236:239], v2 offset:44032
v_max3_f32 v74, v74, v69, v70
v_mfma_f32_16x16x32_bf16 v[224:227], a[72:75], a[192:195], 0
s_waitcnt lgkmcnt(10)
v_exp_f32 v53, v53
v_mfma_f32_16x16x32_bf16 v[224:227], a[76:79], a[196:199], v[224:227]
s_waitcnt lgkmcnt(9)
v_exp_f32 v54, v54
v_mfma_f32_16x16x32_bf16 v[224:227], a[80:83], a[200:203], v[224:227]
s_waitcnt lgkmcnt(8)
v_cvt_pk_bf16_f32 v120, v220, v221
v_cvt_pk_bf16_f32 v121, v222, v223
v_mfma_f32_16x16x32_bf16 v[224:227], a[84:87], a[204:207], v[224:227]
s_waitcnt lgkmcnt(7)
v_exp_f32 v55, v55
v_mfma_f32_16x16x32_bf16 v[224:227], a[88:91], a[208:211], v[224:227]
s_waitcnt lgkmcnt(6)
v_add_f32 v58, v58, v53
v_add_f32 v58, v58, v54
v_mfma_f32_16x16x32_bf16 v[224:227], a[92:95], a[212:215], v[224:227]
v_exp_f32 v82, v82
v_mfma_f32_16x16x32_bf16 v[228:231], a[96:99], a[192:195], 0
s_nop 0
v_add_f32 v58, v58, v55
v_add_f32 v58, v58, v82
v_mfma_f32_16x16x32_bf16 v[228:231], a[100:103], a[196:199], v[228:231]
s_nop 0
v_mov_b32 v59, v58
v_cvt_pk_bf16_f32 v124, v224, v225
v_mfma_f32_16x16x32_bf16 v[228:231], a[104:107], a[200:203], v[228:231]
v_cvt_pk_bf16_f32 v125, v226, v227
v_max3_f32 v74, v74, v71, v86
v_mfma_f32_16x16x32_bf16 v[228:231], a[108:111], a[204:207], v[228:231]
v_permlane32_swap_b32 v58, v59
v_mfma_f32_16x16x32_bf16 v[228:231], a[112:115], a[208:211], v[228:231]
v_add_f32 v58, v58, v59
v_mov_b32 v75, v74
v_mfma_f32_16x16x32_bf16 v[228:231], a[116:119], a[212:215], v[228:231]
v_mov_b32 v59, v58
v_mov_b32 v147, 0
v_mfma_f32_16x16x32_bf16 v[232:235], a[120:123], a[192:195], 0
s_nop 0
ds_read_b128 a[192:195], v2 offset:45056
v_mov_b32 v155, 0
v_mfma_f32_16x16x32_bf16 v[232:235], a[124:127], a[196:199], v[232:235]
s_nop 0
ds_read_b128 a[196:199], v2 offset:46080
v_cvt_pk_bf16_f32 v126, v228, v229
v_mfma_f32_16x16x32_bf16 v[232:235], a[128:131], a[200:203], v[232:235]
ds_read_b128 a[200:203], v2 offset:47104
v_cvt_pk_bf16_f32 v127, v230, v231
v_mfma_f32_16x16x32_bf16 v[232:235], a[132:135], a[204:207], v[232:235]
ds_read_b128 a[204:207], v2 offset:48128
v_subrev_u32 v88, 512, v20
v_mfma_f32_16x16x32_bf16 v[232:235], a[136:139], a[208:211], v[232:235]
ds_read_b128 a[208:211], v2 offset:49152
v_cndmask_b32 v20, v20, v88, s[92:93]
v_mfma_f32_16x16x32_bf16 v[232:235], a[140:143], a[212:215], v[232:235]
s_waitcnt lgkmcnt(10)
ds_read_b128 a[212:215], v2 offset:50176
v_mov_b32 v163, 0
v_mfma_f32_16x16x32_bf16 v[220:223], a[72:75], a[216:219], 0
s_waitcnt lgkmcnt(10)
v_permlane32_swap_b32 v74, v75
v_mfma_f32_16x16x32_bf16 v[220:223], a[76:79], a[220:223], v[220:223]
s_waitcnt lgkmcnt(9)
v_permlane16_swap_b32 v58, v59
v_mfma_f32_16x16x32_bf16 v[220:223], a[80:83], a[224:227], v[220:223]
s_waitcnt lgkmcnt(8)
v_cvt_pk_bf16_f32 v128, v232, v233
v_cvt_pk_bf16_f32 v129, v234, v235
v_mfma_f32_16x16x32_bf16 v[220:223], a[84:87], a[228:231], v[220:223]
s_waitcnt lgkmcnt(7)
v_max_f32 v74, v74, v75
v_add_f32 v58, v58, v59
v_mfma_f32_16x16x32_bf16 v[220:223], a[88:91], a[232:235], v[220:223]
s_waitcnt lgkmcnt(6)
v_mov_b32 v75, v74
v_mov_b32 v171, 0
v_mfma_f32_16x16x32_bf16 v[220:223], a[92:95], a[236:239], v[220:223]
v_rcp_f32 v58, v58
v_mfma_f32_16x16x32_bf16 v[224:227], a[96:99], a[216:219], 0
s_nop 0
v_mul_f32 v44, v44, v58
v_mul_f32 v45, v45, v58
v_mfma_f32_16x16x32_bf16 v[224:227], a[100:103], a[220:223], v[224:227]
s_nop 0
v_permlane16_swap_b32 v74, v75
v_mfma_f32_16x16x32_bf16 v[224:227], a[104:107], a[224:227], v[224:227]
v_cvt_pk_bf16_f32 v132, v220, v221
v_cvt_pk_bf16_f32 v133, v222, v223
v_mfma_f32_16x16x32_bf16 v[224:227], a[108:111], a[228:231], v[224:227]
v_mul_f32 v46, v46, v58
v_mul_f32 v47, v47, v58
v_mfma_f32_16x16x32_bf16 v[224:227], a[112:115], a[232:235], v[224:227]
v_cvt_pk_bf16_f32 v44, v44, v45
v_mul_f32 v48, v48, v58
v_mfma_f32_16x16x32_bf16 v[224:227], a[116:119], a[236:239], v[224:227]
v_mul_f32 v49, v49, v58
v_mul_f32 v50, v50, v58
v_mfma_f32_16x16x32_bf16 v[228:231], a[120:123], a[216:219], 0
s_nop 0
ds_read_b128 a[216:219], v2 offset:51200
v_mul_f32 v51, v51, v58
v_mfma_f32_16x16x32_bf16 v[228:231], a[124:127], a[220:223], v[228:231]
s_nop 0
ds_read_b128 a[220:223], v2 offset:52224
v_cvt_pk_bf16_f32 v134, v224, v225
v_mfma_f32_16x16x32_bf16 v[228:231], a[128:131], a[224:227], v[228:231]
ds_read_b128 a[224:227], v2 offset:53248
v_cvt_pk_bf16_f32 v135, v226, v227
v_mfma_f32_16x16x32_bf16 v[228:231], a[132:135], a[228:231], v[228:231]
ds_read_b128 a[228:231], v2 offset:54272
v_cvt_pk_bf16_f32 v45, v46, v47
v_mfma_f32_16x16x32_bf16 v[228:231], a[136:139], a[232:235], v[228:231]
ds_read_b128 a[232:235], v2 offset:55296
v_max_f32 v74, v74, v75
v_mfma_f32_16x16x32_bf16 v[228:231], a[140:143], a[236:239], v[228:231]
s_waitcnt lgkmcnt(10)
ds_read_b128 a[236:239], v2 offset:56320
v_cvt_pk_bf16_f32 v46, v48, v49
v_mfma_f32_16x16x32_bf16 v[232:235], a[72:75], a[192:195], 0
s_waitcnt lgkmcnt(10)
v_cvt_pk_bf16_f32 v47, v50, v51
v_sub_f32 v60, v60, v74
v_mfma_f32_16x16x32_bf16 v[232:235], a[76:79], a[196:199], v[232:235]
s_waitcnt lgkmcnt(9)
v_cvt_pk_bf16_f32 v136, v228, v229
v_cvt_pk_bf16_f32 v137, v230, v231
v_mfma_f32_16x16x32_bf16 v[232:235], a[80:83], a[200:203], v[232:235]
s_waitcnt lgkmcnt(8)
v_sub_f32 v61, v61, v74
v_mul_f32 v52, v52, v58
v_mfma_f32_16x16x32_bf16 v[232:235], a[84:87], a[204:207], v[232:235]
s_waitcnt lgkmcnt(7)
v_mul_f32 v53, v53, v58
v_sub_f32 v62, v62, v74
v_mfma_f32_16x16x32_bf16 v[232:235], a[88:91], a[208:211], v[232:235]
s_waitcnt lgkmcnt(6)
v_exp_f32 v60, v60
v_mfma_f32_16x16x32_bf16 v[232:235], a[92:95], a[212:215], v[232:235]
v_exp_f32 v61, v61
v_mfma_f32_16x16x32_bf16 v[220:223], a[96:99], a[192:195], 0
s_nop 0
v_mul_f32 v54, v54, v58
v_mul_f32 v55, v55, v58
v_mfma_f32_16x16x32_bf16 v[220:223], a[100:103], a[196:199], v[220:223]
s_nop 0
v_cvt_pk_bf16_f32 v52, v52, v53
v_cvt_pk_bf16_f32 v140, v232, v233
v_mfma_f32_16x16x32_bf16 v[220:223], a[104:107], a[200:203], v[220:223]
v_cvt_pk_bf16_f32 v141, v234, v235
v_sub_f32 v63, v63, v74
v_mfma_f32_16x16x32_bf16 v[220:223], a[108:111], a[204:207], v[220:223]
v_sub_f32 v64, v64, v74
v_sub_f32 v65, v65, v74
v_mfma_f32_16x16x32_bf16 v[220:223], a[112:115], a[208:211], v[220:223]
v_sub_f32 v66, v66, v74
v_sub_f32 v67, v67, v74
v_mfma_f32_16x16x32_bf16 v[220:223], a[116:119], a[212:215], v[220:223]
v_sub_f32 v68, v68, v74
v_sub_f32 v69, v69, v74
v_mfma_f32_16x16x32_bf16 v[224:227], a[120:123], a[192:195], 0
s_nop 0
v_sub_f32 v70, v70, v74
v_sub_f32 v71, v71, v74
v_mfma_f32_16x16x32_bf16 v[224:227], a[124:127], a[196:199], v[224:227]
s_nop 0
v_cvt_pk_bf16_f32 v142, v220, v221
v_cvt_pk_bf16_f32 v143, v222, v223
v_mfma_f32_16x16x32_bf16 v[224:227], a[128:131], a[200:203], v[224:227]
v_sub_f32 v86, v86, v74
v_mul_f32 v82, v82, v58
v_mfma_f32_16x16x32_bf16 v[224:227], a[132:135], a[204:207], v[224:227]
v_exp_f32 v62, v62
v_mfma_f32_16x16x32_bf16 v[224:227], a[136:139], a[208:211], v[224:227]
v_cvt_pk_bf16_f32 v53, v54, v55
v_add_f32 v74, v60, v61
v_mfma_f32_16x16x32_bf16 v[224:227], a[140:143], a[212:215], v[224:227]
s_waitcnt lgkmcnt(5)
v_exp_f32 v63, v63
v_mfma_f32_16x16x32_bf16 v[228:231], a[72:75], a[216:219], 0
s_waitcnt lgkmcnt(4)
v_cvt_pk_bf16_f32 v54, v82, 0
v_mov_b32 v55, 0
v_mfma_f32_16x16x32_bf16 v[228:231], a[76:79], a[220:223], v[228:231]
s_waitcnt lgkmcnt(3)
v_exp_f32 v64, v64
v_mfma_f32_16x16x32_bf16 v[228:231], a[80:83], a[224:227], v[228:231]
s_waitcnt lgkmcnt(2)
v_add_f32 v74, v74, v62
v_add_f32 v74, v74, v63
v_mfma_f32_16x16x32_bf16 v[228:231], a[84:87], a[228:231], v[228:231]
s_waitcnt lgkmcnt(1)
v_exp_f32 v65, v65
v_mfma_f32_16x16x32_bf16 v[228:231], a[88:91], a[232:235], v[228:231]
s_waitcnt lgkmcnt(0)
v_exp_f32 v66, v66
v_mfma_f32_16x16x32_bf16 v[228:231], a[92:95], a[236:239], v[228:231]
v_add_f32 v74, v74, v64
v_add_f32 v74, v74, v65
v_mfma_f32_16x16x32_bf16 v[232:235], a[96:99], a[216:219], 0
v_exp_f32 v67, v67
v_mfma_f32_16x16x32_bf16 v[232:235], a[100:103], a[220:223], v[232:235]
v_exp_f32 v68, v68
v_mfma_f32_16x16x32_bf16 v[232:235], a[104:107], a[224:227], v[232:235]
v_add_f32 v74, v74, v66
v_add_f32 v74, v74, v67
v_mfma_f32_16x16x32_bf16 v[232:235], a[108:111], a[228:231], v[232:235]
v_exp_f32 v69, v69
v_mfma_f32_16x16x32_bf16 v[232:235], a[112:115], a[232:235], v[232:235]
v_exp_f32 v70, v70
v_mfma_f32_16x16x32_bf16 v[232:235], a[116:119], a[236:239], v[232:235]
v_add_f32 v74, v74, v68
v_add_f32 v74, v74, v69
v_mfma_f32_16x16x32_bf16 v[220:223], a[120:123], a[216:219], 0
v_mov_b64 v[244:245], 0
v_mfma_f32_16x16x32_bf16 v[220:223], a[124:127], a[220:223], v[220:223]
v_exp_f32 v71, v71
v_mfma_f32_16x16x32_bf16 v[220:223], a[128:131], a[224:227], v[220:223]
v_exp_f32 v86, v86
v_mfma_f32_16x16x32_bf16 v[220:223], a[132:135], a[228:231], v[220:223]
v_add_f32 v74, v74, v70
v_add_f32 v74, v74, v71
v_mfma_f32_16x16x32_bf16 v[220:223], a[136:139], a[232:235], v[220:223]
v_add_f32 v74, v74, v86
v_mov_b32 v75, v74
v_mfma_f32_16x16x32_bf16 v[220:223], a[140:143], a[236:239], v[220:223]
s_nop 0
v_permlane32_swap_b32 v74, v75
v_mfma_f32_16x16x32_bf16 v[188:191], v[28:31], v[92:95], 0
v_add_f32 v74, v74, v75
v_mov_b32 v75, v74
v_mfma_f32_16x16x32_bf16 v[188:191], v[36:39], v[96:99], v[188:191]
s_nop 0
v_permlane16_swap_b32 v74, v75
v_mfma_f32_16x16x32_bf16 v[192:195], v[28:31], v[100:103], 0
v_add_f32 v74, v74, v75
v_rcp_f32 v74, v74
v_mfma_f32_16x16x32_bf16 v[192:195], v[36:39], v[104:107], v[192:195]
v_mul_f32 v60, v60, v74
v_mul_f32 v61, v61, v74
v_mfma_f32_16x16x32_bf16 v[196:199], v[28:31], v[108:111], 0
s_nop 0
v_mul_f32 v62, v62, v74
v_mul_f32 v63, v63, v74
v_mfma_f32_16x16x32_bf16 v[196:199], v[36:39], v[112:115], v[196:199]
s_nop 0
v_cvt_pk_bf16_f32 v60, v60, v61
v_mul_f32 v64, v64, v74
v_mfma_f32_16x16x32_bf16 v[200:203], v[28:31], v[116:119], 0
v_mul_f32 v65, v65, v74
v_mul_f32 v66, v66, v74
v_mfma_f32_16x16x32_bf16 v[200:203], v[36:39], v[120:123], v[200:203]
v_mul_f32 v67, v67, v74
v_cvt_pk_bf16_f32 v61, v62, v63
v_smfmac_f32_16x16x64_bf16 v[244:247], a[240:243], v[92:99], v0
s_nop 0
s_nop 0
v_cvt_pk_bf16_f32 v62, v64, v65
v_smfmac_f32_16x16x64_bf16 v[244:247], a[244:247], v[100:107], v0
s_nop 0
v_cvt_pk_bf16_f32 v63, v66, v67
v_smfmac_f32_16x16x64_bf16 v[244:247], a[248:251], v[108:115], v0
v_mul_f32 v68, v68, v74
v_smfmac_f32_16x16x64_bf16 v[244:247], a[252:255], v[116:123], v0
v_mul_f32 v69, v69, v74
v_mfma_f32_16x16x32_bf16 v[204:207], v[44:47], v[92:95], 0
v_mul_f32 v70, v70, v74
v_mul_f32 v71, v71, v74
v_mfma_f32_16x16x32_bf16 v[204:207], v[52:55], v[96:99], v[204:207]
v_cvt_pk_bf16_f32 v68, v68, v69
v_cvt_pk_bf16_f32 v64, v188, v192
v_mfma_f32_16x16x32_bf16 v[208:211], v[44:47], v[100:103], 0
v_cvt_pk_bf16_f32 v76, v189, v193
v_cvt_pk_bf16_f32 v78, v190, v194
v_mfma_f32_16x16x32_bf16 v[208:211], v[52:55], v[104:107], v[208:211]
v_cvt_pk_bf16_f32 v80, v191, v195
v_mul_f32 v86, v86, v74
v_mfma_f32_16x16x32_bf16 v[212:215], v[44:47], v[108:111], 0
s_nop 0
v_cvt_pk_bf16_f32 v69, v70, v71
v_cvt_pk_bf16_f32 v70, v86, 0
v_mfma_f32_16x16x32_bf16 v[212:215], v[52:55], v[112:115], v[212:215]
s_nop 0
v_mov_b32 v71, 0
v_cvt_pk_bf16_f32 v65, v196, v200
v_mfma_f32_16x16x32_bf16 v[216:219], v[44:47], v[116:119], 0
v_cvt_pk_bf16_f32 v77, v197, v201
v_cvt_pk_bf16_f32 v79, v198, v202
v_mfma_f32_16x16x32_bf16 v[216:219], v[52:55], v[120:123], v[216:219]
v_cvt_pk_bf16_f32 v81, v199, v203
buffer_store_dwordx2 v[64:65], v14, s[12:15], s28 offen offset:0 sc1
v_mfma_f32_16x16x32_bf16 v[188:191], v[60:63], v[92:95], 0
s_nop 0
v_add_f32 v64, v244, v245
v_cvt_pk_bf16_f32 v64, v64, v64
v_mfma_f32_16x16x32_bf16 v[188:191], v[68:71], v[96:99], v[188:191]
s_nop 0
buffer_store_short v64, v17, s[12:15], s28 offen offset:0 sc1
v_cvt_pk_bf16_f32 v64, v204, v208
v_mfma_f32_16x16x32_bf16 v[192:195], v[60:63], v[100:103], 0
v_cvt_pk_bf16_f32 v82, v205, v209
v_cvt_pk_bf16_f32 v84, v206, v210
v_mfma_f32_16x16x32_bf16 v[192:195], v[68:71], v[104:107], v[192:195]
v_cvt_pk_bf16_f32 v86, v207, v211
v_cvt_pk_bf16_f32 v65, v212, v216
v_mfma_f32_16x16x32_bf16 v[196:199], v[60:63], v[108:111], 0
s_nop 0
v_cvt_pk_bf16_f32 v83, v213, v217
v_cvt_pk_bf16_f32 v85, v214, v218
v_mfma_f32_16x16x32_bf16 v[196:199], v[68:71], v[112:115], v[196:199]
s_nop 0
v_cvt_pk_bf16_f32 v87, v215, v219
v_cvt_pk_bf16_f32 v144, v224, v225
v_mfma_f32_16x16x32_bf16 v[200:203], v[60:63], v[116:119], 0
v_cvt_pk_bf16_f32 v145, v226, v227
v_cvt_pk_bf16_f32 v148, v228, v229
v_mfma_f32_16x16x32_bf16 v[200:203], v[68:71], v[120:123], v[200:203]
v_cvt_pk_bf16_f32 v149, v230, v231
v_cvt_pk_bf16_f32 v150, v232, v233
v_mfma_f32_16x16x32_bf16 v[204:207], v[28:31], v[124:127], 0
s_nop 0
v_cvt_pk_bf16_f32 v151, v234, v235
v_cvt_pk_bf16_f32 v152, v220, v221
v_mfma_f32_16x16x32_bf16 v[204:207], v[36:39], v[128:131], v[204:207]
s_nop 0
v_cvt_pk_bf16_f32 v153, v222, v223
v_mov_b64 v[244:245], 0
v_mfma_f32_16x16x32_bf16 v[208:211], v[28:31], v[132:135], 0
buffer_store_dwordx2 v[76:77], v14, s[12:15], s28 offen offset:384 sc1
v_cvt_pk_bf16_f32 v76, v188, v192
v_mfma_f32_16x16x32_bf16 v[208:211], v[36:39], v[136:139], v[208:211]
v_cvt_pk_bf16_f32 v66, v189, v193
v_cvt_pk_bf16_f32 v88, v190, v194
v_mfma_f32_16x16x32_bf16 v[212:215], v[28:31], v[140:143], 0
s_nop 0
v_cvt_pk_bf16_f32 v90, v191, v195
v_cvt_pk_bf16_f32 v77, v196, v200
v_mfma_f32_16x16x32_bf16 v[212:215], v[36:39], v[144:147], v[212:215]
s_nop 0
v_cvt_pk_bf16_f32 v67, v197, v201
v_cvt_pk_bf16_f32 v89, v198, v202
v_mfma_f32_16x16x32_bf16 v[216:219], v[28:31], v[148:151], 0
v_cvt_pk_bf16_f32 v91, v199, v203
ds_read_b128 a[192:195], v2 offset:57344
v_mfma_f32_16x16x32_bf16 v[216:219], v[36:39], v[152:155], v[216:219]
ds_read_b128 a[196:199], v2 offset:58368
buffer_store_dwordx2 v[78:79], v14, s[12:15], s28 offen offset:768 sc1
v_smfmac_f32_16x16x64_bf16 v[244:247], a[240:243], v[124:131], v0
s_nop 0
s_nop 0
v_cvt_pk_bf16_f32 v92, v204, v208
v_smfmac_f32_16x16x64_bf16 v[244:247], a[244:247], v[132:139], v0
s_nop 0
v_cvt_pk_bf16_f32 v94, v205, v209
v_smfmac_f32_16x16x64_bf16 v[244:247], a[248:251], v[140:147], v0
v_cvt_pk_bf16_f32 v100, v206, v210
v_smfmac_f32_16x16x64_bf16 v[244:247], a[252:255], v[148:155], v0
v_cvt_pk_bf16_f32 v78, v207, v211
v_mfma_f32_16x16x32_bf16 v[188:191], v[44:47], v[124:127], 0
ds_read_b128 a[200:203], v2 offset:59392
ds_read_b128 a[204:207], v2 offset:60416
v_mfma_f32_16x16x32_bf16 v[188:191], v[52:55], v[128:131], v[188:191]
ds_read_b128 a[208:211], v2 offset:61440
ds_read_b128 a[212:215], v2 offset:62464
v_mfma_f32_16x16x32_bf16 v[192:195], v[44:47], v[132:135], 0
v_cvt_pk_bf16_f32 v93, v212, v216
v_cvt_pk_bf16_f32 v95, v213, v217
v_mfma_f32_16x16x32_bf16 v[192:195], v[52:55], v[136:139], v[192:195]
v_cvt_pk_bf16_f32 v101, v214, v218
v_cvt_pk_bf16_f32 v79, v215, v219
v_mfma_f32_16x16x32_bf16 v[196:199], v[44:47], v[140:143], 0
buffer_store_dwordx2 v[64:65], v15, s[12:15], s28 offen offset:0 sc1
ds_read_b128 a[216:219], v2 offset:63488
v_mfma_f32_16x16x32_bf16 v[196:199], v[52:55], v[144:147], v[196:199]
buffer_store_dwordx2 v[80:81], v14, s[12:15], s28 offen offset:1152 sc1
ds_read_b128 a[220:223], v2 offset:64512
v_mfma_f32_16x16x32_bf16 v[200:203], v[44:47], v[148:151], 0
buffer_store_dwordx2 v[82:83], v15, s[12:15], s29 offen offset:0 sc1
ds_read_b128 a[224:227], v3 offset:0
v_mfma_f32_16x16x32_bf16 v[200:203], v[52:55], v[152:155], v[200:203]
ds_read_b128 a[228:231], v3 offset:1024
ds_read_b128 a[232:235], v3 offset:2048
v_mfma_f32_16x16x32_bf16 v[204:207], v[60:63], v[124:127], 0
ds_read_b128 a[236:239], v3 offset:3072
v_add_f32 v64, v244, v245
v_mfma_f32_16x16x32_bf16 v[204:207], v[68:71], v[128:131], v[204:207]
v_cvt_pk_bf16_f32 v64, v64, v64
v_mov_b32 v179, 0
v_mfma_f32_16x16x32_bf16 v[208:211], v[60:63], v[132:135], 0
buffer_store_short v64, v17, s[12:15], s28 offen offset:128 sc1
v_mov_b32 v187, 0
v_mfma_f32_16x16x32_bf16 v[208:211], v[68:71], v[136:139], v[208:211]
v_cvt_pk_bf16_f32 v80, v188, v192
v_cvt_pk_bf16_f32 v82, v189, v193
v_mfma_f32_16x16x32_bf16 v[212:215], v[60:63], v[140:143], 0
buffer_store_dwordx2 v[84:85], v15, s[12:15], s30 offen offset:0 sc1
v_cvt_pk_bf16_f32 v102, v190, v194
v_mfma_f32_16x16x32_bf16 v[212:215], v[68:71], v[144:147], v[212:215]
v_cvt_pk_bf16_f32 v108, v191, v195
v_cvt_pk_bf16_f32 v81, v196, v200
v_mfma_f32_16x16x32_bf16 v[216:219], v[60:63], v[148:151], 0
v_cvt_pk_bf16_f32 v64, v204, v208
v_cvt_pk_bf16_f32 v84, v205, v209
v_mfma_f32_16x16x32_bf16 v[216:219], v[68:71], v[152:155], v[216:219]
s_waitcnt lgkmcnt(11)
v_cvt_pk_bf16_f32 v110, v206, v210
v_cvt_pk_bf16_f32 v72, v207, v211
v_mfma_f32_16x16x32_bf16 v[224:227], a[72:75], a[192:195], 0
LW_p23:
s_cbranch_execz LW_p8
s_waitcnt lgkmcnt(10)
v_cvt_pk_bf16_f32 v83, v197, v201
v_cvt_pk_bf16_f32 v103, v198, v202
v_mfma_f32_16x16x32_bf16 v[224:227], a[76:79], a[196:199], v[224:227]
buffer_store_dwordx2 v[86:87], v15, s[12:15], s31 offen offset:0 sc1
s_waitcnt lgkmcnt(9)
v_cvt_pk_bf16_f32 v109, v199, v203
v_mfma_f32_16x16x32_bf16 v[224:227], a[80:83], a[200:203], v[224:227]
s_waitcnt lgkmcnt(8)
v_cvt_pk_bf16_f32 v65, v212, v216
v_cvt_pk_bf16_f32 v85, v213, v217
v_mfma_f32_16x16x32_bf16 v[224:227], a[84:87], a[204:207], v[224:227]
s_waitcnt lgkmcnt(7)
v_cvt_pk_bf16_f32 v111, v214, v218
v_cvt_pk_bf16_f32 v73, v215, v219
v_mfma_f32_16x16x32_bf16 v[224:227], a[88:91], a[208:211], v[224:227]
s_waitcnt vmcnt(27) lgkmcnt(6)
ds_write_b64 v4, a[0:1] offset:0
v_mfma_f32_16x16x32_bf16 v[224:227], a[92:95], a[212:215], v[224:227]
ds_write_b64 v4, a[2:3] offset:8
v_mfma_f32_16x16x32_bf16 v[228:231], a[96:99], a[192:195], 0
s_waitcnt vmcnt(26)
ds_write_b64 v5, a[4:5] offset:0
v_mfma_f32_16x16x32_bf16 v[228:231], a[100:103], a[196:199], v[228:231]
s_nop 0
ds_write_b64 v5, a[6:7] offset:8
v_mfma_f32_16x16x32_bf16 v[228:231], a[104:107], a[200:203], v[228:231]
v_cvt_pk_bf16_f32 v156, v224, v225
v_cvt_pk_bf16_f32 v157, v226, v227
v_mfma_f32_16x16x32_bf16 v[228:231], a[108:111], a[204:207], v[228:231]
buffer_store_dwordx2 v[76:77], v16, s[12:15], s28 offen offset:0 sc1
ds_read_b128 a[0:3], v6 offset:0
v_mfma_f32_16x16x32_bf16 v[228:231], a[112:115], a[208:211], v[228:231]
ds_read_b128 a[4:7], v7 offset:0
v_mfma_f32_16x16x32_bf16 v[228:231], a[116:119], a[212:215], v[228:231]
s_waitcnt vmcnt(26)
ds_write_b64 v4, a[24:25] offset:2048
v_mfma_f32_16x16x32_bf16 v[232:235], a[120:123], a[192:195], 0
s_nop 0
ds_read_b128 a[192:195], v3 offset:4096
s_nop 0
v_mfma_f32_16x16x32_bf16 v[232:235], a[124:127], a[196:199], v[232:235]
s_nop 0
ds_read_b128 a[196:199], v3 offset:5120
v_cvt_pk_bf16_f32 v158, v228, v229
v_mfma_f32_16x16x32_bf16 v[232:235], a[128:131], a[200:203], v[232:235]
ds_read_b128 a[200:203], v3 offset:6144
v_cvt_pk_bf16_f32 v159, v230, v231
v_mfma_f32_16x16x32_bf16 v[232:235], a[132:135], a[204:207], v[232:235]
buffer_store_dwordx2 v[66:67], v16, s[12:15], s28 offen offset:384 sc1
ds_read_b128 a[204:207], v3 offset:7168
v_mfma_f32_16x16x32_bf16 v[232:235], a[136:139], a[208:211], v[232:235]
ds_read_b128 a[208:211], v3 offset:8192
v_mfma_f32_16x16x32_bf16 v[232:235], a[140:143], a[212:215], v[232:235]
s_waitcnt lgkmcnt(15)
ds_read_b128 a[212:215], v3 offset:9216
v_mfma_f32_16x16x32_bf16 v[220:223], a[72:75], a[216:219], 0
s_nop 0
ds_write_b64 v4, a[26:27] offset:2056
v_mfma_f32_16x16x32_bf16 v[220:223], a[76:79], a[220:223], v[220:223]
s_waitcnt vmcnt(26)
ds_write_b64 v5, a[28:29] offset:2048
v_mfma_f32_16x16x32_bf16 v[220:223], a[80:83], a[224:227], v[220:223]
s_waitcnt lgkmcnt(15)
v_cvt_pk_bf16_f32 v160, v232, v233
v_cvt_pk_bf16_f32 v161, v234, v235
v_mfma_f32_16x16x32_bf16 v[220:223], a[84:87], a[228:231], v[220:223]
buffer_store_dwordx2 v[88:89], v16, s[12:15], s29 offen offset:0 sc1
v_mfma_f32_16x16x32_bf16 v[220:223], a[88:91], a[232:235], v[220:223]
buffer_store_dwordx2 v[90:91], v16, s[12:15], s29 offen offset:384 sc1
v_mfma_f32_16x16x32_bf16 v[220:223], a[92:95], a[236:239], v[220:223]
ds_write_b64 v5, a[30:31] offset:2056
v_mfma_f32_16x16x32_bf16 v[224:227], a[96:99], a[216:219], 0
s_nop 0
ds_read_b128 a[24:27], v6 offset:2048
ds_read_b128 a[28:31], v7 offset:2048
v_mfma_f32_16x16x32_bf16 v[224:227], a[100:103], a[220:223], v[224:227]
s_waitcnt vmcnt(25)
ds_write_b64 v4, a[8:9] offset:2048
v_mfma_f32_16x16x32_bf16 v[224:227], a[104:107], a[224:227], v[224:227]
v_cvt_pk_bf16_f32 v164, v220, v221
v_cvt_pk_bf16_f32 v165, v222, v223
v_mfma_f32_16x16x32_bf16 v[224:227], a[108:111], a[228:231], v[224:227]
buffer_store_dwordx2 v[92:93], v14, s[12:15], s28 offen offset:128 sc1
v_mfma_f32_16x16x32_bf16 v[224:227], a[112:115], a[232:235], v[224:227]
ds_write_b64 v4, a[10:11] offset:2056
v_mfma_f32_16x16x32_bf16 v[224:227], a[116:119], a[236:239], v[224:227]
s_waitcnt vmcnt(25)
ds_write_b64 v5, a[12:13] offset:2048
v_mfma_f32_16x16x32_bf16 v[228:231], a[120:123], a[216:219], 0
s_nop 0
ds_read_b128 a[216:219], v3 offset:10240
s_nop 0
v_mfma_f32_16x16x32_bf16 v[228:231], a[124:127], a[220:223], v[228:231]
s_nop 0
ds_read_b128 a[220:223], v3 offset:11264
v_cvt_pk_bf16_f32 v166, v224, v225
v_mfma_f32_16x16x32_bf16 v[228:231], a[128:131], a[224:227], v[228:231]
ds_read_b128 a[224:227], v3 offset:12288
v_cvt_pk_bf16_f32 v167, v226, v227
v_mfma_f32_16x16x32_bf16 v[228:231], a[132:135], a[228:231], v[228:231]
buffer_store_dwordx2 v[94:95], v14, s[12:15], s28 offen offset:512 sc1
ds_read_b128 a[228:231], v3 offset:13312
v_mfma_f32_16x16x32_bf16 v[228:231], a[136:139], a[232:235], v[228:231]
ds_read_b128 a[232:235], v3 offset:14336
v_mfma_f32_16x16x32_bf16 v[228:231], a[140:143], a[236:239], v[228:231]
s_waitcnt lgkmcnt(15)
ds_read_b128 a[236:239], v3 offset:15360
v_mfma_f32_16x16x32_bf16 v[232:235], a[72:75], a[192:195], 0
s_nop 0
ds_write_b64 v5, a[14:15] offset:2056
v_mfma_f32_16x16x32_bf16 v[232:235], a[76:79], a[196:199], v[232:235]
s_nop 0
ds_read_b128 a[8:11], v6 offset:2048
ds_read_b128 a[12:15], v7 offset:2048
v_mfma_f32_16x16x32_bf16 v[232:235], a[80:83], a[200:203], v[232:235]
v_cvt_pk_bf16_f32 v168, v228, v229
v_cvt_pk_bf16_f32 v169, v230, v231
v_mfma_f32_16x16x32_bf16 v[232:235], a[84:87], a[204:207], v[232:235]
buffer_store_dwordx2 v[100:101], v14, s[12:15], s28 offen offset:896 sc1
s_waitcnt lgkmcnt(15)
v_mfma_f32_16x16x32_bf16 v[232:235], a[88:91], a[208:211], v[232:235]
ds_write_b64 v4, a[48:49] offset:0
v_mfma_f32_16x16x32_bf16 v[232:235], a[92:95], a[212:215], v[232:235]
ds_write_b64 v4, a[50:51] offset:8
v_mfma_f32_16x16x32_bf16 v[220:223], a[96:99], a[192:195], 0
s_nop 0
ds_write_b64 v5, a[52:53] offset:0
v_mfma_f32_16x16x32_bf16 v[220:223], a[100:103], a[196:199], v[220:223]
s_nop 0
ds_write_b64 v5, a[54:55] offset:8
v_mfma_f32_16x16x32_bf16 v[220:223], a[104:107], a[200:203], v[220:223]
v_cvt_pk_bf16_f32 v172, v232, v233
v_cvt_pk_bf16_f32 v173, v234, v235
v_mfma_f32_16x16x32_bf16 v[220:223], a[108:111], a[204:207], v[220:223]
buffer_store_dwordx2 v[78:79], v14, s[12:15], s28 offen offset:1280 sc1
ds_read_b128 a[48:51], v6 offset:0
v_mfma_f32_16x16x32_bf16 v[220:223], a[112:115], a[208:211], v[220:223]
ds_read_b128 a[52:55], v7 offset:0
v_mfma_f32_16x16x32_bf16 v[220:223], a[116:119], a[212:215], v[220:223]
s_waitcnt vmcnt(27)
ds_write_b64 v4, a[32:33] offset:0
v_mfma_f32_16x16x32_bf16 v[224:227], a[120:123], a[192:195], 0
s_nop 0
ds_read_b128 a[192:195], v1 offset:0
s_nop 0
v_mfma_f32_16x16x32_bf16 v[224:227], a[124:127], a[196:199], v[224:227]
s_nop 0
ds_read_b128 a[196:199], v1 offset:1024
v_cvt_pk_bf16_f32 v174, v220, v221
v_mfma_f32_16x16x32_bf16 v[224:227], a[128:131], a[200:203], v[224:227]
buffer_store_dwordx2 v[80:81], v15, s[12:15], s28 offen offset:128 sc1
v_cvt_pk_bf16_f32 v175, v222, v223
v_mfma_f32_16x16x32_bf16 v[224:227], a[132:135], a[204:207], v[224:227]
ds_read_b128 a[200:203], v1 offset:2048
ds_read_b128 a[204:207], v1 offset:3072
v_mfma_f32_16x16x32_bf16 v[224:227], a[136:139], a[208:211], v[224:227]
ds_read_b128 a[208:211], v1 offset:4096
v_mfma_f32_16x16x32_bf16 v[224:227], a[140:143], a[212:215], v[224:227]
s_waitcnt lgkmcnt(15)
ds_write_b64 v4, a[34:35] offset:8
v_mfma_f32_16x16x32_bf16 v[228:231], a[72:75], a[216:219], 0
s_waitcnt vmcnt(27)
ds_write_b64 v5, a[36:37] offset:0
v_mfma_f32_16x16x32_bf16 v[228:231], a[76:79], a[220:223], v[228:231]
s_nop 0
ds_write_b64 v5, a[38:39] offset:8
v_mfma_f32_16x16x32_bf16 v[228:231], a[80:83], a[224:227], v[228:231]
v_cvt_pk_bf16_f32 v176, v224, v225
v_cvt_pk_bf16_f32 v177, v226, v227
v_mfma_f32_16x16x32_bf16 v[228:231], a[84:87], a[228:231], v[228:231]
buffer_store_dwordx2 v[82:83], v15, s[12:15], s29 offen offset:128 sc1
ds_read_b128 a[32:35], v6 offset:0
v_mfma_f32_16x16x32_bf16 v[228:231], a[88:91], a[232:235], v[228:231]
ds_read_b128 a[36:39], v7 offset:0
ds_read_b128 a[212:215], v1 offset:5120
v_mfma_f32_16x16x32_bf16 v[228:231], a[92:95], a[236:239], v[228:231]
s_waitcnt vmcnt(25)
ds_write_b64 v4, a[16:17] offset:0
v_mfma_f32_16x16x32_bf16 v[232:235], a[96:99], a[216:219], 0
s_nop 0
ds_write_b64 v4, a[18:19] offset:8
v_mfma_f32_16x16x32_bf16 v[232:235], a[100:103], a[220:223], v[232:235]
s_waitcnt vmcnt(24)
ds_write_b64 v5, a[20:21] offset:0
v_mfma_f32_16x16x32_bf16 v[232:235], a[104:107], a[224:227], v[232:235]
v_cvt_pk_bf16_f32 v180, v228, v229
v_cvt_pk_bf16_f32 v181, v230, v231
v_mfma_f32_16x16x32_bf16 v[232:235], a[108:111], a[228:231], v[232:235]
buffer_store_dwordx2 v[102:103], v15, s[12:15], s30 offen offset:128 sc1
v_mfma_f32_16x16x32_bf16 v[232:235], a[112:115], a[232:235], v[232:235]
buffer_store_dwordx2 v[108:109], v15, s[12:15], s31 offen offset:128 sc1
v_mfma_f32_16x16x32_bf16 v[232:235], a[116:119], a[236:239], v[232:235]
ds_write_b64 v5, a[22:23] offset:8
v_mfma_f32_16x16x32_bf16 v[220:223], a[120:123], a[216:219], 0
s_nop 0
v_mov_b64 v[244:245], 0
v_mfma_f32_16x16x32_bf16 v[220:223], a[124:127], a[220:223], v[220:223]
s_nop 0
ds_read_b128 a[216:219], v1 offset:6144
ds_read_b128 a[16:19], v6 offset:0
v_mfma_f32_16x16x32_bf16 v[220:223], a[128:131], a[224:227], v[220:223]
v_cvt_pk_bf16_f32 v182, v232, v233
v_cvt_pk_bf16_f32 v183, v234, v235
v_mfma_f32_16x16x32_bf16 v[220:223], a[132:135], a[228:231], v[220:223]
ds_read_b128 a[20:23], v7 offset:0
ds_read_b128 a[220:223], v1 offset:7168
v_mfma_f32_16x16x32_bf16 v[220:223], a[136:139], a[232:235], v[220:223]
ds_read_b128 a[224:227], v1 offset:8192
ds_read_b128 a[228:231], v1 offset:9216
v_mfma_f32_16x16x32_bf16 v[220:223], a[140:143], a[236:239], v[220:223]
ds_read_b128 a[232:235], v1 offset:10240
ds_read_b128 a[236:239], v1 offset:11264
v_mfma_f32_16x16x32_bf16 v[204:207], v[28:31], v[156:159], 0
s_nop 0
ds_write_b64 v4, a[56:57] offset:2048
v_mfma_f32_16x16x32_bf16 v[204:207], v[36:39], v[160:163], v[204:207]
s_nop 0
ds_write_b64 v4, a[58:59] offset:2056
v_mfma_f32_16x16x32_bf16 v[208:211], v[28:31], v[164:167], 0
v_cvt_pk_bf16_f32 v184, v220, v221
v_cvt_pk_bf16_f32 v185, v222, v223
v_mfma_f32_16x16x32_bf16 v[208:211], v[36:39], v[168:171], v[208:211]
ds_write_b64 v5, a[60:61] offset:2048
v_mfma_f32_16x16x32_bf16 v[212:215], v[28:31], v[172:175], 0
s_nop 0
ds_write_b64 v5, a[62:63] offset:2056
v_mfma_f32_16x16x32_bf16 v[212:215], v[36:39], v[176:179], v[212:215]
s_nop 0
ds_read_b128 a[56:59], v6 offset:2048
ds_read_b128 a[60:63], v7 offset:2048
v_mfma_f32_16x16x32_bf16 v[216:219], v[28:31], v[180:183], 0
v_cvt_pk_bf16_f32 v92, v204, v208
v_cvt_pk_bf16_f32 v140, v205, v209
v_mfma_f32_16x16x32_bf16 v[216:219], v[36:39], v[184:187], v[216:219]
v_cvt_pk_bf16_f32 v94, v206, v210
v_cvt_pk_bf16_f32 v142, v207, v211
v_smfmac_f32_16x16x64_bf16 v[244:247], a[240:243], v[156:163], v0
s_waitcnt vmcnt(25)
s_nop 0
ds_write_b64 v4, a[40:41] offset:2048
v_smfmac_f32_16x16x64_bf16 v[244:247], a[244:247], v[164:171], v0
s_nop 0
v_cvt_pk_bf16_f32 v93, v212, v216
v_smfmac_f32_16x16x64_bf16 v[244:247], a[248:251], v[172:179], v0
v_cvt_pk_bf16_f32 v141, v213, v217
v_smfmac_f32_16x16x64_bf16 v[244:247], a[252:255], v[180:187], v0
v_cvt_pk_bf16_f32 v95, v214, v218
v_mfma_f32_16x16x32_bf16 v[188:191], v[44:47], v[156:159], 0
v_cvt_pk_bf16_f32 v143, v215, v219
ds_write_b64 v4, a[42:43] offset:2056
v_mfma_f32_16x16x32_bf16 v[188:191], v[52:55], v[160:163], v[188:191]
s_waitcnt vmcnt(24)
ds_write_b64 v5, a[44:45] offset:2048
v_mfma_f32_16x16x32_bf16 v[192:195], v[44:47], v[164:167], 0
ds_write_b64 v5, a[46:47] offset:2056
v_mfma_f32_16x16x32_bf16 v[192:195], v[52:55], v[168:171], v[192:195]
ds_read_b128 a[40:43], v6 offset:2048
ds_read_b128 a[44:47], v7 offset:2048
v_mfma_f32_16x16x32_bf16 v[196:199], v[44:47], v[172:175], 0
s_nop 0
buffer_store_dwordx2 v[64:65], v16, s[12:15], s28 offen offset:128 sc1
v_add_f32 v64, v244, v245
v_mfma_f32_16x16x32_bf16 v[196:199], v[52:55], v[176:179], v[196:199]
s_nop 0
v_cvt_pk_bf16_f32 v64, v64, v64
buffer_store_dwordx2 v[84:85], v16, s[12:15], s28 offen offset:512 sc1
v_mfma_f32_16x16x32_bf16 v[200:203], v[44:47], v[180:183], 0
buffer_store_short v64, v17, s[12:15], s28 offen offset:256 sc1
s_mov_b32 s28, s32
v_mfma_f32_16x16x32_bf16 v[200:203], v[52:55], v[184:187], v[200:203]
s_add_u32 s32, s34, s35
s_cmp_lt_u32 s33, 5329
s_cselect_b32 s22, 100270464, 0
v_mfma_f32_16x16x32_bf16 v[204:207], v[60:63], v[156:159], 0
s_lshr_b32 s36, s26, 1
s_lshl_b32 s36, s36, 4
s_lshl_b64 s[98:99], 0xffff, s36
v_mfma_f32_16x16x32_bf16 v[204:207], v[68:71], v[160:163], v[204:207]
buffer_store_dwordx2 v[110:111], v16, s[12:15], s29 offen offset:128 sc1
buffer_store_dwordx2 v[72:73], v16, s[12:15], s29 offen offset:512 sc1
v_mfma_f32_16x16x32_bf16 v[208:211], v[60:63], v[164:167], 0
v_cvt_pk_bf16_f32 v100, v188, v192
v_cvt_pk_bf16_f32 v101, v196, v200
v_mfma_f32_16x16x32_bf16 v[208:211], v[68:71], v[168:171], v[208:211]
v_cvt_pk_bf16_f32 v148, v189, v193
v_cvt_pk_bf16_f32 v149, v197, v201
v_mfma_f32_16x16x32_bf16 v[212:215], v[60:63], v[172:175], 0
v_cvt_pk_bf16_f32 v102, v190, v194
v_cvt_pk_bf16_f32 v103, v198, v202
v_mfma_f32_16x16x32_bf16 v[212:215], v[68:71], v[176:179], v[212:215]
v_cvt_pk_bf16_f32 v150, v191, v195
v_cvt_pk_bf16_f32 v151, v199, v203
v_mfma_f32_16x16x32_bf16 v[216:219], v[60:63], v[180:183], 0
s_waitcnt vmcnt(28)
v_cndmask_b32 v26, v21, v24, s[98:99]
ds_write_b64 v4, a[64:65] offset:0
v_mfma_f32_16x16x32_bf16 v[216:219], v[68:71], v[184:187], v[216:219]
s_waitcnt vmcnt(27)
ds_write_b64 v4, a[66:67] offset:8
ds_write_b64 v5, a[68:69] offset:0
ds_write_b64 v5, a[70:71] offset:8
ds_read_b128 a[64:67], v6 offset:0
ds_read_b128 a[68:71], v7 offset:0
s_branch L_loop
L_rot:
LW_p24:
s_cbranch_execz LW_p25
s_cmp_eq_u32 s38, 1
s_cselect_b64 s[4:5], -1, 0
s_cmp_eq_u32 s38, 2
s_cselect_b64 s[6:7], -1, 0
v_cndmask_b32 v228, v8, v10, s[4:5]
v_cndmask_b32 v229, v10, v12, s[4:5]
v_cndmask_b32 v230, v12, v8, s[4:5]
v_cndmask_b32 v228, v228, v12, s[6:7]
v_cndmask_b32 v229, v229, v8, s[6:7]
v_cndmask_b32 v230, v230, v10, s[6:7]
v_mov_b32 v8, v228
v_mov_b32 v10, v229
v_mov_b32 v12, v230
v_cndmask_b32 v228, v9, v11, s[4:5]
v_cndmask_b32 v229, v11, v13, s[4:5]
v_cndmask_b32 v230, v13, v9, s[4:5]
v_cndmask_b32 v228, v228, v13, s[6:7]
v_cndmask_b32 v229, v229, v9, s[6:7]
v_cndmask_b32 v230, v230, v11, s[6:7]
v_mov_b32 v9, v228
v_mov_b32 v11, v229
v_mov_b32 v13, v230
s_branch L_loop1
L_tailL:
LW_p25:
s_cbranch_execz LP_end
v_mov_b64 v[76:77], 0
v_mov_b64 v[78:79], v[26:27]
v_mov_b64 v[80:81], 0
v_mov_b64 v[82:83], v[26:27]
v_smfmac_f32_16x16x64_bf16 v[76:79], a[180:183], a[0:7], v0
v_bfe_u32 v22, v1, 6, 2
v_smfmac_f32_16x16x64_bf16 v[76:79], a[184:187], a[8:15], v0
s_waitcnt lgkmcnt(15)
v_lshlrev_b32 v20, 7, v22
v_smfmac_f32_16x16x64_bf16 v[76:79], a[188:191], a[16:23], v0
v_lshrrev_b32 v22, 8, v1
v_smfmac_f32_16x16x64_bf16 v[80:83], a[180:183], a[24:31], v0
s_nop 0
s_nop 0
v_mov_b64 v[84:85], 0
v_smfmac_f32_16x16x64_bf16 v[80:83], a[184:187], a[32:39], v0
s_waitcnt lgkmcnt(6)
s_nop 0
v_add_f32 v76, v76, v77
v_smfmac_f32_16x16x64_bf16 v[80:83], a[188:191], a[40:47], v0
v_mov_b64 v[86:87], v[26:27]
v_lshl_add_u32 v20, v22, 5, v20
v_bfe_u32 v22, v1, 4, 2
v_smfmac_f32_16x16x64_bf16 v[84:87], a[180:183], a[48:55], v0
s_nop 0
s_nop 0
v_lshl_add_u32 v20, v22, 1, v20
v_smfmac_f32_16x16x64_bf16 v[84:87], a[184:187], a[56:63], v0
s_waitcnt lgkmcnt(0)
v_add_f32 v80, v80, v81
v_smfmac_f32_16x16x64_bf16 v[84:87], a[188:191], a[64:71], v0
v_max3_f32 v88, v19, v76, v80
v_add_u32 v20, 159752, v20
v_cvt_pk_bf16_f32 v108, v204, v208
v_cvt_pk_bf16_f32 v109, v212, v216
v_cvt_pk_bf16_f32 v110, v205, v209
v_cvt_pk_bf16_f32 v111, v213, v217
v_cvt_pk_bf16_f32 v72, v206, v210
v_cvt_pk_bf16_f32 v73, v214, v218
v_add_f32 v84, v84, v85
v_max_f32 v88, v88, v84
v_cvt_pk_bf16_f32 v116, v207, v211
v_cvt_pk_bf16_f32 v117, v215, v219
v_max_f32_dpp v88, v88, v88 row_ror:8 row_mask:0xf bank_mask:0xf
buffer_store_dwordx2 v[72:73], v16, s[12:15], s45 offen offset:256 sc1
buffer_store_dwordx2 v[92:93], v14, s[12:15], s44 offen offset:256 sc1
v_max_f32_dpp v88, v88, v88 row_ror:4 row_mask:0xf bank_mask:0xf
buffer_store_dwordx2 v[140:141], v14, s[12:15], s44 offen offset:640 sc1
buffer_store_dwordx2 v[94:95], v14, s[12:15], s44 offen offset:1024 sc1
v_max_f32_dpp v88, v88, v88 row_ror:2 row_mask:0xf bank_mask:0xf
buffer_store_dwordx2 v[142:143], v14, s[12:15], s44 offen offset:1408 sc1
buffer_store_dwordx2 v[100:101], v15, s[12:15], s44 offen offset:256 sc1
v_max_f32_dpp v88, v88, v88 row_ror:1 row_mask:0xf bank_mask:0xf
v_sub_f32 v89, v19, v88
v_sub_f32 v76, v76, v88
v_sub_f32 v80, v80, v88
v_sub_f32 v84, v84, v88
v_exp_f32 v76, v76
v_exp_f32 v80, v80
v_exp_f32 v84, v84
v_exp_f32 v89, v89
v_add_f32 v88, v76, v80
v_add_f32 v90, v84, v89
v_add_f32 v88, v88, v90
buffer_store_dwordx2 v[148:149], v15, s[12:15], s45 offen offset:256 sc1
buffer_store_dwordx2 v[102:103], v15, s[12:15], s46 offen offset:256 sc1
v_add_f32_dpp v88, v88, v88 row_ror:8 row_mask:0xf bank_mask:0xf
buffer_store_dwordx2 v[150:151], v15, s[12:15], s47 offen offset:256 sc1
buffer_store_dwordx2 v[108:109], v16, s[12:15], s44 offen offset:256 sc1
v_add_f32_dpp v88, v88, v88 row_ror:4 row_mask:0xf bank_mask:0xf
buffer_store_dwordx2 v[110:111], v16, s[12:15], s44 offen offset:640 sc1
buffer_store_dwordx2 v[116:117], v16, s[12:15], s45 offen offset:640 sc1
v_add_f32_dpp v88, v88, v88 row_ror:2 row_mask:0xf bank_mask:0xf
s_nop 0
s_nop 0
v_add_f32_dpp v88, v88, v88 row_ror:1 row_mask:0xf bank_mask:0xf
v_rcp_f32 v88, v88
s_nop 0
v_mul_f32 v76, v76, v88
v_mul_f32 v80, v80, v88
v_mul_f32 v84, v84, v88
v_mul_f32 v89, v89, v88
v_cvt_pk_bf16_f32 v90, v76, v80
v_cvt_pk_bf16_f32 v91, v84, v89
ds_write_b16 v20, v90 offset:0
ds_write_b16_d16_hi v20, v90 offset:512
ds_write_b16 v20, v91 offset:1024
ds_write_b16_d16_hi v20, v91 offset:1536
s_waitcnt lgkmcnt(0)
s_barrier
s_endpgm
L_epiB:
LW_p26:
s_cbranch_execz LP_end
v_cvt_pk_bf16_f32 v108, v204, v208
v_cvt_pk_bf16_f32 v109, v212, v216
v_cvt_pk_bf16_f32 v110, v205, v209
v_cvt_pk_bf16_f32 v111, v213, v217
v_cvt_pk_bf16_f32 v72, v206, v210
v_cvt_pk_bf16_f32 v73, v214, v218
v_cvt_pk_bf16_f32 v116, v207, v211
v_cvt_pk_bf16_f32 v117, v215, v219
buffer_store_dwordx2 v[92:93], v14, s[12:15], s44 offen offset:256 sc1
buffer_store_dwordx2 v[140:141], v14, s[12:15], s44 offen offset:640 sc1
buffer_store_dwordx2 v[94:95], v14, s[12:15], s44 offen offset:1024 sc1
buffer_store_dwordx2 v[142:143], v14, s[12:15], s44 offen offset:1408 sc1
buffer_store_dwordx2 v[100:101], v15, s[12:15], s44 offen offset:256 sc1
buffer_store_dwordx2 v[148:149], v15, s[12:15], s45 offen offset:256 sc1
buffer_store_dwordx2 v[102:103], v15, s[12:15], s46 offen offset:256 sc1
buffer_store_dwordx2 v[150:151], v15, s[12:15], s47 offen offset:256 sc1
buffer_store_dwordx2 v[108:109], v16, s[12:15], s44 offen offset:256 sc1
buffer_store_dwordx2 v[110:111], v16, s[12:15], s44 offen offset:640 sc1
buffer_store_dwordx2 v[72:73], v16, s[12:15], s45 offen offset:256 sc1
buffer_store_dwordx2 v[116:117], v16, s[12:15], s45 offen offset:640 sc1
L_end:
s_endpgm
.globl swin_prep_kernel
.p2align 8
.type swin_prep_kernel,@function
swin_prep_kernel:
s_load_dwordx2 s[20:21], s[0:1], 0
s_load_dwordx2 s[12:13], s[0:1], 16
s_load_dwordx2 s[8:9], s[0:1], 8
s_load_dwordx2 s[16:17], s[0:1], 40
s_getpc_b64 s[34:35]
v_lshlrev_b32 v123, 4, v0
s_and_b32 s34, s34, 0xffffff00
v_min_u32 v123, LP_end-swin_prep_kernel, v123
global_load_dword v122, v123, s[34:35]
v_readfirstlane_b32 s38, v0
s_lshr_b32 s40, s2, 4
s_and_b32 s41, s2, 7
s_lshl3_add_u32 s40, s40, s41
s_cmp_lg_u32 s38, 0
s_cbranch_scc1 LP_walk
s_cmp_ge_u32 s2, 256
s_cbranch_scc1 LP_end
s_add_u32 s42, s40, 80
s_sub_u32 s43, s40, 56
s_cmp_lt_u32 s40, 64
s_cselect_b32 s42, s42, s43
s_bitcmp0_b32 s2, 3
s_cselect_b32 s2, s41, s42
s_cbranch_scc0 LP_piece
s_cmp_lt_u32 s40, 16
s_cbranch_scc1 LP_pl
LP_pf:
s_sub_u32 s45, s40, 16
LP_pf2:
s_mov_b32 s22, 100270464
s_mov_b32 s23, 0x20000
s_mov_b32 s36, 58835169
v_mul_u32_u24 v140, 86, v0
v_lshrrev_b32 v140, 8, v140
v_mul_u32_u24 v141, 3, v140
v_sub_u32 v141, v0, v141
v_lshlrev_b32 v141, 7, v141
v_add_u32 v141, 589824, v141
v_lshrrev_b32 v142, 2, v140
v_lshlrev_b32 v142, 10, v142
v_and_or_b32 v142, v140, 3, v142
v_bfe_u32 v133, v0, 2, 2
v_and_b32 v132, 3, v0
v_mul_u32_u24 v132, 384, v132
v_mul_u32_u24 v131, 196224, v133
v_add_u32 v132, v132, v131
v_cmp_eq_u32 vcc, 3, v133
v_add_u32 v131, 197376, v132
v_lshrrev_b32 v130, 4, v0
v_cndmask_b32 v132, v132, v131, vcc
s_lshr_b32 s39, s45, 3
s_lshl_b32 s39, s39, 6
s_and_b32 s37, s45, 7
s_lshl2_add_u32 s39, s37, s39
v_add_u32 v137, s39, v142
s_add_u32 s39, s39, 32
v_add_u32 v129, s39, v130
v_mul_hi_u32 v139, v129, s36
v_mul_u32_u24 v138, 73, v139
v_sub_u32 v138, v129, v138
v_mul_u32_u24 v139, 1373568, v139
v_mul_u32_u24 v138, 2688, v138
v_add3_u32 v129, v139, v138, v132
s_add_u32 s37, s45, 5248
v_mov_b32 v128, s37
v_cmp_gt_u32 vcc, 20, v140
v_add_u32 v143, s39, v142
v_mul_hi_u32 v139, v137, s36
v_mul_u32_u24 v138, 73, v139
v_sub_u32 v138, v137, v138
v_mul_u32_u24 v139, 1373568, v139
v_mul_u32_u24 v138, 2688, v138
v_add3_u32 v137, v139, v138, v141
v_cndmask_b32 v143, v128, v143, vcc
v_cndmask_b32 v137, -1, v137, vcc
v_cmp_gt_u32 vcc, 5329, v143
v_mul_hi_u32 v139, v143, s36
v_mul_u32_u24 v138, 73, v139
v_sub_u32 v138, v143, v138
v_mul_u32_u24 v139, 1373568, v139
v_mul_u32_u24 v138, 2688, v138
v_add3_u32 v143, v139, v138, v141
v_cndmask_b32 v143, -1, v143, vcc
s_waitcnt lgkmcnt(0)
buffer_load_dword v134, v129, s[20:23], 0 offen offset:0
buffer_load_dword v134, v129, s[20:23], 0 offen offset:128
buffer_load_dword v134, v129, s[20:23], 0 offen offset:256
buffer_load_dword v135, v143, s[20:23], 0 offen offset:0
buffer_load_dword v136, v137, s[20:23], 0 offen offset:0
s_cmp_lt_u32 s45, 112
s_cbranch_scc0 LP_mj
s_endpgm
LP_mj:
s_mov_b32 s18, 147456
s_mov_b32 s19, 0x20000
v_lshlrev_b32 v5, 4, v0
s_waitcnt vmcnt(5)
s_branch LP_mcomp
LP_pl:
s_cmp_lt_u32 s40, 8
s_cselect_b32 s43, 72, 0
s_add_u32 s2, s2, s43
LP_piece:
s_getpc_b64 s[34:35]
LP_pc:
s_sub_u32 s34, s34, LP_pc-standalone__swin_window_attn__vision_kernel
s_subb_u32 s35, s35, 0
s_lshr_b32 s36, s2, 3
s_lshl_b32 s36, s36, 12
v_lshlrev_b32 v120, 6, v0
v_add_u32 v120, s36, v120
v_min_u32 v120, L_end-standalone__swin_window_attn__vision_kernel, v120
global_load_dword v121, v120, s[34:35]
v_and_b32 v1, 15, v0
v_lshrrev_b32 v2, 4, v0
v_lshrrev_b32 v3, 2, v1
v_lshlrev_b32 v3, 3, v3
v_and_b32 v4, 3, v1
v_add_u32 v3, v3, v4
v_mul_u32_u24 v6, 384, v3
v_mul_u32_u24 v3, 1152, v3
v_lshlrev_b32 v4, 4, v2
v_add_u32 v3, v3, v4
v_lshlrev_b32 v5, 4, v0
s_mov_b32 s10, 221184
s_mov_b32 s11, 0x20000
s_mov_b32 s14, 73728
s_mov_b32 s15, 0x20000
s_mov_b32 s18, 147456
s_mov_b32 s19, 0x20000
s_lshl_b32 s26, s2, 10
v_mul_u32_u24 v89, 37, v0
v_lshrrev_b32 v89, 8, v89
v_mul_u32_u24 v89, 193536, v89
v_mul_u32_u24 v88, 384, v0
v_add_u32 v88, v89, v88
v_cmp_gt_u32 vcc, 49, v0
s_cmp_lt_u32 s2, 8
s_cselect_b32 s36, 16, 0
v_cndmask_b32 v88, -1, v88, vcc
s_add_u32 s36, s36, s2
s_addk_i32 s36, 5104
s_mul_hi_u32 s37, s36, 58835169
s_mul_i32 s39, s37, 73
s_sub_u32 s39, s36, s39
s_mul_i32 s37, s37, 1373568
s_mul_i32 s39, s39, 2688
s_add_u32 s44, s37, s39
s_mov_b32 s22, 100270464
s_mov_b32 s23, 0x20000
s_cmp_ge_u32 s2, 72
s_cbranch_scc1 LP_w
s_mul_i32 s27, s2, 43
s_lshr_b32 s27, s27, 9
s_mul_i32 s28, s27, 12
s_sub_u32 s28, s2, s28
s_lshr_b32 s29, s28, 1
s_and_b32 s28, s28, 1
s_lshl_b32 s26, s27, 1
s_add_u32 s26, s26, s28
s_mul_i32 s26, s26, 6
s_add_u32 s26, s26, s29
s_lshl_b32 s26, s26, 10
s_mul_i32 s30, s29, 36864
s_add_u32 s31, s30, 0
s_mul_i32 s32, s27, 36864
s_mul_i32 s33, s28, 4608
s_add_u32 s32, s32, s33
s_add_u32 s32, s32, 384
s_waitcnt lgkmcnt(0)
buffer_load_dwordx4 v[16:19], v3, s[8:11], s31 offen offset:0
buffer_load_dwordx4 v[20:23], v3, s[8:11], s31 offen offset:64
buffer_load_dwordx4 v[24:27], v3, s[8:11], s31 offen offset:128
buffer_load_dwordx4 v[28:31], v3, s[8:11], s31 offen offset:192
buffer_load_dwordx4 v[32:35], v3, s[8:11], s31 offen offset:256
buffer_load_dwordx4 v[36:39], v3, s[8:11], s31 offen offset:320
s_add_u32 s31, s30, 4608
buffer_load_dwordx4 v[40:43], v3, s[8:11], s31 offen offset:0
buffer_load_dwordx4 v[44:47], v3, s[8:11], s31 offen offset:64
buffer_load_dwordx4 v[48:51], v3, s[8:11], s31 offen offset:128
buffer_load_dwordx4 v[52:55], v3, s[8:11], s31 offen offset:192
buffer_load_dwordx4 v[56:59], v3, s[8:11], s31 offen offset:256
buffer_load_dwordx4 v[60:63], v3, s[8:11], s31 offen offset:320
buffer_load_dwordx4 v[64:67], v3, s[8:11], s32 offen offset:0
buffer_load_dwordx4 v[68:71], v3, s[8:11], s32 offen offset:64
buffer_load_dwordx4 v[72:75], v3, s[8:11], s32 offen offset:128
buffer_load_dwordx4 v[76:79], v3, s[8:11], s32 offen offset:192
buffer_load_dwordx4 v[80:83], v3, s[8:11], s32 offen offset:256
buffer_load_dwordx4 v[84:87], v3, s[8:11], s32 offen offset:320
s_add_u32 s45, s2, 104
s_sub_u32 s36, s2, 8
s_cmp_lt_u32 s36, 16
s_cbranch_scc1 LP_pf2
buffer_load_dword v90, v88, s[20:23], s44 offen offset:0
buffer_load_dword v90, v88, s[20:23], s44 offen offset:128
buffer_load_dword v90, v88, s[20:23], s44 offen offset:256
s_waitcnt vmcnt(3)
LP_mcomp:
v_mfma_f32_16x16x32_bf16 v[100:103], v[16:19], v[64:67], 0
v_mfma_f32_16x16x32_bf16 v[104:107], v[40:43], v[64:67], 0
v_mfma_f32_16x16x32_bf16 v[100:103], v[20:23], v[68:71], v[100:103]
v_mfma_f32_16x16x32_bf16 v[104:107], v[44:47], v[68:71], v[104:107]
v_mfma_f32_16x16x32_bf16 v[100:103], v[24:27], v[72:75], v[100:103]
v_mfma_f32_16x16x32_bf16 v[104:107], v[48:51], v[72:75], v[104:107]
v_mfma_f32_16x16x32_bf16 v[100:103], v[28:31], v[76:79], v[100:103]
v_mfma_f32_16x16x32_bf16 v[104:107], v[52:55], v[76:79], v[104:107]
v_mfma_f32_16x16x32_bf16 v[100:103], v[32:35], v[80:83], v[100:103]
v_mfma_f32_16x16x32_bf16 v[104:107], v[56:59], v[80:83], v[104:107]
v_mfma_f32_16x16x32_bf16 v[100:103], v[36:39], v[84:87], v[100:103]
v_mfma_f32_16x16x32_bf16 v[104:107], v[60:63], v[84:87], v[104:107]
s_nop 6
v_mul_f32 v100, 0x3dd53b95, v100
v_mul_f32 v101, 0x3dd53b95, v101
v_mul_f32 v102, 0x3dd53b95, v102
v_mul_f32 v103, 0x3dd53b95, v103
v_mul_f32 v104, 0x3dd53b95, v104
v_mul_f32 v105, 0x3dd53b95, v105
v_mul_f32 v106, 0x3dd53b95, v106
v_mul_f32 v107, 0x3dd53b95, v107
v_cvt_pk_bf16_f32 v108, v100, v101
v_cvt_pk_bf16_f32 v109, v102, v103
v_cvt_pk_bf16_f32 v110, v104, v105
v_cvt_pk_bf16_f32 v111, v106, v107
buffer_store_dwordx4 v[108:111], v5, s[16:19], s26 offen offset:0
s_endpgm
LP_w:
s_sub_u32 s27, s2, 72
s_mul_i32 s28, s27, 43
s_lshr_b32 s28, s28, 8
s_mul_i32 s29, s28, 6
v_lshl_add_u32 v6, v2, 3, v6
s_lshl_b32 s32, s28, 5
s_sub_u32 s29, s27, s29
s_mul_i32 s30, s29, 36864
s_add_u32 s31, s30, 768
s_add_u32 s33, s30, 5376
v_lshlrev_b32 v8, 2, v2
v_sub_u32 v8, v1, v8
v_cmp_gt_u32 vcc, 4, v8
v_lshlrev_b32 v8, 4, v8
v_mov_b32 v10, 0x3f80
v_mov_b32 v11, 0
v_cndmask_b32 v10, 0, v10, vcc
v_lshlrev_b64 v[8:9], v8, v[10:11]
v_and_b32 v12, 3, v1
v_mul_u32_u24 v12, 6144, v12
v_lshrrev_b32 v13, 2, v1
v_lshlrev_b32 v13, 4, v13
v_lshl_add_u32 v13, v2, 8, v13
v_add_u32 v5, v12, v13
s_waitcnt lgkmcnt(0)
buffer_load_dwordx2 v[64:65], v6, s[12:15], s32 offen offset:0
buffer_load_dwordx2 v[66:67], v6, s[12:15], s32 offen offset:1536
s_add_u32 s32, s32, 12288
buffer_load_dwordx2 v[68:69], v6, s[12:15], s32 offen offset:0
buffer_load_dwordx2 v[70:71], v6, s[12:15], s32 offen offset:1536
s_add_u32 s32, s32, 12288
buffer_load_dwordx2 v[72:73], v6, s[12:15], s32 offen offset:0
buffer_load_dwordx2 v[74:75], v6, s[12:15], s32 offen offset:1536
s_add_u32 s32, s32, 12288
buffer_load_dwordx2 v[76:77], v6, s[12:15], s32 offen offset:0
buffer_load_dwordx2 v[78:79], v6, s[12:15], s32 offen offset:1536
s_add_u32 s32, s32, 12288
buffer_load_dwordx2 v[80:81], v6, s[12:15], s32 offen offset:0
buffer_load_dwordx2 v[82:83], v6, s[12:15], s32 offen offset:1536
s_add_u32 s32, s32, 12288
buffer_load_dwordx2 v[84:85], v6, s[12:15], s32 offen offset:0
buffer_load_dwordx2 v[86:87], v6, s[12:15], s32 offen offset:1536
buffer_load_dwordx4 v[16:19], v3, s[8:11], s31 offen offset:0
buffer_load_dwordx4 v[40:43], v3, s[8:11], s33 offen offset:0
buffer_load_dwordx4 v[20:23], v3, s[8:11], s31 offen offset:64
buffer_load_dwordx4 v[44:47], v3, s[8:11], s33 offen offset:64
buffer_load_dwordx4 v[24:27], v3, s[8:11], s31 offen offset:128
buffer_load_dwordx4 v[48:51], v3, s[8:11], s33 offen offset:128
buffer_load_dwordx4 v[28:31], v3, s[8:11], s31 offen offset:192
buffer_load_dwordx4 v[52:55], v3, s[8:11], s33 offen offset:192
buffer_load_dwordx4 v[32:35], v3, s[8:11], s31 offen offset:256
buffer_load_dwordx4 v[56:59], v3, s[8:11], s33 offen offset:256
buffer_load_dwordx4 v[36:39], v3, s[8:11], s31 offen offset:320
buffer_load_dwordx4 v[60:63], v3, s[8:11], s33 offen offset:320
buffer_load_dword v90, v88, s[20:23], s44 offen offset:0
buffer_load_dword v90, v88, s[20:23], s44 offen offset:128
buffer_load_dword v90, v88, s[20:23], s44 offen offset:256
s_lshr_b32 s32, s28, 2
s_mul_i32 s32, s32, 24
s_add_u32 s32, s32, s29
s_add_u32 s32, s32, 72
s_lshl_b32 s32, s32, 10
s_and_b32 s33, s28, 3
s_lshl_b32 s33, s33, 6
s_add_u32 s26, s32, s33
s_waitcnt vmcnt(26)
v_mfma_f32_16x16x16_bf16 v[112:115], v[64:65], v[8:9], 0
s_waitcnt vmcnt(25)
v_mfma_f32_16x16x16_bf16 v[116:119], v[66:67], v[8:9], 0
s_waitcnt vmcnt(24)
v_mfma_f32_16x16x16_bf16 v[120:123], v[68:69], v[8:9], 0
s_waitcnt vmcnt(23)
v_mfma_f32_16x16x16_bf16 v[124:127], v[70:71], v[8:9], 0
s_waitcnt vmcnt(22)
v_mfma_f32_16x16x16_bf16 v[128:131], v[72:73], v[8:9], 0
s_waitcnt vmcnt(21)
v_mfma_f32_16x16x16_bf16 v[132:135], v[74:75], v[8:9], 0
s_waitcnt vmcnt(20)
v_mfma_f32_16x16x16_bf16 v[136:139], v[76:77], v[8:9], 0
s_waitcnt vmcnt(19)
v_mfma_f32_16x16x16_bf16 v[140:143], v[78:79], v[8:9], 0
s_waitcnt vmcnt(18)
v_mfma_f32_16x16x16_bf16 v[144:147], v[80:81], v[8:9], 0
s_waitcnt vmcnt(17)
v_mfma_f32_16x16x16_bf16 v[148:151], v[82:83], v[8:9], 0
s_waitcnt vmcnt(16)
v_mfma_f32_16x16x16_bf16 v[152:155], v[84:85], v[8:9], 0
s_waitcnt vmcnt(15)
v_mfma_f32_16x16x16_bf16 v[156:159], v[86:87], v[8:9], 0
v_cvt_pk_bf16_f32 v64, v112, v113
v_cvt_pk_bf16_f32 v65, v114, v115
v_cvt_pk_bf16_f32 v66, v116, v117
v_cvt_pk_bf16_f32 v67, v118, v119
v_cvt_pk_bf16_f32 v68, v120, v121
v_cvt_pk_bf16_f32 v69, v122, v123
v_cvt_pk_bf16_f32 v70, v124, v125
v_cvt_pk_bf16_f32 v71, v126, v127
v_cvt_pk_bf16_f32 v72, v128, v129
v_cvt_pk_bf16_f32 v73, v130, v131
v_cvt_pk_bf16_f32 v74, v132, v133
v_cvt_pk_bf16_f32 v75, v134, v135
v_cvt_pk_bf16_f32 v76, v136, v137
v_cvt_pk_bf16_f32 v77, v138, v139
v_cvt_pk_bf16_f32 v78, v140, v141
v_cvt_pk_bf16_f32 v79, v142, v143
v_cvt_pk_bf16_f32 v80, v144, v145
v_cvt_pk_bf16_f32 v81, v146, v147
v_cvt_pk_bf16_f32 v82, v148, v149
v_cvt_pk_bf16_f32 v83, v150, v151
v_cvt_pk_bf16_f32 v84, v152, v153
v_cvt_pk_bf16_f32 v85, v154, v155
v_cvt_pk_bf16_f32 v86, v156, v157
v_cvt_pk_bf16_f32 v87, v158, v159
s_waitcnt vmcnt(13)
v_mfma_f32_16x16x32_bf16 v[100:103], v[16:19], v[64:67], 0
v_mfma_f32_16x16x32_bf16 v[104:107], v[40:43], v[64:67], 0
s_waitcnt vmcnt(11)
v_mfma_f32_16x16x32_bf16 v[100:103], v[20:23], v[68:71], v[100:103]
v_mfma_f32_16x16x32_bf16 v[104:107], v[44:47], v[68:71], v[104:107]
s_waitcnt vmcnt(9)
v_mfma_f32_16x16x32_bf16 v[100:103], v[24:27], v[72:75], v[100:103]
v_mfma_f32_16x16x32_bf16 v[104:107], v[48:51], v[72:75], v[104:107]
s_waitcnt vmcnt(7)
v_mfma_f32_16x16x32_bf16 v[100:103], v[28:31], v[76:79], v[100:103]
v_mfma_f32_16x16x32_bf16 v[104:107], v[52:55], v[76:79], v[104:107]
s_waitcnt vmcnt(5)
v_mfma_f32_16x16x32_bf16 v[100:103], v[32:35], v[80:83], v[100:103]
v_mfma_f32_16x16x32_bf16 v[104:107], v[56:59], v[80:83], v[104:107]
s_waitcnt vmcnt(3)
v_mfma_f32_16x16x32_bf16 v[100:103], v[36:39], v[84:87], v[100:103]
v_mfma_f32_16x16x32_bf16 v[104:107], v[60:63], v[84:87], v[104:107]
s_nop 7
v_cvt_pk_bf16_f32 v108, v100, v101
v_cvt_pk_bf16_f32 v109, v102, v103
v_cvt_pk_bf16_f32 v110, v104, v105
v_cvt_pk_bf16_f32 v111, v106, v107
buffer_store_dwordx4 v[108:111], v5, s[16:19], s26 offen offset:0
s_endpgm
LP_walk:
s_mov_b64 exec, 0
s_cmp_eq_u32 s38, 64
s_cbranch_scc1 LW_first0
s_cmp_eq_u32 s38, 128
s_cbranch_scc1 LW_first1
s_branch LW_first2
LP_end:
s_waitcnt lgkmcnt(0)
s_endpgm
.section .rodata,"a"
.p2align 6
.amdhsa_kernel standalone__swin_window_attn__vision_kernel
  .amdhsa_next_free_vgpr 512
  .amdhsa_next_free_sgpr 100
  .amdhsa_accum_offset 256
  .amdhsa_group_segment_fixed_size 0
  .amdhsa_kernarg_size 48
  .amdhsa_user_sgpr_count 2
  .amdhsa_user_sgpr_kernarg_segment_ptr 1
  .amdhsa_system_sgpr_workgroup_id_x 1
.end_amdhsa_kernel
.p2align 6
.amdhsa_kernel swin_prep_kernel
  .amdhsa_next_free_vgpr 160
  .amdhsa_next_free_sgpr 48
  .amdhsa_accum_offset 160
  .amdhsa_group_segment_fixed_size 0
  .amdhsa_kernarg_size 48
  .amdhsa_user_sgpr_count 2
  .amdhsa_user_sgpr_kernarg_segment_ptr 1
  .amdhsa_system_sgpr_workgroup_id_x 1
.end_amdhsa_kernel
```
